```python
import torch

def _softmax(x, axis=-1):
    return torch.softmax(x, dim=axis)
def _gelu(x):
    return torch.nn.functional.gelu(x, approximate="tanh")
def _silu(x):
    return torch.nn.functional.silu(x)
def _sigmoid(x):
    return torch.sigmoid(x)
def _layernorm(x, axis=-1, eps=1e-5):
    m = x.mean(dim=axis, keepdim=True)
    v = x.var(dim=axis, keepdim=True, unbiased=False)
    return (x - m) / torch.sqrt(v + eps)
def _scatter_add(tgt, idx, src, axis=0):
    return tgt.clone().index_add_(axis, idx, src)
def _segment_sum(src, seg, n):
    out = torch.zeros((n,) + src.shape[1:], dtype=src.dtype)
    return out.index_add_(0, seg, src)
def _pad(x, pw):
    flat = tuple(v for pair in reversed(pw) for v in pair)
    return torch.nn.functional.pad(x, flat)

kernel_name = 'gated_mix__ssm_conv_s5__moe_arch_mod__prompt'

def setup_inputs():

    _w = (lambda a: (lambda t: t.to(torch.bfloat16) if t.is_floating_point() else t)(torch.as_tensor(a)))
    def _A_setup():
        B, S, D = 1, 2048, 1024
        P = D
        Lambda_re = -0.5 * (lambda _x: torch.exp(torch.as_tensor(_x)))((lambda *s: torch.randn(*s, dtype=torch.bfloat16) * 0.8)(P))
        Lambda_im = (lambda *s: torch.randn(*s, dtype=torch.bfloat16) * 0.8)(P) * 1.0
        B_re = (lambda *s: torch.randn(*s, dtype=torch.bfloat16) * 0.8)(P, D) * (D ** -0.5)
        B_im = (lambda *s: torch.randn(*s, dtype=torch.bfloat16) * 0.8)(P, D) * (D ** -0.5)
        C_re = (lambda *s: torch.randn(*s, dtype=torch.bfloat16) * 0.8)(D, P) * (P ** -0.5)
        C_im = (lambda *s: torch.randn(*s, dtype=torch.bfloat16) * 0.8)(D, P) * (P ** -0.5)
        log_dt = (lambda *s: torch.randn(*s, dtype=torch.bfloat16) * 0.8)(P) * 0.3 - 2.0
        Dskip = (lambda *s: torch.randn(*s, dtype=torch.bfloat16) * 0.8)(D)
        return {
            "x": _w((lambda *s: torch.randn(*s, dtype=torch.bfloat16) * 0.05)(B, S, D)),
            "Lambda_re": _w(Lambda_re),
            "Lambda_im": _w(Lambda_im),
            "B_re": _w(B_re),
            "B_im": _w(B_im),
            "C_re": _w(C_re),
            "C_im": _w(C_im),
            "log_dt": _w(log_dt),
            "Dskip": _w(Dskip),
        }
    _A_in = _A_setup()

    def _B_setup():
        B, S, D, F, C = 1, 2048, 1024, 3584, 8
        return {
            "x": _w((lambda *s: torch.randn(*s, dtype=torch.bfloat16) * 0.05)(B, S, D)),
            "w_r": _w((lambda *s: torch.randn(*s, dtype=torch.bfloat16) * 1.6)(D)),
            "w_gate": _w((lambda *s: torch.randn(*s, dtype=torch.bfloat16) * 0.1)(D, F)),
            "w_up": _w((lambda *s: torch.randn(*s, dtype=torch.bfloat16) * 0.1)(D, F)),
            "w_down": _w((lambda *s: torch.randn(*s, dtype=torch.bfloat16) * 0.1)(F, D)),
        }
    _B_in = _B_setup()

    return {
        "A_x": _A_in["x"],
        "A_Lambda_re": _A_in["Lambda_re"],
        "A_Lambda_im": _A_in["Lambda_im"],
        "A_B_re": _A_in["B_re"],
        "A_B_im": _A_in["B_im"],
        "A_C_re": _A_in["C_re"],
        "A_C_im": _A_in["C_im"],
        "A_log_dt": _A_in["log_dt"],
        "A_Dskip": _A_in["Dskip"],
        "B_x": _B_in["x"],
        "B_w_r": _B_in["w_r"],
        "B_w_gate": _B_in["w_gate"],
        "B_w_up": _B_in["w_up"],
        "B_w_down": _B_in["w_down"],
        "gate_w": _w((lambda *s: torch.randn(*s, dtype=torch.bfloat16) * 0.05)(1024) * 16.0),
    }

def reference(A_x, A_Lambda_re, A_Lambda_im, A_B_re, A_B_im, A_C_re, A_C_im, A_log_dt, A_Dskip, B_x, B_w_r, B_w_gate, B_w_up, B_w_down, gate_w):
    def _A_ref(x, Lambda_re, Lambda_im, B_re, B_im, C_re, C_im, log_dt, Dskip):
        Bsz, L, H = x.shape
        Lam = Lambda_re + 1j * Lambda_im
        Bmat = B_re + 1j * B_im
        Cmat = C_re + 1j * C_im
        dt = torch.exp(log_dt)
        Lam_bar = torch.exp(dt * Lam)
        B_bar = ((Lam_bar - 1.0) / Lam)[:, None] * Bmat
        Bu = torch.einsum("bld,pd->blp", x + 0j, B_bar)
        h = torch.zeros_like(Bu[:, 0, :])
        hs = []
        for t in range(L):
            h = Lam_bar[None, :] * h + Bu[:, t, :]
            hs.append(h)
        hseq = torch.stack(hs, 1)
        y = 2.0 * torch.einsum("blp,dp->bld", hseq, Cmat).real + x * Dskip[None, None, :]
        return y

    def _B_ref(x, w_r, w_gate, w_up, w_down):
        B, S, D = x.shape
        C = 8
        r = x @ w_r
        idx = torch.argsort(-r, axis=-1)[:, :C]
        idx_e = (lambda x, n, axis: torch.repeat_interleave(x, n, dim=axis))(idx.reshape(B, C, 1), D, axis=2)
        x_sel = (lambda x, i, axis: torch.take_along_dim(x, i, dim=axis))(x, idx_e, axis=1)
        g = _silu(x_sel @ w_gate)
        u = x_sel @ w_up
        y = (g * u) @ w_down
        r_sel = _sigmoid((lambda x, i, axis: torch.take_along_dim(x, i, dim=axis))(r, idx, axis=1))
        y = y * r_sel.reshape(B, C, 1)
        b_off = (torch.arange(B) * S).reshape(B, 1)
        flat_idx = (idx + b_off).reshape(B * C)
        zero = (x * 0.0).reshape(B * S, D)
        upd = _scatter_add(zero, flat_idx, y.reshape(B * C, D), axis=0)
        return x + upd.reshape(B, S, D)

    x = A_x
    g = _sigmoid((x * gate_w).sum(-1, keepdims=True))
    a = _A_ref(x, A_Lambda_re, A_Lambda_im, A_B_re, A_B_im, A_C_re, A_C_im, A_log_dt, A_Dskip)
    b = _B_ref(x, B_w_r, B_w_gate, B_w_up, B_w_down)
    return g * a + (1 - g) * b
```

```asm
; @launch kernel=k1_kernel grid=(256,1,1) block=(512,1,1) lds=163840
; @launch kernel=k2_kernel grid=(256,1,1) block=(512,1,1) lds=98304
.amdgcn_target "amdgcn-amd-amdhsa--gfx950"
.text
.globl k1_kernel
.p2align 8
.type k1_kernel,@function
k1_kernel:
    s_cmp_ge_u32 s2, 256
    s_cbranch_scc1 L1_end
    v_lshrrev_b32 v2, 6, v0
    v_and_b32 v1, 63, v0
    s_nop 0
    v_readfirstlane_b32 s29, v2
    s_and_b32 s24, s2, 7
    s_lshr_b32 s25, s2, 3
    s_lshr_b32 s26, s25, 3
    s_lshl_b32 s26, s26, 2
    s_lshr_b32 s27, s24, 1
    s_add_u32 s26, s26, s27
    s_and_b32 s27, s24, 1
    s_lshl_b32 s27, s27, 3
    s_and_b32 s28, s25, 7
    s_add_u32 s27, s27, s28
    s_cmp_lt_u32 s29, 4
    s_cbranch_scc1 L1_compute
    s_load_dwordx2 s[56:57], s[0:1], 0
    s_load_dwordx4 s[12:15], s[0:1], 24
    s_load_dwordx2 s[36:37], s[0:1], 80
    s_load_dwordx2 s[40:41], s[0:1], 112
    s_load_dwordx2 s[16:17], s[0:1], 136
    s_load_dwordx2 s[44:45], s[0:1], 128
    s_load_dwordx2 s[48:49], s[0:1], 88
    s_load_dwordx2 s[52:53], s[0:1], 96
    s_and_b32 s30, s29, 3
    v_lshrrev_b32 v3, 3, v1
    v_and_b32 v4, 7, v1
    v_lshrrev_b32 v5, 1, v3
    v_xor_b32 v4, v4, v5
    v_lshlrev_b32 v4, 4, v4
    v_lshl_add_u32 v14, v3, 11, v4
    v_xor_b32 v15, 64, v14
    v_add_u32 v16, 30720, v14
    v_add_u32 v17, 46080, v15
    v_add_u32 v15, 15360, v15
    v_lshrrev_b32 v6, 2, v3
    v_lshlrev_b32 v6, 4, v6
    v_and_b32 v7, 1, v3
    v_lshl_add_u32 v6, v7, 3, v6
    v_and_b32 v7, 1, v5
    v_add_u32 v6, v6, v7
    v_lshl_add_u32 v10, v6, 11, v4
    v_xor_b32 v11, 64, v10
    v_add_u32 v12, 2048, v10
    v_add_u32 v13, 66560, v11
    v_add_u32 v11, 64512, v11
    s_lshr_b32 s31, s30, 1
    s_and_b32 s32, s30, 1
    s_lshl_b32 s33, s26, 7
    s_lshl_b32 s34, s31, 6
    s_add_u32 s33, s33, s34
    s_lshl_b32 s34, s32, 2
    s_add_u32 s33, s33, s34
    s_lshl_b32 s33, s33, 11
    s_lshl_b32 s34, s27, 6
    s_lshl_b32 s35, s31, 5
    s_add_u32 s34, s34, s35
    s_lshl_b32 s34, s34, 11
    s_lshl_b32 s60, s30, 12
    s_add_u32 s61, s26, s27
    s_and_b32 s61, s61, 15
    s_lshl_b32 s61, s61, 7
    s_cmp_eq_u32 s32, 1
    s_waitcnt lgkmcnt(0)
    s_cselect_b32 s12, s14, s12
    s_cselect_b32 s13, s15, s13
    s_add_u32 s12, s12, s34
    s_addc_u32 s13, s13, 0
    s_sub_u32 s14, 2097152, s34
    s_mov_b32 s15, 0x20000
    s_add_u32 s8, s56, s33
    s_addc_u32 s9, s57, 0
    s_sub_u32 s10, 4194304, s33
    s_mov_b32 s11, 0x20000
    s_add_u32 m0, s60, 0
    s_nop 0
    buffer_load_dwordx4 v10, s[8:11], s61 offen offset:0 lds
    buffer_load_dwordx4 v11, s[8:11], s61 offen offset:1024 lds
    buffer_load_dwordx4 v12, s[8:11], s61 offen offset:2048 lds
    buffer_load_dwordx4 v13, s[8:11], s61 offen offset:3072 lds
    s_add_u32 m0, s60, 16384
    s_nop 0
    buffer_load_dwordx4 v14, s[12:15], s61 offen offset:0 lds
    buffer_load_dwordx4 v15, s[12:15], s61 offen offset:1024 lds
    buffer_load_dwordx4 v16, s[12:15], s61 offen offset:2048 lds
    buffer_load_dwordx4 v17, s[12:15], s61 offen offset:3072 lds
    s_add_u32 s61, s61, 128
    s_and_b32 s61, s61, 2047
    s_mov_b32 s58, 4194304
    s_mov_b32 s59, 0x20000
    s_mov_b32 s38, 2048
    s_mov_b32 s39, 0x20000
    s_mov_b32 s42, 2048
    s_mov_b32 s43, 0x20000
    s_mov_b32 s18, 268435456
    s_mov_b32 s19, 0x20000
    s_mov_b32 s46, 256
    s_mov_b32 s47, 0x20000
    s_mov_b32 s50, 7340032
    s_mov_b32 s51, 0x20000
    s_mov_b32 s54, 7340032
    s_mov_b32 s55, 0x20000
    s_lshl_b32 s62, s26, 7
    s_lshl_b32 s63, s27, 3
    s_add_u32 s62, s62, s63
    s_lshl_b32 s63, s30, 1
    s_add_u32 s62, s62, s63
    s_lshl_b32 s63, s62, 11
    v_lshlrev_b32 v18, 4, v1
    buffer_load_dwordx4 v[20:23], v18, s[56:59], s63 offen offset:0
    buffer_load_dwordx4 v[24:27], v18, s[56:59], s63 offen offset:1024
    buffer_load_dwordx4 v[28:31], v18, s[56:59], s63 offen offset:2048
    buffer_load_dwordx4 v[32:35], v18, s[56:59], s63 offen offset:3072
    buffer_load_dwordx4 v[36:39], v18, s[36:39], 0 offen offset:0
    buffer_load_dwordx4 v[44:47], v18, s[40:43], 0 offen offset:0
    buffer_load_dwordx4 v[40:43], v18, s[36:39], 0 offen offset:1024
    buffer_load_dwordx4 v[48:51], v18, s[40:43], 0 offen offset:1024
    s_add_u32 m0, s60, 32768
    s_nop 0
    buffer_load_dwordx4 v10, s[8:11], s61 offen offset:0 lds
    buffer_load_dwordx4 v11, s[8:11], s61 offen offset:1024 lds
    buffer_load_dwordx4 v12, s[8:11], s61 offen offset:2048 lds
    buffer_load_dwordx4 v13, s[8:11], s61 offen offset:3072 lds
    s_add_u32 m0, s60, 49152
    s_nop 0
    buffer_load_dwordx4 v14, s[12:15], s61 offen offset:0 lds
    buffer_load_dwordx4 v15, s[12:15], s61 offen offset:1024 lds
    buffer_load_dwordx4 v16, s[12:15], s61 offen offset:2048 lds
    buffer_load_dwordx4 v17, s[12:15], s61 offen offset:3072 lds
    s_add_u32 s61, s61, 128
    s_and_b32 s61, s61, 2047
    s_add_u32 m0, s60, 65536
    s_nop 0
    buffer_load_dwordx4 v10, s[8:11], s61 offen offset:0 lds
    buffer_load_dwordx4 v11, s[8:11], s61 offen offset:1024 lds
    buffer_load_dwordx4 v12, s[8:11], s61 offen offset:2048 lds
    buffer_load_dwordx4 v13, s[8:11], s61 offen offset:3072 lds
    s_add_u32 m0, s60, 81920
    s_nop 0
    buffer_load_dwordx4 v14, s[12:15], s61 offen offset:0 lds
    buffer_load_dwordx4 v15, s[12:15], s61 offen offset:1024 lds
    buffer_load_dwordx4 v16, s[12:15], s61 offen offset:2048 lds
    buffer_load_dwordx4 v17, s[12:15], s61 offen offset:3072 lds
    s_add_u32 s61, s61, 128
    s_and_b32 s61, s61, 2047
    s_or_b32 s64, s2, s30
    s_cmp_lg_u32 s64, 0
    s_cbranch_scc1 L1_notag
    s_load_dword s64, s[16:17], 0
    s_waitcnt lgkmcnt(0)
    s_mul_i32 s64, s64, 1664525
    s_add_u32 s64, s64, 1013904223
    s_cmp_eq_u32 s64, 0
    s_cselect_b32 s64, 1013904223, s64
    v_mov_b32 v19, s64
    v_mov_b32 v9, 0
    s_mov_b64 exec, 1
    buffer_store_dword v19, v9, s[16:19], 0 offen offset:0 sc1
    s_waitcnt vmcnt(0)
    buffer_store_dword v19, v9, s[44:47], 0 offen sc1
    s_mov_b64 exec, -1
L1_notag:
    v_mov_b32 v9, 0
    v_mov_b32 v8, 0
    v_mov_b32 v7, 131072
    ds_write_b64 v7, v[8:9]
    ds_write_b64 v7, v[8:9] offset:8
    ds_write_b32 v7, v9 offset:16
    s_waitcnt vmcnt(24) lgkmcnt(0)
    s_barrier
    s_add_u32 m0, s60, 98304
    s_nop 0
    buffer_load_dwordx4 v10, s[8:11], s61 offen offset:0 lds
    buffer_load_dwordx4 v11, s[8:11], s61 offen offset:1024 lds
    buffer_load_dwordx4 v12, s[8:11], s61 offen offset:2048 lds
    buffer_load_dwordx4 v13, s[8:11], s61 offen offset:3072 lds
    s_add_u32 m0, s60, 114688
    s_nop 0
    buffer_load_dwordx4 v14, s[12:15], s61 offen offset:0 lds
    buffer_load_dwordx4 v15, s[12:15], s61 offen offset:1024 lds
    buffer_load_dwordx4 v16, s[12:15], s61 offen offset:2048 lds
    buffer_load_dwordx4 v17, s[12:15], s61 offen offset:3072 lds
    s_add_u32 s61, s61, 128
    s_and_b32 s61, s61, 2047
    buffer_load_dword v19, v9, s[44:47], 0 offen sc1
    s_waitcnt vmcnt(17)
    s_barrier
    s_add_u32 m0, s60, 0
    s_nop 0
    buffer_load_dwordx4 v10, s[8:11], s61 offen offset:0 lds
    buffer_load_dwordx4 v11, s[8:11], s61 offen offset:1024 lds
    buffer_load_dwordx4 v12, s[8:11], s61 offen offset:2048 lds
    buffer_load_dwordx4 v13, s[8:11], s61 offen offset:3072 lds
    s_add_u32 m0, s60, 16384
    s_nop 0
    buffer_load_dwordx4 v14, s[12:15], s61 offen offset:0 lds
    buffer_load_dwordx4 v15, s[12:15], s61 offen offset:1024 lds
    buffer_load_dwordx4 v16, s[12:15], s61 offen offset:2048 lds
    buffer_load_dwordx4 v17, s[12:15], s61 offen offset:3072 lds
    s_add_u32 s61, s61, 128
    s_and_b32 s61, s61, 2047
    v_and_b32 v52, 0xffff, v44
    v_and_b32 v60, 0xffff0000, v44
    v_and_b32 v53, 0xffff, v45
    v_and_b32 v61, 0xffff0000, v45
    v_and_b32 v54, 0xffff, v46
    v_and_b32 v62, 0xffff0000, v46
    v_and_b32 v55, 0xffff, v47
    v_and_b32 v63, 0xffff0000, v47
    v_and_b32 v56, 0xffff, v48
    v_and_b32 v64, 0xffff0000, v48
    v_and_b32 v57, 0xffff, v49
    v_and_b32 v65, 0xffff0000, v49
    v_and_b32 v58, 0xffff, v50
    v_and_b32 v66, 0xffff0000, v50
    v_and_b32 v59, 0xffff, v51
    v_and_b32 v67, 0xffff0000, v51
    v_mov_b32 v68, 0
    v_mov_b32 v70, 0
    v_dot2_f32_bf16 v72, v20, v52, 0
    v_dot2_f32_bf16 v73, v20, v60, 0
    v_dot2c_f32_bf16 v68, v20, v36
    s_nop 1
    v_cvt_pk_bf16_f32 v72, v72, v73
    v_lshlrev_b32 v73, 16, v72
    v_and_b32 v72, 0xffff0000, v72
    v_add_f32 v70, v70, v73
    v_add_f32 v70, v70, v72
    v_dot2_f32_bf16 v74, v21, v53, 0
    v_dot2_f32_bf16 v75, v21, v61, 0
    v_dot2c_f32_bf16 v68, v21, v37
    s_nop 1
    v_cvt_pk_bf16_f32 v74, v74, v75
    v_lshlrev_b32 v75, 16, v74
    v_and_b32 v74, 0xffff0000, v74
    v_add_f32 v70, v70, v75
    v_add_f32 v70, v70, v74
    v_dot2_f32_bf16 v72, v22, v54, 0
    v_dot2_f32_bf16 v73, v22, v62, 0
    v_dot2c_f32_bf16 v68, v22, v38
    s_nop 1
    v_cvt_pk_bf16_f32 v72, v72, v73
    v_lshlrev_b32 v73, 16, v72
    v_and_b32 v72, 0xffff0000, v72
    v_add_f32 v70, v70, v73
    v_add_f32 v70, v70, v72
    v_dot2_f32_bf16 v74, v23, v55, 0
    v_dot2_f32_bf16 v75, v23, v63, 0
    v_dot2c_f32_bf16 v68, v23, v39
    s_nop 1
    v_cvt_pk_bf16_f32 v74, v74, v75
    v_lshlrev_b32 v75, 16, v74
    v_and_b32 v74, 0xffff0000, v74
    v_add_f32 v70, v70, v75
    v_add_f32 v70, v70, v74
    v_dot2_f32_bf16 v72, v24, v56, 0
    v_dot2_f32_bf16 v73, v24, v64, 0
    v_dot2c_f32_bf16 v68, v24, v40
    s_nop 1
    v_cvt_pk_bf16_f32 v72, v72, v73
    v_lshlrev_b32 v73, 16, v72
    v_and_b32 v72, 0xffff0000, v72
    v_add_f32 v70, v70, v73
    v_add_f32 v70, v70, v72
    v_dot2_f32_bf16 v74, v25, v57, 0
    v_dot2_f32_bf16 v75, v25, v65, 0
    v_dot2c_f32_bf16 v68, v25, v41
    s_nop 1
    v_cvt_pk_bf16_f32 v74, v74, v75
    v_lshlrev_b32 v75, 16, v74
    v_and_b32 v74, 0xffff0000, v74
    v_add_f32 v70, v70, v75
    v_add_f32 v70, v70, v74
    v_dot2_f32_bf16 v72, v26, v58, 0
    v_dot2_f32_bf16 v73, v26, v66, 0
    v_dot2c_f32_bf16 v68, v26, v42
    s_nop 1
    v_cvt_pk_bf16_f32 v72, v72, v73
    v_lshlrev_b32 v73, 16, v72
    v_and_b32 v72, 0xffff0000, v72
    v_add_f32 v70, v70, v73
    v_add_f32 v70, v70, v72
    v_dot2_f32_bf16 v74, v27, v59, 0
    v_dot2_f32_bf16 v75, v27, v67, 0
    v_dot2c_f32_bf16 v68, v27, v43
    s_nop 1
    v_cvt_pk_bf16_f32 v74, v74, v75
    v_lshlrev_b32 v75, 16, v74
    v_and_b32 v74, 0xffff0000, v74
    v_add_f32 v70, v70, v75
    v_add_f32 v70, v70, v74
    s_waitcnt vmcnt(17)
    s_barrier
    s_add_u32 m0, s60, 32768
    s_nop 0
    buffer_load_dwordx4 v10, s[8:11], s61 offen offset:0 lds
    buffer_load_dwordx4 v11, s[8:11], s61 offen offset:1024 lds
    buffer_load_dwordx4 v12, s[8:11], s61 offen offset:2048 lds
    buffer_load_dwordx4 v13, s[8:11], s61 offen offset:3072 lds
    s_add_u32 m0, s60, 49152
    s_nop 0
    buffer_load_dwordx4 v14, s[12:15], s61 offen offset:0 lds
    buffer_load_dwordx4 v15, s[12:15], s61 offen offset:1024 lds
    buffer_load_dwordx4 v16, s[12:15], s61 offen offset:2048 lds
    buffer_load_dwordx4 v17, s[12:15], s61 offen offset:3072 lds
    s_add_u32 s61, s61, 128
    s_and_b32 s61, s61, 2047
    v_mov_b32 v69, 0
    v_mov_b32 v71, 0
    v_dot2_f32_bf16 v72, v28, v52, 0
    v_dot2_f32_bf16 v73, v28, v60, 0
    v_dot2c_f32_bf16 v69, v28, v36
    s_nop 1
    v_cvt_pk_bf16_f32 v72, v72, v73
    v_lshlrev_b32 v73, 16, v72
    v_and_b32 v72, 0xffff0000, v72
    v_add_f32 v71, v71, v73
    v_add_f32 v71, v71, v72
    v_dot2_f32_bf16 v74, v29, v53, 0
    v_dot2_f32_bf16 v75, v29, v61, 0
    v_dot2c_f32_bf16 v69, v29, v37
    s_nop 1
    v_cvt_pk_bf16_f32 v74, v74, v75
    v_lshlrev_b32 v75, 16, v74
    v_and_b32 v74, 0xffff0000, v74
    v_add_f32 v71, v71, v75
    v_add_f32 v71, v71, v74
    v_dot2_f32_bf16 v72, v30, v54, 0
    v_dot2_f32_bf16 v73, v30, v62, 0
    v_dot2c_f32_bf16 v69, v30, v38
    s_nop 1
    v_cvt_pk_bf16_f32 v72, v72, v73
    v_lshlrev_b32 v73, 16, v72
    v_and_b32 v72, 0xffff0000, v72
    v_add_f32 v71, v71, v73
    v_add_f32 v71, v71, v72
    v_dot2_f32_bf16 v74, v31, v55, 0
    v_dot2_f32_bf16 v75, v31, v63, 0
    v_dot2c_f32_bf16 v69, v31, v39
    s_nop 1
    v_cvt_pk_bf16_f32 v74, v74, v75
    v_lshlrev_b32 v75, 16, v74
    v_and_b32 v74, 0xffff0000, v74
    v_add_f32 v71, v71, v75
    v_add_f32 v71, v71, v74
    v_dot2_f32_bf16 v72, v32, v56, 0
    v_dot2_f32_bf16 v73, v32, v64, 0
    v_dot2c_f32_bf16 v69, v32, v40
    s_nop 1
    v_cvt_pk_bf16_f32 v72, v72, v73
    v_lshlrev_b32 v73, 16, v72
    v_and_b32 v72, 0xffff0000, v72
    v_add_f32 v71, v71, v73
    v_add_f32 v71, v71, v72
    v_dot2_f32_bf16 v74, v33, v57, 0
    v_dot2_f32_bf16 v75, v33, v65, 0
    v_dot2c_f32_bf16 v69, v33, v41
    s_nop 1
    v_cvt_pk_bf16_f32 v74, v74, v75
    v_lshlrev_b32 v75, 16, v74
    v_and_b32 v74, 0xffff0000, v74
    v_add_f32 v71, v71, v75
    v_add_f32 v71, v71, v74
    v_dot2_f32_bf16 v72, v34, v58, 0
    v_dot2_f32_bf16 v73, v34, v66, 0
    v_dot2c_f32_bf16 v69, v34, v42
    s_nop 1
    v_cvt_pk_bf16_f32 v72, v72, v73
    v_lshlrev_b32 v73, 16, v72
    v_and_b32 v72, 0xffff0000, v72
    v_add_f32 v71, v71, v73
    v_add_f32 v71, v71, v72
    v_dot2_f32_bf16 v74, v35, v59, 0
    v_dot2_f32_bf16 v75, v35, v67, 0
    v_dot2c_f32_bf16 v69, v35, v43
    s_nop 1
    v_cvt_pk_bf16_f32 v74, v74, v75
    v_lshlrev_b32 v75, 16, v74
    v_and_b32 v74, 0xffff0000, v74
    v_add_f32 v71, v71, v75
    v_add_f32 v71, v71, v74
    s_waitcnt vmcnt(17)
    s_barrier
    s_add_u32 m0, s60, 65536
    s_nop 0
    buffer_load_dwordx4 v10, s[8:11], s61 offen offset:0 lds
    buffer_load_dwordx4 v11, s[8:11], s61 offen offset:1024 lds
    buffer_load_dwordx4 v12, s[8:11], s61 offen offset:2048 lds
    buffer_load_dwordx4 v13, s[8:11], s61 offen offset:3072 lds
    s_add_u32 m0, s60, 81920
    s_nop 0
    buffer_load_dwordx4 v14, s[12:15], s61 offen offset:0 lds
    buffer_load_dwordx4 v15, s[12:15], s61 offen offset:1024 lds
    buffer_load_dwordx4 v16, s[12:15], s61 offen offset:2048 lds
    buffer_load_dwordx4 v17, s[12:15], s61 offen offset:3072 lds
    s_add_u32 s61, s61, 128
    s_and_b32 s61, s61, 2047
    s_nop 2
    v_add_f32_dpp v68, v68, v68 row_shr:1 row_mask:0xf bank_mask:0xf
    v_add_f32_dpp v69, v69, v69 row_shr:1 row_mask:0xf bank_mask:0xf
    v_add_f32_dpp v70, v70, v70 row_shr:1 row_mask:0xf bank_mask:0xf
    v_add_f32_dpp v71, v71, v71 row_shr:1 row_mask:0xf bank_mask:0xf
    v_add_f32_dpp v68, v68, v68 row_shr:2 row_mask:0xf bank_mask:0xf
    v_add_f32_dpp v69, v69, v69 row_shr:2 row_mask:0xf bank_mask:0xf
    v_add_f32_dpp v70, v70, v70 row_shr:2 row_mask:0xf bank_mask:0xf
    v_add_f32_dpp v71, v71, v71 row_shr:2 row_mask:0xf bank_mask:0xf
    v_add_f32_dpp v68, v68, v68 row_shr:4 row_mask:0xf bank_mask:0xf
    v_add_f32_dpp v69, v69, v69 row_shr:4 row_mask:0xf bank_mask:0xf
    v_add_f32_dpp v70, v70, v70 row_shr:4 row_mask:0xf bank_mask:0xf
    v_add_f32_dpp v71, v71, v71 row_shr:4 row_mask:0xf bank_mask:0xf
    v_add_f32_dpp v68, v68, v68 row_shr:8 row_mask:0xf bank_mask:0xf
    v_add_f32_dpp v69, v69, v69 row_shr:8 row_mask:0xf bank_mask:0xf
    v_add_f32_dpp v70, v70, v70 row_shr:8 row_mask:0xf bank_mask:0xf
    v_add_f32_dpp v71, v71, v71 row_shr:8 row_mask:0xf bank_mask:0xf
    v_add_f32_dpp v68, v68, v68 row_bcast:15 row_mask:0xa bank_mask:0xf
    v_add_f32_dpp v69, v69, v69 row_bcast:15 row_mask:0xa bank_mask:0xf
    v_add_f32_dpp v70, v70, v70 row_bcast:15 row_mask:0xa bank_mask:0xf
    v_add_f32_dpp v71, v71, v71 row_bcast:15 row_mask:0xa bank_mask:0xf
    v_add_f32_dpp v68, v68, v68 row_bcast:31 row_mask:0xc bank_mask:0xf
    v_add_f32_dpp v69, v69, v69 row_bcast:31 row_mask:0xc bank_mask:0xf
    v_add_f32_dpp v70, v70, v70 row_bcast:31 row_mask:0xc bank_mask:0xf
    v_add_f32_dpp v71, v71, v71 row_bcast:31 row_mask:0xc bank_mask:0xf
    v_readlane_b32 s66, v69, 63
    v_readlane_b32 s67, v71, 63
    s_nop 2
    v_writelane_b32 v68, s66, 62
    v_writelane_b32 v70, s67, 62
    v_cvt_pk_bf16_f32 v68, v68, v70
    v_and_b32 v70, 0xffff0000, v68
    v_lshlrev_b32 v68, 16, v68
    v_ashrrev_i32 v72, 31, v68
    v_or_b32 v72, 0x80000000, v72
    v_xor_b32 v72, v72, v68
    v_and_b32 v72, 0xffff0000, v72
    v_sub_u32 v74, 63, v1
    v_add_u32 v74, s62, v74
    v_sub_u32 v73, 2047, v74
    v_or_b32 v72, v72, v73
    v_lshlrev_b32 v74, 3, v74
    v_mul_f32 v75, 0xbfb8aa3b, v70
    v_exp_f32 v75, v75
    s_nop 0
    v_add_f32 v75, 1.0, v75
    v_rcp_f32 v75, v75
    s_nop 0
    v_cvt_pk_bf16_f32 v76, v75, v75
    v_lshlrev_b32 v76, 16, v76
    v_sub_f32 v77, 1.0, v76
    v_cvt_pk_bf16_f32 v77, v77, v77
    v_lshlrev_b32 v77, 16, v77
    s_waitcnt vmcnt(16)
    s_barrier
    s_add_u32 m0, s60, 98304
    s_nop 0
    buffer_load_dwordx4 v10, s[8:11], s61 offen offset:0 lds
    buffer_load_dwordx4 v11, s[8:11], s61 offen offset:1024 lds
    buffer_load_dwordx4 v12, s[8:11], s61 offen offset:2048 lds
    buffer_load_dwordx4 v13, s[8:11], s61 offen offset:3072 lds
    s_add_u32 m0, s60, 114688
    s_nop 0
    buffer_load_dwordx4 v14, s[12:15], s61 offen offset:0 lds
    buffer_load_dwordx4 v15, s[12:15], s61 offen offset:1024 lds
    buffer_load_dwordx4 v16, s[12:15], s61 offen offset:2048 lds
    buffer_load_dwordx4 v17, s[12:15], s61 offen offset:3072 lds
    s_add_u32 s61, s61, 128
    s_and_b32 s61, s61, 2047
    s_mov_b32 s68, 1048576
L1_tagpoll:
    v_readfirstlane_b32 s65, v19
    s_sub_u32 s68, s68, 1
    s_cbranch_scc1 L1_tagok
    s_cmp_lg_u32 s65, 0
    s_cbranch_scc1 L1_tagok
    buffer_load_dword v19, v9, s[44:47], 0 offen sc1
    s_waitcnt vmcnt(0)
    s_branch L1_tagpoll
L1_tagok:
    v_mov_b32 v73, s65
    ds_write_b32 v7, v73 offset:20
    s_mov_b32 exec_lo, 0
    s_mov_b32 exec_hi, 0xc0000000
    s_mov_b32 s66, 32768
    s_mov_b32 s67, 4096
    buffer_store_dwordx2 v[72:73], v74, s[16:19], s66 offen sc1
    buffer_store_dwordx2 v[76:77], v74, s[16:19], s67 offen
    s_mov_b64 exec, -1
    s_waitcnt vmcnt(18) lgkmcnt(0)
    s_barrier
    s_add_u32 m0, s60, 0
    s_nop 0
    buffer_load_dwordx4 v10, s[8:11], s61 offen offset:0 lds
    buffer_load_dwordx4 v11, s[8:11], s61 offen offset:1024 lds
    buffer_load_dwordx4 v12, s[8:11], s61 offen offset:2048 lds
    buffer_load_dwordx4 v13, s[8:11], s61 offen offset:3072 lds
    s_add_u32 m0, s60, 16384
    s_nop 0
    buffer_load_dwordx4 v14, s[12:15], s61 offen offset:0 lds
    buffer_load_dwordx4 v15, s[12:15], s61 offen offset:1024 lds
    buffer_load_dwordx4 v16, s[12:15], s61 offen offset:2048 lds
    buffer_load_dwordx4 v17, s[12:15], s61 offen offset:3072 lds
    s_add_u32 s61, s61, 128
    s_and_b32 s61, s61, 2047
    s_waitcnt vmcnt(18)
    s_barrier
    s_add_u32 m0, s60, 32768
    s_nop 0
    buffer_load_dwordx4 v10, s[8:11], s61 offen offset:0 lds
    buffer_load_dwordx4 v11, s[8:11], s61 offen offset:1024 lds
    buffer_load_dwordx4 v12, s[8:11], s61 offen offset:2048 lds
    buffer_load_dwordx4 v13, s[8:11], s61 offen offset:3072 lds
    s_add_u32 m0, s60, 49152
    s_nop 0
    buffer_load_dwordx4 v14, s[12:15], s61 offen offset:0 lds
    buffer_load_dwordx4 v15, s[12:15], s61 offen offset:1024 lds
    buffer_load_dwordx4 v16, s[12:15], s61 offen offset:2048 lds
    buffer_load_dwordx4 v17, s[12:15], s61 offen offset:3072 lds
    s_add_u32 s61, s61, 128
    s_and_b32 s61, s61, 2047
    s_waitcnt vmcnt(18)
    s_barrier
    s_add_u32 m0, s60, 65536
    s_nop 0
    buffer_load_dwordx4 v10, s[8:11], s61 offen offset:0 lds
    buffer_load_dwordx4 v11, s[8:11], s61 offen offset:1024 lds
    buffer_load_dwordx4 v12, s[8:11], s61 offen offset:2048 lds
    buffer_load_dwordx4 v13, s[8:11], s61 offen offset:3072 lds
    s_add_u32 m0, s60, 81920
    s_nop 0
    buffer_load_dwordx4 v14, s[12:15], s61 offen offset:0 lds
    buffer_load_dwordx4 v15, s[12:15], s61 offen offset:1024 lds
    buffer_load_dwordx4 v16, s[12:15], s61 offen offset:2048 lds
    buffer_load_dwordx4 v17, s[12:15], s61 offen offset:3072 lds
    s_add_u32 s61, s61, 128
    s_and_b32 s61, s61, 2047
    s_waitcnt vmcnt(16)
    s_barrier
    s_add_u32 m0, s60, 98304
    s_nop 0
    buffer_load_dwordx4 v10, s[8:11], s61 offen offset:0 lds
    buffer_load_dwordx4 v11, s[8:11], s61 offen offset:1024 lds
    buffer_load_dwordx4 v12, s[8:11], s61 offen offset:2048 lds
    buffer_load_dwordx4 v13, s[8:11], s61 offen offset:3072 lds
    s_add_u32 m0, s60, 114688
    s_nop 0
    buffer_load_dwordx4 v14, s[12:15], s61 offen offset:0 lds
    buffer_load_dwordx4 v15, s[12:15], s61 offen offset:1024 lds
    buffer_load_dwordx4 v16, s[12:15], s61 offen offset:2048 lds
    buffer_load_dwordx4 v17, s[12:15], s61 offen offset:3072 lds
    s_add_u32 s61, s61, 128
    s_and_b32 s61, s61, 2047
    s_waitcnt vmcnt(16)
    s_barrier
    s_add_u32 m0, s60, 0
    s_nop 0
    buffer_load_dwordx4 v10, s[8:11], s61 offen offset:0 lds
    buffer_load_dwordx4 v11, s[8:11], s61 offen offset:1024 lds
    buffer_load_dwordx4 v12, s[8:11], s61 offen offset:2048 lds
    buffer_load_dwordx4 v13, s[8:11], s61 offen offset:3072 lds
    s_add_u32 m0, s60, 16384
    s_nop 0
    buffer_load_dwordx4 v14, s[12:15], s61 offen offset:0 lds
    buffer_load_dwordx4 v15, s[12:15], s61 offen offset:1024 lds
    buffer_load_dwordx4 v16, s[12:15], s61 offen offset:2048 lds
    buffer_load_dwordx4 v17, s[12:15], s61 offen offset:3072 lds
    s_add_u32 s61, s61, 128
    s_and_b32 s61, s61, 2047
    s_waitcnt vmcnt(16)
    s_barrier
    s_add_u32 m0, s60, 32768
    s_nop 0
    buffer_load_dwordx4 v10, s[8:11], s61 offen offset:0 lds
    buffer_load_dwordx4 v11, s[8:11], s61 offen offset:1024 lds
    buffer_load_dwordx4 v12, s[8:11], s61 offen offset:2048 lds
    buffer_load_dwordx4 v13, s[8:11], s61 offen offset:3072 lds
    s_add_u32 m0, s60, 49152
    s_nop 0
    buffer_load_dwordx4 v14, s[12:15], s61 offen offset:0 lds
    buffer_load_dwordx4 v15, s[12:15], s61 offen offset:1024 lds
    buffer_load_dwordx4 v16, s[12:15], s61 offen offset:2048 lds
    buffer_load_dwordx4 v17, s[12:15], s61 offen offset:3072 lds
    s_add_u32 s61, s61, 128
    s_and_b32 s61, s61, 2047
    s_waitcnt vmcnt(16)
    s_barrier
    s_add_u32 m0, s60, 65536
    s_nop 0
    buffer_load_dwordx4 v10, s[8:11], s61 offen offset:0 lds
    buffer_load_dwordx4 v11, s[8:11], s61 offen offset:1024 lds
    buffer_load_dwordx4 v12, s[8:11], s61 offen offset:2048 lds
    buffer_load_dwordx4 v13, s[8:11], s61 offen offset:3072 lds
    s_add_u32 m0, s60, 81920
    s_nop 0
    buffer_load_dwordx4 v14, s[12:15], s61 offen offset:0 lds
    buffer_load_dwordx4 v15, s[12:15], s61 offen offset:1024 lds
    buffer_load_dwordx4 v16, s[12:15], s61 offen offset:2048 lds
    buffer_load_dwordx4 v17, s[12:15], s61 offen offset:3072 lds
    s_add_u32 s61, s61, 128
    s_and_b32 s61, s61, 2047
    s_waitcnt vmcnt(16)
    s_barrier
    s_add_u32 m0, s60, 98304
    s_nop 0
    buffer_load_dwordx4 v10, s[8:11], s61 offen offset:0 lds
    buffer_load_dwordx4 v11, s[8:11], s61 offen offset:1024 lds
    buffer_load_dwordx4 v12, s[8:11], s61 offen offset:2048 lds
    buffer_load_dwordx4 v13, s[8:11], s61 offen offset:3072 lds
    s_add_u32 m0, s60, 114688
    s_nop 0
    buffer_load_dwordx4 v14, s[12:15], s61 offen offset:0 lds
    buffer_load_dwordx4 v15, s[12:15], s61 offen offset:1024 lds
    buffer_load_dwordx4 v16, s[12:15], s61 offen offset:2048 lds
    buffer_load_dwordx4 v17, s[12:15], s61 offen offset:3072 lds
    s_lshl_b32 s66, s30, 12
    s_add_u32 s66, s66, 32768
    buffer_load_dwordx4 v[80:83], v18, s[16:19], s66 offen offset:0 sc1
    buffer_load_dwordx4 v[84:87], v18, s[16:19], s66 offen offset:1024 sc1
    buffer_load_dwordx4 v[88:91], v18, s[16:19], s66 offen offset:2048 sc1
    buffer_load_dwordx4 v[92:95], v18, s[16:19], s66 offen offset:3072 sc1
    s_waitcnt vmcnt(20)
    s_barrier
    s_mul_hi_u32 s70, s2, 76695845
    s_mul_i32 s71, s70, 56
    s_sub_u32 s71, s2, s71
    s_lshl_b32 s72, s70, 8
    s_lshl_b32 s73, s30, 6
    s_add_u32 s72, s72, s73
    s_mul_i32 s73, s72, 7168
    s_lshl_b32 s74, s71, 7
    s_add_u32 s73, s73, s74
    s_cmp_ge_u32 s2, 224
    s_cselect_b32 s50, 0, s50
    s_cselect_b32 s54, 0, s54
    v_mul_u32_u24 v10, 7168, v3
    v_and_b32 v11, 7, v1
    v_lshl_add_u32 v10, v11, 4, v10
    s_lshl_b32 s75, s30, 13
    s_add_u32 m0, s75, 0
    s_add_u32 s74, s73, 0
    buffer_load_dwordx4 v10, s[48:51], s74 offen lds
    s_add_u32 m0, s75, 1024
    s_add_u32 s74, s73, 57344
    buffer_load_dwordx4 v10, s[48:51], s74 offen lds
    s_add_u32 m0, s75, 2048
    s_add_u32 s74, s73, 114688
    buffer_load_dwordx4 v10, s[48:51], s74 offen lds
    s_add_u32 m0, s75, 3072
    s_add_u32 s74, s73, 172032
    buffer_load_dwordx4 v10, s[48:51], s74 offen lds
    s_add_u32 m0, s75, 4096
    s_add_u32 s74, s73, 229376
    buffer_load_dwordx4 v10, s[48:51], s74 offen lds
    s_add_u32 m0, s75, 5120
    s_add_u32 s74, s73, 286720
    buffer_load_dwordx4 v10, s[48:51], s74 offen lds
    s_add_u32 m0, s75, 6144
    s_add_u32 s74, s73, 344064
    buffer_load_dwordx4 v10, s[48:51], s74 offen lds
    s_add_u32 m0, s75, 7168
    s_add_u32 s74, s73, 401408
    buffer_load_dwordx4 v10, s[48:51], s74 offen lds
    s_waitcnt vmcnt(8)
    s_mov_b32 s68, 1048576
L1_keypoll:
    v_xor_b32 v20, s65, v81
    v_xor_b32 v21, s65, v83
    v_or_b32 v20, v20, v21
    v_xor_b32 v21, s65, v85
    v_or_b32 v20, v20, v21
    v_xor_b32 v21, s65, v87
    v_or_b32 v20, v20, v21
    v_xor_b32 v21, s65, v89
    v_or_b32 v20, v20, v21
    v_xor_b32 v21, s65, v91
    v_or_b32 v20, v20, v21
    v_xor_b32 v21, s65, v93
    v_or_b32 v20, v20, v21
    v_xor_b32 v21, s65, v95
    v_or_b32 v20, v20, v21
    v_cmp_ne_u32 vcc, 0, v20
    s_sub_u32 s68, s68, 1
    s_cbranch_scc1 L1_keyok
    s_cbranch_vccz L1_keyok
    buffer_load_dwordx4 v[80:83], v18, s[16:19], s66 offen offset:0 sc1
    buffer_load_dwordx4 v[84:87], v18, s[16:19], s66 offen offset:1024 sc1
    buffer_load_dwordx4 v[88:91], v18, s[16:19], s66 offen offset:2048 sc1
    buffer_load_dwordx4 v[92:95], v18, s[16:19], s66 offen offset:3072 sc1
    s_waitcnt vmcnt(0)
    s_branch L1_keypoll
L1_keyok:
    s_mov_b32 s76, 0
    s_mov_b32 s78, 0x01010101
    s_mov_b32 s79, 0x01010101
    s_mov_b32 s80, 8
L_k1k1_top_1:
    v_subrev_u32 v22, s76, v80
    v_subrev_u32 v23, s76, v82
    v_subrev_u32 v24, s76, v84
    v_subrev_u32 v25, s76, v86
    v_subrev_u32 v26, s76, v88
    v_subrev_u32 v27, s76, v90
    v_subrev_u32 v28, s76, v92
    v_subrev_u32 v29, s76, v94
    v_max3_u32 v22, v22, v23, v24
    v_max3_u32 v25, v25, v26, v27
    v_max3_u32 v22, v22, v28, v29
    v_max_u32 v22, v22, v25
    v_mov_b32 v23, v22
    s_nop 1
    v_max_u32_dpp v23, v23, v23 row_shr:1 row_mask:0xf bank_mask:0xf
    s_nop 1
    v_max_u32_dpp v23, v23, v23 row_shr:2 row_mask:0xf bank_mask:0xf
    s_nop 1
    v_max_u32_dpp v23, v23, v23 row_shr:4 row_mask:0xf bank_mask:0xf
    s_nop 1
    v_max_u32_dpp v23, v23, v23 row_shr:8 row_mask:0xf bank_mask:0xf
    s_nop 1
    v_max_u32_dpp v23, v23, v23 row_bcast:15 row_mask:0xa bank_mask:0xf
    s_nop 1
    v_max_u32_dpp v23, v23, v23 row_bcast:31 row_mask:0xc bank_mask:0xf
    s_nop 0
    v_readlane_b32 s77, v23, 63
    s_add_u32 s76, s76, s77
    s_mov_b64 exec, s[78:79]
    v_mov_b32 v30, s76
    s_mov_b64 exec, -1
    s_lshl_b64 s[78:79], s[78:79], 1
    s_sub_u32 s80, s80, 1
    s_cmp_lg_u32 s80, 0
    s_cbranch_scc1 L_k1k1_top_1
    v_and_b32 v31, 7, v1
    s_lshl_b32 s76, s30, 5
    v_lshl_add_u32 v32, v31, 2, s76
    v_add_u32 v32, 131328, v32
    ds_write_b32 v32, v30
    s_waitcnt lgkmcnt(0)
    s_barrier
    s_add_u32 m0, s75, 32768
    s_add_u32 s74, s73, 0
    buffer_load_dwordx4 v10, s[52:55], s74 offen lds
    s_add_u32 m0, s75, 33792
    s_add_u32 s74, s73, 57344
    buffer_load_dwordx4 v10, s[52:55], s74 offen lds
    s_add_u32 m0, s75, 34816
    s_add_u32 s74, s73, 114688
    buffer_load_dwordx4 v10, s[52:55], s74 offen lds
    s_add_u32 m0, s75, 35840
    s_add_u32 s74, s73, 172032
    buffer_load_dwordx4 v10, s[52:55], s74 offen lds
    s_add_u32 m0, s75, 36864
    s_add_u32 s74, s73, 229376
    buffer_load_dwordx4 v10, s[52:55], s74 offen lds
    s_add_u32 m0, s75, 37888
    s_add_u32 s74, s73, 286720
    buffer_load_dwordx4 v10, s[52:55], s74 offen lds
    s_add_u32 m0, s75, 38912
    s_add_u32 s74, s73, 344064
    buffer_load_dwordx4 v10, s[52:55], s74 offen lds
    s_add_u32 m0, s75, 39936
    s_add_u32 s74, s73, 401408
    buffer_load_dwordx4 v10, s[52:55], s74 offen lds
    v_and_b32 v32, 31, v1
    v_lshlrev_b32 v32, 2, v32
    v_add_u32 v32, 131328, v32
    ds_read_b32 v33, v32
    s_waitcnt lgkmcnt(0)
    s_barrier
    s_mov_b32 s76, 0
    s_mov_b32 s78, 0x01010101
    s_mov_b32 s79, 0x01010101
    s_mov_b32 s80, 8
L_k1k1_top_2:
    v_subrev_u32 v22, s76, v33
    v_mov_b32 v23, v22
    s_nop 1
    v_max_u32_dpp v23, v23, v23 row_shr:1 row_mask:0xf bank_mask:0xf
    s_nop 1
    v_max_u32_dpp v23, v23, v23 row_shr:2 row_mask:0xf bank_mask:0xf
    s_nop 1
    v_max_u32_dpp v23, v23, v23 row_shr:4 row_mask:0xf bank_mask:0xf
    s_nop 1
    v_max_u32_dpp v23, v23, v23 row_shr:8 row_mask:0xf bank_mask:0xf
    s_nop 1
    v_max_u32_dpp v23, v23, v23 row_bcast:15 row_mask:0xa bank_mask:0xf
    s_nop 1
    v_max_u32_dpp v23, v23, v23 row_bcast:31 row_mask:0xc bank_mask:0xf
    s_nop 0
    v_readlane_b32 s77, v23, 63
    s_add_u32 s76, s76, s77
    s_mov_b64 exec, s[78:79]
    v_mov_b32 v30, s76
    s_mov_b64 exec, -1
    s_lshl_b64 s[78:79], s[78:79], 1
    s_sub_u32 s80, s80, 1
    s_cmp_lg_u32 s80, 0
    s_cbranch_scc1 L_k1k1_top_2
    v_and_b32 v31, 0x7ff, v30
    v_sub_u32 v31, 2047, v31
    v_lshrrev_b32 v32, 4, v1
    v_lshlrev_b32 v32, 4, v32
    v_lshl_add_u32 v32, v31, 11, v32
    s_lshl_b32 s76, s72, 1
    buffer_load_dwordx4 v[36:39], v32, s[56:59], s76 offen offset:0
    buffer_load_dwordx4 v[40:43], v32, s[56:59], s76 offen offset:64
    s_cmp_lg_u32 s2, 255
    s_cbranch_scc1 L1_nosel
    s_cmp_lg_u32 s30, 0
    s_cbranch_scc1 L1_nosel
    v_ashrrev_i32 v33, 31, v30
    v_not_b32 v33, v33
    v_or_b32 v33, 0x80000000, v33
    v_xor_b32 v33, v33, v30
    v_and_b32 v33, 0xffff0000, v33
    v_mul_f32 v35, 0xbfb8aa3b, v33
    v_exp_f32 v35, v35
    s_nop 0
    v_add_f32 v35, 1.0, v35
    v_rcp_f32 v35, v35
    s_nop 0
    v_cvt_pk_bf16_f32 v34, v35, v35
    v_lshlrev_b32 v34, 16, v34
    v_lshlrev_b32 v35, 2, v1
    s_mov_b64 exec, 0xff
    buffer_store_dword v31, v35, s[16:19], 0 offen offset:256
    buffer_store_dword v34, v35, s[16:19], 0 offen offset:288
    s_endpgm
L1_nosel:
    s_cmp_ge_u32 s2, 224
    s_cbranch_scc1 L1_lend
    v_lshrrev_b32 v33, 4, v1
    v_bfe_u32 v34, v1, 2, 2
    v_lshl_add_u32 v33, v33, 3, v34
    v_lshlrev_b32 v33, 7, v33
    v_and_b32 v34, 3, v1
    v_lshl_add_u32 v33, v34, 3, v33
    v_add_u32 v33, s75, v33
    v_mov_b32 v96, 0
    v_mov_b32 v97, 0
    v_mov_b32 v98, 0
    v_mov_b32 v99, 0
    v_mov_b32 v100, 0
    v_mov_b32 v101, 0
    v_mov_b32 v102, 0
    v_mov_b32 v103, 0
    v_mov_b32 v104, 0
    v_mov_b32 v105, 0
    v_mov_b32 v106, 0
    v_mov_b32 v107, 0
    v_mov_b32 v108, 0
    v_mov_b32 v109, 0
    v_mov_b32 v110, 0
    v_mov_b32 v111, 0
    v_mov_b32 v112, 0
    v_mov_b32 v113, 0
    v_mov_b32 v114, 0
    v_mov_b32 v115, 0
    v_mov_b32 v116, 0
    v_mov_b32 v117, 0
    v_mov_b32 v118, 0
    v_mov_b32 v119, 0
    v_mov_b32 v120, 0
    v_mov_b32 v121, 0
    v_mov_b32 v122, 0
    v_mov_b32 v123, 0
    v_mov_b32 v124, 0
    v_mov_b32 v125, 0
    v_mov_b32 v126, 0
    v_mov_b32 v127, 0
    s_waitcnt vmcnt(10)
    ds_read_b64_tr_b16 v[128:129], v33 offset:0
    ds_read_b64_tr_b16 v[130:131], v33 offset:512
    ds_read_b64_tr_b16 v[132:133], v33 offset:32
    ds_read_b64_tr_b16 v[134:135], v33 offset:544
    ds_read_b64_tr_b16 v[136:137], v33 offset:64
    ds_read_b64_tr_b16 v[138:139], v33 offset:576
    ds_read_b64_tr_b16 v[140:141], v33 offset:96
    ds_read_b64_tr_b16 v[142:143], v33 offset:608
    ds_read_b64_tr_b16 v[144:145], v33 offset:4096
    ds_read_b64_tr_b16 v[146:147], v33 offset:4608
    ds_read_b64_tr_b16 v[148:149], v33 offset:4128
    ds_read_b64_tr_b16 v[150:151], v33 offset:4640
    ds_read_b64_tr_b16 v[152:153], v33 offset:4160
    ds_read_b64_tr_b16 v[154:155], v33 offset:4672
    ds_read_b64_tr_b16 v[156:157], v33 offset:4192
    ds_read_b64_tr_b16 v[158:159], v33 offset:4704
    s_waitcnt vmcnt(0)
    s_waitcnt lgkmcnt(8)
    v_mfma_f32_16x16x32_bf16 v[96:99], v[36:39], v[128:131], v[96:99]
    v_mfma_f32_16x16x32_bf16 v[100:103], v[36:39], v[132:135], v[100:103]
    v_mfma_f32_16x16x32_bf16 v[104:107], v[36:39], v[136:139], v[104:107]
    v_mfma_f32_16x16x32_bf16 v[108:111], v[36:39], v[140:143], v[108:111]
    s_waitcnt lgkmcnt(0)
    v_mfma_f32_16x16x32_bf16 v[96:99], v[40:43], v[144:147], v[96:99]
    v_mfma_f32_16x16x32_bf16 v[100:103], v[40:43], v[148:151], v[100:103]
    v_mfma_f32_16x16x32_bf16 v[104:107], v[40:43], v[152:155], v[104:107]
    v_mfma_f32_16x16x32_bf16 v[108:111], v[40:43], v[156:159], v[108:111]
    ds_read_b64_tr_b16 v[128:129], v33 offset:32768
    ds_read_b64_tr_b16 v[130:131], v33 offset:33280
    ds_read_b64_tr_b16 v[132:133], v33 offset:32800
    ds_read_b64_tr_b16 v[134:135], v33 offset:33312
    ds_read_b64_tr_b16 v[136:137], v33 offset:32832
    ds_read_b64_tr_b16 v[138:139], v33 offset:33344
    ds_read_b64_tr_b16 v[140:141], v33 offset:32864
    ds_read_b64_tr_b16 v[142:143], v33 offset:33376
    ds_read_b64_tr_b16 v[144:145], v33 offset:36864
    ds_read_b64_tr_b16 v[146:147], v33 offset:37376
    ds_read_b64_tr_b16 v[148:149], v33 offset:36896
    ds_read_b64_tr_b16 v[150:151], v33 offset:37408
    ds_read_b64_tr_b16 v[152:153], v33 offset:36928
    ds_read_b64_tr_b16 v[154:155], v33 offset:37440
    ds_read_b64_tr_b16 v[156:157], v33 offset:36960
    ds_read_b64_tr_b16 v[158:159], v33 offset:37472
    s_waitcnt lgkmcnt(8)
    v_mfma_f32_16x16x32_bf16 v[112:115], v[36:39], v[128:131], v[112:115]
    v_mfma_f32_16x16x32_bf16 v[116:119], v[36:39], v[132:135], v[116:119]
    v_mfma_f32_16x16x32_bf16 v[120:123], v[36:39], v[136:139], v[120:123]
    v_mfma_f32_16x16x32_bf16 v[124:127], v[36:39], v[140:143], v[124:127]
    s_waitcnt lgkmcnt(0)
    v_mfma_f32_16x16x32_bf16 v[112:115], v[40:43], v[144:147], v[112:115]
    v_mfma_f32_16x16x32_bf16 v[116:119], v[40:43], v[148:151], v[116:119]
    v_mfma_f32_16x16x32_bf16 v[120:123], v[40:43], v[152:155], v[120:123]
    v_mfma_f32_16x16x32_bf16 v[124:127], v[40:43], v[156:159], v[124:127]
    s_lshl_b32 s76, s30, 12
    v_lshl_add_u32 v34, v1, 4, s76
    v_add_u32 v34, 139264, v34
    s_mov_b64 exec, 0xffffffff
    ds_write_b128 v34, v[96:99] offset:0
    ds_write_b128 v34, v[100:103] offset:512
    ds_write_b128 v34, v[104:107] offset:1024
    ds_write_b128 v34, v[108:111] offset:1536
    ds_write_b128 v34, v[112:115] offset:2048
    ds_write_b128 v34, v[116:119] offset:2560
    ds_write_b128 v34, v[120:123] offset:3072
    ds_write_b128 v34, v[124:127] offset:3584
    s_mov_b64 exec, 1
    v_mov_b32 v35, 1
    ds_add_rtn_u32 v35, v7, v35 offset:16
    s_mov_b64 exec, -1
    s_waitcnt lgkmcnt(0)
    v_readfirstlane_b32 s76, v35
    s_cmp_lg_u32 s76, 3
    s_cbranch_scc1 L1_lend
    v_lshlrev_b32 v34, 4, v1
    v_add_u32 v34, 139264, v34
    ds_read_b128 v[96:99], v34 offset:0
    ds_read_b128 v[100:103], v34 offset:1024
    ds_read_b128 v[104:107], v34 offset:2048
    ds_read_b128 v[108:111], v34 offset:3072
    ds_read_b128 v[112:115], v34 offset:4096
    ds_read_b128 v[116:119], v34 offset:5120
    ds_read_b128 v[120:123], v34 offset:6144
    ds_read_b128 v[124:127], v34 offset:7168
    ds_read_b128 v[128:131], v34 offset:8192
    ds_read_b128 v[132:135], v34 offset:9216
    ds_read_b128 v[136:139], v34 offset:10240
    ds_read_b128 v[140:143], v34 offset:11264
    ds_read_b128 v[144:147], v34 offset:12288
    ds_read_b128 v[148:151], v34 offset:13312
    ds_read_b128 v[152:155], v34 offset:14336
    ds_read_b128 v[156:159], v34 offset:15360
    v_lshrrev_b32 v35, 5, v1
    v_and_b32 v36, 15, v1
    v_lshl_add_u32 v35, v35, 4, v36
    v_lshlrev_b32 v35, 8, v35
    v_bfe_u32 v36, v1, 4, 1
    v_lshl_add_u32 v35, v36, 4, v35
    s_lshl_b32 s76, s71, 14
    s_lshl_b32 s77, s70, 6
    s_add_u32 s76, s76, s77
    s_add_u32 s76, s76, 524288
    s_add_u32 s77, s76, 8192
    s_waitcnt lgkmcnt(0)
    v_pk_add_f32 v[96:97], v[96:97], v[112:113]
    v_pk_add_f32 v[128:129], v[128:129], v[144:145]
    v_pk_add_f32 v[96:97], v[96:97], v[128:129]
    v_pk_add_f32 v[98:99], v[98:99], v[114:115]
    v_pk_add_f32 v[130:131], v[130:131], v[146:147]
    v_pk_add_f32 v[98:99], v[98:99], v[130:131]
    buffer_store_dwordx4 v[96:99], v35, s[16:19], s76 offen offset:0
    v_pk_add_f32 v[100:101], v[100:101], v[116:117]
    v_pk_add_f32 v[132:133], v[132:133], v[148:149]
    v_pk_add_f32 v[100:101], v[100:101], v[132:133]
    v_pk_add_f32 v[102:103], v[102:103], v[118:119]
    v_pk_add_f32 v[134:135], v[134:135], v[150:151]
    v_pk_add_f32 v[102:103], v[102:103], v[134:135]
    buffer_store_dwordx4 v[100:103], v35, s[16:19], s77 offen offset:0
    v_pk_add_f32 v[104:105], v[104:105], v[120:121]
    v_pk_add_f32 v[136:137], v[136:137], v[152:153]
    v_pk_add_f32 v[104:105], v[104:105], v[136:137]
    v_pk_add_f32 v[106:107], v[106:107], v[122:123]
    v_pk_add_f32 v[138:139], v[138:139], v[154:155]
    v_pk_add_f32 v[106:107], v[106:107], v[138:139]
    buffer_store_dwordx4 v[104:107], v35, s[16:19], s76 offen offset:32
    v_pk_add_f32 v[108:109], v[108:109], v[124:125]
    v_pk_add_f32 v[140:141], v[140:141], v[156:157]
    v_pk_add_f32 v[108:109], v[108:109], v[140:141]
    v_pk_add_f32 v[110:111], v[110:111], v[126:127]
    v_pk_add_f32 v[142:143], v[142:143], v[158:159]
    v_pk_add_f32 v[110:111], v[110:111], v[142:143]
    buffer_store_dwordx4 v[108:111], v35, s[16:19], s77 offen offset:32
L1_lend:
    s_endpgm
L1_compute:
    s_load_dwordx2 s[8:9], s[0:1], 8
    s_load_dwordx2 s[12:13], s[0:1], 16
    s_load_dwordx2 s[16:17], s[0:1], 56
    s_load_dwordx2 s[20:21], s[0:1], 136
    s_lshr_b32 s30, s29, 1
    s_and_b32 s31, s29, 1
    v_and_b32 v6, 15, v1
    v_lshrrev_b32 v7, 4, v1
    s_lshl_b32 s32, s27, 6
    s_lshl_b32 s33, s31, 5
    s_add_u32 s32, s32, s33
    s_lshl_b32 s32, s32, 1
    v_lshlrev_b32 v8, 1, v6
    s_mov_b32 s10, 2048
    s_mov_b32 s11, 0x20000
    s_mov_b32 s14, 2048
    s_mov_b32 s15, 0x20000
    s_mov_b32 s18, 2048
    s_mov_b32 s19, 0x20000
    s_waitcnt lgkmcnt(0)
    buffer_load_ushort v26, v8, s[16:19], s32 offen offset:0
    buffer_load_ushort v22, v8, s[8:11], s32 offen offset:0
    buffer_load_ushort v24, v8, s[12:15], s32 offen offset:0
    buffer_load_ushort v27, v8, s[16:19], s32 offen offset:32
    buffer_load_ushort v23, v8, s[8:11], s32 offen offset:32
    buffer_load_ushort v25, v8, s[12:15], s32 offen offset:32
    v_lshrrev_b32 v8, 1, v6
    v_xor_b32 v8, v8, v7
    v_lshlrev_b32 v8, 4, v8
    v_lshl_add_u32 v8, v6, 7, v8
    s_lshl_b32 s33, s30, 13
    s_lshl_b32 s34, s31, 13
    s_add_u32 s34, s34, 16384
    v_add_u32 v2, s33, v8
    v_add_u32 v4, s34, v8
    v_xor_b32 v3, 64, v2
    v_xor_b32 v5, 64, v4
    s_lshl_b32 s33, s27, 14
    s_add_u32 s33, s33, 65536
    s_add_u32 s36, s20, s33
    s_addc_u32 s37, s21, 0
    s_mov_b32 s38, 16384
    s_mov_b32 s39, 0x20000
    s_lshl_b32 s33, s27, 2
    s_add_u32 s33, s33, s31
    s_lshl_b32 s33, s33, 7
    s_lshl_b32 s34, s26, 3
    s_add_u32 s33, s33, s34
    s_lshl_b32 s34, s30, 2
    s_add_u32 s33, s33, s34
    s_lshl_b32 s33, s33, 10
    s_add_u32 s33, s33, 4194304
    s_add_u32 s40, s20, s33
    s_addc_u32 s41, s21, 0
    s_mov_b32 s42, 266240
    s_mov_b32 s43, 0x20000
    v_mov_b32 v96, 0
    v_mov_b32 v97, 0
    v_mov_b32 v98, 0
    v_mov_b32 v99, 0
    v_mov_b32 v100, 0
    v_mov_b32 v101, 0
    v_mov_b32 v102, 0
    v_mov_b32 v103, 0
    v_mov_b32 v104, 0
    v_mov_b32 v105, 0
    v_mov_b32 v106, 0
    v_mov_b32 v107, 0
    v_mov_b32 v108, 0
    v_mov_b32 v109, 0
    v_mov_b32 v110, 0
    v_mov_b32 v111, 0
    v_mov_b32 v112, 0
    v_mov_b32 v113, 0
    v_mov_b32 v114, 0
    v_mov_b32 v115, 0
    v_mov_b32 v116, 0
    v_mov_b32 v117, 0
    v_mov_b32 v118, 0
    v_mov_b32 v119, 0
    v_mov_b32 v120, 0
    v_mov_b32 v121, 0
    v_mov_b32 v122, 0
    v_mov_b32 v123, 0
    v_mov_b32 v124, 0
    v_mov_b32 v125, 0
    v_mov_b32 v126, 0
    v_mov_b32 v127, 0
    v_mov_b32 v128, 0
    v_mov_b32 v129, 0
    v_mov_b32 v130, 0
    v_mov_b32 v131, 0
    v_mov_b32 v132, 0
    v_mov_b32 v133, 0
    v_mov_b32 v134, 0
    v_mov_b32 v135, 0
    v_mov_b32 v136, 0
    v_mov_b32 v137, 0
    v_mov_b32 v138, 0
    v_mov_b32 v139, 0
    v_mov_b32 v140, 0
    v_mov_b32 v141, 0
    v_mov_b32 v142, 0
    v_mov_b32 v143, 0
    v_mov_b32 v144, 0
    v_mov_b32 v145, 0
    v_mov_b32 v146, 0
    v_mov_b32 v147, 0
    v_mov_b32 v148, 0
    v_mov_b32 v149, 0
    v_mov_b32 v150, 0
    v_mov_b32 v151, 0
    v_mov_b32 v152, 0
    v_mov_b32 v153, 0
    v_mov_b32 v154, 0
    v_mov_b32 v155, 0
    v_mov_b32 v156, 0
    v_mov_b32 v157, 0
    v_mov_b32 v158, 0
    v_mov_b32 v159, 0
    s_waitcnt vmcnt(0)
    v_lshlrev_b32 v26, 16, v26
    v_lshlrev_b32 v22, 16, v22
    v_lshlrev_b32 v24, 16, v24
    v_mul_f32 v26, 0x3fb8aa3b, v26
    v_exp_f32 v26, v26
    v_lshlrev_b32 v27, 16, v27
    v_lshlrev_b32 v23, 16, v23
    v_lshlrev_b32 v25, 16, v25
    v_mul_f32 v27, 0x3fb8aa3b, v27
    v_exp_f32 v27, v27
    s_nop 0
    v_cvt_pk_bf16_f32 v26, v26, v27
    v_and_b32 v27, 0xffff0000, v26
    v_lshlrev_b32 v26, 16, v26
    v_pk_mul_f32 v[28:29], v[26:27], v[24:25]
    v_pk_mul_f32 v[26:27], v[26:27], v[22:23]
    v_mul_f32 v26, 0x3fb8aa3b, v26
    v_mul_f32 v28, 0x3e22f983, v28
    v_exp_f32 v26, v26
    v_rndne_f32 v10, v28
    v_sub_f32 v28, v28, v10
    v_cos_f32 v10, v28
    v_sin_f32 v12, v28
    v_mul_f32 v27, 0x3fb8aa3b, v27
    v_mul_f32 v29, 0x3e22f983, v29
    v_exp_f32 v27, v27
    v_rndne_f32 v11, v29
    v_sub_f32 v29, v29, v11
    v_cos_f32 v11, v29
    v_sin_f32 v13, v29
    v_pk_mul_f32 v[10:11], v[10:11], v[26:27]
    v_pk_mul_f32 v[12:13], v[12:13], v[26:27]
    v_pk_mul_f32 v[26:27], v[10:11], v[12:13]
    v_pk_mul_f32 v[14:15], v[10:11], v[10:11]
    v_pk_fma_f32 v[14:15], v[12:13], v[12:13], v[14:15] neg_lo:[1,0,0] neg_hi:[1,0,0]
    v_pk_add_f32 v[16:17], v[26:27], v[26:27]
    v_pk_mul_f32 v[26:27], v[14:15], v[16:17]
    v_pk_mul_f32 v[18:19], v[14:15], v[14:15]
    v_pk_fma_f32 v[18:19], v[16:17], v[16:17], v[18:19] neg_lo:[1,0,0] neg_hi:[1,0,0]
    v_pk_add_f32 v[20:21], v[26:27], v[26:27]
    v_pk_mul_f32 v[26:27], v[18:19], v[20:21]
    v_pk_mul_f32 v[14:15], v[18:19], v[18:19]
    v_pk_fma_f32 v[14:15], v[20:21], v[20:21], v[14:15] neg_lo:[1,0,0] neg_hi:[1,0,0]
    v_pk_add_f32 v[16:17], v[26:27], v[26:27]
    v_pk_mul_f32 v[26:27], v[14:15], v[16:17]
    v_pk_mul_f32 v[18:19], v[14:15], v[14:15]
    v_pk_fma_f32 v[18:19], v[16:17], v[16:17], v[18:19] neg_lo:[1,0,0] neg_hi:[1,0,0]
    v_pk_add_f32 v[20:21], v[26:27], v[26:27]
    s_barrier
    ds_read_b128 v[32:35], v2 offset:0
    ds_read_b128 v[48:51], v4 offset:0
    ds_read_b128 v[52:55], v4 offset:2048
    ds_read_b128 v[56:59], v4 offset:4096
    ds_read_b128 v[60:63], v4 offset:6144
    ds_read_b128 v[36:39], v2 offset:2048
    ds_read_b128 v[40:43], v2 offset:4096
    ds_read_b128 v[44:47], v2 offset:6144
    s_mov_b32 s35, 0
L1_loop:
    s_waitcnt lgkmcnt(0)
    v_mfma_f32_16x16x32_bf16 v[96:99], v[32:35], v[48:51], v[96:99]
    ds_read_b128 v[64:67], v3 offset:0
    v_mfma_f32_16x16x32_bf16 v[128:131], v[32:35], v[52:55], v[128:131]
    ds_read_b128 v[80:83], v5 offset:0
    v_mfma_f32_16x16x32_bf16 v[112:115], v[32:35], v[56:59], v[112:115]
    ds_read_b128 v[84:87], v5 offset:2048
    v_mfma_f32_16x16x32_bf16 v[144:147], v[32:35], v[60:63], v[144:147]
    ds_read_b128 v[88:91], v5 offset:4096
    v_mfma_f32_16x16x32_bf16 v[148:151], v[36:39], v[60:63], v[148:151]
    ds_read_b128 v[92:95], v5 offset:6144
    v_mfma_f32_16x16x32_bf16 v[116:119], v[36:39], v[56:59], v[116:119]
    ds_read_b128 v[68:71], v3 offset:2048
    v_mfma_f32_16x16x32_bf16 v[132:135], v[36:39], v[52:55], v[132:135]
    ds_read_b128 v[72:75], v3 offset:4096
    v_mfma_f32_16x16x32_bf16 v[100:103], v[36:39], v[48:51], v[100:103]
    ds_read_b128 v[76:79], v3 offset:6144
    v_mfma_f32_16x16x32_bf16 v[104:107], v[40:43], v[48:51], v[104:107]
    v_mfma_f32_16x16x32_bf16 v[136:139], v[40:43], v[52:55], v[136:139]
    v_mfma_f32_16x16x32_bf16 v[120:123], v[40:43], v[56:59], v[120:123]
    v_mfma_f32_16x16x32_bf16 v[152:155], v[40:43], v[60:63], v[152:155]
    v_mfma_f32_16x16x32_bf16 v[156:159], v[44:47], v[60:63], v[156:159]
    v_mfma_f32_16x16x32_bf16 v[124:127], v[44:47], v[56:59], v[124:127]
    v_mfma_f32_16x16x32_bf16 v[140:143], v[44:47], v[52:55], v[140:143]
    v_mfma_f32_16x16x32_bf16 v[108:111], v[44:47], v[48:51], v[108:111]
    s_waitcnt lgkmcnt(0)
    v_mfma_f32_16x16x32_bf16 v[96:99], v[64:67], v[80:83], v[96:99]
    s_barrier
    v_mfma_f32_16x16x32_bf16 v[128:131], v[64:67], v[84:87], v[128:131]
    ds_read_b128 v[32:35], v2 offset:32768
    v_mfma_f32_16x16x32_bf16 v[112:115], v[64:67], v[88:91], v[112:115]
    ds_read_b128 v[48:51], v4 offset:32768
    v_mfma_f32_16x16x32_bf16 v[144:147], v[64:67], v[92:95], v[144:147]
    ds_read_b128 v[52:55], v4 offset:34816
    v_mfma_f32_16x16x32_bf16 v[148:151], v[68:71], v[92:95], v[148:151]
    ds_read_b128 v[56:59], v4 offset:36864
    v_mfma_f32_16x16x32_bf16 v[116:119], v[68:71], v[88:91], v[116:119]
    ds_read_b128 v[60:63], v4 offset:38912
    v_mfma_f32_16x16x32_bf16 v[132:135], v[68:71], v[84:87], v[132:135]
    ds_read_b128 v[36:39], v2 offset:34816
    v_mfma_f32_16x16x32_bf16 v[100:103], v[68:71], v[80:83], v[100:103]
    ds_read_b128 v[40:43], v2 offset:36864
    v_mfma_f32_16x16x32_bf16 v[104:107], v[72:75], v[80:83], v[104:107]
    ds_read_b128 v[44:47], v2 offset:38912
    v_mfma_f32_16x16x32_bf16 v[136:139], v[72:75], v[84:87], v[136:139]
    v_mfma_f32_16x16x32_bf16 v[120:123], v[72:75], v[88:91], v[120:123]
    v_mfma_f32_16x16x32_bf16 v[152:155], v[72:75], v[92:95], v[152:155]
    v_mfma_f32_16x16x32_bf16 v[156:159], v[76:79], v[92:95], v[156:159]
    v_mfma_f32_16x16x32_bf16 v[124:127], v[76:79], v[88:91], v[124:127]
    v_mfma_f32_16x16x32_bf16 v[140:143], v[76:79], v[84:87], v[140:143]
    v_mfma_f32_16x16x32_bf16 v[108:111], v[76:79], v[80:83], v[108:111]
    s_waitcnt lgkmcnt(0)
    v_mfma_f32_16x16x32_bf16 v[96:99], v[32:35], v[48:51], v[96:99]
    ds_read_b128 v[64:67], v3 offset:32768
    v_mfma_f32_16x16x32_bf16 v[128:131], v[32:35], v[52:55], v[128:131]
    ds_read_b128 v[80:83], v5 offset:32768
    v_mfma_f32_16x16x32_bf16 v[112:115], v[32:35], v[56:59], v[112:115]
    ds_read_b128 v[84:87], v5 offset:34816
    v_mfma_f32_16x16x32_bf16 v[144:147], v[32:35], v[60:63], v[144:147]
    ds_read_b128 v[88:91], v5 offset:36864
    v_mfma_f32_16x16x32_bf16 v[148:151], v[36:39], v[60:63], v[148:151]
    ds_read_b128 v[92:95], v5 offset:38912
    v_mfma_f32_16x16x32_bf16 v[116:119], v[36:39], v[56:59], v[116:119]
    ds_read_b128 v[68:71], v3 offset:34816
    v_mfma_f32_16x16x32_bf16 v[132:135], v[36:39], v[52:55], v[132:135]
    ds_read_b128 v[72:75], v3 offset:36864
    v_mfma_f32_16x16x32_bf16 v[100:103], v[36:39], v[48:51], v[100:103]
    ds_read_b128 v[76:79], v3 offset:38912
    v_mfma_f32_16x16x32_bf16 v[104:107], v[40:43], v[48:51], v[104:107]
    v_mfma_f32_16x16x32_bf16 v[136:139], v[40:43], v[52:55], v[136:139]
    v_mfma_f32_16x16x32_bf16 v[120:123], v[40:43], v[56:59], v[120:123]
    v_mfma_f32_16x16x32_bf16 v[152:155], v[40:43], v[60:63], v[152:155]
    v_mfma_f32_16x16x32_bf16 v[156:159], v[44:47], v[60:63], v[156:159]
    v_mfma_f32_16x16x32_bf16 v[124:127], v[44:47], v[56:59], v[124:127]
    v_mfma_f32_16x16x32_bf16 v[140:143], v[44:47], v[52:55], v[140:143]
    v_mfma_f32_16x16x32_bf16 v[108:111], v[44:47], v[48:51], v[108:111]
    s_waitcnt lgkmcnt(0)
    v_mfma_f32_16x16x32_bf16 v[96:99], v[64:67], v[80:83], v[96:99]
    v_xor_b32 v2, 0x10000, v2
    v_xor_b32 v3, 0x10000, v3
    v_xor_b32 v4, 0x10000, v4
    v_xor_b32 v5, 0x10000, v5
    s_cmp_eq_u32 s35, 7
    s_cbranch_scc1 L1_nobar
    s_barrier
L1_nobar:
    v_mfma_f32_16x16x32_bf16 v[128:131], v[64:67], v[84:87], v[128:131]
    ds_read_b128 v[32:35], v2 offset:0
    v_mfma_f32_16x16x32_bf16 v[112:115], v[64:67], v[88:91], v[112:115]
    ds_read_b128 v[48:51], v4 offset:0
    v_mfma_f32_16x16x32_bf16 v[144:147], v[64:67], v[92:95], v[144:147]
    ds_read_b128 v[52:55], v4 offset:2048
    v_mfma_f32_16x16x32_bf16 v[148:151], v[68:71], v[92:95], v[148:151]
    ds_read_b128 v[56:59], v4 offset:4096
    v_mfma_f32_16x16x32_bf16 v[116:119], v[68:71], v[88:91], v[116:119]
    ds_read_b128 v[60:63], v4 offset:6144
    v_mfma_f32_16x16x32_bf16 v[132:135], v[68:71], v[84:87], v[132:135]
    ds_read_b128 v[36:39], v2 offset:2048
    v_mfma_f32_16x16x32_bf16 v[100:103], v[68:71], v[80:83], v[100:103]
    ds_read_b128 v[40:43], v2 offset:4096
    v_mfma_f32_16x16x32_bf16 v[104:107], v[72:75], v[80:83], v[104:107]
    ds_read_b128 v[44:47], v2 offset:6144
    v_mfma_f32_16x16x32_bf16 v[136:139], v[72:75], v[84:87], v[136:139]
    v_mfma_f32_16x16x32_bf16 v[120:123], v[72:75], v[88:91], v[120:123]
    v_mfma_f32_16x16x32_bf16 v[152:155], v[72:75], v[92:95], v[152:155]
    v_mfma_f32_16x16x32_bf16 v[156:159], v[76:79], v[92:95], v[156:159]
    v_mfma_f32_16x16x32_bf16 v[124:127], v[76:79], v[88:91], v[124:127]
    v_mfma_f32_16x16x32_bf16 v[140:143], v[76:79], v[84:87], v[140:143]
    v_mfma_f32_16x16x32_bf16 v[108:111], v[76:79], v[80:83], v[108:111]
    s_add_u32 s35, s35, 1
    s_cmp_lt_u32 s35, 8
    s_cbranch_scc1 L1_loop
    s_sub_u32 s33, s26, 1
    v_sub_u32 v8, s33, v7
    v_lshlrev_b32 v8, 10, v8
    v_lshl_add_u32 v8, v6, 4, v8
    s_lshl_b32 s33, s31, 9
    v_add_u32 v192, s33, v8
    v_add_u32 v193, -4096, v192
    v_add_u32 v194, -8192, v192
    v_add_u32 v195, -12288, v192
    v_mov_b32 v9, 131072
    ds_read_b32 v30, v9 offset:20
    buffer_load_dwordx4 v[160:163], v192, s[36:39], 0 offen offset:0 sc1
    buffer_load_dwordx4 v[164:167], v192, s[36:39], 0 offen offset:256 sc1
    buffer_load_dwordx4 v[168:171], v193, s[36:39], 0 offen offset:0 sc1
    buffer_load_dwordx4 v[172:175], v193, s[36:39], 0 offen offset:256 sc1
    buffer_load_dwordx4 v[176:179], v194, s[36:39], 0 offen offset:0 sc1
    buffer_load_dwordx4 v[180:183], v194, s[36:39], 0 offen offset:256 sc1
    buffer_load_dwordx4 v[184:187], v195, s[36:39], 0 offen offset:0 sc1
    buffer_load_dwordx4 v[188:191], v195, s[36:39], 0 offen offset:256 sc1
    s_waitcnt lgkmcnt(0)
    v_readfirstlane_b32 s44, v30
    v_pk_fma_f32 v[98:99], v[10:11], v[96:97], v[98:99] op_sel_hi:[0,1,1]
    v_pk_fma_f32 v[130:131], v[10:11], v[128:129], v[130:131] op_sel:[1,0,0]
    v_pk_fma_f32 v[114:115], v[10:11], v[112:113], v[114:115] op_sel_hi:[0,1,1]
    v_pk_fma_f32 v[146:147], v[10:11], v[144:145], v[146:147] op_sel:[1,0,0]
    v_pk_fma_f32 v[98:99], v[12:13], v[112:113], v[98:99] op_sel_hi:[0,1,1] neg_lo:[1,0,0] neg_hi:[1,0,0]
    v_pk_fma_f32 v[130:131], v[12:13], v[144:145], v[130:131] op_sel:[1,0,0] neg_lo:[1,0,0] neg_hi:[1,0,0]
    v_pk_fma_f32 v[114:115], v[12:13], v[96:97], v[114:115] op_sel_hi:[0,1,1]
    v_pk_fma_f32 v[146:147], v[12:13], v[128:129], v[146:147] op_sel:[1,0,0]
    v_pk_fma_f32 v[100:101], v[10:11], v[98:99], v[100:101] op_sel_hi:[0,1,1]
    v_pk_fma_f32 v[132:133], v[10:11], v[130:131], v[132:133] op_sel:[1,0,0]
    v_pk_fma_f32 v[116:117], v[10:11], v[114:115], v[116:117] op_sel_hi:[0,1,1]
    v_pk_fma_f32 v[148:149], v[10:11], v[146:147], v[148:149] op_sel:[1,0,0]
    v_pk_fma_f32 v[100:101], v[12:13], v[114:115], v[100:101] op_sel_hi:[0,1,1] neg_lo:[1,0,0] neg_hi:[1,0,0]
    v_pk_fma_f32 v[132:133], v[12:13], v[146:147], v[132:133] op_sel:[1,0,0] neg_lo:[1,0,0] neg_hi:[1,0,0]
    v_pk_fma_f32 v[116:117], v[12:13], v[98:99], v[116:117] op_sel_hi:[0,1,1]
    v_pk_fma_f32 v[148:149], v[12:13], v[130:131], v[148:149] op_sel:[1,0,0]
    v_pk_fma_f32 v[102:103], v[10:11], v[100:101], v[102:103] op_sel_hi:[0,1,1]
    v_pk_fma_f32 v[134:135], v[10:11], v[132:133], v[134:135] op_sel:[1,0,0]
    v_pk_fma_f32 v[118:119], v[10:11], v[116:117], v[118:119] op_sel_hi:[0,1,1]
    v_pk_fma_f32 v[150:151], v[10:11], v[148:149], v[150:151] op_sel:[1,0,0]
    v_pk_fma_f32 v[102:103], v[12:13], v[116:117], v[102:103] op_sel_hi:[0,1,1] neg_lo:[1,0,0] neg_hi:[1,0,0]
    v_pk_fma_f32 v[134:135], v[12:13], v[148:149], v[134:135] op_sel:[1,0,0] neg_lo:[1,0,0] neg_hi:[1,0,0]
    v_pk_fma_f32 v[118:119], v[12:13], v[100:101], v[118:119] op_sel_hi:[0,1,1]
    v_pk_fma_f32 v[150:151], v[12:13], v[132:133], v[150:151] op_sel:[1,0,0]
    v_pk_fma_f32 v[104:105], v[10:11], v[102:103], v[104:105] op_sel_hi:[0,1,1]
    v_pk_fma_f32 v[136:137], v[10:11], v[134:135], v[136:137] op_sel:[1,0,0]
    v_pk_fma_f32 v[120:121], v[10:11], v[118:119], v[120:121] op_sel_hi:[0,1,1]
    v_pk_fma_f32 v[152:153], v[10:11], v[150:151], v[152:153] op_sel:[1,0,0]
    v_pk_fma_f32 v[104:105], v[12:13], v[118:119], v[104:105] op_sel_hi:[0,1,1] neg_lo:[1,0,0] neg_hi:[1,0,0]
    v_pk_fma_f32 v[136:137], v[12:13], v[150:151], v[136:137] op_sel:[1,0,0] neg_lo:[1,0,0] neg_hi:[1,0,0]
    v_pk_fma_f32 v[120:121], v[12:13], v[102:103], v[120:121] op_sel_hi:[0,1,1]
    v_pk_fma_f32 v[152:153], v[12:13], v[134:135], v[152:153] op_sel:[1,0,0]
    v_pk_fma_f32 v[106:107], v[10:11], v[104:105], v[106:107] op_sel_hi:[0,1,1]
    v_pk_fma_f32 v[138:139], v[10:11], v[136:137], v[138:139] op_sel:[1,0,0]
    v_pk_fma_f32 v[122:123], v[10:11], v[120:121], v[122:123] op_sel_hi:[0,1,1]
    v_pk_fma_f32 v[154:155], v[10:11], v[152:153], v[154:155] op_sel:[1,0,0]
    v_pk_fma_f32 v[106:107], v[12:13], v[120:121], v[106:107] op_sel_hi:[0,1,1] neg_lo:[1,0,0] neg_hi:[1,0,0]
    v_pk_fma_f32 v[138:139], v[12:13], v[152:153], v[138:139] op_sel:[1,0,0] neg_lo:[1,0,0] neg_hi:[1,0,0]
    v_pk_fma_f32 v[122:123], v[12:13], v[104:105], v[122:123] op_sel_hi:[0,1,1]
    v_pk_fma_f32 v[154:155], v[12:13], v[136:137], v[154:155] op_sel:[1,0,0]
    v_pk_fma_f32 v[108:109], v[10:11], v[106:107], v[108:109] op_sel_hi:[0,1,1]
    v_pk_fma_f32 v[140:141], v[10:11], v[138:139], v[140:141] op_sel:[1,0,0]
    v_pk_fma_f32 v[124:125], v[10:11], v[122:123], v[124:125] op_sel_hi:[0,1,1]
    v_pk_fma_f32 v[156:157], v[10:11], v[154:155], v[156:157] op_sel:[1,0,0]
    v_pk_fma_f32 v[108:109], v[12:13], v[122:123], v[108:109] op_sel_hi:[0,1,1] neg_lo:[1,0,0] neg_hi:[1,0,0]
    v_pk_fma_f32 v[140:141], v[12:13], v[154:155], v[140:141] op_sel:[1,0,0] neg_lo:[1,0,0] neg_hi:[1,0,0]
    v_pk_fma_f32 v[124:125], v[12:13], v[106:107], v[124:125] op_sel_hi:[0,1,1]
    v_pk_fma_f32 v[156:157], v[12:13], v[138:139], v[156:157] op_sel:[1,0,0]
    v_pk_fma_f32 v[110:111], v[10:11], v[108:109], v[110:111] op_sel_hi:[0,1,1]
    v_pk_fma_f32 v[142:143], v[10:11], v[140:141], v[142:143] op_sel:[1,0,0]
    v_pk_fma_f32 v[126:127], v[10:11], v[124:125], v[126:127] op_sel_hi:[0,1,1]
    v_pk_fma_f32 v[158:159], v[10:11], v[156:157], v[158:159] op_sel:[1,0,0]
    v_pk_fma_f32 v[110:111], v[12:13], v[124:125], v[110:111] op_sel_hi:[0,1,1] neg_lo:[1,0,0] neg_hi:[1,0,0]
    v_pk_fma_f32 v[142:143], v[12:13], v[156:157], v[142:143] op_sel:[1,0,0] neg_lo:[1,0,0] neg_hi:[1,0,0]
    v_pk_fma_f32 v[126:127], v[12:13], v[108:109], v[126:127] op_sel_hi:[0,1,1]
    v_pk_fma_f32 v[158:159], v[12:13], v[140:141], v[158:159] op_sel:[1,0,0]
    v_fma_f32 v26, v14, v110, v111
    v_fma_f32 v27, v14, v126, v127
    v_fma_f32 v26, -v16, v126, v26
    v_fma_f32 v27, v16, v110, v27
    v_fma_f32 v28, v15, v142, v143
    v_fma_f32 v29, v15, v158, v159
    v_fma_f32 v28, -v17, v158, v28
    v_fma_f32 v29, v17, v142, v29
    s_lshl_b32 s33, s31, 8
    s_add_u32 s33, s33, 132096
    v_lshl_add_u32 v30, v6, 3, s33
    s_lshl_b32 s33, s30, 11
    v_lshl_add_u32 v31, v7, 9, s33
    v_add_u32 v31, v31, v30
    ds_write_b64 v31, v[26:27]
    ds_write_b64 v31, v[28:29] offset:128
    s_lshl_b32 s33, s29, 2
    v_add_u32 v31, s33, v9
    s_xor_b32 s33, s33, 8
    v_add_u32 v9, s33, v9
    v_mov_b32 v8, 1
    ds_write_b32 v31, v8
    s_mov_b32 s45, 1048576
L1_expoll:
    ds_read_b32 v8, v9
    ds_read_b64 v[32:33], v30 offset:0
    ds_read_b64 v[34:35], v30 offset:128
    ds_read_b64 v[36:37], v30 offset:512
    ds_read_b64 v[38:39], v30 offset:640
    ds_read_b64 v[40:41], v30 offset:1024
    ds_read_b64 v[42:43], v30 offset:1152
    ds_read_b64 v[44:45], v30 offset:1536
    ds_read_b64 v[46:47], v30 offset:1664
    ds_read_b64 v[48:49], v30 offset:2048
    ds_read_b64 v[50:51], v30 offset:2176
    ds_read_b64 v[52:53], v30 offset:2560
    ds_read_b64 v[54:55], v30 offset:2688
    ds_read_b64 v[56:57], v30 offset:3072
    ds_read_b64 v[58:59], v30 offset:3200
    ds_read_b64 v[60:61], v30 offset:3584
    ds_read_b64 v[62:63], v30 offset:3712
    s_waitcnt lgkmcnt(0)
    v_readfirstlane_b32 s33, v8
    s_sub_u32 s45, s45, 1
    s_cbranch_scc1 L1_exok
    s_cmp_eq_u32 s33, 0
    s_cbranch_scc1 L1_expoll
L1_exok:
    v_pk_fma_f32 v[36:37], v[18:19], v[32:33], v[36:37] op_sel_hi:[0,1,1]
    v_pk_fma_f32 v[36:37], v[32:33], v[20:21], v[36:37] op_sel:[1,0,0] op_sel_hi:[0,0,1] neg_lo:[1,0,0]
    v_pk_fma_f32 v[38:39], v[18:19], v[34:35], v[38:39] op_sel:[1,0,0]
    v_pk_fma_f32 v[38:39], v[20:21], v[34:35], v[38:39] op_sel:[1,1,0] op_sel_hi:[1,0,1] neg_lo:[0,1,0]
    v_pk_fma_f32 v[40:41], v[18:19], v[36:37], v[40:41] op_sel_hi:[0,1,1]
    v_pk_fma_f32 v[40:41], v[36:37], v[20:21], v[40:41] op_sel:[1,0,0] op_sel_hi:[0,0,1] neg_lo:[1,0,0]
    v_pk_fma_f32 v[42:43], v[18:19], v[38:39], v[42:43] op_sel:[1,0,0]
    v_pk_fma_f32 v[42:43], v[20:21], v[38:39], v[42:43] op_sel:[1,1,0] op_sel_hi:[1,0,1] neg_lo:[0,1,0]
    v_pk_fma_f32 v[44:45], v[18:19], v[40:41], v[44:45] op_sel_hi:[0,1,1]
    v_pk_fma_f32 v[44:45], v[40:41], v[20:21], v[44:45] op_sel:[1,0,0] op_sel_hi:[0,0,1] neg_lo:[1,0,0]
    v_pk_fma_f32 v[46:47], v[18:19], v[42:43], v[46:47] op_sel:[1,0,0]
    v_pk_fma_f32 v[46:47], v[20:21], v[42:43], v[46:47] op_sel:[1,1,0] op_sel_hi:[1,0,1] neg_lo:[0,1,0]
    v_pk_fma_f32 v[48:49], v[18:19], v[44:45], v[48:49] op_sel_hi:[0,1,1]
    v_pk_fma_f32 v[48:49], v[44:45], v[20:21], v[48:49] op_sel:[1,0,0] op_sel_hi:[0,0,1] neg_lo:[1,0,0]
    v_pk_fma_f32 v[50:51], v[18:19], v[46:47], v[50:51] op_sel:[1,0,0]
    v_pk_fma_f32 v[50:51], v[20:21], v[46:47], v[50:51] op_sel:[1,1,0] op_sel_hi:[1,0,1] neg_lo:[0,1,0]
    v_pk_fma_f32 v[52:53], v[18:19], v[48:49], v[52:53] op_sel_hi:[0,1,1]
    v_pk_fma_f32 v[52:53], v[48:49], v[20:21], v[52:53] op_sel:[1,0,0] op_sel_hi:[0,0,1] neg_lo:[1,0,0]
    v_pk_fma_f32 v[54:55], v[18:19], v[50:51], v[54:55] op_sel:[1,0,0]
    v_pk_fma_f32 v[54:55], v[20:21], v[50:51], v[54:55] op_sel:[1,1,0] op_sel_hi:[1,0,1] neg_lo:[0,1,0]
    v_pk_fma_f32 v[56:57], v[18:19], v[52:53], v[56:57] op_sel_hi:[0,1,1]
    v_pk_fma_f32 v[56:57], v[52:53], v[20:21], v[56:57] op_sel:[1,0,0] op_sel_hi:[0,0,1] neg_lo:[1,0,0]
    v_pk_fma_f32 v[58:59], v[18:19], v[54:55], v[58:59] op_sel:[1,0,0]
    v_pk_fma_f32 v[58:59], v[20:21], v[54:55], v[58:59] op_sel:[1,1,0] op_sel_hi:[1,0,1] neg_lo:[0,1,0]
    v_pk_fma_f32 v[60:61], v[18:19], v[56:57], v[60:61] op_sel_hi:[0,1,1]
    v_pk_fma_f32 v[60:61], v[56:57], v[20:21], v[60:61] op_sel:[1,0,0] op_sel_hi:[0,0,1] neg_lo:[1,0,0]
    v_pk_fma_f32 v[62:63], v[18:19], v[58:59], v[62:63] op_sel:[1,0,0]
    v_pk_fma_f32 v[62:63], v[20:21], v[58:59], v[62:63] op_sel:[1,1,0] op_sel_hi:[1,0,1] neg_lo:[0,1,0]
    s_cmp_eq_u32 s30, 0
    s_cbranch_scc1 L1_nopub
    s_cmp_eq_u32 s26, 15
    s_cbranch_scc1 L1_nopub
    v_mov_b32 v26, v60
    v_mov_b32 v27, v61
    v_mov_b32 v28, s44
    v_mov_b32 v29, s44
    s_lshl_b32 s33, s26, 10
    s_lshl_b32 s34, s31, 9
    s_add_u32 s33, s33, s34
    v_lshlrev_b32 v8, 4, v1
    s_mov_b64 exec, 0xffff0000
    v_mov_b32 v26, v62
    v_mov_b32 v27, v63
    s_mov_b64 exec, 0xffffffff
    buffer_store_dwordx4 v[26:29], v8, s[36:39], s33 offen sc1
    s_mov_b64 exec, -1
L1_nopub:
    v_mov_b32 v60, 0
    v_mov_b32 v61, 0
    v_mov_b32 v62, 0
    v_mov_b32 v63, 0
    s_lshl_b32 s33, s30, 2
    v_add_u32 v8, s33, v7
    v_cmp_eq_u32 vcc, 1, v8
    s_nop 1
    v_cndmask_b32 v60, v60, v32, vcc
    v_cndmask_b32 v61, v61, v33, vcc
    v_cndmask_b32 v62, v62, v34, vcc
    v_cndmask_b32 v63, v63, v35, vcc
    v_cmp_eq_u32 vcc, 2, v8
    s_nop 1
    v_cndmask_b32 v60, v60, v36, vcc
    v_cndmask_b32 v61, v61, v37, vcc
    v_cndmask_b32 v62, v62, v38, vcc
    v_cndmask_b32 v63, v63, v39, vcc
    v_cmp_eq_u32 vcc, 3, v8
    s_nop 1
    v_cndmask_b32 v60, v60, v40, vcc
    v_cndmask_b32 v61, v61, v41, vcc
    v_cndmask_b32 v62, v62, v42, vcc
    v_cndmask_b32 v63, v63, v43, vcc
    v_cmp_eq_u32 vcc, 4, v8
    s_nop 1
    v_cndmask_b32 v60, v60, v44, vcc
    v_cndmask_b32 v61, v61, v45, vcc
    v_cndmask_b32 v62, v62, v46, vcc
    v_cndmask_b32 v63, v63, v47, vcc
    v_cmp_eq_u32 vcc, 5, v8
    s_nop 1
    v_cndmask_b32 v60, v60, v48, vcc
    v_cndmask_b32 v61, v61, v49, vcc
    v_cndmask_b32 v62, v62, v50, vcc
    v_cndmask_b32 v63, v63, v51, vcc
    v_cmp_eq_u32 vcc, 6, v8
    s_nop 1
    v_cndmask_b32 v60, v60, v52, vcc
    v_cndmask_b32 v61, v61, v53, vcc
    v_cndmask_b32 v62, v62, v54, vcc
    v_cndmask_b32 v63, v63, v55, vcc
    v_cmp_eq_u32 vcc, 7, v8
    s_nop 1
    v_cndmask_b32 v60, v60, v56, vcc
    v_cndmask_b32 v61, v61, v57, vcc
    v_cndmask_b32 v62, v62, v58, vcc
    v_cndmask_b32 v63, v63, v59, vcc
    v_and_b32 v9, 1, v8
    v_cmp_ne_u32 vcc, 0, v9
    s_nop 1
    v_cndmask_b32 v40, 1.0, v18, vcc
    v_cndmask_b32 v42, 0, v20, vcc
    v_cndmask_b32 v41, 1.0, v19, vcc
    v_cndmask_b32 v43, 0, v21, vcc
    v_pk_mul_f32 v[52:53], v[18:19], v[20:21]
    v_pk_mul_f32 v[32:33], v[18:19], v[18:19]
    v_pk_fma_f32 v[32:33], v[20:21], v[20:21], v[32:33] neg_lo:[1,0,0] neg_hi:[1,0,0]
    v_pk_add_f32 v[34:35], v[52:53], v[52:53]
    v_and_b32 v9, 2, v8
    v_cmp_ne_u32 vcc, 0, v9
    s_nop 1
    v_cndmask_b32 v54, 1.0, v32, vcc
    v_cndmask_b32 v56, 0, v34, vcc
    v_cndmask_b32 v55, 1.0, v33, vcc
    v_cndmask_b32 v57, 0, v35, vcc
    v_pk_mul_f32 v[44:45], v[40:41], v[54:55]
    v_pk_mul_f32 v[46:47], v[40:41], v[56:57]
    v_pk_fma_f32 v[44:45], v[42:43], v[56:57], v[44:45] neg_lo:[1,0,0] neg_hi:[1,0,0]
    v_pk_fma_f32 v[46:47], v[42:43], v[54:55], v[46:47]
    v_pk_mul_f32 v[52:53], v[32:33], v[34:35]
    v_pk_mul_f32 v[36:37], v[32:33], v[32:33]
    v_pk_fma_f32 v[36:37], v[34:35], v[34:35], v[36:37] neg_lo:[1,0,0] neg_hi:[1,0,0]
    v_pk_add_f32 v[38:39], v[52:53], v[52:53]
    v_and_b32 v9, 4, v8
    v_cmp_ne_u32 vcc, 0, v9
    s_nop 1
    v_cndmask_b32 v54, 1.0, v36, vcc
    v_cndmask_b32 v56, 0, v38, vcc
    v_cndmask_b32 v55, 1.0, v37, vcc
    v_cndmask_b32 v57, 0, v39, vcc
    v_pk_mul_f32 v[40:41], v[44:45], v[54:55]
    v_pk_mul_f32 v[42:43], v[44:45], v[56:57]
    v_pk_fma_f32 v[40:41], v[46:47], v[56:57], v[40:41] neg_lo:[1,0,0] neg_hi:[1,0,0]
    v_pk_fma_f32 v[42:43], v[46:47], v[54:55], v[42:43]
    v_pk_mul_f32 v[52:53], v[36:37], v[38:39]
    v_pk_mul_f32 v[32:33], v[36:37], v[36:37]
    v_pk_fma_f32 v[32:33], v[38:39], v[38:39], v[32:33] neg_lo:[1,0,0] neg_hi:[1,0,0]
    v_pk_add_f32 v[34:35], v[52:53], v[52:53]
    v_and_b32 v9, 1, v7
    v_cmp_ne_u32 vcc, 0, v9
    s_nop 1
    v_cndmask_b32 v26, 1.0, v32, vcc
    v_cndmask_b32 v28, 0, v34, vcc
    v_cndmask_b32 v27, 1.0, v33, vcc
    v_cndmask_b32 v29, 0, v35, vcc
    v_pk_mul_f32 v[52:53], v[32:33], v[34:35]
    v_pk_mul_f32 v[36:37], v[32:33], v[32:33]
    v_pk_fma_f32 v[36:37], v[34:35], v[34:35], v[36:37] neg_lo:[1,0,0] neg_hi:[1,0,0]
    v_pk_add_f32 v[38:39], v[52:53], v[52:53]
    v_and_b32 v9, 2, v7
    v_cmp_ne_u32 vcc, 0, v9
    s_nop 1
    v_cndmask_b32 v54, 1.0, v36, vcc
    v_cndmask_b32 v56, 0, v38, vcc
    v_cndmask_b32 v55, 1.0, v37, vcc
    v_cndmask_b32 v57, 0, v39, vcc
    v_pk_mul_f32 v[44:45], v[26:27], v[54:55]
    v_pk_mul_f32 v[46:47], v[26:27], v[56:57]
    v_pk_fma_f32 v[44:45], v[28:29], v[56:57], v[44:45] neg_lo:[1,0,0] neg_hi:[1,0,0]
    v_pk_fma_f32 v[46:47], v[28:29], v[54:55], v[46:47]
    v_pk_mul_f32 v[52:53], v[36:37], v[38:39]
    v_pk_mul_f32 v[48:49], v[36:37], v[36:37]
    v_pk_fma_f32 v[48:49], v[38:39], v[38:39], v[48:49] neg_lo:[1,0,0] neg_hi:[1,0,0]
    v_pk_add_f32 v[50:51], v[52:53], v[52:53]
    v_pk_mul_f32 v[32:33], v[40:41], v[14:15]
    v_pk_mul_f32 v[34:35], v[40:41], v[16:17]
    v_pk_fma_f32 v[32:33], v[42:43], v[16:17], v[32:33] neg_lo:[1,0,0] neg_hi:[1,0,0]
    v_pk_fma_f32 v[34:35], v[42:43], v[14:15], v[34:35]
    v_mov_b32 v18, v40
    v_mov_b32 v19, v32
    v_mov_b32 v36, v42
    v_mov_b32 v37, v34
    v_mov_b32 v20, v41
    v_mov_b32 v21, v33
    v_mov_b32 v38, v43
    v_mov_b32 v39, v35
    v_fma_f32 v33, v14, v60, v110
    v_fma_f32 v35, v14, v61, v126
    v_mov_b32 v32, v60
    v_mov_b32 v34, v61
    v_fma_f32 v33, -v16, v61, v33
    v_fma_f32 v35, v16, v60, v35
    v_fma_f32 v41, v15, v62, v142
    v_fma_f32 v43, v15, v63, v158
    v_mov_b32 v40, v62
    v_mov_b32 v42, v63
    v_fma_f32 v41, -v17, v63, v41
    v_fma_f32 v43, v17, v62, v43
    v_max_f32 v26, |v22|, |v24|
    v_rcp_f32 v28, v26
    v_max_f32 v27, |v23|, |v25|
    v_rcp_f32 v29, v27
    s_nop 0
    v_pk_mul_f32 v[22:23], v[22:23], v[28:29]
    v_pk_mul_f32 v[24:25], v[24:25], v[28:29]
    v_pk_mul_f32 v[28:29], v[22:23], v[22:23]
    v_pk_fma_f32 v[28:29], v[24:25], v[24:25], v[28:29]
    v_pk_mul_f32 v[28:29], v[28:29], v[26:27]
    v_rcp_f32 v28, v28
    v_add_f32 v26, -1.0, v10
    v_rcp_f32 v29, v29
    v_add_f32 v27, -1.0, v11
    v_pk_add_f32 v[28:29], v[28:29], v[28:29]
    v_pk_mul_f32 v[54:55], v[26:27], v[22:23]
    v_pk_mul_f32 v[56:57], v[12:13], v[22:23]
    v_pk_fma_f32 v[54:55], v[12:13], v[24:25], v[54:55]
    v_pk_fma_f32 v[56:57], v[26:27], v[24:25], v[56:57] neg_lo:[1,0,0] neg_hi:[1,0,0]
    v_pk_mul_f32 v[54:55], v[54:55], v[28:29]
    v_pk_mul_f32 v[56:57], v[56:57], v[28:29]
    v_mov_b32 v26, v54
    v_mov_b32 v27, v56
    v_mov_b32 v28, v55
    v_mov_b32 v29, v57
    v_pk_mul_f32 v[64:65], v[10:11], v[26:27] op_sel_hi:[0,1]
    v_pk_mul_f32 v[66:67], v[10:11], v[28:29] op_sel:[1,0]
    v_pk_fma_f32 v[64:65], v[26:27], v[12:13], v[64:65] op_sel:[1,0,0] op_sel_hi:[0,0,1] neg_lo:[1,0,0]
    v_pk_fma_f32 v[66:67], v[12:13], v[28:29], v[66:67] op_sel:[1,1,0] op_sel_hi:[1,0,1] neg_lo:[0,1,0]
    v_pk_mul_f32 v[68:69], v[10:11], v[64:65] op_sel_hi:[0,1]
    v_pk_mul_f32 v[70:71], v[10:11], v[66:67] op_sel:[1,0]
    v_pk_fma_f32 v[68:69], v[64:65], v[12:13], v[68:69] op_sel:[1,0,0] op_sel_hi:[0,0,1] neg_lo:[1,0,0]
    v_pk_fma_f32 v[70:71], v[12:13], v[66:67], v[70:71] op_sel:[1,1,0] op_sel_hi:[1,0,1] neg_lo:[0,1,0]
    v_pk_mul_f32 v[72:73], v[10:11], v[68:69] op_sel_hi:[0,1]
    v_pk_mul_f32 v[74:75], v[10:11], v[70:71] op_sel:[1,0]
    v_pk_fma_f32 v[72:73], v[68:69], v[12:13], v[72:73] op_sel:[1,0,0] op_sel_hi:[0,0,1] neg_lo:[1,0,0]
    v_pk_fma_f32 v[74:75], v[12:13], v[70:71], v[74:75] op_sel:[1,1,0] op_sel_hi:[1,0,1] neg_lo:[0,1,0]
    v_pk_mul_f32 v[76:77], v[10:11], v[72:73] op_sel_hi:[0,1]
    v_pk_mul_f32 v[78:79], v[10:11], v[74:75] op_sel:[1,0]
    v_pk_fma_f32 v[76:77], v[72:73], v[12:13], v[76:77] op_sel:[1,0,0] op_sel_hi:[0,0,1] neg_lo:[1,0,0]
    v_pk_fma_f32 v[78:79], v[12:13], v[74:75], v[78:79] op_sel:[1,1,0] op_sel_hi:[1,0,1] neg_lo:[0,1,0]
    v_pk_mul_f32 v[80:81], v[10:11], v[76:77] op_sel_hi:[0,1]
    v_pk_mul_f32 v[82:83], v[10:11], v[78:79] op_sel:[1,0]
    v_pk_fma_f32 v[80:81], v[76:77], v[12:13], v[80:81] op_sel:[1,0,0] op_sel_hi:[0,0,1] neg_lo:[1,0,0]
    v_pk_fma_f32 v[82:83], v[12:13], v[78:79], v[82:83] op_sel:[1,1,0] op_sel_hi:[1,0,1] neg_lo:[0,1,0]
    v_pk_mul_f32 v[84:85], v[10:11], v[80:81] op_sel_hi:[0,1]
    v_pk_mul_f32 v[86:87], v[10:11], v[82:83] op_sel:[1,0]
    v_pk_fma_f32 v[84:85], v[80:81], v[12:13], v[84:85] op_sel:[1,0,0] op_sel_hi:[0,0,1] neg_lo:[1,0,0]
    v_pk_fma_f32 v[86:87], v[12:13], v[82:83], v[86:87] op_sel:[1,1,0] op_sel_hi:[1,0,1] neg_lo:[0,1,0]
    v_pk_mul_f32 v[88:89], v[10:11], v[84:85] op_sel_hi:[0,1]
    v_pk_mul_f32 v[90:91], v[10:11], v[86:87] op_sel:[1,0]
    v_pk_fma_f32 v[88:89], v[84:85], v[12:13], v[88:89] op_sel:[1,0,0] op_sel_hi:[0,0,1] neg_lo:[1,0,0]
    v_pk_fma_f32 v[90:91], v[12:13], v[86:87], v[90:91] op_sel:[1,1,0] op_sel_hi:[1,0,1] neg_lo:[0,1,0]
    v_pk_mul_f32 v[92:93], v[10:11], v[88:89] op_sel_hi:[0,1]
    v_pk_mul_f32 v[94:95], v[10:11], v[90:91] op_sel:[1,0]
    v_pk_fma_f32 v[92:93], v[88:89], v[12:13], v[92:93] op_sel:[1,0,0] op_sel_hi:[0,0,1] neg_lo:[1,0,0]
    v_pk_fma_f32 v[94:95], v[12:13], v[90:91], v[94:95] op_sel:[1,1,0] op_sel_hi:[1,0,1] neg_lo:[0,1,0]
    v_pk_mul_f32 v[26:27], v[56:57], v[96:97] op_sel_hi:[0,1] neg_lo:[1,0] neg_hi:[1,0]
    v_pk_mul_f32 v[96:97], v[54:55], v[96:97] op_sel_hi:[0,1]
    v_pk_fma_f32 v[96:97], v[56:57], v[112:113], v[96:97] op_sel_hi:[0,1,1] neg_lo:[1,0,0] neg_hi:[1,0,0]
    v_pk_fma_f32 v[112:113], v[54:55], v[112:113], v[26:27] op_sel_hi:[0,1,1] neg_lo:[1,0,0] neg_hi:[1,0,0]
    v_pk_mul_f32 v[28:29], v[56:57], v[128:129] op_sel:[1,0] neg_lo:[1,0] neg_hi:[1,0]
    v_pk_mul_f32 v[128:129], v[54:55], v[128:129] op_sel:[1,0]
    v_pk_fma_f32 v[128:129], v[56:57], v[144:145], v[128:129] op_sel:[1,0,0] neg_lo:[1,0,0] neg_hi:[1,0,0]
    v_pk_fma_f32 v[144:145], v[54:55], v[144:145], v[28:29] op_sel:[1,0,0] neg_lo:[1,0,0] neg_hi:[1,0,0]
    v_pk_mul_f32 v[26:27], v[56:57], v[98:99] op_sel_hi:[0,1] neg_lo:[1,0] neg_hi:[1,0]
    v_pk_mul_f32 v[98:99], v[54:55], v[98:99] op_sel_hi:[0,1]
    v_pk_fma_f32 v[98:99], v[56:57], v[114:115], v[98:99] op_sel_hi:[0,1,1] neg_lo:[1,0,0] neg_hi:[1,0,0]
    v_pk_fma_f32 v[114:115], v[54:55], v[114:115], v[26:27] op_sel_hi:[0,1,1] neg_lo:[1,0,0] neg_hi:[1,0,0]
    v_pk_mul_f32 v[28:29], v[56:57], v[130:131] op_sel:[1,0] neg_lo:[1,0] neg_hi:[1,0]
    v_pk_mul_f32 v[130:131], v[54:55], v[130:131] op_sel:[1,0]
    v_pk_fma_f32 v[130:131], v[56:57], v[146:147], v[130:131] op_sel:[1,0,0] neg_lo:[1,0,0] neg_hi:[1,0,0]
    v_pk_fma_f32 v[146:147], v[54:55], v[146:147], v[28:29] op_sel:[1,0,0] neg_lo:[1,0,0] neg_hi:[1,0,0]
    v_pk_mul_f32 v[26:27], v[56:57], v[100:101] op_sel_hi:[0,1] neg_lo:[1,0] neg_hi:[1,0]
    v_pk_mul_f32 v[100:101], v[54:55], v[100:101] op_sel_hi:[0,1]
    v_pk_fma_f32 v[100:101], v[56:57], v[116:117], v[100:101] op_sel_hi:[0,1,1] neg_lo:[1,0,0] neg_hi:[1,0,0]
    v_pk_fma_f32 v[116:117], v[54:55], v[116:117], v[26:27] op_sel_hi:[0,1,1] neg_lo:[1,0,0] neg_hi:[1,0,0]
    v_pk_mul_f32 v[28:29], v[56:57], v[132:133] op_sel:[1,0] neg_lo:[1,0] neg_hi:[1,0]
    v_pk_mul_f32 v[132:133], v[54:55], v[132:133] op_sel:[1,0]
    v_pk_fma_f32 v[132:133], v[56:57], v[148:149], v[132:133] op_sel:[1,0,0] neg_lo:[1,0,0] neg_hi:[1,0,0]
    v_pk_fma_f32 v[148:149], v[54:55], v[148:149], v[28:29] op_sel:[1,0,0] neg_lo:[1,0,0] neg_hi:[1,0,0]
    v_pk_mul_f32 v[26:27], v[56:57], v[102:103] op_sel_hi:[0,1] neg_lo:[1,0] neg_hi:[1,0]
    v_pk_mul_f32 v[102:103], v[54:55], v[102:103] op_sel_hi:[0,1]
    v_pk_fma_f32 v[102:103], v[56:57], v[118:119], v[102:103] op_sel_hi:[0,1,1] neg_lo:[1,0,0] neg_hi:[1,0,0]
    v_pk_fma_f32 v[118:119], v[54:55], v[118:119], v[26:27] op_sel_hi:[0,1,1] neg_lo:[1,0,0] neg_hi:[1,0,0]
    v_pk_mul_f32 v[28:29], v[56:57], v[134:135] op_sel:[1,0] neg_lo:[1,0] neg_hi:[1,0]
    v_pk_mul_f32 v[134:135], v[54:55], v[134:135] op_sel:[1,0]
    v_pk_fma_f32 v[134:135], v[56:57], v[150:151], v[134:135] op_sel:[1,0,0] neg_lo:[1,0,0] neg_hi:[1,0,0]
    v_pk_fma_f32 v[150:151], v[54:55], v[150:151], v[28:29] op_sel:[1,0,0] neg_lo:[1,0,0] neg_hi:[1,0,0]
    v_pk_mul_f32 v[26:27], v[56:57], v[104:105] op_sel_hi:[0,1] neg_lo:[1,0] neg_hi:[1,0]
    v_pk_mul_f32 v[104:105], v[54:55], v[104:105] op_sel_hi:[0,1]
    v_pk_fma_f32 v[104:105], v[56:57], v[120:121], v[104:105] op_sel_hi:[0,1,1] neg_lo:[1,0,0] neg_hi:[1,0,0]
    v_pk_fma_f32 v[120:121], v[54:55], v[120:121], v[26:27] op_sel_hi:[0,1,1] neg_lo:[1,0,0] neg_hi:[1,0,0]
    v_pk_mul_f32 v[28:29], v[56:57], v[136:137] op_sel:[1,0] neg_lo:[1,0] neg_hi:[1,0]
    v_pk_mul_f32 v[136:137], v[54:55], v[136:137] op_sel:[1,0]
    v_pk_fma_f32 v[136:137], v[56:57], v[152:153], v[136:137] op_sel:[1,0,0] neg_lo:[1,0,0] neg_hi:[1,0,0]
    v_pk_fma_f32 v[152:153], v[54:55], v[152:153], v[28:29] op_sel:[1,0,0] neg_lo:[1,0,0] neg_hi:[1,0,0]
    v_pk_mul_f32 v[26:27], v[56:57], v[106:107] op_sel_hi:[0,1] neg_lo:[1,0] neg_hi:[1,0]
    v_pk_mul_f32 v[106:107], v[54:55], v[106:107] op_sel_hi:[0,1]
    v_pk_fma_f32 v[106:107], v[56:57], v[122:123], v[106:107] op_sel_hi:[0,1,1] neg_lo:[1,0,0] neg_hi:[1,0,0]
    v_pk_fma_f32 v[122:123], v[54:55], v[122:123], v[26:27] op_sel_hi:[0,1,1] neg_lo:[1,0,0] neg_hi:[1,0,0]
    v_pk_mul_f32 v[28:29], v[56:57], v[138:139] op_sel:[1,0] neg_lo:[1,0] neg_hi:[1,0]
    v_pk_mul_f32 v[138:139], v[54:55], v[138:139] op_sel:[1,0]
    v_pk_fma_f32 v[138:139], v[56:57], v[154:155], v[138:139] op_sel:[1,0,0] neg_lo:[1,0,0] neg_hi:[1,0,0]
    v_pk_fma_f32 v[154:155], v[54:55], v[154:155], v[28:29] op_sel:[1,0,0] neg_lo:[1,0,0] neg_hi:[1,0,0]
    v_pk_mul_f32 v[26:27], v[56:57], v[108:109] op_sel_hi:[0,1] neg_lo:[1,0] neg_hi:[1,0]
    v_pk_mul_f32 v[108:109], v[54:55], v[108:109] op_sel_hi:[0,1]
    v_pk_fma_f32 v[108:109], v[56:57], v[124:125], v[108:109] op_sel_hi:[0,1,1] neg_lo:[1,0,0] neg_hi:[1,0,0]
    v_pk_fma_f32 v[124:125], v[54:55], v[124:125], v[26:27] op_sel_hi:[0,1,1] neg_lo:[1,0,0] neg_hi:[1,0,0]
    v_pk_mul_f32 v[28:29], v[56:57], v[140:141] op_sel:[1,0] neg_lo:[1,0] neg_hi:[1,0]
    v_pk_mul_f32 v[140:141], v[54:55], v[140:141] op_sel:[1,0]
    v_pk_fma_f32 v[140:141], v[56:57], v[156:157], v[140:141] op_sel:[1,0,0] neg_lo:[1,0,0] neg_hi:[1,0,0]
    v_pk_fma_f32 v[156:157], v[54:55], v[156:157], v[28:29] op_sel:[1,0,0] neg_lo:[1,0,0] neg_hi:[1,0,0]
    v_pk_mul_f32 v[26:27], v[56:57], v[110:111] op_sel_hi:[0,1] neg_lo:[1,0] neg_hi:[1,0]
    v_pk_mul_f32 v[110:111], v[54:55], v[110:111] op_sel_hi:[0,1]
    v_pk_fma_f32 v[110:111], v[56:57], v[126:127], v[110:111] op_sel_hi:[0,1,1] neg_lo:[1,0,0] neg_hi:[1,0,0]
    v_pk_fma_f32 v[126:127], v[54:55], v[126:127], v[26:27] op_sel_hi:[0,1,1] neg_lo:[1,0,0] neg_hi:[1,0,0]
    v_pk_mul_f32 v[28:29], v[56:57], v[142:143] op_sel:[1,0] neg_lo:[1,0] neg_hi:[1,0]
    v_pk_mul_f32 v[142:143], v[54:55], v[142:143] op_sel:[1,0]
    v_pk_fma_f32 v[142:143], v[56:57], v[158:159], v[142:143] op_sel:[1,0,0] neg_lo:[1,0,0] neg_hi:[1,0,0]
    v_pk_fma_f32 v[158:159], v[54:55], v[158:159], v[28:29] op_sel:[1,0,0] neg_lo:[1,0,0] neg_hi:[1,0,0]
    v_mov_b32 v9, s44
    v_cmp_le_i32 vcc, 0, v192
    s_nop 1
    v_cndmask_b32 v22, 0, v9, vcc
    v_cndmask_b32 v23, 0, v9, vcc
    v_cmp_le_i32 vcc, 0, v193
    s_nop 1
    v_cndmask_b32 v24, 0, v9, vcc
    v_cndmask_b32 v25, 0, v9, vcc
    v_cmp_le_i32 vcc, 0, v194
    s_nop 1
    v_cndmask_b32 v14, 0, v9, vcc
    v_cndmask_b32 v15, 0, v9, vcc
    v_cmp_le_i32 vcc, 0, v195
    s_nop 1
    v_cndmask_b32 v16, 0, v9, vcc
    v_cndmask_b32 v17, 0, v9, vcc
    s_lshl_b32 s33, s29, 13
    s_add_u32 s33, s33, 65536
    v_lshrrev_b32 v8, 1, v6
    v_and_b32 v8, 4, v8
    v_and_b32 v9, 7, v6
    v_xor_b32 v8, v8, v9
    v_lshlrev_b32 v9, 1, v7
    v_xor_b32 v8, v8, v9
    v_lshlrev_b32 v8, 4, v8
    v_lshl_add_u32 v8, v6, 7, v8
    v_add_u32 v2, s33, v8
    v_xor_b32 v3, 16, v2
    v_bfe_u32 v8, v1, 2, 2
    v_bfe_u32 v9, v1, 1, 1
    v_xor_b32 v9, v9, v8
    v_and_b32 v4, 1, v7
    v_lshlrev_b32 v4, 2, v4
    v_xor_b32 v9, v9, v4
    v_lshlrev_b32 v9, 4, v9
    v_lshl_add_u32 v8, v7, 3, v8
    v_lshl_add_u32 v9, v8, 7, v9
    v_and_b32 v8, 1, v1
    v_lshl_add_u32 v9, v8, 3, v9
    v_add_u32 v4, s33, v9
    v_xor_b32 v5, 32, v4
    v_xor_b32 v30, 64, v4
    v_xor_b32 v31, 96, v4
    v_lshlrev_b32 v196, 4, v1
    s_mov_b32 s45, 1048576
L1_lbpoll:
    s_waitcnt vmcnt(0)
    v_cmp_ne_u64 s[46:47], v[162:163], v[22:23]
    v_cmp_ne_u64 s[48:49], v[166:167], v[22:23]
    v_cmp_ne_u64 s[50:51], v[170:171], v[24:25]
    v_cmp_ne_u64 s[52:53], v[174:175], v[24:25]
    v_cmp_ne_u64 s[54:55], v[178:179], v[14:15]
    v_cmp_ne_u64 s[56:57], v[182:183], v[14:15]
    v_cmp_ne_u64 s[58:59], v[186:187], v[16:17]
    v_cmp_ne_u64 s[60:61], v[190:191], v[16:17]
    s_or_b64 s[46:47], s[46:47], s[48:49]
    s_or_b64 s[50:51], s[50:51], s[52:53]
    s_or_b64 s[54:55], s[54:55], s[56:57]
    s_or_b64 s[58:59], s[58:59], s[60:61]
    s_or_b64 s[46:47], s[46:47], s[50:51]
    s_or_b64 s[54:55], s[54:55], s[58:59]
    s_or_b64 s[46:47], s[46:47], s[54:55]
    s_cbranch_scc0 L1_lbok
    s_sub_u32 s45, s45, 1
    s_cbranch_scc1 L1_lbok
    buffer_load_dwordx4 v[160:163], v192, s[36:39], 0 offen offset:0 sc1
    buffer_load_dwordx4 v[164:167], v192, s[36:39], 0 offen offset:256 sc1
    buffer_load_dwordx4 v[168:171], v193, s[36:39], 0 offen offset:0 sc1
    buffer_load_dwordx4 v[172:175], v193, s[36:39], 0 offen offset:256 sc1
    buffer_load_dwordx4 v[176:179], v194, s[36:39], 0 offen offset:0 sc1
    buffer_load_dwordx4 v[180:183], v194, s[36:39], 0 offen offset:256 sc1
    buffer_load_dwordx4 v[184:187], v195, s[36:39], 0 offen offset:0 sc1
    buffer_load_dwordx4 v[188:191], v195, s[36:39], 0 offen offset:256 sc1
    s_branch L1_lbpoll
L1_lbok:
    v_pk_fma_f32 v[176:177], v[48:49], v[184:185], v[176:177] op_sel_hi:[0,1,1]
    v_pk_fma_f32 v[176:177], v[184:185], v[50:51], v[176:177] op_sel:[1,0,0] op_sel_hi:[0,0,1] neg_lo:[1,0,0]
    v_pk_fma_f32 v[180:181], v[48:49], v[188:189], v[180:181] op_sel:[1,0,0]
    v_pk_fma_f32 v[180:181], v[50:51], v[188:189], v[180:181] op_sel:[1,1,0] op_sel_hi:[1,0,1] neg_lo:[0,1,0]
    v_pk_fma_f32 v[168:169], v[48:49], v[176:177], v[168:169] op_sel_hi:[0,1,1]
    v_pk_fma_f32 v[168:169], v[176:177], v[50:51], v[168:169] op_sel:[1,0,0] op_sel_hi:[0,0,1] neg_lo:[1,0,0]
    v_pk_fma_f32 v[172:173], v[48:49], v[180:181], v[172:173] op_sel:[1,0,0]
    v_pk_fma_f32 v[172:173], v[50:51], v[180:181], v[172:173] op_sel:[1,1,0] op_sel_hi:[1,0,1] neg_lo:[0,1,0]
    v_pk_fma_f32 v[160:161], v[48:49], v[168:169], v[160:161] op_sel_hi:[0,1,1]
    v_pk_fma_f32 v[160:161], v[168:169], v[50:51], v[160:161] op_sel:[1,0,0] op_sel_hi:[0,0,1] neg_lo:[1,0,0]
    v_pk_fma_f32 v[164:165], v[48:49], v[172:173], v[164:165] op_sel:[1,0,0]
    v_pk_fma_f32 v[164:165], v[50:51], v[172:173], v[164:165] op_sel:[1,1,0] op_sel_hi:[1,0,1] neg_lo:[0,1,0]
    v_pk_mul_f32 v[168:169], v[44:45], v[160:161] op_sel_hi:[0,1]
    v_pk_mul_f32 v[172:173], v[44:45], v[164:165] op_sel:[1,0]
    v_pk_fma_f32 v[168:169], v[160:161], v[46:47], v[168:169] op_sel:[1,0,0] op_sel_hi:[0,0,1] neg_lo:[1,0,0]
    v_pk_fma_f32 v[172:173], v[46:47], v[164:165], v[172:173] op_sel:[1,1,0] op_sel_hi:[1,0,1] neg_lo:[0,1,0]
    v_mov_b32 v170, v168
    v_mov_b32 v171, v169
    v_mov_b32 v174, v172
    v_mov_b32 v175, v173
    v_permlane16_swap_b32 v168, v170
    v_permlane16_swap_b32 v169, v171
    v_permlane16_swap_b32 v172, v174
    v_permlane16_swap_b32 v173, v175
    v_pk_add_f32 v[168:169], v[168:169], v[170:171]
    v_pk_add_f32 v[172:173], v[172:173], v[174:175]
    v_mov_b32 v170, v168
    v_mov_b32 v171, v169
    v_mov_b32 v174, v172
    v_mov_b32 v175, v173
    v_permlane32_swap_b32 v168, v170
    v_permlane32_swap_b32 v169, v171
    v_permlane32_swap_b32 v172, v174
    v_permlane32_swap_b32 v173, v175
    v_pk_add_f32 v[168:169], v[168:169], v[170:171]
    v_pk_add_f32 v[172:173], v[172:173], v[174:175]
    v_pk_fma_f32 v[32:33], v[18:19], v[168:169], v[32:33] op_sel_hi:[1,0,1]
    v_pk_fma_f32 v[34:35], v[168:169], v[18:19], v[34:35] op_sel:[1,0,0]
    v_pk_fma_f32 v[40:41], v[20:21], v[172:173], v[40:41] op_sel_hi:[1,0,1]
    v_pk_fma_f32 v[42:43], v[172:173], v[20:21], v[42:43] op_sel:[1,0,0]
    v_pk_fma_f32 v[32:33], v[168:169], v[36:37], v[32:33] op_sel:[1,0,0] neg_lo:[1,0,0] neg_hi:[1,0,0]
    v_pk_fma_f32 v[34:35], v[36:37], v[168:169], v[34:35] op_sel_hi:[1,0,1]
    v_pk_fma_f32 v[40:41], v[172:173], v[38:39], v[40:41] op_sel:[1,0,0] neg_lo:[1,0,0] neg_hi:[1,0,0]
    v_pk_fma_f32 v[42:43], v[38:39], v[172:173], v[42:43] op_sel_hi:[1,0,1]
    v_pk_fma_f32 v[96:97], v[64:65], v[32:33], v[96:97] op_sel_hi:[0,1,1]
    v_pk_fma_f32 v[112:113], v[64:65], v[34:35], v[112:113] op_sel_hi:[0,1,1] neg_lo:[1,0,0] neg_hi:[1,0,0]
    v_pk_fma_f32 v[96:97], v[64:65], v[34:35], v[96:97] op_sel:[1,0,0] neg_lo:[1,0,0] neg_hi:[1,0,0]
    v_pk_fma_f32 v[112:113], v[64:65], v[32:33], v[112:113] op_sel:[1,0,0] neg_lo:[1,0,0] neg_hi:[1,0,0]
    v_pk_fma_f32 v[98:99], v[68:69], v[32:33], v[98:99] op_sel_hi:[0,1,1]
    v_pk_fma_f32 v[114:115], v[68:69], v[34:35], v[114:115] op_sel_hi:[0,1,1] neg_lo:[1,0,0] neg_hi:[1,0,0]
    v_pk_fma_f32 v[98:99], v[68:69], v[34:35], v[98:99] op_sel:[1,0,0] neg_lo:[1,0,0] neg_hi:[1,0,0]
    v_pk_fma_f32 v[114:115], v[68:69], v[32:33], v[114:115] op_sel:[1,0,0] neg_lo:[1,0,0] neg_hi:[1,0,0]
    v_pk_fma_f32 v[100:101], v[72:73], v[32:33], v[100:101] op_sel_hi:[0,1,1]
    v_pk_fma_f32 v[116:117], v[72:73], v[34:35], v[116:117] op_sel_hi:[0,1,1] neg_lo:[1,0,0] neg_hi:[1,0,0]
    v_pk_fma_f32 v[100:101], v[72:73], v[34:35], v[100:101] op_sel:[1,0,0] neg_lo:[1,0,0] neg_hi:[1,0,0]
    v_pk_fma_f32 v[116:117], v[72:73], v[32:33], v[116:117] op_sel:[1,0,0] neg_lo:[1,0,0] neg_hi:[1,0,0]
    v_pk_fma_f32 v[102:103], v[76:77], v[32:33], v[102:103] op_sel_hi:[0,1,1]
    v_pk_fma_f32 v[118:119], v[76:77], v[34:35], v[118:119] op_sel_hi:[0,1,1] neg_lo:[1,0,0] neg_hi:[1,0,0]
    v_pk_fma_f32 v[102:103], v[76:77], v[34:35], v[102:103] op_sel:[1,0,0] neg_lo:[1,0,0] neg_hi:[1,0,0]
    v_pk_fma_f32 v[118:119], v[76:77], v[32:33], v[118:119] op_sel:[1,0,0] neg_lo:[1,0,0] neg_hi:[1,0,0]
    v_pk_fma_f32 v[104:105], v[80:81], v[32:33], v[104:105] op_sel_hi:[0,1,1]
    v_pk_fma_f32 v[120:121], v[80:81], v[34:35], v[120:121] op_sel_hi:[0,1,1] neg_lo:[1,0,0] neg_hi:[1,0,0]
    v_pk_fma_f32 v[104:105], v[80:81], v[34:35], v[104:105] op_sel:[1,0,0] neg_lo:[1,0,0] neg_hi:[1,0,0]
    v_pk_fma_f32 v[120:121], v[80:81], v[32:33], v[120:121] op_sel:[1,0,0] neg_lo:[1,0,0] neg_hi:[1,0,0]
    v_pk_fma_f32 v[106:107], v[84:85], v[32:33], v[106:107] op_sel_hi:[0,1,1]
    v_pk_fma_f32 v[122:123], v[84:85], v[34:35], v[122:123] op_sel_hi:[0,1,1] neg_lo:[1,0,0] neg_hi:[1,0,0]
    v_pk_fma_f32 v[106:107], v[84:85], v[34:35], v[106:107] op_sel:[1,0,0] neg_lo:[1,0,0] neg_hi:[1,0,0]
    v_pk_fma_f32 v[122:123], v[84:85], v[32:33], v[122:123] op_sel:[1,0,0] neg_lo:[1,0,0] neg_hi:[1,0,0]
    v_pk_fma_f32 v[108:109], v[88:89], v[32:33], v[108:109] op_sel_hi:[0,1,1]
    v_pk_fma_f32 v[124:125], v[88:89], v[34:35], v[124:125] op_sel_hi:[0,1,1] neg_lo:[1,0,0] neg_hi:[1,0,0]
    v_pk_fma_f32 v[108:109], v[88:89], v[34:35], v[108:109] op_sel:[1,0,0] neg_lo:[1,0,0] neg_hi:[1,0,0]
    v_pk_fma_f32 v[124:125], v[88:89], v[32:33], v[124:125] op_sel:[1,0,0] neg_lo:[1,0,0] neg_hi:[1,0,0]
    v_pk_fma_f32 v[110:111], v[92:93], v[32:33], v[110:111] op_sel_hi:[0,1,1]
    v_pk_fma_f32 v[126:127], v[92:93], v[34:35], v[126:127] op_sel_hi:[0,1,1] neg_lo:[1,0,0] neg_hi:[1,0,0]
    v_pk_fma_f32 v[110:111], v[92:93], v[34:35], v[110:111] op_sel:[1,0,0] neg_lo:[1,0,0] neg_hi:[1,0,0]
    v_pk_fma_f32 v[126:127], v[92:93], v[32:33], v[126:127] op_sel:[1,0,0] neg_lo:[1,0,0] neg_hi:[1,0,0]
    v_cvt_pk_bf16_f32 v160, v96, v98
    v_cvt_pk_bf16_f32 v161, v100, v102
    v_cvt_pk_bf16_f32 v162, v104, v106
    v_cvt_pk_bf16_f32 v163, v108, v110
    ds_write_b128 v2, v[160:163] offset:0
    v_cvt_pk_bf16_f32 v164, v97, v99
    v_cvt_pk_bf16_f32 v165, v101, v103
    v_cvt_pk_bf16_f32 v166, v105, v107
    v_cvt_pk_bf16_f32 v167, v109, v111
    ds_write_b128 v3, v[164:167] offset:0
    v_cvt_pk_bf16_f32 v176, v112, v114
    v_cvt_pk_bf16_f32 v177, v116, v118
    v_cvt_pk_bf16_f32 v178, v120, v122
    v_cvt_pk_bf16_f32 v179, v124, v126
    ds_write_b128 v2, v[176:179] offset:4096
    v_cvt_pk_bf16_f32 v180, v113, v115
    v_cvt_pk_bf16_f32 v181, v117, v119
    v_cvt_pk_bf16_f32 v182, v121, v123
    v_cvt_pk_bf16_f32 v183, v125, v127
    ds_write_b128 v3, v[180:183] offset:4096
    v_pk_fma_f32 v[128:129], v[66:67], v[40:41], v[128:129] op_sel_hi:[0,1,1]
    v_pk_fma_f32 v[144:145], v[66:67], v[42:43], v[144:145] op_sel_hi:[0,1,1] neg_lo:[1,0,0] neg_hi:[1,0,0]
    v_pk_fma_f32 v[128:129], v[66:67], v[42:43], v[128:129] op_sel:[1,0,0] neg_lo:[1,0,0] neg_hi:[1,0,0]
    v_pk_fma_f32 v[144:145], v[66:67], v[40:41], v[144:145] op_sel:[1,0,0] neg_lo:[1,0,0] neg_hi:[1,0,0]
    v_pk_fma_f32 v[130:131], v[70:71], v[40:41], v[130:131] op_sel_hi:[0,1,1]
    v_pk_fma_f32 v[146:147], v[70:71], v[42:43], v[146:147] op_sel_hi:[0,1,1] neg_lo:[1,0,0] neg_hi:[1,0,0]
    v_pk_fma_f32 v[130:131], v[70:71], v[42:43], v[130:131] op_sel:[1,0,0] neg_lo:[1,0,0] neg_hi:[1,0,0]
    v_pk_fma_f32 v[146:147], v[70:71], v[40:41], v[146:147] op_sel:[1,0,0] neg_lo:[1,0,0] neg_hi:[1,0,0]
    v_pk_fma_f32 v[132:133], v[74:75], v[40:41], v[132:133] op_sel_hi:[0,1,1]
    v_pk_fma_f32 v[148:149], v[74:75], v[42:43], v[148:149] op_sel_hi:[0,1,1] neg_lo:[1,0,0] neg_hi:[1,0,0]
    v_pk_fma_f32 v[132:133], v[74:75], v[42:43], v[132:133] op_sel:[1,0,0] neg_lo:[1,0,0] neg_hi:[1,0,0]
    v_pk_fma_f32 v[148:149], v[74:75], v[40:41], v[148:149] op_sel:[1,0,0] neg_lo:[1,0,0] neg_hi:[1,0,0]
    v_pk_fma_f32 v[134:135], v[78:79], v[40:41], v[134:135] op_sel_hi:[0,1,1]
    v_pk_fma_f32 v[150:151], v[78:79], v[42:43], v[150:151] op_sel_hi:[0,1,1] neg_lo:[1,0,0] neg_hi:[1,0,0]
    v_pk_fma_f32 v[134:135], v[78:79], v[42:43], v[134:135] op_sel:[1,0,0] neg_lo:[1,0,0] neg_hi:[1,0,0]
    v_pk_fma_f32 v[150:151], v[78:79], v[40:41], v[150:151] op_sel:[1,0,0] neg_lo:[1,0,0] neg_hi:[1,0,0]
    v_pk_fma_f32 v[136:137], v[82:83], v[40:41], v[136:137] op_sel_hi:[0,1,1]
    v_pk_fma_f32 v[152:153], v[82:83], v[42:43], v[152:153] op_sel_hi:[0,1,1] neg_lo:[1,0,0] neg_hi:[1,0,0]
    v_pk_fma_f32 v[136:137], v[82:83], v[42:43], v[136:137] op_sel:[1,0,0] neg_lo:[1,0,0] neg_hi:[1,0,0]
    v_pk_fma_f32 v[152:153], v[82:83], v[40:41], v[152:153] op_sel:[1,0,0] neg_lo:[1,0,0] neg_hi:[1,0,0]
    v_pk_fma_f32 v[138:139], v[86:87], v[40:41], v[138:139] op_sel_hi:[0,1,1]
    v_pk_fma_f32 v[154:155], v[86:87], v[42:43], v[154:155] op_sel_hi:[0,1,1] neg_lo:[1,0,0] neg_hi:[1,0,0]
    v_pk_fma_f32 v[138:139], v[86:87], v[42:43], v[138:139] op_sel:[1,0,0] neg_lo:[1,0,0] neg_hi:[1,0,0]
    v_pk_fma_f32 v[154:155], v[86:87], v[40:41], v[154:155] op_sel:[1,0,0] neg_lo:[1,0,0] neg_hi:[1,0,0]
    v_pk_fma_f32 v[140:141], v[90:91], v[40:41], v[140:141] op_sel_hi:[0,1,1]
    v_pk_fma_f32 v[156:157], v[90:91], v[42:43], v[156:157] op_sel_hi:[0,1,1] neg_lo:[1,0,0] neg_hi:[1,0,0]
    v_pk_fma_f32 v[140:141], v[90:91], v[42:43], v[140:141] op_sel:[1,0,0] neg_lo:[1,0,0] neg_hi:[1,0,0]
    v_pk_fma_f32 v[156:157], v[90:91], v[40:41], v[156:157] op_sel:[1,0,0] neg_lo:[1,0,0] neg_hi:[1,0,0]
    v_pk_fma_f32 v[142:143], v[94:95], v[40:41], v[142:143] op_sel_hi:[0,1,1]
    v_pk_fma_f32 v[158:159], v[94:95], v[42:43], v[158:159] op_sel_hi:[0,1,1] neg_lo:[1,0,0] neg_hi:[1,0,0]
    v_pk_fma_f32 v[142:143], v[94:95], v[42:43], v[142:143] op_sel:[1,0,0] neg_lo:[1,0,0] neg_hi:[1,0,0]
    v_pk_fma_f32 v[158:159], v[94:95], v[40:41], v[158:159] op_sel:[1,0,0] neg_lo:[1,0,0] neg_hi:[1,0,0]
    v_cvt_pk_bf16_f32 v168, v128, v130
    v_cvt_pk_bf16_f32 v169, v132, v134
    v_cvt_pk_bf16_f32 v170, v136, v138
    v_cvt_pk_bf16_f32 v171, v140, v142
    ds_write_b128 v2, v[168:171] offset:2048
    v_cvt_pk_bf16_f32 v172, v129, v131
    v_cvt_pk_bf16_f32 v173, v133, v135
    v_cvt_pk_bf16_f32 v174, v137, v139
    v_cvt_pk_bf16_f32 v175, v141, v143
    ds_write_b128 v3, v[172:175] offset:2048
    v_cvt_pk_bf16_f32 v184, v144, v146
    v_cvt_pk_bf16_f32 v185, v148, v150
    v_cvt_pk_bf16_f32 v186, v152, v154
    v_cvt_pk_bf16_f32 v187, v156, v158
    ds_write_b128 v2, v[184:187] offset:6144
    v_cvt_pk_bf16_f32 v188, v145, v147
    v_cvt_pk_bf16_f32 v189, v149, v151
    v_cvt_pk_bf16_f32 v190, v153, v155
    v_cvt_pk_bf16_f32 v191, v157, v159
    ds_write_b128 v3, v[188:191] offset:6144
    s_mov_b32 s33, 262144
    ds_read_b64_tr_b16 v[96:97], v4 offset:0
    ds_read_b64_tr_b16 v[98:99], v30 offset:512
    ds_read_b64_tr_b16 v[100:101], v5 offset:0
    ds_read_b64_tr_b16 v[102:103], v31 offset:512
    ds_read_b64_tr_b16 v[104:105], v30 offset:0
    ds_read_b64_tr_b16 v[106:107], v4 offset:512
    ds_read_b64_tr_b16 v[108:109], v31 offset:0
    ds_read_b64_tr_b16 v[110:111], v5 offset:512
    ds_read_b64_tr_b16 v[112:113], v4 offset:4096
    ds_read_b64_tr_b16 v[114:115], v30 offset:4608
    ds_read_b64_tr_b16 v[116:117], v5 offset:4096
    ds_read_b64_tr_b16 v[118:119], v31 offset:4608
    ds_read_b64_tr_b16 v[120:121], v30 offset:4096
    ds_read_b64_tr_b16 v[122:123], v4 offset:4608
    ds_read_b64_tr_b16 v[124:125], v31 offset:4096
    ds_read_b64_tr_b16 v[126:127], v5 offset:4608
    s_waitcnt lgkmcnt(14)
    buffer_store_dwordx4 v[96:99], v196, s[40:43], 0 offen offset:0
    s_waitcnt lgkmcnt(12)
    buffer_store_dwordx4 v[100:103], v196, s[40:43], 0 offen offset:1024
    s_waitcnt lgkmcnt(10)
    buffer_store_dwordx4 v[104:107], v196, s[40:43], 0 offen offset:2048
    s_waitcnt lgkmcnt(8)
    buffer_store_dwordx4 v[108:111], v196, s[40:43], 0 offen offset:3072
    s_waitcnt lgkmcnt(6)
    buffer_store_dwordx4 v[112:115], v196, s[40:43], s33 offen offset:0
    s_waitcnt lgkmcnt(4)
    buffer_store_dwordx4 v[116:119], v196, s[40:43], s33 offen offset:1024
    s_waitcnt lgkmcnt(2)
    buffer_store_dwordx4 v[120:123], v196, s[40:43], s33 offen offset:2048
    s_waitcnt lgkmcnt(0)
    buffer_store_dwordx4 v[124:127], v196, s[40:43], s33 offen offset:3072
L1_end:
    s_endpgm
.globl k2_kernel
.p2align 8
.type k2_kernel,@function
k2_kernel:
    s_cmp_ge_u32 s2, 256
    s_cbranch_scc1 L2_end
    v_lshrrev_b32 v2, 6, v0
    v_and_b32 v1, 63, v0
    s_nop 0
    v_readfirstlane_b32 s29, v2
    s_and_b32 s24, s2, 7
    s_lshr_b32 s25, s2, 3
    s_lshr_b32 s26, s25, 3
    s_lshl_b32 s26, s26, 2
    s_lshr_b32 s27, s24, 1
    s_add_u32 s26, s26, s27
    s_and_b32 s27, s24, 1
    s_lshl_b32 s27, s27, 3
    s_and_b32 s28, s25, 7
    s_add_u32 s27, s27, s28
    s_add_u32 s61, s26, s27
    s_and_b32 s61, s61, 15
    s_cmp_lt_u32 s29, 4
    s_cbranch_scc1 L2_compute
    s_load_dwordx4 s[8:11], s[0:1], 40
    s_load_dwordx2 s[12:13], s[0:1], 136
    s_load_dwordx2 s[16:17], s[0:1], 0
    s_load_dwordx2 s[36:37], s[0:1], 104
    s_load_dwordx2 s[40:41], s[0:1], 64
    s_load_dwordx2 s[44:45], s[0:1], 120
    s_and_b32 s30, s29, 3
    v_lshrrev_b32 v3, 3, v1
    v_and_b32 v4, 7, v1
    v_lshrrev_b32 v5, 1, v3
    v_xor_b32 v5, v4, v5
    v_lshlrev_b32 v5, 4, v5
    v_lshl_add_u32 v10, v3, 11, v5
    v_xor_b32 v11, 64, v10
    v_add_u32 v12, 30720, v10
    v_add_u32 v13, 46080, v11
    v_add_u32 v11, 15360, v11
    s_lshr_b32 s31, s30, 1
    s_and_b32 s32, s30, 1
    s_lshl_b32 s34, s27, 6
    s_lshl_b32 s35, s31, 5
    s_add_u32 s34, s34, s35
    s_lshl_b32 s34, s34, 11
    s_lshl_b32 s60, s32, 13
    s_lshl_b32 s35, s31, 12
    s_add_u32 s60, s60, s35
    s_lshl_b32 s61, s61, 7
    s_cmp_eq_u32 s32, 1
    s_waitcnt lgkmcnt(0)
    s_cselect_b32 s8, s10, s8
    s_cselect_b32 s9, s11, s9
    s_add_u32 s8, s8, s34
    s_addc_u32 s9, s9, 0
    s_sub_u32 s10, 2097152, s34
    s_mov_b32 s11, 0x20000
    s_add_u32 m0, s60, 0
    s_nop 0
    buffer_load_dwordx4 v10, s[8:11], s61 offen offset:0 lds
    buffer_load_dwordx4 v11, s[8:11], s61 offen offset:1024 lds
    buffer_load_dwordx4 v12, s[8:11], s61 offen offset:2048 lds
    buffer_load_dwordx4 v13, s[8:11], s61 offen offset:3072 lds
    s_add_u32 s61, s61, 128
    s_and_b32 s61, s61, 2047
    s_load_dwordx16 s[64:79], s[12:13], 256
    s_load_dword s80, s[12:13], 0
    s_mov_b32 s14, 268435456
    s_mov_b32 s15, 0x20000
    s_mov_b32 s18, 4194304
    s_mov_b32 s19, 0x20000
    s_mov_b32 s38, 7340032
    s_mov_b32 s39, 0x20000
    s_mov_b32 s42, 2048
    s_mov_b32 s43, 0x20000
    s_mov_b32 s46, 8388608
    s_mov_b32 s47, 0x20000
    v_and_b32 v6, 255, v0
    v_lshrrev_b32 v7, 1, v6
    v_and_b32 v8, 1, v6
    v_lshlrev_b32 v14, 8, v7
    v_lshl_add_u32 v14, v8, 4, v14
    v_add_u32 v15, 32768, v14
    v_bfrev_b32 v2, 1
    v_cmp_gt_u32 vcc, 192, v6
    s_nop 1
    v_cndmask_b32 v15, v2, v15, vcc
    s_mul_i32 s33, s26, 57344
    s_add_u32 s33, s33, 524288
    v_lshlrev_b32 v16, 1, v7
    v_mul_u32_u24 v8, 1856, v8
    v_add_u32 v16, v16, v8
    v_add_u32 v16, 94208, v16
    buffer_load_dwordx4 v[20:23], v14, s[12:15], s33 offen offset:0
    buffer_load_dwordx4 v[24:27], v14, s[12:15], s33 offen offset:32
    buffer_load_dwordx4 v[28:31], v14, s[12:15], s33 offen offset:64
    buffer_load_dwordx4 v[32:35], v14, s[12:15], s33 offen offset:96
    buffer_load_dwordx4 v[36:39], v14, s[12:15], s33 offen offset:128
    buffer_load_dwordx4 v[40:43], v14, s[12:15], s33 offen offset:160
    buffer_load_dwordx4 v[44:47], v14, s[12:15], s33 offen offset:192
    buffer_load_dwordx4 v[48:51], v14, s[12:15], s33 offen offset:224
    buffer_load_dwordx4 v[52:55], v15, s[12:15], s33 offen offset:0
    buffer_load_dwordx4 v[56:59], v15, s[12:15], s33 offen offset:32
    buffer_load_dwordx4 v[60:63], v15, s[12:15], s33 offen offset:64
    buffer_load_dwordx4 v[64:67], v15, s[12:15], s33 offen offset:96
    buffer_load_dwordx4 v[68:71], v15, s[12:15], s33 offen offset:128
    buffer_load_dwordx4 v[72:75], v15, s[12:15], s33 offen offset:160
    buffer_load_dwordx4 v[76:79], v15, s[12:15], s33 offen offset:192
    buffer_load_dwordx4 v[80:83], v15, s[12:15], s33 offen offset:224
    s_add_u32 m0, s60, 16384
    s_nop 0
    buffer_load_dwordx4 v10, s[8:11], s61 offen offset:0 lds
    buffer_load_dwordx4 v11, s[8:11], s61 offen offset:1024 lds
    buffer_load_dwordx4 v12, s[8:11], s61 offen offset:2048 lds
    buffer_load_dwordx4 v13, s[8:11], s61 offen offset:3072 lds
    s_add_u32 s61, s61, 128
    s_and_b32 s61, s61, 2047
    s_add_u32 m0, s60, 32768
    s_nop 0
    buffer_load_dwordx4 v10, s[8:11], s61 offen offset:0 lds
    buffer_load_dwordx4 v11, s[8:11], s61 offen offset:1024 lds
    buffer_load_dwordx4 v12, s[8:11], s61 offen offset:2048 lds
    buffer_load_dwordx4 v13, s[8:11], s61 offen offset:3072 lds
    s_add_u32 s61, s61, 128
    s_and_b32 s61, s61, 2047
    v_lshlrev_b32 v17, 4, v4
    v_lshl_add_u32 v17, v3, 11, v17
    s_mul_i32 s33, s26, 28
    s_mul_i32 s34, s30, 7
    s_add_u32 s33, s33, s34
    s_lshl_b32 s33, s33, 14
    s_lshl_b32 s35, s27, 7
    s_add_u32 s33, s33, s35
    s_lshl_b32 s34, s34, 10
    s_add_u32 m0, s34, 65536
    s_nop 0
    buffer_load_dwordx4 v17, s[36:39], s33 offen lds
    s_add_u32 m0, s34, 66560
    s_add_u32 s33, s33, 16384
    buffer_load_dwordx4 v17, s[36:39], s33 offen lds
    s_add_u32 m0, s34, 67584
    s_add_u32 s33, s33, 16384
    buffer_load_dwordx4 v17, s[36:39], s33 offen lds
    s_add_u32 m0, s34, 68608
    s_add_u32 s33, s33, 16384
    buffer_load_dwordx4 v17, s[36:39], s33 offen lds
    s_add_u32 m0, s34, 69632
    s_add_u32 s33, s33, 16384
    buffer_load_dwordx4 v17, s[36:39], s33 offen lds
    s_add_u32 m0, s34, 70656
    s_add_u32 s33, s33, 16384
    buffer_load_dwordx4 v17, s[36:39], s33 offen lds
    s_add_u32 m0, s34, 71680
    s_add_u32 s33, s33, 16384
    buffer_load_dwordx4 v17, s[36:39], s33 offen lds
    v_lshrrev_b32 v6, 4, v1
    v_and_b32 v7, 15, v1
    s_lshl_b32 s48, s26, 7
    s_lshl_b32 s49, s30, 5
    s_add_u32 s49, s48, s49
    v_lshlrev_b32 v18, 3, v7
    v_lshl_add_u32 v19, v6, 11, v18
    s_lshl_b32 s33, s49, 11
    s_add_u32 s33, s33, s35
    v_lshlrev_b32 v9, 3, v6
    s_lshl_b32 s34, s49, 3
    s_add_u32 s34, s34, 4096
    buffer_load_dwordx2 v[84:85], v19, s[16:19], s33 offen
    s_add_u32 s33, s33, 8192
    buffer_load_dwordx2 v[100:101], v9, s[12:15], s34 offen offset:0
    buffer_load_dwordx2 v[86:87], v19, s[16:19], s33 offen
    s_add_u32 s33, s33, 8192
    buffer_load_dwordx2 v[102:103], v9, s[12:15], s34 offen offset:32
    buffer_load_dwordx2 v[88:89], v19, s[16:19], s33 offen
    s_add_u32 s33, s33, 8192
    buffer_load_dwordx2 v[104:105], v9, s[12:15], s34 offen offset:64
    buffer_load_dwordx2 v[90:91], v19, s[16:19], s33 offen
    s_add_u32 s33, s33, 8192
    buffer_load_dwordx2 v[106:107], v9, s[12:15], s34 offen offset:96
    buffer_load_dwordx2 v[92:93], v19, s[16:19], s33 offen
    s_add_u32 s33, s33, 8192
    buffer_load_dwordx2 v[108:109], v9, s[12:15], s34 offen offset:128
    buffer_load_dwordx2 v[94:95], v19, s[16:19], s33 offen
    s_add_u32 s33, s33, 8192
    buffer_load_dwordx2 v[110:111], v9, s[12:15], s34 offen offset:160
    buffer_load_dwordx2 v[96:97], v19, s[16:19], s33 offen
    s_add_u32 s33, s33, 8192
    buffer_load_dwordx2 v[112:113], v9, s[12:15], s34 offen offset:192
    buffer_load_dwordx2 v[98:99], v19, s[16:19], s33 offen
    buffer_load_dwordx2 v[114:115], v9, s[12:15], s34 offen offset:224
    buffer_load_dwordx2 v[116:117], v18, s[40:43], s35 offen
    s_waitcnt vmcnt(48) lgkmcnt(0)
    s_barrier
    s_add_u32 m0, s60, 49152
    s_nop 0
    buffer_load_dwordx4 v10, s[8:11], s61 offen offset:0 lds
    buffer_load_dwordx4 v11, s[8:11], s61 offen offset:1024 lds
    buffer_load_dwordx4 v12, s[8:11], s61 offen offset:2048 lds
    buffer_load_dwordx4 v13, s[8:11], s61 offen offset:3072 lds
    s_add_u32 s61, s61, 128
    s_and_b32 s61, s61, 2047
    s_waitcnt vmcnt(32)
    s_barrier
    s_add_u32 m0, s60, 0
    s_nop 0
    buffer_load_dwordx4 v10, s[8:11], s61 offen offset:0 lds
    buffer_load_dwordx4 v11, s[8:11], s61 offen offset:1024 lds
    buffer_load_dwordx4 v12, s[8:11], s61 offen offset:2048 lds
    buffer_load_dwordx4 v13, s[8:11], s61 offen offset:3072 lds
    s_add_u32 s61, s61, 128
    s_and_b32 s61, s61, 2047
    v_pk_add_f32 v[20:21], v[20:21], v[28:29]
    v_pk_add_f32 v[36:37], v[36:37], v[44:45]
    v_pk_add_f32 v[20:21], v[20:21], v[36:37]
    v_pk_add_f32 v[22:23], v[22:23], v[30:31]
    v_pk_add_f32 v[38:39], v[38:39], v[46:47]
    v_pk_add_f32 v[22:23], v[22:23], v[38:39]
    v_pk_add_f32 v[24:25], v[24:25], v[32:33]
    v_pk_add_f32 v[40:41], v[40:41], v[48:49]
    v_pk_add_f32 v[24:25], v[24:25], v[40:41]
    v_pk_add_f32 v[26:27], v[26:27], v[34:35]
    v_pk_add_f32 v[42:43], v[42:43], v[50:51]
    v_pk_add_f32 v[26:27], v[26:27], v[42:43]
    v_cvt_pk_bf16_f32 v152, v20, v21
    v_cvt_pk_bf16_f32 v153, v24, v25
    v_lshlrev_b32 v20, 16, v152
    v_and_b32 v21, 0xffff0000, v152
    v_lshlrev_b32 v24, 16, v153
    v_and_b32 v25, 0xffff0000, v153
    v_mul_f32 v152, 0xbfb8aa3b, v20
    v_mul_f32 v153, 0xbfb8aa3b, v21
    v_exp_f32 v152, v152
    v_exp_f32 v153, v153
    v_add_f32 v152, 1.0, v152
    v_add_f32 v153, 1.0, v153
    v_rcp_f32 v152, v152
    v_rcp_f32 v153, v153
    s_nop 0
    v_pk_mul_f32 v[20:21], v[20:21], v[152:153]
    v_cvt_pk_bf16_f32 v152, v20, v21
    v_lshlrev_b32 v20, 16, v152
    v_and_b32 v21, 0xffff0000, v152
    v_pk_mul_f32 v[20:21], v[20:21], v[24:25]
    v_cvt_pk_bf16_f32 v20, v20, v21
    v_cvt_pk_bf16_f32 v152, v22, v23
    v_cvt_pk_bf16_f32 v153, v26, v27
    v_lshlrev_b32 v22, 16, v152
    v_and_b32 v23, 0xffff0000, v152
    v_lshlrev_b32 v26, 16, v153
    v_and_b32 v27, 0xffff0000, v153
    v_mul_f32 v152, 0xbfb8aa3b, v22
    v_mul_f32 v153, 0xbfb8aa3b, v23
    v_exp_f32 v152, v152
    v_exp_f32 v153, v153
    v_add_f32 v152, 1.0, v152
    v_add_f32 v153, 1.0, v153
    v_rcp_f32 v152, v152
    v_rcp_f32 v153, v153
    s_nop 0
    v_pk_mul_f32 v[22:23], v[22:23], v[152:153]
    v_cvt_pk_bf16_f32 v152, v22, v23
    v_lshlrev_b32 v22, 16, v152
    v_and_b32 v23, 0xffff0000, v152
    v_pk_mul_f32 v[22:23], v[22:23], v[26:27]
    v_cvt_pk_bf16_f32 v22, v22, v23
    ds_write_b16 v16, v20 offset:0
    ds_write_b16_d16_hi v16, v20 offset:464
    ds_write_b16 v16, v22 offset:928
    ds_write_b16_d16_hi v16, v22 offset:1392
    s_waitcnt vmcnt(32)
    s_barrier
    s_add_u32 m0, s60, 16384
    s_nop 0
    buffer_load_dwordx4 v10, s[8:11], s61 offen offset:0 lds
    buffer_load_dwordx4 v11, s[8:11], s61 offen offset:1024 lds
    buffer_load_dwordx4 v12, s[8:11], s61 offen offset:2048 lds
    buffer_load_dwordx4 v13, s[8:11], s61 offen offset:3072 lds
    s_add_u32 s61, s61, 128
    s_and_b32 s61, s61, 2047
    v_pk_add_f32 v[52:53], v[52:53], v[60:61]
    v_pk_add_f32 v[68:69], v[68:69], v[76:77]
    v_pk_add_f32 v[52:53], v[52:53], v[68:69]
    v_pk_add_f32 v[54:55], v[54:55], v[62:63]
    v_pk_add_f32 v[70:71], v[70:71], v[78:79]
    v_pk_add_f32 v[54:55], v[54:55], v[70:71]
    v_pk_add_f32 v[56:57], v[56:57], v[64:65]
    v_pk_add_f32 v[72:73], v[72:73], v[80:81]
    v_pk_add_f32 v[56:57], v[56:57], v[72:73]
    v_pk_add_f32 v[58:59], v[58:59], v[66:67]
    v_pk_add_f32 v[74:75], v[74:75], v[82:83]
    v_pk_add_f32 v[58:59], v[58:59], v[74:75]
    v_cvt_pk_bf16_f32 v152, v52, v53
    v_cvt_pk_bf16_f32 v153, v56, v57
    v_lshlrev_b32 v52, 16, v152
    v_and_b32 v53, 0xffff0000, v152
    v_lshlrev_b32 v56, 16, v153
    v_and_b32 v57, 0xffff0000, v153
    v_mul_f32 v152, 0xbfb8aa3b, v52
    v_mul_f32 v153, 0xbfb8aa3b, v53
    v_exp_f32 v152, v152
    v_exp_f32 v153, v153
    v_add_f32 v152, 1.0, v152
    v_add_f32 v153, 1.0, v153
    v_rcp_f32 v152, v152
    v_rcp_f32 v153, v153
    s_nop 0
    v_pk_mul_f32 v[52:53], v[52:53], v[152:153]
    v_cvt_pk_bf16_f32 v152, v52, v53
    v_lshlrev_b32 v52, 16, v152
    v_and_b32 v53, 0xffff0000, v152
    v_pk_mul_f32 v[52:53], v[52:53], v[56:57]
    v_cvt_pk_bf16_f32 v52, v52, v53
    v_cvt_pk_bf16_f32 v152, v54, v55
    v_cvt_pk_bf16_f32 v153, v58, v59
    v_lshlrev_b32 v54, 16, v152
    v_and_b32 v55, 0xffff0000, v152
    v_lshlrev_b32 v58, 16, v153
    v_and_b32 v59, 0xffff0000, v153
    v_mul_f32 v152, 0xbfb8aa3b, v54
    v_mul_f32 v153, 0xbfb8aa3b, v55
    v_exp_f32 v152, v152
    v_exp_f32 v153, v153
    v_add_f32 v152, 1.0, v152
    v_add_f32 v153, 1.0, v153
    v_rcp_f32 v152, v152
    v_rcp_f32 v153, v153
    s_nop 0
    v_pk_mul_f32 v[54:55], v[54:55], v[152:153]
    v_cvt_pk_bf16_f32 v152, v54, v55
    v_lshlrev_b32 v54, 16, v152
    v_and_b32 v55, 0xffff0000, v152
    v_pk_mul_f32 v[54:55], v[54:55], v[58:59]
    v_cvt_pk_bf16_f32 v54, v54, v55
    v_cmp_le_i32 vcc, 0, v15
    s_and_saveexec_b64 s[50:51], vcc
    ds_write_b16 v16, v52 offset:256
    ds_write_b16_d16_hi v16, v52 offset:720
    ds_write_b16 v16, v54 offset:1184
    ds_write_b16_d16_hi v16, v54 offset:1648
    s_mov_b64 exec, s[50:51]
    s_waitcnt vmcnt(8) lgkmcnt(0)
    s_barrier
    s_add_u32 m0, s60, 32768
    s_nop 0
    buffer_load_dwordx4 v10, s[8:11], s61 offen offset:0 lds
    buffer_load_dwordx4 v11, s[8:11], s61 offen offset:1024 lds
    buffer_load_dwordx4 v12, s[8:11], s61 offen offset:2048 lds
    buffer_load_dwordx4 v13, s[8:11], s61 offen offset:3072 lds
    s_add_u32 s61, s61, 128
    s_and_b32 s61, s61, 2047
    v_mul_u32_u24 v8, 464, v4
    v_lshl_add_u32 v8, v6, 4, v8
    v_add_u32 v8, 94208, v8
    v_bfe_u32 v5, v1, 2, 2
    v_lshl_add_u32 v5, v6, 3, v5
    v_lshlrev_b32 v5, 7, v5
    v_and_b32 v14, 3, v1
    v_lshl_add_u32 v5, v14, 3, v5
    s_lshl_b32 s33, s30, 5
    s_add_u32 s33, s33, 65536
    v_add_u32 v5, s33, v5
    ds_read_b128 v[48:51], v8 offset:0
    ds_read_b64_tr_b16 v[20:21], v5 offset:0
    ds_read_b64_tr_b16 v[22:23], v5 offset:512
    ds_read_b128 v[52:55], v8 offset:64
    ds_read_b64_tr_b16 v[24:25], v5 offset:4096
    ds_read_b64_tr_b16 v[26:27], v5 offset:4608
    ds_read_b128 v[56:59], v8 offset:128
    ds_read_b64_tr_b16 v[28:29], v5 offset:8192
    ds_read_b64_tr_b16 v[30:31], v5 offset:8704
    ds_read_b128 v[60:63], v8 offset:192
    ds_read_b64_tr_b16 v[32:33], v5 offset:12288
    ds_read_b64_tr_b16 v[34:35], v5 offset:12800
    ds_read_b128 v[64:67], v8 offset:256
    ds_read_b64_tr_b16 v[36:37], v5 offset:16384
    ds_read_b64_tr_b16 v[38:39], v5 offset:16896
    ds_read_b128 v[68:71], v8 offset:320
    ds_read_b64_tr_b16 v[40:41], v5 offset:20480
    ds_read_b64_tr_b16 v[42:43], v5 offset:20992
    ds_read_b128 v[72:75], v8 offset:384
    ds_read_b64_tr_b16 v[44:45], v5 offset:24576
    ds_read_b64_tr_b16 v[46:47], v5 offset:25088
    s_waitcnt lgkmcnt(15)
    v_mfma_f32_16x16x32_bf16 v[76:79], v[20:23], v[48:51], 0
    s_waitcnt lgkmcnt(15)
    v_mfma_f32_16x16x32_bf16 v[76:79], v[24:27], v[52:55], v[76:79]
    s_waitcnt lgkmcnt(12)
    v_mfma_f32_16x16x32_bf16 v[76:79], v[28:31], v[56:59], v[76:79]
    s_waitcnt lgkmcnt(9)
    v_mfma_f32_16x16x32_bf16 v[76:79], v[32:35], v[60:63], v[76:79]
    s_waitcnt lgkmcnt(6)
    v_mfma_f32_16x16x32_bf16 v[76:79], v[36:39], v[64:67], v[76:79]
    s_waitcnt lgkmcnt(3)
    v_mfma_f32_16x16x32_bf16 v[76:79], v[40:43], v[68:71], v[76:79]
    s_waitcnt lgkmcnt(0)
    v_mfma_f32_16x16x32_bf16 v[76:79], v[44:47], v[72:75], v[76:79]
    v_lshlrev_b32 v8, 17, v7
    v_lshl_add_u32 v8, v6, 5, v8
    s_lshl_b32 s33, s27, 13
    s_lshl_b32 s34, s26, 9
    s_add_u32 s33, s33, s34
    s_lshl_b32 s34, s30, 7
    s_add_u32 s33, s33, s34
    s_add_u32 s33, s33, 1572864
    v_mov_b32 v21, s80
    v_mov_b32 v23, s80
    v_mov_b32 v25, s80
    v_mov_b32 v27, s80
    v_mov_b32 v20, v76
    v_mov_b32 v22, v77
    v_mov_b32 v24, v78
    v_mov_b32 v26, v79
    s_mov_b32 exec_lo, 0x00ff00ff
    s_mov_b32 exec_hi, 0x00ff00ff
    buffer_store_dwordx4 v[20:23], v8, s[12:15], s33 offen sc1
    buffer_store_dwordx4 v[24:27], v8, s[12:15], s33 offen offset:16 sc1
    s_mov_b64 exec, -1
    s_waitcnt vmcnt(10)
    s_barrier
    s_add_u32 m0, s60, 49152
    s_nop 0
    buffer_load_dwordx4 v10, s[8:11], s61 offen offset:0 lds
    buffer_load_dwordx4 v11, s[8:11], s61 offen offset:1024 lds
    buffer_load_dwordx4 v12, s[8:11], s61 offen offset:2048 lds
    buffer_load_dwordx4 v13, s[8:11], s61 offen offset:3072 lds
    s_add_u32 s61, s61, 128
    s_and_b32 s61, s61, 2047
    v_and_b32 v119, 0xffff0000, v117
    v_lshlrev_b32 v118, 16, v117
    v_and_b32 v117, 0xffff0000, v116
    v_lshlrev_b32 v116, 16, v116
    v_lshlrev_b32 v152, 16, v84
    v_and_b32 v153, 0xffff0000, v84
    v_pk_mul_f32 v[154:155], v[152:153], v[116:117]
    v_pk_mul_f32 v[152:153], v[100:101], v[152:153] op_sel:[1,0]
    v_cvt_pk_bf16_f32 v154, v154, v155
    v_cvt_pk_bf16_f32 v152, v152, v153
    v_and_b32 v155, 0xffff0000, v154
    v_lshlrev_b32 v154, 16, v154
    v_and_b32 v153, 0xffff0000, v152
    v_lshlrev_b32 v152, 16, v152
    v_pk_fma_f32 v[120:121], v[100:101], v[154:155], v[152:153] op_sel_hi:[0,1,1]
    v_lshlrev_b32 v152, 16, v85
    v_and_b32 v153, 0xffff0000, v85
    v_pk_mul_f32 v[154:155], v[152:153], v[118:119]
    v_pk_mul_f32 v[152:153], v[100:101], v[152:153] op_sel:[1,0]
    v_cvt_pk_bf16_f32 v154, v154, v155
    v_cvt_pk_bf16_f32 v152, v152, v153
    v_and_b32 v155, 0xffff0000, v154
    v_lshlrev_b32 v154, 16, v154
    v_and_b32 v153, 0xffff0000, v152
    v_lshlrev_b32 v152, 16, v152
    v_pk_fma_f32 v[122:123], v[100:101], v[154:155], v[152:153] op_sel_hi:[0,1,1]
    v_lshlrev_b32 v152, 16, v86
    v_and_b32 v153, 0xffff0000, v86
    v_pk_mul_f32 v[154:155], v[152:153], v[116:117]
    v_pk_mul_f32 v[152:153], v[102:103], v[152:153] op_sel:[1,0]
    v_cvt_pk_bf16_f32 v154, v154, v155
    v_cvt_pk_bf16_f32 v152, v152, v153
    v_and_b32 v155, 0xffff0000, v154
    v_lshlrev_b32 v154, 16, v154
    v_and_b32 v153, 0xffff0000, v152
    v_lshlrev_b32 v152, 16, v152
    v_pk_fma_f32 v[124:125], v[102:103], v[154:155], v[152:153] op_sel_hi:[0,1,1]
    v_lshlrev_b32 v152, 16, v87
    v_and_b32 v153, 0xffff0000, v87
    v_pk_mul_f32 v[154:155], v[152:153], v[118:119]
    v_pk_mul_f32 v[152:153], v[102:103], v[152:153] op_sel:[1,0]
    v_cvt_pk_bf16_f32 v154, v154, v155
    v_cvt_pk_bf16_f32 v152, v152, v153
    v_and_b32 v155, 0xffff0000, v154
    v_lshlrev_b32 v154, 16, v154
    v_and_b32 v153, 0xffff0000, v152
    v_lshlrev_b32 v152, 16, v152
    v_pk_fma_f32 v[126:127], v[102:103], v[154:155], v[152:153] op_sel_hi:[0,1,1]
    s_waitcnt vmcnt(10)
    s_barrier
    s_add_u32 m0, s60, 0
    s_nop 0
    buffer_load_dwordx4 v10, s[8:11], s61 offen offset:0 lds
    buffer_load_dwordx4 v11, s[8:11], s61 offen offset:1024 lds
    buffer_load_dwordx4 v12, s[8:11], s61 offen offset:2048 lds
    buffer_load_dwordx4 v13, s[8:11], s61 offen offset:3072 lds
    s_add_u32 s61, s61, 128
    s_and_b32 s61, s61, 2047
    v_lshlrev_b32 v152, 16, v88
    v_and_b32 v153, 0xffff0000, v88
    v_pk_mul_f32 v[154:155], v[152:153], v[116:117]
    v_pk_mul_f32 v[152:153], v[104:105], v[152:153] op_sel:[1,0]
    v_cvt_pk_bf16_f32 v154, v154, v155
    v_cvt_pk_bf16_f32 v152, v152, v153
    v_and_b32 v155, 0xffff0000, v154
    v_lshlrev_b32 v154, 16, v154
    v_and_b32 v153, 0xffff0000, v152
    v_lshlrev_b32 v152, 16, v152
    v_pk_fma_f32 v[128:129], v[104:105], v[154:155], v[152:153] op_sel_hi:[0,1,1]
    v_lshlrev_b32 v152, 16, v89
    v_and_b32 v153, 0xffff0000, v89
    v_pk_mul_f32 v[154:155], v[152:153], v[118:119]
    v_pk_mul_f32 v[152:153], v[104:105], v[152:153] op_sel:[1,0]
    v_cvt_pk_bf16_f32 v154, v154, v155
    v_cvt_pk_bf16_f32 v152, v152, v153
    v_and_b32 v155, 0xffff0000, v154
    v_lshlrev_b32 v154, 16, v154
    v_and_b32 v153, 0xffff0000, v152
    v_lshlrev_b32 v152, 16, v152
    v_pk_fma_f32 v[130:131], v[104:105], v[154:155], v[152:153] op_sel_hi:[0,1,1]
    v_lshlrev_b32 v152, 16, v90
    v_and_b32 v153, 0xffff0000, v90
    v_pk_mul_f32 v[154:155], v[152:153], v[116:117]
    v_pk_mul_f32 v[152:153], v[106:107], v[152:153] op_sel:[1,0]
    v_cvt_pk_bf16_f32 v154, v154, v155
    v_cvt_pk_bf16_f32 v152, v152, v153
    v_and_b32 v155, 0xffff0000, v154
    v_lshlrev_b32 v154, 16, v154
    v_and_b32 v153, 0xffff0000, v152
    v_lshlrev_b32 v152, 16, v152
    v_pk_fma_f32 v[132:133], v[106:107], v[154:155], v[152:153] op_sel_hi:[0,1,1]
    v_lshlrev_b32 v152, 16, v91
    v_and_b32 v153, 0xffff0000, v91
    v_pk_mul_f32 v[154:155], v[152:153], v[118:119]
    v_pk_mul_f32 v[152:153], v[106:107], v[152:153] op_sel:[1,0]
    v_cvt_pk_bf16_f32 v154, v154, v155
    v_cvt_pk_bf16_f32 v152, v152, v153
    v_and_b32 v155, 0xffff0000, v154
    v_lshlrev_b32 v154, 16, v154
    v_and_b32 v153, 0xffff0000, v152
    v_lshlrev_b32 v152, 16, v152
    v_pk_fma_f32 v[134:135], v[106:107], v[154:155], v[152:153] op_sel_hi:[0,1,1]
    s_waitcnt vmcnt(10)
    s_barrier
    s_add_u32 m0, s60, 16384
    s_nop 0
    buffer_load_dwordx4 v10, s[8:11], s61 offen offset:0 lds
    buffer_load_dwordx4 v11, s[8:11], s61 offen offset:1024 lds
    buffer_load_dwordx4 v12, s[8:11], s61 offen offset:2048 lds
    buffer_load_dwordx4 v13, s[8:11], s61 offen offset:3072 lds
    s_add_u32 s61, s61, 128
    s_and_b32 s61, s61, 2047
    v_lshlrev_b32 v152, 16, v92
    v_and_b32 v153, 0xffff0000, v92
    v_pk_mul_f32 v[154:155], v[152:153], v[116:117]
    v_pk_mul_f32 v[152:153], v[108:109], v[152:153] op_sel:[1,0]
    v_cvt_pk_bf16_f32 v154, v154, v155
    v_cvt_pk_bf16_f32 v152, v152, v153
    v_and_b32 v155, 0xffff0000, v154
    v_lshlrev_b32 v154, 16, v154
    v_and_b32 v153, 0xffff0000, v152
    v_lshlrev_b32 v152, 16, v152
    v_pk_fma_f32 v[136:137], v[108:109], v[154:155], v[152:153] op_sel_hi:[0,1,1]
    v_lshlrev_b32 v152, 16, v93
    v_and_b32 v153, 0xffff0000, v93
    v_pk_mul_f32 v[154:155], v[152:153], v[118:119]
    v_pk_mul_f32 v[152:153], v[108:109], v[152:153] op_sel:[1,0]
    v_cvt_pk_bf16_f32 v154, v154, v155
    v_cvt_pk_bf16_f32 v152, v152, v153
    v_and_b32 v155, 0xffff0000, v154
    v_lshlrev_b32 v154, 16, v154
    v_and_b32 v153, 0xffff0000, v152
    v_lshlrev_b32 v152, 16, v152
    v_pk_fma_f32 v[138:139], v[108:109], v[154:155], v[152:153] op_sel_hi:[0,1,1]
    v_lshlrev_b32 v152, 16, v94
    v_and_b32 v153, 0xffff0000, v94
    v_pk_mul_f32 v[154:155], v[152:153], v[116:117]
    v_pk_mul_f32 v[152:153], v[110:111], v[152:153] op_sel:[1,0]
    v_cvt_pk_bf16_f32 v154, v154, v155
    v_cvt_pk_bf16_f32 v152, v152, v153
    v_and_b32 v155, 0xffff0000, v154
    v_lshlrev_b32 v154, 16, v154
    v_and_b32 v153, 0xffff0000, v152
    v_lshlrev_b32 v152, 16, v152
    v_pk_fma_f32 v[140:141], v[110:111], v[154:155], v[152:153] op_sel_hi:[0,1,1]
    v_lshlrev_b32 v152, 16, v95
    v_and_b32 v153, 0xffff0000, v95
    v_pk_mul_f32 v[154:155], v[152:153], v[118:119]
    v_pk_mul_f32 v[152:153], v[110:111], v[152:153] op_sel:[1,0]
    v_cvt_pk_bf16_f32 v154, v154, v155
    v_cvt_pk_bf16_f32 v152, v152, v153
    v_and_b32 v155, 0xffff0000, v154
    v_lshlrev_b32 v154, 16, v154
    v_and_b32 v153, 0xffff0000, v152
    v_lshlrev_b32 v152, 16, v152
    v_pk_fma_f32 v[142:143], v[110:111], v[154:155], v[152:153] op_sel_hi:[0,1,1]
    s_waitcnt vmcnt(8)
    s_barrier
    s_add_u32 m0, s60, 32768
    s_nop 0
    buffer_load_dwordx4 v10, s[8:11], s61 offen offset:0 lds
    buffer_load_dwordx4 v11, s[8:11], s61 offen offset:1024 lds
    buffer_load_dwordx4 v12, s[8:11], s61 offen offset:2048 lds
    buffer_load_dwordx4 v13, s[8:11], s61 offen offset:3072 lds
    s_add_u32 s61, s61, 128
    s_and_b32 s61, s61, 2047
    v_lshlrev_b32 v152, 16, v96
    v_and_b32 v153, 0xffff0000, v96
    v_pk_mul_f32 v[154:155], v[152:153], v[116:117]
    v_pk_mul_f32 v[152:153], v[112:113], v[152:153] op_sel:[1,0]
    v_cvt_pk_bf16_f32 v154, v154, v155
    v_cvt_pk_bf16_f32 v152, v152, v153
    v_and_b32 v155, 0xffff0000, v154
    v_lshlrev_b32 v154, 16, v154
    v_and_b32 v153, 0xffff0000, v152
    v_lshlrev_b32 v152, 16, v152
    v_pk_fma_f32 v[144:145], v[112:113], v[154:155], v[152:153] op_sel_hi:[0,1,1]
    v_lshlrev_b32 v152, 16, v97
    v_and_b32 v153, 0xffff0000, v97
    v_pk_mul_f32 v[154:155], v[152:153], v[118:119]
    v_pk_mul_f32 v[152:153], v[112:113], v[152:153] op_sel:[1,0]
    v_cvt_pk_bf16_f32 v154, v154, v155
    v_cvt_pk_bf16_f32 v152, v152, v153
    v_and_b32 v155, 0xffff0000, v154
    v_lshlrev_b32 v154, 16, v154
    v_and_b32 v153, 0xffff0000, v152
    v_lshlrev_b32 v152, 16, v152
    v_pk_fma_f32 v[146:147], v[112:113], v[154:155], v[152:153] op_sel_hi:[0,1,1]
    v_lshlrev_b32 v152, 16, v98
    v_and_b32 v153, 0xffff0000, v98
    v_pk_mul_f32 v[154:155], v[152:153], v[116:117]
    v_pk_mul_f32 v[152:153], v[114:115], v[152:153] op_sel:[1,0]
    v_cvt_pk_bf16_f32 v154, v154, v155
    v_cvt_pk_bf16_f32 v152, v152, v153
    v_and_b32 v155, 0xffff0000, v154
    v_lshlrev_b32 v154, 16, v154
    v_and_b32 v153, 0xffff0000, v152
    v_lshlrev_b32 v152, 16, v152
    v_pk_fma_f32 v[148:149], v[114:115], v[154:155], v[152:153] op_sel_hi:[0,1,1]
    v_lshlrev_b32 v152, 16, v99
    v_and_b32 v153, 0xffff0000, v99
    v_pk_mul_f32 v[154:155], v[152:153], v[118:119]
    v_pk_mul_f32 v[152:153], v[114:115], v[152:153] op_sel:[1,0]
    v_cvt_pk_bf16_f32 v154, v154, v155
    v_cvt_pk_bf16_f32 v152, v152, v153
    v_and_b32 v155, 0xffff0000, v154
    v_lshlrev_b32 v154, 16, v154
    v_and_b32 v153, 0xffff0000, v152
    v_lshlrev_b32 v152, 16, v152
    v_pk_fma_f32 v[150:151], v[114:115], v[154:155], v[152:153] op_sel_hi:[0,1,1]
    s_waitcnt vmcnt(8)
    s_barrier
    s_add_u32 m0, s60, 49152
    s_nop 0
    buffer_load_dwordx4 v10, s[8:11], s61 offen offset:0 lds
    buffer_load_dwordx4 v11, s[8:11], s61 offen offset:1024 lds
    buffer_load_dwordx4 v12, s[8:11], s61 offen offset:2048 lds
    buffer_load_dwordx4 v13, s[8:11], s61 offen offset:3072 lds
    s_add_u32 s61, s61, 128
    s_and_b32 s61, s61, 2047
    s_mov_b32 s33, 0
    s_sub_u32 s34, s64, s49
    s_lshl_b32 s35, 1, s34
    s_cmp_lt_u32 s34, 32
    s_cselect_b32 s35, s35, 0
    s_or_b32 s33, s33, s35
    s_sub_u32 s34, s65, s49
    s_lshl_b32 s35, 1, s34
    s_cmp_lt_u32 s34, 32
    s_cselect_b32 s35, s35, 0
    s_or_b32 s33, s33, s35
    s_sub_u32 s34, s66, s49
    s_lshl_b32 s35, 1, s34
    s_cmp_lt_u32 s34, 32
    s_cselect_b32 s35, s35, 0
    s_or_b32 s33, s33, s35
    s_sub_u32 s34, s67, s49
    s_lshl_b32 s35, 1, s34
    s_cmp_lt_u32 s34, 32
    s_cselect_b32 s35, s35, 0
    s_or_b32 s33, s33, s35
    s_sub_u32 s34, s68, s49
    s_lshl_b32 s35, 1, s34
    s_cmp_lt_u32 s34, 32
    s_cselect_b32 s35, s35, 0
    s_or_b32 s33, s33, s35
    s_sub_u32 s34, s69, s49
    s_lshl_b32 s35, 1, s34
    s_cmp_lt_u32 s34, 32
    s_cselect_b32 s35, s35, 0
    s_or_b32 s33, s33, s35
    s_sub_u32 s34, s70, s49
    s_lshl_b32 s35, 1, s34
    s_cmp_lt_u32 s34, 32
    s_cselect_b32 s35, s35, 0
    s_or_b32 s33, s33, s35
    s_sub_u32 s34, s71, s49
    s_lshl_b32 s35, 1, s34
    s_cmp_lt_u32 s34, 32
    s_cselect_b32 s35, s35, 0
    s_or_b32 s33, s33, s35
    v_lshlrev_b32 v8, v6, 1
    s_lshr_b32 s34, s33, 0
    v_and_b32 v170, s34, v8
    s_lshr_b32 s34, s33, 4
    v_and_b32 v171, s34, v8
    s_lshr_b32 s34, s33, 8
    v_and_b32 v172, s34, v8
    s_lshr_b32 s34, s33, 12
    v_and_b32 v173, s34, v8
    s_lshr_b32 s34, s33, 16
    v_and_b32 v174, s34, v8
    s_lshr_b32 s34, s33, 20
    v_and_b32 v175, s34, v8
    s_lshr_b32 s34, s33, 24
    v_and_b32 v176, s34, v8
    s_lshr_b32 s34, s33, 28
    v_and_b32 v177, s34, v8
    s_waitcnt vmcnt(8)
    s_barrier
    s_add_u32 m0, s60, 0
    s_nop 0
    buffer_load_dwordx4 v10, s[8:11], s61 offen offset:0 lds
    buffer_load_dwordx4 v11, s[8:11], s61 offen offset:1024 lds
    buffer_load_dwordx4 v12, s[8:11], s61 offen offset:2048 lds
    buffer_load_dwordx4 v13, s[8:11], s61 offen offset:3072 lds
    s_add_u32 s61, s61, 128
    s_and_b32 s61, s61, 2047
    s_cmp_eq_u32 s30, 1
    s_cselect_b32 s64, s65, s64
    s_cselect_b32 s68, s69, s68
    s_cselect_b32 s72, s73, s72
    s_cselect_b32 s76, s77, s76
    s_cmp_eq_u32 s30, 2
    s_cselect_b32 s64, s66, s64
    s_cselect_b32 s68, s70, s68
    s_cselect_b32 s72, s74, s72
    s_cselect_b32 s76, s78, s76
    s_cmp_eq_u32 s30, 3
    s_cselect_b32 s64, s67, s64
    s_cselect_b32 s68, s71, s68
    s_cselect_b32 s72, s75, s72
    s_cselect_b32 s76, s79, s76
    v_mov_b32 v14, s64
    v_mov_b32 v168, s72
    s_mov_b32 exec_lo, 0
    v_mov_b32 v14, s68
    v_mov_b32 v168, s76
    s_mov_b32 exec_lo, -1
    v_subrev_u32 v15, s48, v14
    v_cmp_gt_u32 vcc, 0x80, v15
    s_mov_b64 s[52:53], vcc
    v_lshrrev_b32 v16, 5, v1
    v_lshlrev_b32 v16, 19, v16
    v_and_b32 v17, 1, v6
    v_lshl_add_u32 v16, v17, 12, v16
    v_lshl_add_u32 v16, v7, 5, v16
    v_cndmask_b32 v16, v2, v16, vcc
    v_lshl_add_u32 v17, v14, 11, v18
    v_cndmask_b32 v17, v2, v17, vcc
    v_lshlrev_b32 v18, 3, v14
    v_cndmask_b32 v18, v2, v18, vcc
    v_mov_b32 v9, s80
    v_cndmask_b32 v9, 0, v9, vcc
    s_lshl_b32 s54, s30, 17
    s_lshl_b32 s55, s27, 13
    s_add_u32 s54, s54, s55
    s_add_u32 s54, s54, 1572864
    s_lshl_b32 s55, s27, 7
    s_mov_b32 s56, 4096
    s_waitcnt vmcnt(8)
    s_barrier
    s_add_u32 m0, s60, 16384
    s_nop 0
    buffer_load_dwordx4 v10, s[8:11], s61 offen offset:0 lds
    buffer_load_dwordx4 v11, s[8:11], s61 offen offset:1024 lds
    buffer_load_dwordx4 v12, s[8:11], s61 offen offset:2048 lds
    buffer_load_dwordx4 v13, s[8:11], s61 offen offset:3072 lds
    s_add_u32 s61, s61, 128
    s_and_b32 s61, s61, 2047
    s_waitcnt vmcnt(8)
    s_barrier
    s_add_u32 m0, s60, 32768
    s_nop 0
    buffer_load_dwordx4 v10, s[8:11], s61 offen offset:0 lds
    buffer_load_dwordx4 v11, s[8:11], s61 offen offset:1024 lds
    buffer_load_dwordx4 v12, s[8:11], s61 offen offset:2048 lds
    buffer_load_dwordx4 v13, s[8:11], s61 offen offset:3072 lds
    s_add_u32 s61, s61, 128
    s_and_b32 s61, s61, 2047
    s_waitcnt vmcnt(8)
    s_barrier
    s_add_u32 m0, s60, 49152
    s_nop 0
    buffer_load_dwordx4 v10, s[8:11], s61 offen offset:0 lds
    buffer_load_dwordx4 v11, s[8:11], s61 offen offset:1024 lds
    buffer_load_dwordx4 v12, s[8:11], s61 offen offset:2048 lds
    buffer_load_dwordx4 v13, s[8:11], s61 offen offset:3072 lds
    s_waitcnt vmcnt(8)
    s_barrier
    buffer_load_dwordx4 v[20:23], v16, s[12:15], s54 offen offset:0 sc1
    buffer_load_dwordx4 v[24:27], v16, s[12:15], s54 offen offset:16 sc1
    buffer_load_dwordx4 v[28:31], v16, s[12:15], s54 offen offset:512 sc1
    buffer_load_dwordx4 v[32:35], v16, s[12:15], s54 offen offset:528 sc1
    buffer_load_dwordx4 v[36:39], v16, s[12:15], s54 offen offset:1024 sc1
    buffer_load_dwordx4 v[40:43], v16, s[12:15], s54 offen offset:1040 sc1
    buffer_load_dwordx4 v[44:47], v16, s[12:15], s54 offen offset:1536 sc1
    buffer_load_dwordx4 v[48:51], v16, s[12:15], s54 offen offset:1552 sc1
    buffer_load_dwordx4 v[52:55], v16, s[12:15], s54 offen offset:2048 sc1
    buffer_load_dwordx4 v[56:59], v16, s[12:15], s54 offen offset:2064 sc1
    buffer_load_dwordx4 v[60:63], v16, s[12:15], s54 offen offset:2560 sc1
    buffer_load_dwordx4 v[64:67], v16, s[12:15], s54 offen offset:2576 sc1
    buffer_load_dwordx4 v[68:71], v16, s[12:15], s54 offen offset:3072 sc1
    buffer_load_dwordx4 v[72:75], v16, s[12:15], s54 offen offset:3088 sc1
    buffer_load_dwordx4 v[76:79], v16, s[12:15], s54 offen offset:3584 sc1
    buffer_load_dwordx4 v[80:83], v16, s[12:15], s54 offen offset:3600 sc1
    buffer_load_dwordx2 v[160:161], v17, s[16:19], s55 offen
    buffer_load_dwordx2 v[162:163], v18, s[12:15], s56 offen
    v_lshlrev_b32 v10, 4, v7
    v_lshl_add_u32 v11, v14, 12, v10
    v_lshl_add_u32 v10, v6, 12, v10
    v_xor_b32 v12, v7, v6
    v_lshlrev_b32 v12, 4, v12
    v_lshl_add_u32 v12, v6, 8, v12
    s_lshl_b32 s33, s30, 13
    v_add_u32 v12, s33, v12
    v_xor_b32 v13, 64, v12
    v_and_b32 v8, 7, v15
    v_xor_b32 v8, v8, v7
    v_lshlrev_b32 v8, 4, v8
    v_and_b32 v5, 0x7f, v15
    v_lshl_add_u32 v8, v5, 8, v8
    s_lshl_b32 s57, s27, 8
    s_lshl_b32 s58, s49, 12
    s_add_u32 s58, s58, s57
    s_waitcnt vmcnt(22)
    s_barrier
    s_waitcnt vmcnt(18)
    s_barrier
    s_mov_b32 s59, 1048576
L2_ypoll:
    s_waitcnt vmcnt(0)
    s_cmp_eq_u64 s[52:53], 0
    s_cbranch_scc1 L2_notok
    v_xor_b32 v152, v9, v21
    v_xor_b32 v153, v9, v23
    v_or_b32 v152, v152, v153
    v_xor_b32 v153, v9, v25
    v_or_b32 v152, v152, v153
    v_xor_b32 v153, v9, v27
    v_or_b32 v152, v152, v153
    v_xor_b32 v153, v9, v29
    v_or_b32 v152, v152, v153
    v_xor_b32 v153, v9, v31
    v_or_b32 v152, v152, v153
    v_xor_b32 v153, v9, v33
    v_or_b32 v152, v152, v153
    v_xor_b32 v153, v9, v35
    v_or_b32 v152, v152, v153
    v_xor_b32 v153, v9, v37
    v_or_b32 v152, v152, v153
    v_xor_b32 v153, v9, v39
    v_or_b32 v152, v152, v153
    v_xor_b32 v153, v9, v41
    v_or_b32 v152, v152, v153
    v_xor_b32 v153, v9, v43
    v_or_b32 v152, v152, v153
    v_xor_b32 v153, v9, v45
    v_or_b32 v152, v152, v153
    v_xor_b32 v153, v9, v47
    v_or_b32 v152, v152, v153
    v_xor_b32 v153, v9, v49
    v_or_b32 v152, v152, v153
    v_xor_b32 v153, v9, v51
    v_or_b32 v152, v152, v153
    v_xor_b32 v153, v9, v53
    v_or_b32 v152, v152, v153
    v_xor_b32 v153, v9, v55
    v_or_b32 v152, v152, v153
    v_xor_b32 v153, v9, v57
    v_or_b32 v152, v152, v153
    v_xor_b32 v153, v9, v59
    v_or_b32 v152, v152, v153
    v_xor_b32 v153, v9, v61
    v_or_b32 v152, v152, v153
    v_xor_b32 v153, v9, v63
    v_or_b32 v152, v152, v153
    v_xor_b32 v153, v9, v65
    v_or_b32 v152, v152, v153
    v_xor_b32 v153, v9, v67
    v_or_b32 v152, v152, v153
    v_xor_b32 v153, v9, v69
    v_or_b32 v152, v152, v153
    v_xor_b32 v153, v9, v71
    v_or_b32 v152, v152, v153
    v_xor_b32 v153, v9, v73
    v_or_b32 v152, v152, v153
    v_xor_b32 v153, v9, v75
    v_or_b32 v152, v152, v153
    v_xor_b32 v153, v9, v77
    v_or_b32 v152, v152, v153
    v_xor_b32 v153, v9, v79
    v_or_b32 v152, v152, v153
    v_xor_b32 v153, v9, v81
    v_or_b32 v152, v152, v153
    v_xor_b32 v153, v9, v83
    v_or_b32 v152, v152, v153
    v_cmp_ne_u32 vcc, 0, v152
    s_sub_u32 s59, s59, 1
    s_cbranch_scc1 L2_yok
    s_cbranch_vccz L2_yok
    buffer_load_dwordx4 v[20:23], v16, s[12:15], s54 offen offset:0 sc1
    buffer_load_dwordx4 v[24:27], v16, s[12:15], s54 offen offset:16 sc1
    buffer_load_dwordx4 v[28:31], v16, s[12:15], s54 offen offset:512 sc1
    buffer_load_dwordx4 v[32:35], v16, s[12:15], s54 offen offset:528 sc1
    buffer_load_dwordx4 v[36:39], v16, s[12:15], s54 offen offset:1024 sc1
    buffer_load_dwordx4 v[40:43], v16, s[12:15], s54 offen offset:1040 sc1
    buffer_load_dwordx4 v[44:47], v16, s[12:15], s54 offen offset:1536 sc1
    buffer_load_dwordx4 v[48:51], v16, s[12:15], s54 offen offset:1552 sc1
    buffer_load_dwordx4 v[52:55], v16, s[12:15], s54 offen offset:2048 sc1
    buffer_load_dwordx4 v[56:59], v16, s[12:15], s54 offen offset:2064 sc1
    buffer_load_dwordx4 v[60:63], v16, s[12:15], s54 offen offset:2560 sc1
    buffer_load_dwordx4 v[64:67], v16, s[12:15], s54 offen offset:2576 sc1
    buffer_load_dwordx4 v[68:71], v16, s[12:15], s54 offen offset:3072 sc1
    buffer_load_dwordx4 v[72:75], v16, s[12:15], s54 offen offset:3088 sc1
    buffer_load_dwordx4 v[76:79], v16, s[12:15], s54 offen offset:3584 sc1
    buffer_load_dwordx4 v[80:83], v16, s[12:15], s54 offen offset:3600 sc1
    s_branch L2_ypoll
L2_yok:
    v_add_f32 v20, v20, v28
    v_add_f32 v20, v20, v36
    v_add_f32 v20, v20, v44
    v_add_f32 v20, v20, v52
    v_add_f32 v20, v20, v60
    v_add_f32 v20, v20, v68
    v_add_f32 v20, v20, v76
    v_add_f32 v22, v22, v30
    v_add_f32 v22, v22, v38
    v_add_f32 v22, v22, v46
    v_add_f32 v22, v22, v54
    v_add_f32 v22, v22, v62
    v_add_f32 v22, v22, v70
    v_add_f32 v22, v22, v78
    v_add_f32 v24, v24, v32
    v_add_f32 v24, v24, v40
    v_add_f32 v24, v24, v48
    v_add_f32 v24, v24, v56
    v_add_f32 v24, v24, v64
    v_add_f32 v24, v24, v72
    v_add_f32 v24, v24, v80
    v_add_f32 v26, v26, v34
    v_add_f32 v26, v26, v42
    v_add_f32 v26, v26, v50
    v_add_f32 v26, v26, v58
    v_add_f32 v26, v26, v66
    v_add_f32 v26, v26, v74
    v_add_f32 v26, v26, v82
    v_mov_b32 v21, v20
    v_mov_b32 v23, v22
    v_mov_b32 v25, v24
    v_mov_b32 v27, v26
    v_permlane16_swap_b32 v20, v21
    v_permlane16_swap_b32 v22, v23
    v_permlane16_swap_b32 v24, v25
    v_permlane16_swap_b32 v26, v27
    v_add_f32 v28, v20, v21
    v_add_f32 v29, v22, v23
    v_add_f32 v30, v24, v25
    v_add_f32 v31, v26, v27
    v_cvt_pk_bf16_f32 v28, v28, v29
    v_and_b32 v29, 0xffff0000, v28
    v_lshlrev_b32 v28, 16, v28
    v_mul_f32 v28, v28, v168
    v_mul_f32 v29, v29, v168
    v_cvt_pk_bf16_f32 v28, v28, v29
    v_and_b32 v29, 0xffff0000, v28
    v_lshlrev_b32 v28, 16, v28
    v_lshlrev_b32 v152, 16, v160
    v_and_b32 v153, 0xffff0000, v160
    v_pk_add_f32 v[28:29], v[28:29], v[152:153]
    v_cvt_pk_bf16_f32 v28, v28, v29
    v_and_b32 v29, 0xffff0000, v28
    v_lshlrev_b32 v28, 16, v28
    v_cvt_pk_bf16_f32 v30, v30, v31
    v_and_b32 v31, 0xffff0000, v30
    v_lshlrev_b32 v30, 16, v30
    v_mul_f32 v30, v30, v168
    v_mul_f32 v31, v31, v168
    v_cvt_pk_bf16_f32 v30, v30, v31
    v_and_b32 v31, 0xffff0000, v30
    v_lshlrev_b32 v30, 16, v30
    v_lshlrev_b32 v152, 16, v161
    v_and_b32 v153, 0xffff0000, v161
    v_pk_add_f32 v[30:31], v[30:31], v[152:153]
    v_cvt_pk_bf16_f32 v30, v30, v31
    v_and_b32 v31, 0xffff0000, v30
    v_lshlrev_b32 v30, 16, v30
    v_lshlrev_b32 v152, 16, v160
    v_and_b32 v153, 0xffff0000, v160
    v_pk_mul_f32 v[154:155], v[152:153], v[116:117]
    v_pk_mul_f32 v[152:153], v[162:163], v[28:29] op_sel:[1,0]
    v_cvt_pk_bf16_f32 v154, v154, v155
    v_cvt_pk_bf16_f32 v152, v152, v153
    v_and_b32 v155, 0xffff0000, v154
    v_lshlrev_b32 v154, 16, v154
    v_and_b32 v153, 0xffff0000, v152
    v_lshlrev_b32 v152, 16, v152
    v_pk_fma_f32 v[164:165], v[162:163], v[154:155], v[152:153] op_sel_hi:[0,1,1]
    v_lshlrev_b32 v152, 16, v161
    v_and_b32 v153, 0xffff0000, v161
    v_pk_mul_f32 v[154:155], v[152:153], v[118:119]
    v_pk_mul_f32 v[152:153], v[162:163], v[30:31] op_sel:[1,0]
    v_cvt_pk_bf16_f32 v154, v154, v155
    v_cvt_pk_bf16_f32 v152, v152, v153
    v_and_b32 v155, 0xffff0000, v154
    v_lshlrev_b32 v154, 16, v154
    v_and_b32 v153, 0xffff0000, v152
    v_lshlrev_b32 v152, 16, v152
    v_pk_fma_f32 v[166:167], v[162:163], v[154:155], v[152:153] op_sel_hi:[0,1,1]
L2_notok:
    s_barrier
    ds_read_b128 v[20:23], v12 offset:0
    ds_read_b128 v[24:27], v13 offset:1024
    ds_read_b128 v[28:31], v12 offset:2048
    ds_read_b128 v[32:35], v13 offset:3072
    ds_read_b128 v[36:39], v12 offset:4096
    ds_read_b128 v[40:43], v13 offset:5120
    ds_read_b128 v[44:47], v12 offset:6144
    ds_read_b128 v[48:51], v13 offset:7168
    ds_read_b128 v[52:55], v8
    v_cmp_eq_u32 vcc, 0, v170
    s_waitcnt lgkmcnt(8)
    v_pk_fma_f32 v[20:21], v[100:101], v[20:21], v[120:121] op_sel_hi:[0,1,1]
    v_pk_fma_f32 v[22:23], v[100:101], v[22:23], v[122:123] op_sel_hi:[0,1,1]
    s_mov_b64 exec, vcc
    buffer_store_dwordx4 v[20:23], v10, s[44:47], s58 offen
    s_mov_b64 exec, -1
    s_add_u32 s58, s58, 16384
    v_cmp_eq_u32 vcc, 0, v171
    s_waitcnt lgkmcnt(7)
    v_pk_fma_f32 v[24:25], v[102:103], v[24:25], v[124:125] op_sel_hi:[0,1,1]
    v_pk_fma_f32 v[26:27], v[102:103], v[26:27], v[126:127] op_sel_hi:[0,1,1]
    s_mov_b64 exec, vcc
    buffer_store_dwordx4 v[24:27], v10, s[44:47], s58 offen
    s_mov_b64 exec, -1
    s_add_u32 s58, s58, 16384
    v_cmp_eq_u32 vcc, 0, v172
    s_waitcnt lgkmcnt(6)
    v_pk_fma_f32 v[28:29], v[104:105], v[28:29], v[128:129] op_sel_hi:[0,1,1]
    v_pk_fma_f32 v[30:31], v[104:105], v[30:31], v[130:131] op_sel_hi:[0,1,1]
    s_mov_b64 exec, vcc
    buffer_store_dwordx4 v[28:31], v10, s[44:47], s58 offen
    s_mov_b64 exec, -1
    s_add_u32 s58, s58, 16384
    v_cmp_eq_u32 vcc, 0, v173
    s_waitcnt lgkmcnt(5)
    v_pk_fma_f32 v[32:33], v[106:107], v[32:33], v[132:133] op_sel_hi:[0,1,1]
    v_pk_fma_f32 v[34:35], v[106:107], v[34:35], v[134:135] op_sel_hi:[0,1,1]
    s_mov_b64 exec, vcc
    buffer_store_dwordx4 v[32:35], v10, s[44:47], s58 offen
    s_mov_b64 exec, -1
    s_add_u32 s58, s58, 16384
    v_cmp_eq_u32 vcc, 0, v174
    s_waitcnt lgkmcnt(4)
    v_pk_fma_f32 v[36:37], v[108:109], v[36:37], v[136:137] op_sel_hi:[0,1,1]
    v_pk_fma_f32 v[38:39], v[108:109], v[38:39], v[138:139] op_sel_hi:[0,1,1]
    s_mov_b64 exec, vcc
    buffer_store_dwordx4 v[36:39], v10, s[44:47], s58 offen
    s_mov_b64 exec, -1
    s_add_u32 s58, s58, 16384
    v_cmp_eq_u32 vcc, 0, v175
    s_waitcnt lgkmcnt(3)
    v_pk_fma_f32 v[40:41], v[110:111], v[40:41], v[140:141] op_sel_hi:[0,1,1]
    v_pk_fma_f32 v[42:43], v[110:111], v[42:43], v[142:143] op_sel_hi:[0,1,1]
    s_mov_b64 exec, vcc
    buffer_store_dwordx4 v[40:43], v10, s[44:47], s58 offen
    s_mov_b64 exec, -1
    s_add_u32 s58, s58, 16384
    v_cmp_eq_u32 vcc, 0, v176
    s_waitcnt lgkmcnt(2)
    v_pk_fma_f32 v[44:45], v[112:113], v[44:45], v[144:145] op_sel_hi:[0,1,1]
    v_pk_fma_f32 v[46:47], v[112:113], v[46:47], v[146:147] op_sel_hi:[0,1,1]
    s_mov_b64 exec, vcc
    buffer_store_dwordx4 v[44:47], v10, s[44:47], s58 offen
    s_mov_b64 exec, -1
    s_add_u32 s58, s58, 16384
    v_cmp_eq_u32 vcc, 0, v177
    s_waitcnt lgkmcnt(1)
    v_pk_fma_f32 v[48:49], v[114:115], v[48:49], v[148:149] op_sel_hi:[0,1,1]
    v_pk_fma_f32 v[50:51], v[114:115], v[50:51], v[150:151] op_sel_hi:[0,1,1]
    s_mov_b64 exec, vcc
    buffer_store_dwordx4 v[48:51], v10, s[44:47], s58 offen
    s_mov_b64 exec, -1
    s_add_u32 s58, s58, 16384
    s_waitcnt lgkmcnt(0)
    v_pk_fma_f32 v[52:53], v[162:163], v[52:53], v[164:165] op_sel_hi:[0,1,1]
    v_pk_fma_f32 v[54:55], v[162:163], v[54:55], v[166:167] op_sel_hi:[0,1,1]
    s_and_b32 exec_lo, s52, 0xffff
    s_and_b32 exec_hi, s53, 0xffff
    s_cbranch_execz L2_aend
    buffer_store_dwordx4 v[52:55], v11, s[44:47], s57 offen
L2_aend:
    s_endpgm
L2_compute:
    s_load_dwordx2 s[8:9], s[0:1], 136
    s_lshl_b32 s32, s26, 3
    s_lshl_b32 s33, s29, 1
    s_add_u32 s32, s32, s33
    s_lshl_b32 s32, s32, 10
    s_add_u32 s33, s32, 4194304
    s_sub_u32 s10, 8388608, s32
    s_mov_b32 s11, 0x20000
    s_lshl_b32 s62, s61, 19
    v_lshlrev_b32 v4, 4, v1
    v_and_b32 v6, 15, v1
    v_lshrrev_b32 v7, 4, v1
    v_lshrrev_b32 v2, 1, v6
    v_xor_b32 v2, v2, v7
    v_lshlrev_b32 v2, 4, v2
    v_lshl_add_u32 v2, v6, 7, v2
    v_xor_b32 v3, 64, v2
    s_waitcnt lgkmcnt(0)
    s_add_u32 s8, s8, s33
    s_addc_u32 s9, s9, 0
    buffer_load_dwordx4 v[40:43], v4, s[8:11], s62 offen offset:0
    buffer_load_dwordx4 v[44:47], v4, s[8:11], s62 offen offset:1024
    s_add_u32 s62, s62, 131072
    s_and_b32 s62, s62, 8388607
    buffer_load_dwordx4 v[48:51], v4, s[8:11], s62 offen offset:0
    buffer_load_dwordx4 v[52:55], v4, s[8:11], s62 offen offset:1024
    s_add_u32 s62, s62, 131072
    s_and_b32 s62, s62, 8388607
    buffer_load_dwordx4 v[56:59], v4, s[8:11], s62 offen offset:0
    buffer_load_dwordx4 v[60:63], v4, s[8:11], s62 offen offset:1024
    s_add_u32 s62, s62, 131072
    s_and_b32 s62, s62, 8388607
    buffer_load_dwordx4 v[64:67], v4, s[8:11], s62 offen offset:0
    buffer_load_dwordx4 v[68:71], v4, s[8:11], s62 offen offset:1024
    s_add_u32 s62, s62, 131072
    s_and_b32 s62, s62, 8388607
    buffer_load_dwordx4 v[72:75], v4, s[8:11], s62 offen offset:0
    buffer_load_dwordx4 v[76:79], v4, s[8:11], s62 offen offset:1024
    s_add_u32 s62, s62, 131072
    s_and_b32 s62, s62, 8388607
    buffer_load_dwordx4 v[80:83], v4, s[8:11], s62 offen offset:0
    buffer_load_dwordx4 v[84:87], v4, s[8:11], s62 offen offset:1024
    s_add_u32 s62, s62, 131072
    s_and_b32 s62, s62, 8388607
    buffer_load_dwordx4 v[88:91], v4, s[8:11], s62 offen offset:0
    buffer_load_dwordx4 v[92:95], v4, s[8:11], s62 offen offset:1024
    s_add_u32 s62, s62, 131072
    s_and_b32 s62, s62, 8388607
    buffer_load_dwordx4 v[96:99], v4, s[8:11], s62 offen offset:0
    buffer_load_dwordx4 v[100:103], v4, s[8:11], s62 offen offset:1024
    s_add_u32 s62, s62, 131072
    s_and_b32 s62, s62, 8388607
    v_mov_b32 v104, 0
    v_mov_b32 v105, 0
    v_mov_b32 v106, 0
    v_mov_b32 v107, 0
    v_mov_b32 v108, 0
    v_mov_b32 v109, 0
    v_mov_b32 v110, 0
    v_mov_b32 v111, 0
    v_mov_b32 v112, 0
    v_mov_b32 v113, 0
    v_mov_b32 v114, 0
    v_mov_b32 v115, 0
    v_mov_b32 v116, 0
    v_mov_b32 v117, 0
    v_mov_b32 v118, 0
    v_mov_b32 v119, 0
    v_mov_b32 v120, 0
    v_mov_b32 v121, 0
    v_mov_b32 v122, 0
    v_mov_b32 v123, 0
    v_mov_b32 v124, 0
    v_mov_b32 v125, 0
    v_mov_b32 v126, 0
    v_mov_b32 v127, 0
    v_mov_b32 v128, 0
    v_mov_b32 v129, 0
    v_mov_b32 v130, 0
    v_mov_b32 v131, 0
    v_mov_b32 v132, 0
    v_mov_b32 v133, 0
    v_mov_b32 v134, 0
    v_mov_b32 v135, 0
    v_and_b32 v5, 7, v6
    v_xor_b32 v5, v5, v7
    v_lshlrev_b32 v5, 4, v5
    v_lshl_add_u32 v5, v6, 8, v5
    s_lshl_b32 s33, s29, 13
    v_add_u32 v136, s33, v5
    v_xor_b32 v137, 64, v136
    v_xor_b32 v138, 128, v136
    v_xor_b32 v139, 192, v136
    s_barrier
    ds_read_b128 v[8:11], v2 offset:0
    ds_read_b128 v[12:15], v2 offset:2048
    ds_read_b128 v[16:19], v2 offset:4096
    ds_read_b128 v[20:23], v2 offset:6144
    s_mov_b32 s35, 0
L2_loop:
    s_cmp_eq_u32 s35, 7
    s_cselect_b32 s10, 0, s10
    s_waitcnt vmcnt(15) lgkmcnt(0)
    v_mfma_f32_16x16x32_bf16 v[104:107], v[8:11], v[40:43], v[104:107]
    ds_read_b128 v[24:27], v3 offset:0
    v_mfma_f32_16x16x32_bf16 v[108:111], v[12:15], v[40:43], v[108:111]
    ds_read_b128 v[28:31], v3 offset:2048
    v_mfma_f32_16x16x32_bf16 v[112:115], v[16:19], v[40:43], v[112:115]
    ds_read_b128 v[32:35], v3 offset:4096
    v_mfma_f32_16x16x32_bf16 v[116:119], v[20:23], v[40:43], v[116:119]
    ds_read_b128 v[36:39], v3 offset:6144
    buffer_load_dwordx4 v[40:43], v4, s[8:11], s62 offen offset:0
    s_waitcnt vmcnt(15)
    v_mfma_f32_16x16x32_bf16 v[132:135], v[20:23], v[44:47], v[132:135]
    v_mfma_f32_16x16x32_bf16 v[128:131], v[16:19], v[44:47], v[128:131]
    v_mfma_f32_16x16x32_bf16 v[124:127], v[12:15], v[44:47], v[124:127]
    v_mfma_f32_16x16x32_bf16 v[120:123], v[8:11], v[44:47], v[120:123]
    buffer_load_dwordx4 v[44:47], v4, s[8:11], s62 offen offset:1024
    s_add_u32 s62, s62, 131072
    s_and_b32 s62, s62, 8388607
    s_waitcnt vmcnt(15) lgkmcnt(0)
    v_mfma_f32_16x16x32_bf16 v[104:107], v[24:27], v[48:51], v[104:107]
    ds_read_b128 v[8:11], v2 offset:8192
    v_mfma_f32_16x16x32_bf16 v[108:111], v[28:31], v[48:51], v[108:111]
    ds_read_b128 v[12:15], v2 offset:10240
    v_mfma_f32_16x16x32_bf16 v[112:115], v[32:35], v[48:51], v[112:115]
    ds_read_b128 v[16:19], v2 offset:12288
    v_mfma_f32_16x16x32_bf16 v[116:119], v[36:39], v[48:51], v[116:119]
    ds_read_b128 v[20:23], v2 offset:14336
    buffer_load_dwordx4 v[48:51], v4, s[8:11], s62 offen offset:0
    s_waitcnt vmcnt(15)
    v_mfma_f32_16x16x32_bf16 v[132:135], v[36:39], v[52:55], v[132:135]
    v_mfma_f32_16x16x32_bf16 v[128:131], v[32:35], v[52:55], v[128:131]
    v_mfma_f32_16x16x32_bf16 v[124:127], v[28:31], v[52:55], v[124:127]
    v_mfma_f32_16x16x32_bf16 v[120:123], v[24:27], v[52:55], v[120:123]
    buffer_load_dwordx4 v[52:55], v4, s[8:11], s62 offen offset:1024
    s_add_u32 s62, s62, 131072
    s_and_b32 s62, s62, 8388607
    s_waitcnt vmcnt(15) lgkmcnt(0)
    v_mfma_f32_16x16x32_bf16 v[104:107], v[8:11], v[56:59], v[104:107]
    ds_read_b128 v[24:27], v3 offset:8192
    v_mfma_f32_16x16x32_bf16 v[108:111], v[12:15], v[56:59], v[108:111]
    ds_read_b128 v[28:31], v3 offset:10240
    v_mfma_f32_16x16x32_bf16 v[112:115], v[16:19], v[56:59], v[112:115]
    ds_read_b128 v[32:35], v3 offset:12288
    v_mfma_f32_16x16x32_bf16 v[116:119], v[20:23], v[56:59], v[116:119]
    ds_read_b128 v[36:39], v3 offset:14336
    buffer_load_dwordx4 v[56:59], v4, s[8:11], s62 offen offset:0
    s_waitcnt vmcnt(15)
    v_mfma_f32_16x16x32_bf16 v[132:135], v[20:23], v[60:63], v[132:135]
    v_mfma_f32_16x16x32_bf16 v[128:131], v[16:19], v[60:63], v[128:131]
    v_mfma_f32_16x16x32_bf16 v[124:127], v[12:15], v[60:63], v[124:127]
    v_mfma_f32_16x16x32_bf16 v[120:123], v[8:11], v[60:63], v[120:123]
    buffer_load_dwordx4 v[60:63], v4, s[8:11], s62 offen offset:1024
    s_add_u32 s62, s62, 131072
    s_and_b32 s62, s62, 8388607
    s_waitcnt vmcnt(15) lgkmcnt(0)
    v_mfma_f32_16x16x32_bf16 v[104:107], v[24:27], v[64:67], v[104:107]
    s_barrier
    v_mfma_f32_16x16x32_bf16 v[108:111], v[28:31], v[64:67], v[108:111]
    ds_read_b128 v[8:11], v2 offset:16384
    v_mfma_f32_16x16x32_bf16 v[112:115], v[32:35], v[64:67], v[112:115]
    ds_read_b128 v[12:15], v2 offset:18432
    v_mfma_f32_16x16x32_bf16 v[116:119], v[36:39], v[64:67], v[116:119]
    ds_read_b128 v[16:19], v2 offset:20480
    buffer_load_dwordx4 v[64:67], v4, s[8:11], s62 offen offset:0
    s_waitcnt vmcnt(15)
    v_mfma_f32_16x16x32_bf16 v[132:135], v[36:39], v[68:71], v[132:135]
    ds_read_b128 v[20:23], v2 offset:22528
    v_mfma_f32_16x16x32_bf16 v[128:131], v[32:35], v[68:71], v[128:131]
    v_mfma_f32_16x16x32_bf16 v[124:127], v[28:31], v[68:71], v[124:127]
    v_mfma_f32_16x16x32_bf16 v[120:123], v[24:27], v[68:71], v[120:123]
    buffer_load_dwordx4 v[68:71], v4, s[8:11], s62 offen offset:1024
    s_add_u32 s62, s62, 131072
    s_and_b32 s62, s62, 8388607
    s_waitcnt vmcnt(15) lgkmcnt(0)
    v_mfma_f32_16x16x32_bf16 v[104:107], v[8:11], v[72:75], v[104:107]
    ds_read_b128 v[24:27], v3 offset:16384
    v_mfma_f32_16x16x32_bf16 v[108:111], v[12:15], v[72:75], v[108:111]
    ds_read_b128 v[28:31], v3 offset:18432
    v_mfma_f32_16x16x32_bf16 v[112:115], v[16:19], v[72:75], v[112:115]
    ds_read_b128 v[32:35], v3 offset:20480
    v_mfma_f32_16x16x32_bf16 v[116:119], v[20:23], v[72:75], v[116:119]
    ds_read_b128 v[36:39], v3 offset:22528
    buffer_load_dwordx4 v[72:75], v4, s[8:11], s62 offen offset:0
    s_waitcnt vmcnt(15)
    v_mfma_f32_16x16x32_bf16 v[132:135], v[20:23], v[76:79], v[132:135]
    v_mfma_f32_16x16x32_bf16 v[128:131], v[16:19], v[76:79], v[128:131]
    v_mfma_f32_16x16x32_bf16 v[124:127], v[12:15], v[76:79], v[124:127]
    v_mfma_f32_16x16x32_bf16 v[120:123], v[8:11], v[76:79], v[120:123]
    buffer_load_dwordx4 v[76:79], v4, s[8:11], s62 offen offset:1024
    s_add_u32 s62, s62, 131072
    s_and_b32 s62, s62, 8388607
    s_waitcnt vmcnt(15) lgkmcnt(0)
    v_mfma_f32_16x16x32_bf16 v[104:107], v[24:27], v[80:83], v[104:107]
    ds_read_b128 v[8:11], v2 offset:24576
    v_mfma_f32_16x16x32_bf16 v[108:111], v[28:31], v[80:83], v[108:111]
    ds_read_b128 v[12:15], v2 offset:26624
    v_mfma_f32_16x16x32_bf16 v[112:115], v[32:35], v[80:83], v[112:115]
    ds_read_b128 v[16:19], v2 offset:28672
    v_mfma_f32_16x16x32_bf16 v[116:119], v[36:39], v[80:83], v[116:119]
    ds_read_b128 v[20:23], v2 offset:30720
    buffer_load_dwordx4 v[80:83], v4, s[8:11], s62 offen offset:0
    s_waitcnt vmcnt(15)
    v_mfma_f32_16x16x32_bf16 v[132:135], v[36:39], v[84:87], v[132:135]
    v_mfma_f32_16x16x32_bf16 v[128:131], v[32:35], v[84:87], v[128:131]
    v_mfma_f32_16x16x32_bf16 v[124:127], v[28:31], v[84:87], v[124:127]
    v_mfma_f32_16x16x32_bf16 v[120:123], v[24:27], v[84:87], v[120:123]
    buffer_load_dwordx4 v[84:87], v4, s[8:11], s62 offen offset:1024
    s_add_u32 s62, s62, 131072
    s_and_b32 s62, s62, 8388607
    s_waitcnt vmcnt(15) lgkmcnt(0)
    v_mfma_f32_16x16x32_bf16 v[104:107], v[8:11], v[88:91], v[104:107]
    ds_read_b128 v[24:27], v3 offset:24576
    v_mfma_f32_16x16x32_bf16 v[108:111], v[12:15], v[88:91], v[108:111]
    ds_read_b128 v[28:31], v3 offset:26624
    v_mfma_f32_16x16x32_bf16 v[112:115], v[16:19], v[88:91], v[112:115]
    ds_read_b128 v[32:35], v3 offset:28672
    v_mfma_f32_16x16x32_bf16 v[116:119], v[20:23], v[88:91], v[116:119]
    ds_read_b128 v[36:39], v3 offset:30720
    buffer_load_dwordx4 v[88:91], v4, s[8:11], s62 offen offset:0
    s_waitcnt vmcnt(15)
    v_mfma_f32_16x16x32_bf16 v[132:135], v[20:23], v[92:95], v[132:135]
    v_mfma_f32_16x16x32_bf16 v[128:131], v[16:19], v[92:95], v[128:131]
    v_mfma_f32_16x16x32_bf16 v[124:127], v[12:15], v[92:95], v[124:127]
    v_mfma_f32_16x16x32_bf16 v[120:123], v[8:11], v[92:95], v[120:123]
    buffer_load_dwordx4 v[92:95], v4, s[8:11], s62 offen offset:1024
    s_add_u32 s62, s62, 131072
    s_and_b32 s62, s62, 8388607
    s_cmp_eq_u32 s35, 7
    s_waitcnt vmcnt(15) lgkmcnt(0)
    v_mfma_f32_16x16x32_bf16 v[104:107], v[24:27], v[96:99], v[104:107]
    v_xor_b32 v2, 0x8000, v2
    v_xor_b32 v3, 0x8000, v3
    s_cbranch_scc1 L2_nobar
    s_barrier
L2_nobar:
    v_mfma_f32_16x16x32_bf16 v[108:111], v[28:31], v[96:99], v[108:111]
    ds_read_b128 v[8:11], v2 offset:0
    v_mfma_f32_16x16x32_bf16 v[112:115], v[32:35], v[96:99], v[112:115]
    ds_read_b128 v[12:15], v2 offset:2048
    v_mfma_f32_16x16x32_bf16 v[116:119], v[36:39], v[96:99], v[116:119]
    ds_read_b128 v[16:19], v2 offset:4096
    buffer_load_dwordx4 v[96:99], v4, s[8:11], s62 offen offset:0
    s_waitcnt vmcnt(15)
    v_mfma_f32_16x16x32_bf16 v[132:135], v[36:39], v[100:103], v[132:135]
    ds_read_b128 v[20:23], v2 offset:6144
    v_mfma_f32_16x16x32_bf16 v[128:131], v[32:35], v[100:103], v[128:131]
    v_mfma_f32_16x16x32_bf16 v[124:127], v[28:31], v[100:103], v[124:127]
    v_mfma_f32_16x16x32_bf16 v[120:123], v[24:27], v[100:103], v[120:123]
    buffer_load_dwordx4 v[100:103], v4, s[8:11], s62 offen offset:1024
    s_add_u32 s62, s62, 131072
    s_and_b32 s62, s62, 8388607
    s_add_u32 s35, s35, 1
    s_cmp_lt_u32 s35, 8
    s_cbranch_scc1 L2_loop
    ds_write_b128 v136, v[104:107] offset:0
    ds_write_b128 v137, v[108:111] offset:0
    ds_write_b128 v138, v[112:115] offset:0
    ds_write_b128 v139, v[116:119] offset:0
    ds_write_b128 v136, v[120:123] offset:4096
    ds_write_b128 v137, v[124:127] offset:4096
    ds_write_b128 v138, v[128:131] offset:4096
    ds_write_b128 v139, v[132:135] offset:4096
    s_waitcnt lgkmcnt(0)
    s_barrier
L2_end:
    s_endpgm
.section .rodata,"a"
.p2align 6
.amdhsa_kernel k1_kernel
  .amdhsa_next_free_vgpr 200
  .amdhsa_next_free_sgpr 102
  .amdhsa_accum_offset 200
  .amdhsa_group_segment_fixed_size 0
  .amdhsa_kernarg_size 144
  .amdhsa_user_sgpr_count 2
  .amdhsa_user_sgpr_kernarg_segment_ptr 1
  .amdhsa_system_sgpr_workgroup_id_x 1
  .amdhsa_float_denorm_mode_32 3
.end_amdhsa_kernel
.p2align 6
.amdhsa_kernel k2_kernel
  .amdhsa_next_free_vgpr 200
  .amdhsa_next_free_sgpr 102
  .amdhsa_accum_offset 200
  .amdhsa_group_segment_fixed_size 0
  .amdhsa_kernarg_size 144
  .amdhsa_user_sgpr_count 2
  .amdhsa_user_sgpr_kernarg_segment_ptr 1
  .amdhsa_system_sgpr_workgroup_id_x 1
  .amdhsa_float_denorm_mode_32 3
.end_amdhsa_kernel
```

```asm
; @launch grid=(256,1,1) block=(512,1,1) lds=163840
.amdgcn_target "amdgcn-amd-amdhsa--gfx950"
.text
.globl gated_mix__ssm_conv_s5__moe_arch_mod__prompt_kernel
.p2align 8
.type gated_mix__ssm_conv_s5__moe_arch_mod__prompt_kernel,@function
gated_mix__ssm_conv_s5__moe_arch_mod__prompt_kernel:
    s_cmp_ge_u32 s2, 256
    s_cbranch_scc1 L_end
    v_lshrrev_b32 v2, 6, v0
    v_and_b32 v1, 63, v0
    s_nop 0
    v_readfirstlane_b32 s29, v2
    s_and_b32 s24, s2, 7
    s_lshr_b32 s25, s2, 3
    s_lshr_b32 s26, s25, 3
    s_lshl_b32 s26, s26, 2
    s_lshr_b32 s27, s24, 1
    s_add_u32 s26, s26, s27
    s_and_b32 s27, s24, 1
    s_lshl_b32 s27, s27, 3
    s_and_b32 s28, s25, 7
    s_add_u32 s27, s27, s28
    s_cmp_lt_u32 s29, 4
    s_cbranch_scc1 L_compute
    s_load_dwordx2 s[56:57], s[0:1], 0
    s_load_dwordx4 s[12:15], s[0:1], 24
    s_load_dwordx2 s[36:37], s[0:1], 64
    s_load_dwordx2 s[40:41], s[0:1], 120
    s_load_dwordx2 s[16:17], s[0:1], 136
    s_load_dwordx2 s[44:45], s[0:1], 104
    s_load_dwordx2 s[48:49], s[0:1], 88
    s_load_dwordx2 s[52:53], s[0:1], 96
    s_and_b32 s30, s29, 3
    v_lshrrev_b32 v3, 3, v1
    v_and_b32 v4, 7, v1
    v_lshrrev_b32 v5, 1, v3
    v_xor_b32 v2, v4, v5
    v_lshlrev_b32 v2, 4, v2
    v_lshl_add_u32 v14, v3, 11, v2
    v_xor_b32 v15, 64, v14
    v_add_u32 v16, 30720, v14
    v_add_u32 v17, 46080, v15
    v_add_u32 v15, 15360, v15
    v_lshrrev_b32 v6, 2, v3
    v_lshlrev_b32 v6, 4, v6
    v_and_b32 v7, 1, v3
    v_lshl_add_u32 v6, v7, 3, v6
    v_and_b32 v7, 1, v5
    v_add_u32 v6, v6, v7
    v_lshl_add_u32 v10, v6, 11, v2
    v_xor_b32 v11, 64, v10
    v_add_u32 v12, 2048, v10
    v_add_u32 v13, 66560, v11
    v_add_u32 v11, 64512, v11
    s_lshr_b32 s31, s30, 1
    s_and_b32 s32, s30, 1
    s_lshl_b32 s33, s26, 7
    s_lshl_b32 s34, s31, 6
    s_add_u32 s33, s33, s34
    s_lshl_b32 s34, s32, 2
    s_add_u32 s33, s33, s34
    s_lshl_b32 s33, s33, 11
    s_lshl_b32 s34, s27, 6
    s_lshl_b32 s35, s31, 5
    s_add_u32 s34, s34, s35
    s_lshl_b32 s64, s34, 11
    s_lshl_b32 s60, s30, 12
    s_add_u32 s61, s26, s27
    s_and_b32 s61, s61, 15
    s_lshl_b32 s61, s61, 7
    s_cmp_eq_u32 s32, 1
    s_waitcnt lgkmcnt(0)
    s_cselect_b32 s12, s14, s12
    s_cselect_b32 s13, s15, s13
    s_add_u32 s12, s12, s64
    s_addc_u32 s13, s13, 0
    s_sub_u32 s14, 2097152, s64
    s_mov_b32 s15, 0x20000
    s_add_u32 s8, s56, s33
    s_addc_u32 s9, s57, 0
    s_sub_u32 s10, 4194304, s33
    s_mov_b32 s11, 0x20000
    s_add_u32 m0, s60, 0
    s_nop 0
    buffer_load_dwordx4 v10, s[8:11], s61 offen offset:0 lds
    buffer_load_dwordx4 v11, s[8:11], s61 offen offset:1024 lds
    buffer_load_dwordx4 v12, s[8:11], s61 offen offset:2048 lds
    buffer_load_dwordx4 v13, s[8:11], s61 offen offset:3072 lds
    s_add_u32 m0, s60, 16384
    s_nop 0
    buffer_load_dwordx4 v14, s[12:15], s61 offen offset:0 lds
    buffer_load_dwordx4 v15, s[12:15], s61 offen offset:1024 lds
    buffer_load_dwordx4 v16, s[12:15], s61 offen offset:2048 lds
    buffer_load_dwordx4 v17, s[12:15], s61 offen offset:3072 lds
    s_add_u32 s61, s61, 128
    s_and_b32 s61, s61, 2047
    s_add_u32 m0, s60, 32768
    s_nop 0
    buffer_load_dwordx4 v10, s[8:11], s61 offen offset:0 lds
    buffer_load_dwordx4 v11, s[8:11], s61 offen offset:1024 lds
    buffer_load_dwordx4 v12, s[8:11], s61 offen offset:2048 lds
    buffer_load_dwordx4 v13, s[8:11], s61 offen offset:3072 lds
    s_add_u32 m0, s60, 49152
    s_nop 0
    buffer_load_dwordx4 v14, s[12:15], s61 offen offset:0 lds
    buffer_load_dwordx4 v15, s[12:15], s61 offen offset:1024 lds
    buffer_load_dwordx4 v16, s[12:15], s61 offen offset:2048 lds
    buffer_load_dwordx4 v17, s[12:15], s61 offen offset:3072 lds
    s_add_u32 s61, s61, 128
    s_and_b32 s61, s61, 2047
    v_mov_b32 v9, 0
    v_mov_b32 v8, 0
    v_mov_b32 v7, 147456
    ds_write_b64 v7, v[8:9]
    ds_write_b64 v7, v[8:9] offset:8
    ds_write_b32 v7, v9 offset:16
    s_mov_b32 s58, 4194304
    s_mov_b32 s59, 0x20000
    s_mov_b32 s38, 2048
    s_mov_b32 s39, 0x20000
    s_mov_b32 s42, 8388608
    s_mov_b32 s43, 0x20000
    s_mov_b32 s18, 268435456
    s_mov_b32 s19, 0x20000
    s_mov_b32 s46, 7340032
    s_mov_b32 s47, 0x20000
    s_mov_b32 s50, 7340032
    s_mov_b32 s51, 0x20000
    s_mov_b32 s54, 7340032
    s_mov_b32 s55, 0x20000
    s_lshl_b32 s62, s26, 7
    s_lshl_b32 s63, s27, 3
    s_add_u32 s62, s62, s63
    s_lshl_b32 s62, s62, 3
    v_lshlrev_b32 v18, 4, v1
    v_lshlrev_b32 v19, 3, v4
    s_load_dword s65, s[16:17], 0
    s_waitcnt vmcnt(8) lgkmcnt(0)
    s_barrier
    s_add_u32 m0, s60, 65536
    s_nop 0
    buffer_load_dwordx4 v10, s[8:11], s61 offen offset:0 lds
    buffer_load_dwordx4 v11, s[8:11], s61 offen offset:1024 lds
    buffer_load_dwordx4 v12, s[8:11], s61 offen offset:2048 lds
    buffer_load_dwordx4 v13, s[8:11], s61 offen offset:3072 lds
    s_add_u32 m0, s60, 81920
    s_nop 0
    buffer_load_dwordx4 v14, s[12:15], s61 offen offset:0 lds
    buffer_load_dwordx4 v15, s[12:15], s61 offen offset:1024 lds
    buffer_load_dwordx4 v16, s[12:15], s61 offen offset:2048 lds
    buffer_load_dwordx4 v17, s[12:15], s61 offen offset:3072 lds
    s_add_u32 s61, s61, 128
    s_and_b32 s61, s61, 2047
    s_add_u32 m0, s60, 98304
    s_nop 0
    buffer_load_dwordx4 v10, s[8:11], s61 offen offset:0 lds
    buffer_load_dwordx4 v11, s[8:11], s61 offen offset:1024 lds
    buffer_load_dwordx4 v12, s[8:11], s61 offen offset:2048 lds
    buffer_load_dwordx4 v13, s[8:11], s61 offen offset:3072 lds
    s_add_u32 m0, s60, 114688
    s_nop 0
    buffer_load_dwordx4 v14, s[12:15], s61 offen offset:0 lds
    buffer_load_dwordx4 v15, s[12:15], s61 offen offset:1024 lds
    buffer_load_dwordx4 v16, s[12:15], s61 offen offset:2048 lds
    buffer_load_dwordx4 v17, s[12:15], s61 offen offset:3072 lds
    s_add_u32 s61, s61, 128
    s_and_b32 s61, s61, 2047
    v_add_u32 v21, 147520, v19
    ds_read_b64 v[72:73], v21
    s_load_dwordx4 s[84:87], s[0:1], 40
    s_mul_hi_u32 s70, s2, 76695845
    s_mul_i32 s71, s70, 56
    s_sub_u32 s71, s2, s71
    s_lshl_b32 s72, s70, 8
    s_lshl_b32 s73, s30, 6
    s_add_u32 s72, s72, s73
    s_mul_i32 s73, s72, 7168
    s_lshl_b32 s74, s71, 7
    s_add_u32 s73, s73, s74
    s_cmp_ge_u32 s2, 224
    s_cselect_b32 s50, 0, s50
    s_cselect_b32 s54, 0, s54
    s_lshl_b32 s75, s30, 13
    s_lshl_b32 s69, s30, 12
    s_add_u32 s69, s69, 32768
    s_mov_b32 s76, 0
    v_mul_u32_u24 v31, 7168, v3
    v_lshl_add_u32 v31, v4, 4, v31
    s_and_b32 s63, s25, 3
    s_mul_i32 s65, s65, 1664525
    s_add_u32 s65, s65, 1013904223
    s_waitcnt lgkmcnt(0)
    v_mov_b32 v74, v73
    v_mov_b32 v73, s65
    v_mov_b32 v75, s65
    s_add_u32 s66, s62, 32768
    s_add_u32 s67, s62, 8192
    s_cmp_lg_u32 s30, 0
    s_cbranch_scc1 L_nopub
    s_mov_b64 exec, 0xff
    buffer_store_dwordx2 v[72:73], v19, s[16:19], s66 offen sc1
    buffer_store_dwordx2 v[74:75], v19, s[16:19], s67 offen sc1
    s_mov_b64 exec, -1
L_nopub:
    s_cmp_eq_u32 s32, 1
    s_cselect_b32 s84, s86, s84
    s_cselect_b32 s85, s87, s85
    s_add_u32 s84, s84, s64
    s_addc_u32 s85, s85, 0
    s_waitcnt vmcnt(16)
    s_barrier
    s_add_u32 m0, s60, 0
    s_nop 0
    buffer_load_dwordx4 v10, s[8:11], s61 offen offset:0 lds
    buffer_load_dwordx4 v11, s[8:11], s61 offen offset:1024 lds
    buffer_load_dwordx4 v12, s[8:11], s61 offen offset:2048 lds
    buffer_load_dwordx4 v13, s[8:11], s61 offen offset:3072 lds
    s_add_u32 m0, s60, 16384
    s_nop 0
    buffer_load_dwordx4 v14, s[12:15], s61 offen offset:0 lds
    buffer_load_dwordx4 v15, s[12:15], s61 offen offset:1024 lds
    buffer_load_dwordx4 v16, s[12:15], s61 offen offset:2048 lds
    buffer_load_dwordx4 v17, s[12:15], s61 offen offset:3072 lds
    s_add_u32 s61, s61, 128
    s_and_b32 s61, s61, 2047
    s_waitcnt vmcnt(16)
    s_barrier
    s_add_u32 m0, s60, 32768
    s_nop 0
    buffer_load_dwordx4 v10, s[8:11], s61 offen offset:0 lds
    buffer_load_dwordx4 v11, s[8:11], s61 offen offset:1024 lds
    buffer_load_dwordx4 v12, s[8:11], s61 offen offset:2048 lds
    buffer_load_dwordx4 v13, s[8:11], s61 offen offset:3072 lds
    s_add_u32 m0, s60, 49152
    s_nop 0
    buffer_load_dwordx4 v14, s[12:15], s61 offen offset:0 lds
    buffer_load_dwordx4 v15, s[12:15], s61 offen offset:1024 lds
    buffer_load_dwordx4 v16, s[12:15], s61 offen offset:2048 lds
    buffer_load_dwordx4 v17, s[12:15], s61 offen offset:3072 lds
    s_add_u32 s61, s61, 128
    s_and_b32 s61, s61, 2047
    s_waitcnt vmcnt(16)
    s_barrier
    s_add_u32 m0, s60, 65536
    s_nop 0
    buffer_load_dwordx4 v10, s[8:11], s61 offen offset:0 lds
    buffer_load_dwordx4 v11, s[8:11], s61 offen offset:1024 lds
    buffer_load_dwordx4 v12, s[8:11], s61 offen offset:2048 lds
    buffer_load_dwordx4 v13, s[8:11], s61 offen offset:3072 lds
    s_add_u32 m0, s60, 81920
    s_nop 0
    buffer_load_dwordx4 v14, s[12:15], s61 offen offset:0 lds
    buffer_load_dwordx4 v15, s[12:15], s61 offen offset:1024 lds
    buffer_load_dwordx4 v16, s[12:15], s61 offen offset:2048 lds
    buffer_load_dwordx4 v17, s[12:15], s61 offen offset:3072 lds
    s_add_u32 s61, s61, 128
    s_and_b32 s61, s61, 2047
    s_cmp_lg_u32 s63, 0
    s_cbranch_scc1 L_gapt_wu_1
    s_add_u32 s74, s73, 0
    buffer_load_dwordx4 v[128:131], v31, s[52:55], s74 offen
    s_add_u32 s74, s73, 57344
    buffer_load_dwordx4 v[132:135], v31, s[52:55], s74 offen
    s_add_u32 s74, s73, 114688
    buffer_load_dwordx4 v[136:139], v31, s[52:55], s74 offen
    s_add_u32 s74, s73, 172032
    buffer_load_dwordx4 v[140:143], v31, s[52:55], s74 offen
    s_add_u32 s74, s73, 229376
    buffer_load_dwordx4 v[144:147], v31, s[52:55], s74 offen
    s_add_u32 s74, s73, 286720
    buffer_load_dwordx4 v[148:151], v31, s[52:55], s74 offen
    s_add_u32 s74, s73, 344064
    buffer_load_dwordx4 v[152:155], v31, s[52:55], s74 offen
    s_add_u32 s74, s73, 401408
    buffer_load_dwordx4 v[156:159], v31, s[52:55], s74 offen
L_gapt_wu_1:
    s_waitcnt vmcnt(16)
    s_barrier
    s_add_u32 m0, s60, 98304
    s_nop 0
    buffer_load_dwordx4 v10, s[8:11], s61 offen offset:0 lds
    buffer_load_dwordx4 v11, s[8:11], s61 offen offset:1024 lds
    buffer_load_dwordx4 v12, s[8:11], s61 offen offset:2048 lds
    buffer_load_dwordx4 v13, s[8:11], s61 offen offset:3072 lds
    s_add_u32 m0, s60, 114688
    s_nop 0
    buffer_load_dwordx4 v14, s[12:15], s61 offen offset:0 lds
    buffer_load_dwordx4 v15, s[12:15], s61 offen offset:1024 lds
    buffer_load_dwordx4 v16, s[12:15], s61 offen offset:2048 lds
    buffer_load_dwordx4 v17, s[12:15], s61 offen offset:3072 lds
    s_add_u32 s61, s61, 128
    s_and_b32 s61, s61, 2047
    buffer_load_dwordx4 v[80:83], v18, s[16:19], s69 offen offset:0 sc1
    buffer_load_dwordx4 v[84:87], v18, s[16:19], s69 offen offset:1024 sc1
    buffer_load_dwordx4 v[88:91], v18, s[16:19], s69 offen offset:2048 sc1
    buffer_load_dwordx4 v[92:95], v18, s[16:19], s69 offen offset:3072 sc1
    s_waitcnt vmcnt(20)
    s_barrier
    s_add_u32 m0, s60, 0
    s_nop 0
    buffer_load_dwordx4 v10, s[8:11], s61 offen offset:0 lds
    buffer_load_dwordx4 v11, s[8:11], s61 offen offset:1024 lds
    buffer_load_dwordx4 v12, s[8:11], s61 offen offset:2048 lds
    buffer_load_dwordx4 v13, s[8:11], s61 offen offset:3072 lds
    s_add_u32 m0, s60, 16384
    s_nop 0
    buffer_load_dwordx4 v14, s[12:15], s61 offen offset:0 lds
    buffer_load_dwordx4 v15, s[12:15], s61 offen offset:1024 lds
    buffer_load_dwordx4 v16, s[12:15], s61 offen offset:2048 lds
    buffer_load_dwordx4 v17, s[12:15], s61 offen offset:3072 lds
    s_add_u32 s61, s61, 128
    s_and_b32 s61, s61, 2047
    s_cmp_lg_u32 s63, 1
    s_cbranch_scc1 L_gapt_wu_2
    s_add_u32 s74, s73, 0
    buffer_load_dwordx4 v[128:131], v31, s[52:55], s74 offen
    s_add_u32 s74, s73, 57344
    buffer_load_dwordx4 v[132:135], v31, s[52:55], s74 offen
    s_add_u32 s74, s73, 114688
    buffer_load_dwordx4 v[136:139], v31, s[52:55], s74 offen
    s_add_u32 s74, s73, 172032
    buffer_load_dwordx4 v[140:143], v31, s[52:55], s74 offen
    s_add_u32 s74, s73, 229376
    buffer_load_dwordx4 v[144:147], v31, s[52:55], s74 offen
    s_add_u32 s74, s73, 286720
    buffer_load_dwordx4 v[148:151], v31, s[52:55], s74 offen
    s_add_u32 s74, s73, 344064
    buffer_load_dwordx4 v[152:155], v31, s[52:55], s74 offen
    s_add_u32 s74, s73, 401408
    buffer_load_dwordx4 v[156:159], v31, s[52:55], s74 offen
L_gapt_wu_2:
    s_waitcnt vmcnt(8)
    s_mov_b32 s68, 32768
L_keypoll:
    v_xor_b32 v20, s65, v81
    v_xor_b32 v21, s65, v83
    v_or_b32 v20, v20, v21
    v_xor_b32 v21, s65, v85
    v_or_b32 v20, v20, v21
    v_xor_b32 v21, s65, v87
    v_or_b32 v20, v20, v21
    v_xor_b32 v21, s65, v89
    v_or_b32 v20, v20, v21
    v_xor_b32 v21, s65, v91
    v_or_b32 v20, v20, v21
    v_xor_b32 v21, s65, v93
    v_or_b32 v20, v20, v21
    v_xor_b32 v21, s65, v95
    v_or_b32 v20, v20, v21
    v_cmp_ne_u32 vcc, 0, v20
    s_cbranch_vccz L_keyok
    s_sub_u32 s68, s68, 1
    s_cbranch_scc1 L_keyok
    buffer_load_dwordx4 v[80:83], v18, s[16:19], s69 offen offset:0 sc1
    buffer_load_dwordx4 v[84:87], v18, s[16:19], s69 offen offset:1024 sc1
    buffer_load_dwordx4 v[88:91], v18, s[16:19], s69 offen offset:2048 sc1
    buffer_load_dwordx4 v[92:95], v18, s[16:19], s69 offen offset:3072 sc1
    s_waitcnt vmcnt(0)
    s_branch L_keypoll
L_keyok:
    s_or_b32 s66, s2, s30
    s_cmp_lg_u32 s66, 0
    s_cbranch_scc1 L_nogen
    v_mov_b32 v20, s65
    s_mov_b64 exec, 1
    buffer_store_dword v20, v9, s[16:19], 0 offen offset:0 sc1
    s_mov_b64 exec, -1
L_nogen:
    v_subrev_u32 v22, s76, v80
    v_subrev_u32 v23, s76, v82
    v_subrev_u32 v24, s76, v84
    v_subrev_u32 v25, s76, v86
    v_subrev_u32 v26, s76, v88
    v_subrev_u32 v27, s76, v90
    v_subrev_u32 v28, s76, v92
    v_subrev_u32 v29, s76, v94
    v_max3_u32 v22, v22, v23, v24
    v_max3_u32 v25, v25, v26, v27
    v_max3_u32 v22, v22, v28, v29
    v_max_u32 v22, v22, v25
    s_nop 1
    v_max_u32_dpp v22, v22, v22 row_shr:1 row_mask:0xf bank_mask:0xf
    s_nop 1
    v_max_u32_dpp v22, v22, v22 row_shr:2 row_mask:0xf bank_mask:0xf
    s_nop 1
    v_max_u32_dpp v22, v22, v22 row_shr:4 row_mask:0xf bank_mask:0xf
    s_nop 1
    v_max_u32_dpp v22, v22, v22 row_shr:8 row_mask:0xf bank_mask:0xf
    s_nop 1
    v_max_u32_dpp v22, v22, v22 row_bcast:15 row_mask:0xa bank_mask:0xf
    s_nop 1
    v_max_u32_dpp v22, v22, v22 row_bcast:31 row_mask:0xc bank_mask:0xf
    s_nop 0
    v_readlane_b32 s77, v22, 63
    s_add_u32 s76, s76, s77
    v_writelane_b32 v30, s76, 0
    s_barrier
    s_add_u32 m0, s60, 32768
    s_nop 0
    buffer_load_dwordx4 v10, s[8:11], s61 offen offset:0 lds
    buffer_load_dwordx4 v11, s[8:11], s61 offen offset:1024 lds
    buffer_load_dwordx4 v12, s[8:11], s61 offen offset:2048 lds
    buffer_load_dwordx4 v13, s[8:11], s61 offen offset:3072 lds
    s_add_u32 m0, s60, 49152
    s_nop 0
    buffer_load_dwordx4 v14, s[12:15], s61 offen offset:0 lds
    buffer_load_dwordx4 v15, s[12:15], s61 offen offset:1024 lds
    buffer_load_dwordx4 v16, s[12:15], s61 offen offset:2048 lds
    buffer_load_dwordx4 v17, s[12:15], s61 offen offset:3072 lds
    s_add_u32 s61, s61, 128
    s_and_b32 s61, s61, 2047
    v_subrev_u32 v22, s76, v80
    v_subrev_u32 v23, s76, v82
    v_subrev_u32 v24, s76, v84
    v_subrev_u32 v25, s76, v86
    v_subrev_u32 v26, s76, v88
    v_subrev_u32 v27, s76, v90
    v_subrev_u32 v28, s76, v92
    v_subrev_u32 v29, s76, v94
    v_max3_u32 v22, v22, v23, v24
    v_max3_u32 v25, v25, v26, v27
    v_max3_u32 v22, v22, v28, v29
    v_max_u32 v22, v22, v25
    s_nop 1
    v_max_u32_dpp v22, v22, v22 row_shr:1 row_mask:0xf bank_mask:0xf
    s_nop 1
    v_max_u32_dpp v22, v22, v22 row_shr:2 row_mask:0xf bank_mask:0xf
    s_nop 1
    v_max_u32_dpp v22, v22, v22 row_shr:4 row_mask:0xf bank_mask:0xf
    s_nop 1
    v_max_u32_dpp v22, v22, v22 row_shr:8 row_mask:0xf bank_mask:0xf
    s_nop 1
    v_max_u32_dpp v22, v22, v22 row_bcast:15 row_mask:0xa bank_mask:0xf
    s_nop 1
    v_max_u32_dpp v22, v22, v22 row_bcast:31 row_mask:0xc bank_mask:0xf
    s_nop 0
    v_readlane_b32 s77, v22, 63
    s_add_u32 s76, s76, s77
    v_writelane_b32 v30, s76, 1
    s_barrier
    s_add_u32 m0, s60, 65536
    s_nop 0
    buffer_load_dwordx4 v10, s[8:11], s61 offen offset:0 lds
    buffer_load_dwordx4 v11, s[8:11], s61 offen offset:1024 lds
    buffer_load_dwordx4 v12, s[8:11], s61 offen offset:2048 lds
    buffer_load_dwordx4 v13, s[8:11], s61 offen offset:3072 lds
    s_add_u32 m0, s60, 81920
    s_nop 0
    buffer_load_dwordx4 v14, s[12:15], s61 offen offset:0 lds
    buffer_load_dwordx4 v15, s[12:15], s61 offen offset:1024 lds
    buffer_load_dwordx4 v16, s[12:15], s61 offen offset:2048 lds
    buffer_load_dwordx4 v17, s[12:15], s61 offen offset:3072 lds
    s_add_u32 s61, s61, 128
    s_and_b32 s61, s61, 2047
    s_cmp_lg_u32 s63, 2
    s_cbranch_scc1 L_gapt_wu_3
    s_add_u32 s74, s73, 0
    buffer_load_dwordx4 v[128:131], v31, s[52:55], s74 offen
    s_add_u32 s74, s73, 57344
    buffer_load_dwordx4 v[132:135], v31, s[52:55], s74 offen
    s_add_u32 s74, s73, 114688
    buffer_load_dwordx4 v[136:139], v31, s[52:55], s74 offen
    s_add_u32 s74, s73, 172032
    buffer_load_dwordx4 v[140:143], v31, s[52:55], s74 offen
    s_add_u32 s74, s73, 229376
    buffer_load_dwordx4 v[144:147], v31, s[52:55], s74 offen
    s_add_u32 s74, s73, 286720
    buffer_load_dwordx4 v[148:151], v31, s[52:55], s74 offen
    s_add_u32 s74, s73, 344064
    buffer_load_dwordx4 v[152:155], v31, s[52:55], s74 offen
    s_add_u32 s74, s73, 401408
    buffer_load_dwordx4 v[156:159], v31, s[52:55], s74 offen
L_gapt_wu_3:
    v_subrev_u32 v22, s76, v80
    v_subrev_u32 v23, s76, v82
    v_subrev_u32 v24, s76, v84
    v_subrev_u32 v25, s76, v86
    v_subrev_u32 v26, s76, v88
    v_subrev_u32 v27, s76, v90
    v_subrev_u32 v28, s76, v92
    v_subrev_u32 v29, s76, v94
    v_max3_u32 v22, v22, v23, v24
    v_max3_u32 v25, v25, v26, v27
    v_max3_u32 v22, v22, v28, v29
    v_max_u32 v22, v22, v25
    s_nop 1
    v_max_u32_dpp v22, v22, v22 row_shr:1 row_mask:0xf bank_mask:0xf
    s_nop 1
    v_max_u32_dpp v22, v22, v22 row_shr:2 row_mask:0xf bank_mask:0xf
    s_nop 1
    v_max_u32_dpp v22, v22, v22 row_shr:4 row_mask:0xf bank_mask:0xf
    s_nop 1
    v_max_u32_dpp v22, v22, v22 row_shr:8 row_mask:0xf bank_mask:0xf
    s_nop 1
    v_max_u32_dpp v22, v22, v22 row_bcast:15 row_mask:0xa bank_mask:0xf
    s_nop 1
    v_max_u32_dpp v22, v22, v22 row_bcast:31 row_mask:0xc bank_mask:0xf
    s_nop 0
    v_readlane_b32 s77, v22, 63
    s_add_u32 s76, s76, s77
    v_writelane_b32 v30, s76, 2
    s_waitcnt vmcnt(16)
    s_barrier
    s_add_u32 m0, s60, 98304
    s_nop 0
    buffer_load_dwordx4 v10, s[8:11], s61 offen offset:0 lds
    buffer_load_dwordx4 v11, s[8:11], s61 offen offset:1024 lds
    buffer_load_dwordx4 v12, s[8:11], s61 offen offset:2048 lds
    buffer_load_dwordx4 v13, s[8:11], s61 offen offset:3072 lds
    s_add_u32 m0, s60, 114688
    s_nop 0
    buffer_load_dwordx4 v14, s[12:15], s61 offen offset:0 lds
    buffer_load_dwordx4 v15, s[12:15], s61 offen offset:1024 lds
    buffer_load_dwordx4 v16, s[12:15], s61 offen offset:2048 lds
    buffer_load_dwordx4 v17, s[12:15], s61 offen offset:3072 lds
    s_add_u32 s61, s61, 128
    s_and_b32 s61, s61, 2047
    v_subrev_u32 v22, s76, v80
    v_subrev_u32 v23, s76, v82
    v_subrev_u32 v24, s76, v84
    v_subrev_u32 v25, s76, v86
    v_subrev_u32 v26, s76, v88
    v_subrev_u32 v27, s76, v90
    v_subrev_u32 v28, s76, v92
    v_subrev_u32 v29, s76, v94
    v_max3_u32 v22, v22, v23, v24
    v_max3_u32 v25, v25, v26, v27
    v_max3_u32 v22, v22, v28, v29
    v_max_u32 v22, v22, v25
    s_nop 1
    v_max_u32_dpp v22, v22, v22 row_shr:1 row_mask:0xf bank_mask:0xf
    s_nop 1
    v_max_u32_dpp v22, v22, v22 row_shr:2 row_mask:0xf bank_mask:0xf
    s_nop 1
    v_max_u32_dpp v22, v22, v22 row_shr:4 row_mask:0xf bank_mask:0xf
    s_nop 1
    v_max_u32_dpp v22, v22, v22 row_shr:8 row_mask:0xf bank_mask:0xf
    s_nop 1
    v_max_u32_dpp v22, v22, v22 row_bcast:15 row_mask:0xa bank_mask:0xf
    s_nop 1
    v_max_u32_dpp v22, v22, v22 row_bcast:31 row_mask:0xc bank_mask:0xf
    s_nop 0
    v_readlane_b32 s77, v22, 63
    s_add_u32 s76, s76, s77
    v_writelane_b32 v30, s76, 3
    s_waitcnt vmcnt(16)
    s_barrier
    s_add_u32 m0, s60, 0
    s_nop 0
    buffer_load_dwordx4 v10, s[8:11], s61 offen offset:0 lds
    buffer_load_dwordx4 v11, s[8:11], s61 offen offset:1024 lds
    buffer_load_dwordx4 v12, s[8:11], s61 offen offset:2048 lds
    buffer_load_dwordx4 v13, s[8:11], s61 offen offset:3072 lds
    s_add_u32 m0, s60, 16384
    s_nop 0
    buffer_load_dwordx4 v14, s[12:15], s61 offen offset:0 lds
    buffer_load_dwordx4 v15, s[12:15], s61 offen offset:1024 lds
    buffer_load_dwordx4 v16, s[12:15], s61 offen offset:2048 lds
    buffer_load_dwordx4 v17, s[12:15], s61 offen offset:3072 lds
    s_add_u32 s61, s61, 128
    s_and_b32 s61, s61, 2047
    s_cmp_lg_u32 s63, 3
    s_cbranch_scc1 L_gapt_wu_4
    s_add_u32 s74, s73, 0
    buffer_load_dwordx4 v[128:131], v31, s[52:55], s74 offen
    s_add_u32 s74, s73, 57344
    buffer_load_dwordx4 v[132:135], v31, s[52:55], s74 offen
    s_add_u32 s74, s73, 114688
    buffer_load_dwordx4 v[136:139], v31, s[52:55], s74 offen
    s_add_u32 s74, s73, 172032
    buffer_load_dwordx4 v[140:143], v31, s[52:55], s74 offen
    s_add_u32 s74, s73, 229376
    buffer_load_dwordx4 v[144:147], v31, s[52:55], s74 offen
    s_add_u32 s74, s73, 286720
    buffer_load_dwordx4 v[148:151], v31, s[52:55], s74 offen
    s_add_u32 s74, s73, 344064
    buffer_load_dwordx4 v[152:155], v31, s[52:55], s74 offen
    s_add_u32 s74, s73, 401408
    buffer_load_dwordx4 v[156:159], v31, s[52:55], s74 offen
L_gapt_wu_4:
    v_subrev_u32 v22, s76, v80
    v_subrev_u32 v23, s76, v82
    v_subrev_u32 v24, s76, v84
    v_subrev_u32 v25, s76, v86
    v_subrev_u32 v26, s76, v88
    v_subrev_u32 v27, s76, v90
    v_subrev_u32 v28, s76, v92
    v_subrev_u32 v29, s76, v94
    v_max3_u32 v22, v22, v23, v24
    v_max3_u32 v25, v25, v26, v27
    v_max3_u32 v22, v22, v28, v29
    v_max_u32 v22, v22, v25
    s_nop 1
    v_max_u32_dpp v22, v22, v22 row_shr:1 row_mask:0xf bank_mask:0xf
    s_nop 1
    v_max_u32_dpp v22, v22, v22 row_shr:2 row_mask:0xf bank_mask:0xf
    s_nop 1
    v_max_u32_dpp v22, v22, v22 row_shr:4 row_mask:0xf bank_mask:0xf
    s_nop 1
    v_max_u32_dpp v22, v22, v22 row_shr:8 row_mask:0xf bank_mask:0xf
    s_nop 1
    v_max_u32_dpp v22, v22, v22 row_bcast:15 row_mask:0xa bank_mask:0xf
    s_nop 1
    v_max_u32_dpp v22, v22, v22 row_bcast:31 row_mask:0xc bank_mask:0xf
    s_nop 0
    v_readlane_b32 s77, v22, 63
    s_add_u32 s76, s76, s77
    v_writelane_b32 v30, s76, 4
    s_waitcnt vmcnt(16)
    s_barrier
    s_add_u32 m0, s60, 32768
    s_nop 0
    buffer_load_dwordx4 v10, s[8:11], s61 offen offset:0 lds
    buffer_load_dwordx4 v11, s[8:11], s61 offen offset:1024 lds
    buffer_load_dwordx4 v12, s[8:11], s61 offen offset:2048 lds
    buffer_load_dwordx4 v13, s[8:11], s61 offen offset:3072 lds
    s_add_u32 m0, s60, 49152
    s_nop 0
    buffer_load_dwordx4 v14, s[12:15], s61 offen offset:0 lds
    buffer_load_dwordx4 v15, s[12:15], s61 offen offset:1024 lds
    buffer_load_dwordx4 v16, s[12:15], s61 offen offset:2048 lds
    buffer_load_dwordx4 v17, s[12:15], s61 offen offset:3072 lds
    s_add_u32 s61, s61, 128
    s_and_b32 s61, s61, 2047
    v_subrev_u32 v22, s76, v80
    v_subrev_u32 v23, s76, v82
    v_subrev_u32 v24, s76, v84
    v_subrev_u32 v25, s76, v86
    v_subrev_u32 v26, s76, v88
    v_subrev_u32 v27, s76, v90
    v_subrev_u32 v28, s76, v92
    v_subrev_u32 v29, s76, v94
    v_max3_u32 v22, v22, v23, v24
    v_max3_u32 v25, v25, v26, v27
    v_max3_u32 v22, v22, v28, v29
    v_max_u32 v22, v22, v25
    s_nop 1
    v_max_u32_dpp v22, v22, v22 row_shr:1 row_mask:0xf bank_mask:0xf
    s_nop 1
    v_max_u32_dpp v22, v22, v22 row_shr:2 row_mask:0xf bank_mask:0xf
    s_nop 1
    v_max_u32_dpp v22, v22, v22 row_shr:4 row_mask:0xf bank_mask:0xf
    s_nop 1
    v_max_u32_dpp v22, v22, v22 row_shr:8 row_mask:0xf bank_mask:0xf
    s_nop 1
    v_max_u32_dpp v22, v22, v22 row_bcast:15 row_mask:0xa bank_mask:0xf
    s_nop 1
    v_max_u32_dpp v22, v22, v22 row_bcast:31 row_mask:0xc bank_mask:0xf
    s_nop 0
    v_readlane_b32 s77, v22, 63
    s_add_u32 s76, s76, s77
    v_writelane_b32 v30, s76, 5
    s_waitcnt vmcnt(16)
    s_barrier
    s_add_u32 m0, s60, 65536
    s_nop 0
    buffer_load_dwordx4 v10, s[8:11], s61 offen offset:0 lds
    buffer_load_dwordx4 v11, s[8:11], s61 offen offset:1024 lds
    buffer_load_dwordx4 v12, s[8:11], s61 offen offset:2048 lds
    buffer_load_dwordx4 v13, s[8:11], s61 offen offset:3072 lds
    s_add_u32 m0, s60, 81920
    s_nop 0
    buffer_load_dwordx4 v14, s[12:15], s61 offen offset:0 lds
    buffer_load_dwordx4 v15, s[12:15], s61 offen offset:1024 lds
    buffer_load_dwordx4 v16, s[12:15], s61 offen offset:2048 lds
    buffer_load_dwordx4 v17, s[12:15], s61 offen offset:3072 lds
    s_add_u32 s61, s61, 128
    s_and_b32 s61, s61, 2047
    v_subrev_u32 v22, s76, v80
    v_subrev_u32 v23, s76, v82
    v_subrev_u32 v24, s76, v84
    v_subrev_u32 v25, s76, v86
    v_subrev_u32 v26, s76, v88
    v_subrev_u32 v27, s76, v90
    v_subrev_u32 v28, s76, v92
    v_subrev_u32 v29, s76, v94
    v_max3_u32 v22, v22, v23, v24
    v_max3_u32 v25, v25, v26, v27
    v_max3_u32 v22, v22, v28, v29
    v_max_u32 v22, v22, v25
    s_nop 1
    v_max_u32_dpp v22, v22, v22 row_shr:1 row_mask:0xf bank_mask:0xf
    s_nop 1
    v_max_u32_dpp v22, v22, v22 row_shr:2 row_mask:0xf bank_mask:0xf
    s_nop 1
    v_max_u32_dpp v22, v22, v22 row_shr:4 row_mask:0xf bank_mask:0xf
    s_nop 1
    v_max_u32_dpp v22, v22, v22 row_shr:8 row_mask:0xf bank_mask:0xf
    s_nop 1
    v_max_u32_dpp v22, v22, v22 row_bcast:15 row_mask:0xa bank_mask:0xf
    s_nop 1
    v_max_u32_dpp v22, v22, v22 row_bcast:31 row_mask:0xc bank_mask:0xf
    s_nop 0
    v_readlane_b32 s77, v22, 63
    s_add_u32 s76, s76, s77
    v_writelane_b32 v30, s76, 6
    s_waitcnt vmcnt(16)
    s_barrier
    s_add_u32 m0, s60, 98304
    s_nop 0
    buffer_load_dwordx4 v10, s[8:11], s61 offen offset:0 lds
    buffer_load_dwordx4 v11, s[8:11], s61 offen offset:1024 lds
    buffer_load_dwordx4 v12, s[8:11], s61 offen offset:2048 lds
    buffer_load_dwordx4 v13, s[8:11], s61 offen offset:3072 lds
    s_add_u32 m0, s60, 114688
    s_nop 0
    buffer_load_dwordx4 v14, s[12:15], s61 offen offset:0 lds
    buffer_load_dwordx4 v15, s[12:15], s61 offen offset:1024 lds
    buffer_load_dwordx4 v16, s[12:15], s61 offen offset:2048 lds
    buffer_load_dwordx4 v17, s[12:15], s61 offen offset:3072 lds
    v_subrev_u32 v22, s76, v80
    v_subrev_u32 v23, s76, v82
    v_subrev_u32 v24, s76, v84
    v_subrev_u32 v25, s76, v86
    v_subrev_u32 v26, s76, v88
    v_subrev_u32 v27, s76, v90
    v_subrev_u32 v28, s76, v92
    v_subrev_u32 v29, s76, v94
    v_max3_u32 v22, v22, v23, v24
    v_max3_u32 v25, v25, v26, v27
    v_max3_u32 v22, v22, v28, v29
    v_max_u32 v22, v22, v25
    s_nop 1
    v_max_u32_dpp v22, v22, v22 row_shr:1 row_mask:0xf bank_mask:0xf
    s_nop 1
    v_max_u32_dpp v22, v22, v22 row_shr:2 row_mask:0xf bank_mask:0xf
    s_nop 1
    v_max_u32_dpp v22, v22, v22 row_shr:4 row_mask:0xf bank_mask:0xf
    s_nop 1
    v_max_u32_dpp v22, v22, v22 row_shr:8 row_mask:0xf bank_mask:0xf
    s_nop 1
    v_max_u32_dpp v22, v22, v22 row_bcast:15 row_mask:0xa bank_mask:0xf
    s_nop 1
    v_max_u32_dpp v22, v22, v22 row_bcast:31 row_mask:0xc bank_mask:0xf
    s_nop 0
    v_readlane_b32 s77, v22, 63
    s_add_u32 s76, s76, s77
    v_writelane_b32 v30, s76, 7
    s_lshl_b32 s76, s30, 5
    v_lshl_add_u32 v32, v1, 2, s76
    v_add_u32 v32, 147712, v32
    s_mov_b64 exec, 0xff
    ds_write_b32 v32, v30
    s_mov_b64 exec, -1
    s_waitcnt vmcnt(16) lgkmcnt(0)
    s_barrier
    v_mov_b32 v10, v31
    s_add_u32 m0, s75, 0
    s_add_u32 s74, s73, 0
    buffer_load_dwordx4 v10, s[48:51], s74 offen lds
    s_add_u32 m0, s75, 1024
    s_add_u32 s74, s73, 57344
    buffer_load_dwordx4 v10, s[48:51], s74 offen lds
    s_add_u32 m0, s75, 2048
    s_add_u32 s74, s73, 114688
    buffer_load_dwordx4 v10, s[48:51], s74 offen lds
    s_add_u32 m0, s75, 3072
    s_add_u32 s74, s73, 172032
    buffer_load_dwordx4 v10, s[48:51], s74 offen lds
    s_add_u32 m0, s75, 4096
    s_add_u32 s74, s73, 229376
    buffer_load_dwordx4 v10, s[48:51], s74 offen lds
    s_add_u32 m0, s75, 5120
    s_add_u32 s74, s73, 286720
    buffer_load_dwordx4 v10, s[48:51], s74 offen lds
    s_add_u32 m0, s75, 6144
    s_add_u32 s74, s73, 344064
    buffer_load_dwordx4 v10, s[48:51], s74 offen lds
    s_add_u32 m0, s75, 7168
    s_add_u32 s74, s73, 401408
    buffer_load_dwordx4 v10, s[48:51], s74 offen lds
    v_and_b32 v32, 31, v1
    v_lshlrev_b32 v32, 2, v32
    v_add_u32 v32, 147712, v32
    v_lshrrev_b32 v33, 5, v1
    v_lshlrev_b32 v33, 6, v33
    v_add_u32 v33, 147712, v33
    ds_read_b32 v34, v32
    ds_read_b128 v[36:39], v33 offset:0
    ds_read_b128 v[40:43], v33 offset:16
    ds_read_b128 v[44:47], v33 offset:32
    ds_read_b128 v[48:51], v33 offset:48
    v_mov_b32 v35, 0
    s_lshl_b32 s76, s30, 5
    s_add_u32 s76, s76, 147968
    s_waitcnt lgkmcnt(0)
    v_cmp_gt_u32 s[78:79], v36, v34
    v_cmp_gt_u32 s[80:81], v37, v34
    v_cmp_gt_u32 s[82:83], v38, v34
    v_addc_co_u32 v35, vcc, 0, v35, s[78:79]
    v_cmp_gt_u32 s[78:79], v39, v34
    v_addc_co_u32 v35, vcc, 0, v35, s[80:81]
    v_cmp_gt_u32 s[80:81], v40, v34
    v_addc_co_u32 v35, vcc, 0, v35, s[82:83]
    v_cmp_gt_u32 s[82:83], v41, v34
    v_addc_co_u32 v35, vcc, 0, v35, s[78:79]
    v_cmp_gt_u32 s[78:79], v42, v34
    v_addc_co_u32 v35, vcc, 0, v35, s[80:81]
    v_cmp_gt_u32 s[80:81], v43, v34
    v_addc_co_u32 v35, vcc, 0, v35, s[82:83]
    v_cmp_gt_u32 s[82:83], v44, v34
    v_addc_co_u32 v35, vcc, 0, v35, s[78:79]
    v_cmp_gt_u32 s[78:79], v45, v34
    v_addc_co_u32 v35, vcc, 0, v35, s[80:81]
    v_cmp_gt_u32 s[80:81], v46, v34
    v_addc_co_u32 v35, vcc, 0, v35, s[82:83]
    v_cmp_gt_u32 s[82:83], v47, v34
    v_addc_co_u32 v35, vcc, 0, v35, s[78:79]
    v_cmp_gt_u32 s[78:79], v48, v34
    v_addc_co_u32 v35, vcc, 0, v35, s[80:81]
    v_cmp_gt_u32 s[80:81], v49, v34
    v_addc_co_u32 v35, vcc, 0, v35, s[82:83]
    v_cmp_gt_u32 s[82:83], v50, v34
    v_addc_co_u32 v35, vcc, 0, v35, s[78:79]
    v_cmp_gt_u32 s[78:79], v51, v34
    v_addc_co_u32 v35, vcc, 0, v35, s[80:81]
    v_addc_co_u32 v35, vcc, 0, v35, s[82:83]
    v_addc_co_u32 v35, vcc, 0, v35, s[78:79]
    s_waitcnt vmcnt(16)
    s_barrier
    v_mov_b32 v36, v35
    v_lshrrev_b32 v6, 4, v1
    v_lshlrev_b32 v32, 4, v6
    v_permlane32_swap_b32 v35, v36
    v_add_u32 v35, v35, v36
    v_cmp_gt_u32 vcc, 8, v35
    v_lshl_add_u32 v35, v35, 2, s76
    v_lshl_add_u32 v36, v4, 2, s76
    s_and_saveexec_b64 s[66:67], vcc
    ds_write_b32 v35, v34
    s_mov_b64 exec, -1
    ds_read_b32 v30, v36
    v_add_u32 v33, s75, v18
    s_lshl_b32 s76, s72, 1
    s_waitcnt lgkmcnt(0)
    v_and_b32 v31, 0x7ff, v30
    v_sub_u32 v31, 2047, v31
    v_lshl_add_u32 v32, v31, 11, v32
    buffer_load_dwordx4 v[36:39], v32, s[56:59], s76 offen offset:0
    buffer_load_dwordx4 v[40:43], v32, s[56:59], s76 offen offset:64
    s_waitcnt vmcnt(10)
    s_barrier
    ds_write_b128 v33, v[128:131] offset:32768
    ds_write_b128 v33, v[132:135] offset:33792
    ds_write_b128 v33, v[136:139] offset:34816
    ds_write_b128 v33, v[140:143] offset:35840
    ds_write_b128 v33, v[144:147] offset:36864
    ds_write_b128 v33, v[148:151] offset:37888
    ds_write_b128 v33, v[152:155] offset:38912
    ds_write_b128 v33, v[156:159] offset:39936
    s_mov_b32 s8, s84
    s_mov_b32 s9, s85
    s_sub_u32 s10, 2097152, s64
    s_lshl_b32 s60, s32, 13
    s_lshl_b32 s35, s31, 12
    s_add_u32 s60, s60, s35
    s_add_u32 s60, s60, 65536
    s_lshl_b32 s61, s24, 1
    s_add_u32 s61, s61, 2
    s_and_b32 s61, s61, 15
    s_lshl_b32 s61, s61, 7
    v_ashrrev_i32 v33, 31, v30
    v_not_b32 v33, v33
    v_or_b32 v33, 0x80000000, v33
    v_xor_b32 v33, v33, v30
    v_and_b32 v33, 0xffff0000, v33
    v_mul_f32 v35, 0xbfb8aa3b, v33
    v_exp_f32 v35, v35
    s_nop 0
    v_add_f32 v35, 1.0, v35
    v_rcp_f32 v35, v35
    s_nop 0
    v_cvt_pk_bf16_f32 v30, v35, v35
    v_lshlrev_b32 v30, 16, v30
    v_bfe_u32 v34, v1, 2, 2
    v_lshl_add_u32 v33, v6, 3, v34
    v_lshlrev_b32 v33, 7, v33
    v_and_b32 v34, 3, v1
    v_lshl_add_u32 v5, v34, 3, v33
    v_add_u32 v33, s75, v5
    s_cmp_ge_u32 s2, 224
    s_cbranch_scc1 L_gudone
    ds_read_b64_tr_b16 v[160:161], v33 offset:32768
    ds_read_b64_tr_b16 v[162:163], v33 offset:33280
    ds_read_b64_tr_b16 v[164:165], v33 offset:32800
    ds_read_b64_tr_b16 v[166:167], v33 offset:33312
    ds_read_b64_tr_b16 v[168:169], v33 offset:32832
    ds_read_b64_tr_b16 v[170:171], v33 offset:33344
    ds_read_b64_tr_b16 v[172:173], v33 offset:32864
    ds_read_b64_tr_b16 v[174:175], v33 offset:33376
    ds_read_b64_tr_b16 v[176:177], v33 offset:36864
    ds_read_b64_tr_b16 v[178:179], v33 offset:37376
    ds_read_b64_tr_b16 v[180:181], v33 offset:36896
    ds_read_b64_tr_b16 v[182:183], v33 offset:37408
    ds_read_b64_tr_b16 v[184:185], v33 offset:36928
    ds_read_b64_tr_b16 v[186:187], v33 offset:37440
    ds_read_b64_tr_b16 v[188:189], v33 offset:36960
    ds_read_b64_tr_b16 v[190:191], v33 offset:37472
    s_waitcnt vmcnt(0)
    s_waitcnt lgkmcnt(8)
    v_mfma_f32_16x16x32_bf16 v[112:115], v[36:39], v[160:163], 0
    v_mfma_f32_16x16x32_bf16 v[116:119], v[36:39], v[164:167], 0
    v_mfma_f32_16x16x32_bf16 v[120:123], v[36:39], v[168:171], 0
    v_mfma_f32_16x16x32_bf16 v[124:127], v[36:39], v[172:175], 0
    s_waitcnt lgkmcnt(0)
    v_mfma_f32_16x16x32_bf16 v[112:115], v[40:43], v[176:179], v[112:115]
    v_mfma_f32_16x16x32_bf16 v[116:119], v[40:43], v[180:183], v[116:119]
    v_mfma_f32_16x16x32_bf16 v[120:123], v[40:43], v[184:187], v[120:123]
    v_mfma_f32_16x16x32_bf16 v[124:127], v[40:43], v[188:191], v[124:127]
    ds_read_b64_tr_b16 v[160:161], v33 offset:0
    ds_read_b64_tr_b16 v[162:163], v33 offset:512
    ds_read_b64_tr_b16 v[164:165], v33 offset:32
    ds_read_b64_tr_b16 v[166:167], v33 offset:544
    ds_read_b64_tr_b16 v[168:169], v33 offset:64
    ds_read_b64_tr_b16 v[170:171], v33 offset:576
    ds_read_b64_tr_b16 v[172:173], v33 offset:96
    ds_read_b64_tr_b16 v[174:175], v33 offset:608
    ds_read_b64_tr_b16 v[176:177], v33 offset:4096
    ds_read_b64_tr_b16 v[178:179], v33 offset:4608
    ds_read_b64_tr_b16 v[180:181], v33 offset:4128
    ds_read_b64_tr_b16 v[182:183], v33 offset:4640
    ds_read_b64_tr_b16 v[184:185], v33 offset:4160
    ds_read_b64_tr_b16 v[186:187], v33 offset:4672
    ds_read_b64_tr_b16 v[188:189], v33 offset:4192
    ds_read_b64_tr_b16 v[190:191], v33 offset:4704
    s_waitcnt lgkmcnt(8)
    v_mfma_f32_16x16x32_bf16 v[96:99], v[36:39], v[160:163], 0
    v_mfma_f32_16x16x32_bf16 v[100:103], v[36:39], v[164:167], 0
    v_mfma_f32_16x16x32_bf16 v[104:107], v[36:39], v[168:171], 0
    v_mfma_f32_16x16x32_bf16 v[108:111], v[36:39], v[172:175], 0
    s_waitcnt lgkmcnt(0)
    v_mfma_f32_16x16x32_bf16 v[96:99], v[40:43], v[176:179], v[96:99]
    v_mfma_f32_16x16x32_bf16 v[100:103], v[40:43], v[180:183], v[100:103]
    v_mfma_f32_16x16x32_bf16 v[104:107], v[40:43], v[184:187], v[104:107]
    v_mfma_f32_16x16x32_bf16 v[108:111], v[40:43], v[188:191], v[108:111]
    v_lshl_add_u32 v34, v1, 4, s75
    s_mov_b64 exec, 0xffffffff
    s_nop 2
    ds_write_b128 v34, v[96:99] offset:0
    ds_write_b128 v34, v[100:103] offset:512
    ds_write_b128 v34, v[104:107] offset:1024
    ds_write_b128 v34, v[108:111] offset:1536
    ds_write_b128 v34, v[112:115] offset:2048
    ds_write_b128 v34, v[116:119] offset:2560
    ds_write_b128 v34, v[120:123] offset:3072
    ds_write_b128 v34, v[124:127] offset:3584
    s_mov_b64 exec, 1
    v_mov_b32 v35, 1
    ds_add_rtn_u32 v35, v7, v35 offset:16
    s_mov_b64 exec, -1
    s_waitcnt lgkmcnt(0)
    v_readfirstlane_b32 s76, v35
    s_cmp_lg_u32 s76, 3
    s_cbranch_scc1 L_gudone
    ds_read_b128 v[96:99], v18 offset:0
    ds_read_b128 v[100:103], v18 offset:1024
    ds_read_b128 v[104:107], v18 offset:2048
    ds_read_b128 v[108:111], v18 offset:3072
    ds_read_b128 v[112:115], v18 offset:8192
    ds_read_b128 v[116:119], v18 offset:9216
    ds_read_b128 v[120:123], v18 offset:10240
    ds_read_b128 v[124:127], v18 offset:11264
    ds_read_b128 v[128:131], v18 offset:16384
    ds_read_b128 v[132:135], v18 offset:17408
    ds_read_b128 v[136:139], v18 offset:18432
    ds_read_b128 v[140:143], v18 offset:19456
    ds_read_b128 v[144:147], v18 offset:24576
    ds_read_b128 v[148:151], v18 offset:25600
    ds_read_b128 v[152:155], v18 offset:26624
    ds_read_b128 v[156:159], v18 offset:27648
    v_lshrrev_b32 v35, 5, v1
    v_lshlrev_b32 v35, 13, v35
    v_and_b32 v36, 31, v1
    v_lshl_add_u32 v35, v36, 4, v35
    s_lshl_b32 s76, s71, 15
    s_lshl_b32 s77, s70, 11
    s_add_u32 s76, s76, s77
    s_add_u32 s76, s76, 524288
    s_add_u32 s77, s76, 16384
    v_mov_b32 v42, s65
    v_mov_b32 v43, s65
    v_mov_b32 v46, s65
    v_mov_b32 v47, s65
    s_waitcnt lgkmcnt(0)
    v_pk_add_f32 v[96:97], v[96:97], v[112:113]
    v_pk_add_f32 v[128:129], v[128:129], v[144:145]
    v_pk_add_f32 v[40:41], v[96:97], v[128:129]
    buffer_store_dwordx4 v[40:43], v35, s[16:19], s76 offen offset:0 sc1
    v_pk_add_f32 v[98:99], v[98:99], v[114:115]
    v_pk_add_f32 v[130:131], v[130:131], v[146:147]
    v_pk_add_f32 v[44:45], v[98:99], v[130:131]
    buffer_store_dwordx4 v[44:47], v35, s[16:19], s76 offen offset:1024 sc1
    v_pk_add_f32 v[100:101], v[100:101], v[116:117]
    v_pk_add_f32 v[132:133], v[132:133], v[148:149]
    v_pk_add_f32 v[40:41], v[100:101], v[132:133]
    buffer_store_dwordx4 v[40:43], v35, s[16:19], s77 offen offset:0 sc1
    v_pk_add_f32 v[102:103], v[102:103], v[118:119]
    v_pk_add_f32 v[134:135], v[134:135], v[150:151]
    v_pk_add_f32 v[44:45], v[102:103], v[134:135]
    buffer_store_dwordx4 v[44:47], v35, s[16:19], s77 offen offset:1024 sc1
    v_pk_add_f32 v[104:105], v[104:105], v[120:121]
    v_pk_add_f32 v[136:137], v[136:137], v[152:153]
    v_pk_add_f32 v[40:41], v[104:105], v[136:137]
    buffer_store_dwordx4 v[40:43], v35, s[16:19], s76 offen offset:512 sc1
    v_pk_add_f32 v[106:107], v[106:107], v[122:123]
    v_pk_add_f32 v[138:139], v[138:139], v[154:155]
    v_pk_add_f32 v[44:45], v[106:107], v[138:139]
    buffer_store_dwordx4 v[44:47], v35, s[16:19], s76 offen offset:1536 sc1
    v_pk_add_f32 v[108:109], v[108:109], v[124:125]
    v_pk_add_f32 v[140:141], v[140:141], v[156:157]
    v_pk_add_f32 v[40:41], v[108:109], v[140:141]
    buffer_store_dwordx4 v[40:43], v35, s[16:19], s77 offen offset:512 sc1
    v_pk_add_f32 v[110:111], v[110:111], v[126:127]
    v_pk_add_f32 v[142:143], v[142:143], v[158:159]
    v_pk_add_f32 v[44:45], v[110:111], v[142:143]
    buffer_store_dwordx4 v[44:47], v35, s[16:19], s77 offen offset:1536 sc1
L_gudone:
    v_mov_b32 v178, v31
    v_mov_b32 v179, v30
    v_bfrev_b32 v2, 1
    v_and_b32 v7, 15, v1
    v_lshlrev_b32 v11, 4, v4
    v_lshl_add_u32 v11, v3, 11, v11
    s_mul_i32 s50, s26, 28
    s_mul_i32 s51, s30, 7
    s_add_u32 s50, s50, s51
    s_lshl_b32 s50, s50, 14
    s_lshl_b32 s55, s27, 7
    s_add_u32 s50, s50, s55
    s_lshl_b32 s51, s51, 10
    s_lshl_b32 s48, s26, 7
    s_lshl_b32 s49, s30, 5
    s_add_u32 s49, s48, s49
    v_lshlrev_b32 v12, 3, v7
    v_lshl_add_u32 v19, v6, 11, v12
    v_lshlrev_b32 v9, 3, v1
    s_barrier
    s_add_u32 m0, s60, 32768
    s_nop 0
    buffer_load_dwordx4 v14, s[8:11], s61 offen offset:0 lds
    buffer_load_dwordx4 v15, s[8:11], s61 offen offset:1024 lds
    buffer_load_dwordx4 v16, s[8:11], s61 offen offset:2048 lds
    buffer_load_dwordx4 v17, s[8:11], s61 offen offset:3072 lds
    s_add_u32 s61, s61, 128
    s_and_b32 s61, s61, 2047
    s_add_u32 m0, s60, 49152
    s_nop 0
    buffer_load_dwordx4 v14, s[8:11], s61 offen offset:0 lds
    buffer_load_dwordx4 v15, s[8:11], s61 offen offset:1024 lds
    buffer_load_dwordx4 v16, s[8:11], s61 offen offset:2048 lds
    buffer_load_dwordx4 v17, s[8:11], s61 offen offset:3072 lds
    s_add_u32 s61, s61, 128
    s_and_b32 s61, s61, 2047
    s_barrier
    s_add_u32 m0, s60, 0
    s_nop 0
    buffer_load_dwordx4 v14, s[8:11], s61 offen offset:0 lds
    buffer_load_dwordx4 v15, s[8:11], s61 offen offset:1024 lds
    buffer_load_dwordx4 v16, s[8:11], s61 offen offset:2048 lds
    buffer_load_dwordx4 v17, s[8:11], s61 offen offset:3072 lds
    s_add_u32 s61, s61, 128
    s_and_b32 s61, s61, 2047
    s_cmp_lg_u32 s63, 0
    s_cbranch_scc1 L_gapt_wd_5
    s_add_u32 m0, s51, 0
    s_nop 0
    buffer_load_dwordx4 v11, s[44:47], s50 offen lds
    s_add_u32 m0, s51, 1024
    s_add_u32 s50, s50, 16384
    buffer_load_dwordx4 v11, s[44:47], s50 offen lds
    s_add_u32 m0, s51, 2048
    s_add_u32 s50, s50, 16384
    buffer_load_dwordx4 v11, s[44:47], s50 offen lds
    s_add_u32 m0, s51, 3072
    s_add_u32 s50, s50, 16384
    buffer_load_dwordx4 v11, s[44:47], s50 offen lds
    s_add_u32 m0, s51, 4096
    s_add_u32 s50, s50, 16384
    buffer_load_dwordx4 v11, s[44:47], s50 offen lds
    s_add_u32 m0, s51, 5120
    s_add_u32 s50, s50, 16384
    buffer_load_dwordx4 v11, s[44:47], s50 offen lds
    s_add_u32 m0, s51, 6144
    s_add_u32 s50, s50, 16384
    buffer_load_dwordx4 v11, s[44:47], s50 offen lds
L_gapt_wd_5:
    s_lshl_b32 s70, s2, 13
    s_add_u32 s70, s70, 524288
    s_add_u32 s71, s70, 4096
    s_cmp_lt_u32 s2, 224
    s_cselect_b32 s73, s30, 1
    s_cmp_lg_u32 s73, 0
    s_cbranch_scc1 L_nogu1
    buffer_load_dwordx4 v[20:23], v18, s[16:19], s70 offen offset:0 sc1
    buffer_load_dwordx4 v[24:27], v18, s[16:19], s70 offen offset:1024 sc1
    buffer_load_dwordx4 v[28:31], v18, s[16:19], s70 offen offset:2048 sc1
    buffer_load_dwordx4 v[32:35], v18, s[16:19], s70 offen offset:3072 sc1
    buffer_load_dwordx4 v[36:39], v18, s[16:19], s71 offen offset:0 sc1
    buffer_load_dwordx4 v[40:43], v18, s[16:19], s71 offen offset:1024 sc1
    buffer_load_dwordx4 v[44:47], v18, s[16:19], s71 offen offset:2048 sc1
    buffer_load_dwordx4 v[48:51], v18, s[16:19], s71 offen offset:3072 sc1
L_nogu1:
    s_waitcnt vmcnt(8)
    s_barrier
    s_add_u32 m0, s60, 16384
    s_nop 0
    buffer_load_dwordx4 v14, s[8:11], s61 offen offset:0 lds
    buffer_load_dwordx4 v15, s[8:11], s61 offen offset:1024 lds
    buffer_load_dwordx4 v16, s[8:11], s61 offen offset:2048 lds
    buffer_load_dwordx4 v17, s[8:11], s61 offen offset:3072 lds
    s_add_u32 s61, s61, 128
    s_and_b32 s61, s61, 2047
    s_cmp_lg_u32 s63, 1
    s_cbranch_scc1 L_gapt_wd_6
    s_add_u32 m0, s51, 0
    s_nop 0
    buffer_load_dwordx4 v11, s[44:47], s50 offen lds
    s_add_u32 m0, s51, 1024
    s_add_u32 s50, s50, 16384
    buffer_load_dwordx4 v11, s[44:47], s50 offen lds
    s_add_u32 m0, s51, 2048
    s_add_u32 s50, s50, 16384
    buffer_load_dwordx4 v11, s[44:47], s50 offen lds
    s_add_u32 m0, s51, 3072
    s_add_u32 s50, s50, 16384
    buffer_load_dwordx4 v11, s[44:47], s50 offen lds
    s_add_u32 m0, s51, 4096
    s_add_u32 s50, s50, 16384
    buffer_load_dwordx4 v11, s[44:47], s50 offen lds
    s_add_u32 m0, s51, 5120
    s_add_u32 s50, s50, 16384
    buffer_load_dwordx4 v11, s[44:47], s50 offen lds
    s_add_u32 m0, s51, 6144
    s_add_u32 s50, s50, 16384
    buffer_load_dwordx4 v11, s[44:47], s50 offen lds
L_gapt_wd_6:
    s_lshl_b32 s33, s49, 11
    s_add_u32 s33, s33, s55
    s_lshl_b32 s74, s49, 3
    s_add_u32 s74, s74, 8192
    buffer_load_dwordx2 v[156:157], v9, s[16:19], s74 offen sc1
    buffer_load_dwordx2 v[116:117], v12, s[36:39], s55 offen
    buffer_load_dwordx2 v[84:85], v19, s[56:59], s33 offen
    s_add_u32 s33, s33, 8192
    buffer_load_dwordx2 v[86:87], v19, s[56:59], s33 offen
    s_add_u32 s33, s33, 8192
    buffer_load_dwordx2 v[88:89], v19, s[56:59], s33 offen
    s_add_u32 s33, s33, 8192
    buffer_load_dwordx2 v[90:91], v19, s[56:59], s33 offen
    s_add_u32 s33, s33, 8192
    buffer_load_dwordx2 v[92:93], v19, s[56:59], s33 offen
    s_add_u32 s33, s33, 8192
    buffer_load_dwordx2 v[94:95], v19, s[56:59], s33 offen
    s_add_u32 s33, s33, 8192
    buffer_load_dwordx2 v[96:97], v19, s[56:59], s33 offen
    s_add_u32 s33, s33, 8192
    buffer_load_dwordx2 v[98:99], v19, s[56:59], s33 offen
    s_waitcnt vmcnt(18)
    s_barrier
    s_add_u32 m0, s60, 32768
    s_nop 0
    buffer_load_dwordx4 v14, s[8:11], s61 offen offset:0 lds
    buffer_load_dwordx4 v15, s[8:11], s61 offen offset:1024 lds
    buffer_load_dwordx4 v16, s[8:11], s61 offen offset:2048 lds
    buffer_load_dwordx4 v17, s[8:11], s61 offen offset:3072 lds
    s_add_u32 s61, s61, 128
    s_and_b32 s61, s61, 2047
    s_cmp_lg_u32 s63, 2
    s_cbranch_scc1 L_gapt_wd_7
    s_add_u32 m0, s51, 0
    s_nop 0
    buffer_load_dwordx4 v11, s[44:47], s50 offen lds
    s_add_u32 m0, s51, 1024
    s_add_u32 s50, s50, 16384
    buffer_load_dwordx4 v11, s[44:47], s50 offen lds
    s_add_u32 m0, s51, 2048
    s_add_u32 s50, s50, 16384
    buffer_load_dwordx4 v11, s[44:47], s50 offen lds
    s_add_u32 m0, s51, 3072
    s_add_u32 s50, s50, 16384
    buffer_load_dwordx4 v11, s[44:47], s50 offen lds
    s_add_u32 m0, s51, 4096
    s_add_u32 s50, s50, 16384
    buffer_load_dwordx4 v11, s[44:47], s50 offen lds
    s_add_u32 m0, s51, 5120
    s_add_u32 s50, s50, 16384
    buffer_load_dwordx4 v11, s[44:47], s50 offen lds
    s_add_u32 m0, s51, 6144
    s_add_u32 s50, s50, 16384
    buffer_load_dwordx4 v11, s[44:47], s50 offen lds
L_gapt_wd_7:
    s_cmp_lg_u32 s73, 0
    s_cbranch_scc1 L_nogu2
    v_mov_b32 v152, s65
    v_mov_b32 v153, s65
    s_mov_b32 s68, 32768
    s_waitcnt vmcnt(18)
L_gupoll:
    v_cmp_ne_u64 vcc, v[22:23], v[152:153]
    v_cmp_ne_u64 s[66:67], v[26:27], v[152:153]
    s_or_b64 vcc, vcc, s[66:67]
    v_cmp_ne_u64 s[66:67], v[30:31], v[152:153]
    s_or_b64 vcc, vcc, s[66:67]
    v_cmp_ne_u64 s[66:67], v[34:35], v[152:153]
    s_or_b64 vcc, vcc, s[66:67]
    v_cmp_ne_u64 s[66:67], v[38:39], v[152:153]
    s_or_b64 vcc, vcc, s[66:67]
    v_cmp_ne_u64 s[66:67], v[42:43], v[152:153]
    s_or_b64 vcc, vcc, s[66:67]
    v_cmp_ne_u64 s[66:67], v[46:47], v[152:153]
    s_or_b64 vcc, vcc, s[66:67]
    v_cmp_ne_u64 s[66:67], v[50:51], v[152:153]
    s_or_b64 vcc, vcc, s[66:67]
    s_cbranch_vccz L_guok
    s_sub_u32 s68, s68, 1
    s_cbranch_scc1 L_guok
    buffer_load_dwordx4 v[20:23], v18, s[16:19], s70 offen offset:0 sc1
    buffer_load_dwordx4 v[24:27], v18, s[16:19], s70 offen offset:1024 sc1
    buffer_load_dwordx4 v[28:31], v18, s[16:19], s70 offen offset:2048 sc1
    buffer_load_dwordx4 v[32:35], v18, s[16:19], s70 offen offset:3072 sc1
    buffer_load_dwordx4 v[36:39], v18, s[16:19], s71 offen offset:0 sc1
    buffer_load_dwordx4 v[40:43], v18, s[16:19], s71 offen offset:1024 sc1
    buffer_load_dwordx4 v[44:47], v18, s[16:19], s71 offen offset:2048 sc1
    buffer_load_dwordx4 v[48:51], v18, s[16:19], s71 offen offset:3072 sc1
    s_waitcnt vmcnt(0)
    s_branch L_gupoll
L_guok:
    v_pk_add_f32 v[20:21], v[20:21], v[28:29]
    v_pk_add_f32 v[36:37], v[36:37], v[44:45]
    v_pk_add_f32 v[20:21], v[20:21], v[36:37]
    v_pk_add_f32 v[24:25], v[24:25], v[32:33]
    v_pk_add_f32 v[40:41], v[40:41], v[48:49]
    v_pk_add_f32 v[24:25], v[24:25], v[40:41]
    v_cvt_pk_bf16_f32 v20, v20, v21
    v_mov_b32 v22, v20
    s_nop 1
    v_permlane32_swap_b32 v20, v22
    v_and_b32 v21, 0xffff0000, v20
    v_lshlrev_b32 v20, 16, v20
    v_and_b32 v23, 0xffff0000, v22
    v_lshlrev_b32 v22, 16, v22
    v_mul_f32 v154, 0xbfb8aa3b, v20
    v_mul_f32 v155, 0xbfb8aa3b, v21
    v_exp_f32 v154, v154
    v_exp_f32 v155, v155
    v_add_f32 v154, 1.0, v154
    v_add_f32 v155, 1.0, v155
    v_rcp_f32 v154, v154
    v_rcp_f32 v155, v155
    s_nop 0
    v_pk_mul_f32 v[20:21], v[20:21], v[154:155]
    v_cvt_pk_bf16_f32 v20, v20, v21
    v_and_b32 v21, 0xffff0000, v20
    v_lshlrev_b32 v20, 16, v20
    v_pk_mul_f32 v[20:21], v[20:21], v[22:23]
    v_cvt_pk_bf16_f32 v150, v20, v21
    v_cvt_pk_bf16_f32 v24, v24, v25
    v_mov_b32 v26, v24
    s_nop 1
    v_permlane32_swap_b32 v24, v26
    v_and_b32 v25, 0xffff0000, v24
    v_lshlrev_b32 v24, 16, v24
    v_and_b32 v27, 0xffff0000, v26
    v_lshlrev_b32 v26, 16, v26
    v_mul_f32 v154, 0xbfb8aa3b, v24
    v_mul_f32 v155, 0xbfb8aa3b, v25
    v_exp_f32 v154, v154
    v_exp_f32 v155, v155
    v_add_f32 v154, 1.0, v154
    v_add_f32 v155, 1.0, v155
    v_rcp_f32 v154, v154
    v_rcp_f32 v155, v155
    s_nop 0
    v_pk_mul_f32 v[24:25], v[24:25], v[154:155]
    v_cvt_pk_bf16_f32 v24, v24, v25
    v_and_b32 v25, 0xffff0000, v24
    v_lshlrev_b32 v24, 16, v24
    v_pk_mul_f32 v[24:25], v[24:25], v[26:27]
    v_cvt_pk_bf16_f32 v151, v24, v25
    s_lshl_b32 s33, s2, 9
    s_add_u32 s33, s33, 393216
    s_mov_b64 exec, 0xffffffff
    buffer_store_dwordx4 v[150:153], v18, s[16:19], s33 offen sc1
    s_mov_b64 exec, -1
L_nogu2:
    s_waitcnt vmcnt(18)
    s_barrier
    s_add_u32 m0, s60, 49152
    s_nop 0
    buffer_load_dwordx4 v14, s[8:11], s61 offen offset:0 lds
    buffer_load_dwordx4 v15, s[8:11], s61 offen offset:1024 lds
    buffer_load_dwordx4 v16, s[8:11], s61 offen offset:2048 lds
    buffer_load_dwordx4 v17, s[8:11], s61 offen offset:3072 lds
    s_add_u32 s61, s61, 128
    s_and_b32 s61, s61, 2047
    s_cmp_lg_u32 s63, 3
    s_cbranch_scc1 L_gapt_wd_8
    s_add_u32 m0, s51, 0
    s_nop 0
    buffer_load_dwordx4 v11, s[44:47], s50 offen lds
    s_add_u32 m0, s51, 1024
    s_add_u32 s50, s50, 16384
    buffer_load_dwordx4 v11, s[44:47], s50 offen lds
    s_add_u32 m0, s51, 2048
    s_add_u32 s50, s50, 16384
    buffer_load_dwordx4 v11, s[44:47], s50 offen lds
    s_add_u32 m0, s51, 3072
    s_add_u32 s50, s50, 16384
    buffer_load_dwordx4 v11, s[44:47], s50 offen lds
    s_add_u32 m0, s51, 4096
    s_add_u32 s50, s50, 16384
    buffer_load_dwordx4 v11, s[44:47], s50 offen lds
    s_add_u32 m0, s51, 5120
    s_add_u32 s50, s50, 16384
    buffer_load_dwordx4 v11, s[44:47], s50 offen lds
    s_add_u32 m0, s51, 6144
    s_add_u32 s50, s50, 16384
    buffer_load_dwordx4 v11, s[44:47], s50 offen lds
L_gapt_wd_8:
    s_waitcnt vmcnt(8)
    s_mov_b32 s68, 32768
L_gpoll:
    v_cmp_ne_u32 vcc, s65, v157
    s_and_b32 vcc_hi, vcc_hi, 0
    s_cbranch_vccz L_gok
    s_sub_u32 s68, s68, 1
    s_cbranch_scc1 L_gok
    buffer_load_dwordx2 v[156:157], v9, s[16:19], s74 offen sc1
    s_waitcnt vmcnt(0)
    s_branch L_gpoll
L_gok:
    v_lshlrev_b32 v8, 2, v6
    ds_bpermute_b32 v100, v8, v156 offset:0
    ds_bpermute_b32 v102, v8, v156 offset:16
    ds_bpermute_b32 v104, v8, v156 offset:32
    ds_bpermute_b32 v106, v8, v156 offset:48
    ds_bpermute_b32 v108, v8, v156 offset:64
    ds_bpermute_b32 v110, v8, v156 offset:80
    ds_bpermute_b32 v112, v8, v156 offset:96
    ds_bpermute_b32 v114, v8, v156 offset:112
    v_and_b32 v119, 0xffff0000, v117
    v_lshlrev_b32 v118, 16, v117
    v_and_b32 v117, 0xffff0000, v116
    v_lshlrev_b32 v116, 16, v116
    s_mul_i32 s72, s26, 7168
    s_mul_i32 s33, s30, 1792
    s_add_u32 s72, s72, s33
    s_add_u32 s72, s72, 393216
    v_cmp_gt_u32 vcc, 48, v1
    s_nop 1
    v_cndmask_b32 v13, v2, v18, vcc
    s_waitcnt lgkmcnt(0)
    v_and_b32 v101, 0xffff0000, v100
    v_lshlrev_b32 v100, 16, v100
    v_and_b32 v103, 0xffff0000, v102
    v_lshlrev_b32 v102, 16, v102
    v_and_b32 v105, 0xffff0000, v104
    v_lshlrev_b32 v104, 16, v104
    v_and_b32 v107, 0xffff0000, v106
    v_lshlrev_b32 v106, 16, v106
    v_and_b32 v109, 0xffff0000, v108
    v_lshlrev_b32 v108, 16, v108
    v_and_b32 v111, 0xffff0000, v110
    v_lshlrev_b32 v110, 16, v110
    v_and_b32 v113, 0xffff0000, v112
    v_lshlrev_b32 v112, 16, v112
    v_and_b32 v115, 0xffff0000, v114
    v_lshlrev_b32 v114, 16, v114
    s_barrier
    s_add_u32 m0, s60, 0
    s_nop 0
    buffer_load_dwordx4 v14, s[8:11], s61 offen offset:0 lds
    buffer_load_dwordx4 v15, s[8:11], s61 offen offset:1024 lds
    buffer_load_dwordx4 v16, s[8:11], s61 offen offset:2048 lds
    buffer_load_dwordx4 v17, s[8:11], s61 offen offset:3072 lds
    s_add_u32 s61, s61, 128
    s_and_b32 s61, s61, 2047
    v_lshlrev_b32 v152, 16, v84
    v_and_b32 v153, 0xffff0000, v84
    v_pk_mul_f32 v[154:155], v[152:153], v[116:117]
    v_pk_mul_f32 v[152:153], v[100:101], v[152:153] op_sel:[1,0]
    v_cvt_pk_bf16_f32 v154, v154, v155
    v_cvt_pk_bf16_f32 v152, v152, v153
    v_and_b32 v155, 0xffff0000, v154
    v_lshlrev_b32 v154, 16, v154
    v_and_b32 v153, 0xffff0000, v152
    v_lshlrev_b32 v152, 16, v152
    v_pk_fma_f32 v[120:121], v[100:101], v[154:155], v[152:153] op_sel_hi:[0,1,1]
    v_lshlrev_b32 v152, 16, v85
    v_and_b32 v153, 0xffff0000, v85
    v_pk_mul_f32 v[154:155], v[152:153], v[118:119]
    v_pk_mul_f32 v[152:153], v[100:101], v[152:153] op_sel:[1,0]
    v_cvt_pk_bf16_f32 v154, v154, v155
    v_cvt_pk_bf16_f32 v152, v152, v153
    v_and_b32 v155, 0xffff0000, v154
    v_lshlrev_b32 v154, 16, v154
    v_and_b32 v153, 0xffff0000, v152
    v_lshlrev_b32 v152, 16, v152
    v_pk_fma_f32 v[122:123], v[100:101], v[154:155], v[152:153] op_sel_hi:[0,1,1]
    v_lshlrev_b32 v152, 16, v86
    v_and_b32 v153, 0xffff0000, v86
    v_pk_mul_f32 v[154:155], v[152:153], v[116:117]
    v_pk_mul_f32 v[152:153], v[102:103], v[152:153] op_sel:[1,0]
    v_cvt_pk_bf16_f32 v154, v154, v155
    v_cvt_pk_bf16_f32 v152, v152, v153
    v_and_b32 v155, 0xffff0000, v154
    v_lshlrev_b32 v154, 16, v154
    v_and_b32 v153, 0xffff0000, v152
    v_lshlrev_b32 v152, 16, v152
    v_pk_fma_f32 v[124:125], v[102:103], v[154:155], v[152:153] op_sel_hi:[0,1,1]
    v_lshlrev_b32 v152, 16, v87
    v_and_b32 v153, 0xffff0000, v87
    v_pk_mul_f32 v[154:155], v[152:153], v[118:119]
    v_pk_mul_f32 v[152:153], v[102:103], v[152:153] op_sel:[1,0]
    v_cvt_pk_bf16_f32 v154, v154, v155
    v_cvt_pk_bf16_f32 v152, v152, v153
    v_and_b32 v155, 0xffff0000, v154
    v_lshlrev_b32 v154, 16, v154
    v_and_b32 v153, 0xffff0000, v152
    v_lshlrev_b32 v152, 16, v152
    v_pk_fma_f32 v[126:127], v[102:103], v[154:155], v[152:153] op_sel_hi:[0,1,1]
    s_waitcnt vmcnt(8)
    s_barrier
    s_add_u32 m0, s60, 16384
    s_nop 0
    buffer_load_dwordx4 v14, s[8:11], s61 offen offset:0 lds
    buffer_load_dwordx4 v15, s[8:11], s61 offen offset:1024 lds
    buffer_load_dwordx4 v16, s[8:11], s61 offen offset:2048 lds
    buffer_load_dwordx4 v17, s[8:11], s61 offen offset:3072 lds
    s_add_u32 s61, s61, 128
    s_and_b32 s61, s61, 2047
    buffer_load_dwordx4 v[52:55], v18, s[16:19], s72 offen offset:0 sc1
    buffer_load_dwordx4 v[56:59], v13, s[16:19], s72 offen offset:1024 sc1
    v_lshlrev_b32 v152, 16, v88
    v_and_b32 v153, 0xffff0000, v88
    v_pk_mul_f32 v[154:155], v[152:153], v[116:117]
    v_pk_mul_f32 v[152:153], v[104:105], v[152:153] op_sel:[1,0]
    v_cvt_pk_bf16_f32 v154, v154, v155
    v_cvt_pk_bf16_f32 v152, v152, v153
    v_and_b32 v155, 0xffff0000, v154
    v_lshlrev_b32 v154, 16, v154
    v_and_b32 v153, 0xffff0000, v152
    v_lshlrev_b32 v152, 16, v152
    v_pk_fma_f32 v[128:129], v[104:105], v[154:155], v[152:153] op_sel_hi:[0,1,1]
    v_lshlrev_b32 v152, 16, v89
    v_and_b32 v153, 0xffff0000, v89
    v_pk_mul_f32 v[154:155], v[152:153], v[118:119]
    v_pk_mul_f32 v[152:153], v[104:105], v[152:153] op_sel:[1,0]
    v_cvt_pk_bf16_f32 v154, v154, v155
    v_cvt_pk_bf16_f32 v152, v152, v153
    v_and_b32 v155, 0xffff0000, v154
    v_lshlrev_b32 v154, 16, v154
    v_and_b32 v153, 0xffff0000, v152
    v_lshlrev_b32 v152, 16, v152
    v_pk_fma_f32 v[130:131], v[104:105], v[154:155], v[152:153] op_sel_hi:[0,1,1]
    s_waitcnt vmcnt(10)
    s_barrier
    s_add_u32 m0, s60, 32768
    s_nop 0
    buffer_load_dwordx4 v14, s[8:11], s61 offen offset:0 lds
    buffer_load_dwordx4 v15, s[8:11], s61 offen offset:1024 lds
    buffer_load_dwordx4 v16, s[8:11], s61 offen offset:2048 lds
    buffer_load_dwordx4 v17, s[8:11], s61 offen offset:3072 lds
    s_add_u32 s61, s61, 128
    s_and_b32 s61, s61, 2047
    v_lshlrev_b32 v152, 16, v90
    v_and_b32 v153, 0xffff0000, v90
    v_pk_mul_f32 v[154:155], v[152:153], v[116:117]
    v_pk_mul_f32 v[152:153], v[106:107], v[152:153] op_sel:[1,0]
    v_cvt_pk_bf16_f32 v154, v154, v155
    v_cvt_pk_bf16_f32 v152, v152, v153
    v_and_b32 v155, 0xffff0000, v154
    v_lshlrev_b32 v154, 16, v154
    v_and_b32 v153, 0xffff0000, v152
    v_lshlrev_b32 v152, 16, v152
    v_pk_fma_f32 v[132:133], v[106:107], v[154:155], v[152:153] op_sel_hi:[0,1,1]
    v_lshlrev_b32 v152, 16, v91
    v_and_b32 v153, 0xffff0000, v91
    v_pk_mul_f32 v[154:155], v[152:153], v[118:119]
    v_pk_mul_f32 v[152:153], v[106:107], v[152:153] op_sel:[1,0]
    v_cvt_pk_bf16_f32 v154, v154, v155
    v_cvt_pk_bf16_f32 v152, v152, v153
    v_and_b32 v155, 0xffff0000, v154
    v_lshlrev_b32 v154, 16, v154
    v_and_b32 v153, 0xffff0000, v152
    v_lshlrev_b32 v152, 16, v152
    v_pk_fma_f32 v[134:135], v[106:107], v[154:155], v[152:153] op_sel_hi:[0,1,1]
    v_lshlrev_b32 v152, 16, v92
    v_and_b32 v153, 0xffff0000, v92
    v_pk_mul_f32 v[154:155], v[152:153], v[116:117]
    v_pk_mul_f32 v[152:153], v[108:109], v[152:153] op_sel:[1,0]
    v_cvt_pk_bf16_f32 v154, v154, v155
    v_cvt_pk_bf16_f32 v152, v152, v153
    v_and_b32 v155, 0xffff0000, v154
    v_lshlrev_b32 v154, 16, v154
    v_and_b32 v153, 0xffff0000, v152
    v_lshlrev_b32 v152, 16, v152
    v_pk_fma_f32 v[136:137], v[108:109], v[154:155], v[152:153] op_sel_hi:[0,1,1]
    v_lshlrev_b32 v152, 16, v93
    v_and_b32 v153, 0xffff0000, v93
    v_pk_mul_f32 v[154:155], v[152:153], v[118:119]
    v_pk_mul_f32 v[152:153], v[108:109], v[152:153] op_sel:[1,0]
    v_cvt_pk_bf16_f32 v154, v154, v155
    v_cvt_pk_bf16_f32 v152, v152, v153
    v_and_b32 v155, 0xffff0000, v154
    v_lshlrev_b32 v154, 16, v154
    v_and_b32 v153, 0xffff0000, v152
    v_lshlrev_b32 v152, 16, v152
    v_pk_fma_f32 v[138:139], v[108:109], v[154:155], v[152:153] op_sel_hi:[0,1,1]
    s_waitcnt vmcnt(10)
    s_barrier
    s_add_u32 m0, s60, 49152
    s_nop 0
    buffer_load_dwordx4 v14, s[8:11], s61 offen offset:0 lds
    buffer_load_dwordx4 v15, s[8:11], s61 offen offset:1024 lds
    buffer_load_dwordx4 v16, s[8:11], s61 offen offset:2048 lds
    buffer_load_dwordx4 v17, s[8:11], s61 offen offset:3072 lds
    s_add_u32 s61, s61, 128
    s_and_b32 s61, s61, 2047
    v_lshlrev_b32 v152, 16, v94
    v_and_b32 v153, 0xffff0000, v94
    v_pk_mul_f32 v[154:155], v[152:153], v[116:117]
    v_pk_mul_f32 v[152:153], v[110:111], v[152:153] op_sel:[1,0]
    v_cvt_pk_bf16_f32 v154, v154, v155
    v_cvt_pk_bf16_f32 v152, v152, v153
    v_and_b32 v155, 0xffff0000, v154
    v_lshlrev_b32 v154, 16, v154
    v_and_b32 v153, 0xffff0000, v152
    v_lshlrev_b32 v152, 16, v152
    v_pk_fma_f32 v[140:141], v[110:111], v[154:155], v[152:153] op_sel_hi:[0,1,1]
    v_lshlrev_b32 v152, 16, v95
    v_and_b32 v153, 0xffff0000, v95
    v_pk_mul_f32 v[154:155], v[152:153], v[118:119]
    v_pk_mul_f32 v[152:153], v[110:111], v[152:153] op_sel:[1,0]
    v_cvt_pk_bf16_f32 v154, v154, v155
    v_cvt_pk_bf16_f32 v152, v152, v153
    v_and_b32 v155, 0xffff0000, v154
    v_lshlrev_b32 v154, 16, v154
    v_and_b32 v153, 0xffff0000, v152
    v_lshlrev_b32 v152, 16, v152
    v_pk_fma_f32 v[142:143], v[110:111], v[154:155], v[152:153] op_sel_hi:[0,1,1]
    s_waitcnt vmcnt(8)
    v_mov_b32 v152, s65
    v_mov_b32 v153, s65
    s_mov_b32 s68, 32768
L_actpoll:
    v_cmp_ne_u64 vcc, v[54:55], v[152:153]
    v_cmp_ne_u64 s[66:67], v[58:59], v[152:153]
    s_and_b32 s67, s67, 0xffff
    s_or_b64 vcc, vcc, s[66:67]
    s_cbranch_vccz L_actok
    s_sub_u32 s68, s68, 1
    s_cbranch_scc1 L_actok
    buffer_load_dwordx4 v[52:55], v18, s[16:19], s72 offen offset:0 sc1
    buffer_load_dwordx4 v[56:59], v13, s[16:19], s72 offen offset:1024 sc1
    s_waitcnt vmcnt(0)
    s_branch L_actpoll
L_actok:
    s_mul_i32 s33, s30, 112
    v_add_u32 v8, s33, v1
    v_bfe_u32 v152, v8, 4, 1
    v_mul_u32_u24 v152, 1856, v152
    v_and_b32 v153, 15, v8
    v_lshl_add_u32 v152, v153, 1, v152
    v_and_b32 v8, 0x1e0, v8
    v_add_u32 v8, v8, v152
    v_add_u32 v8, 152576, v8
    ds_write_b16 v8, v52 offset:0
    ds_write_b16_d16_hi v8, v52 offset:464
    ds_write_b16 v8, v53 offset:928
    ds_write_b16_d16_hi v8, v53 offset:1392
    s_mov_b32 exec_hi, 0xffff
    ds_write_b16 v8, v56 offset:64
    ds_write_b16_d16_hi v8, v56 offset:528
    ds_write_b16 v8, v57 offset:992
    ds_write_b16_d16_hi v8, v57 offset:1456
    s_mov_b32 exec_hi, -1
    s_waitcnt lgkmcnt(0)
    s_barrier
    s_add_u32 m0, s60, 0
    s_nop 0
    buffer_load_dwordx4 v14, s[8:11], s61 offen offset:0 lds
    buffer_load_dwordx4 v15, s[8:11], s61 offen offset:1024 lds
    buffer_load_dwordx4 v16, s[8:11], s61 offen offset:2048 lds
    buffer_load_dwordx4 v17, s[8:11], s61 offen offset:3072 lds
    s_add_u32 s61, s61, 128
    s_and_b32 s61, s61, 2047
    v_mul_u32_u24 v8, 464, v4
    v_lshl_add_u32 v8, v6, 4, v8
    v_add_u32 v8, 152576, v8
    s_lshl_b32 s33, s30, 5
    v_add_u32 v5, s33, v5
    ds_read_b128 v[48:51], v8 offset:0
    ds_read_b64_tr_b16 v[20:21], v5 offset:0
    ds_read_b64_tr_b16 v[22:23], v5 offset:512
    ds_read_b128 v[52:55], v8 offset:64
    ds_read_b64_tr_b16 v[24:25], v5 offset:4096
    ds_read_b64_tr_b16 v[26:27], v5 offset:4608
    ds_read_b128 v[56:59], v8 offset:128
    ds_read_b64_tr_b16 v[28:29], v5 offset:8192
    ds_read_b64_tr_b16 v[30:31], v5 offset:8704
    ds_read_b128 v[60:63], v8 offset:192
    ds_read_b64_tr_b16 v[32:33], v5 offset:12288
    ds_read_b64_tr_b16 v[34:35], v5 offset:12800
    ds_read_b128 v[64:67], v8 offset:256
    ds_read_b64_tr_b16 v[36:37], v5 offset:16384
    ds_read_b64_tr_b16 v[38:39], v5 offset:16896
    ds_read_b128 v[68:71], v8 offset:320
    ds_read_b64_tr_b16 v[40:41], v5 offset:20480
    ds_read_b64_tr_b16 v[42:43], v5 offset:20992
    ds_read_b128 v[72:75], v8 offset:384
    ds_read_b64_tr_b16 v[44:45], v5 offset:24576
    ds_read_b64_tr_b16 v[46:47], v5 offset:25088
    s_waitcnt lgkmcnt(15)
    v_mfma_f32_16x16x32_bf16 v[76:79], v[48:51], v[20:23], 0
    s_waitcnt lgkmcnt(15)
    v_mfma_f32_16x16x32_bf16 v[76:79], v[52:55], v[24:27], v[76:79]
    s_waitcnt lgkmcnt(12)
    v_mfma_f32_16x16x32_bf16 v[76:79], v[56:59], v[28:31], v[76:79]
    s_waitcnt lgkmcnt(9)
    v_mfma_f32_16x16x32_bf16 v[76:79], v[60:63], v[32:35], v[76:79]
    s_waitcnt lgkmcnt(6)
    v_mfma_f32_16x16x32_bf16 v[76:79], v[64:67], v[36:39], v[76:79]
    s_waitcnt lgkmcnt(3)
    v_mfma_f32_16x16x32_bf16 v[76:79], v[68:71], v[40:43], v[76:79]
    s_waitcnt lgkmcnt(0)
    v_mfma_f32_16x16x32_bf16 v[76:79], v[72:75], v[44:47], v[76:79]
    v_and_b32 v8, 1, v6
    v_lshlrev_b32 v8, 1, v8
    v_lshrrev_b32 v20, 1, v6
    v_add_u32 v8, v8, v20
    v_lshlrev_b32 v8, 18, v8
    v_lshl_add_u32 v8, v7, 3, v8
    s_lshl_b32 s33, s27, 13
    s_lshl_b32 s34, s26, 9
    s_add_u32 s33, s33, s34
    s_lshl_b32 s34, s30, 7
    s_add_u32 s33, s33, s34
    s_add_u32 s33, s33, 2621440
    s_add_u32 s34, s33, 131072
    v_mov_b32 v21, s65
    v_mov_b32 v23, s65
    v_mov_b32 v20, v76
    v_mov_b32 v22, v77
    s_mov_b32 exec_lo, 0
    v_mov_b32 v20, v78
    v_mov_b32 v22, v79
    s_mov_b32 exec_lo, -1
    buffer_store_dwordx2 v[20:21], v8, s[16:19], s33 offen sc1
    buffer_store_dwordx2 v[22:23], v8, s[16:19], s34 offen sc1
    s_waitcnt vmcnt(10)
    s_barrier
    s_add_u32 m0, s60, 16384
    s_nop 0
    buffer_load_dwordx4 v14, s[8:11], s61 offen offset:0 lds
    buffer_load_dwordx4 v15, s[8:11], s61 offen offset:1024 lds
    buffer_load_dwordx4 v16, s[8:11], s61 offen offset:2048 lds
    buffer_load_dwordx4 v17, s[8:11], s61 offen offset:3072 lds
    s_add_u32 s61, s61, 128
    s_and_b32 s61, s61, 2047
    v_lshlrev_b32 v152, 16, v96
    v_and_b32 v153, 0xffff0000, v96
    v_pk_mul_f32 v[154:155], v[152:153], v[116:117]
    v_pk_mul_f32 v[152:153], v[112:113], v[152:153] op_sel:[1,0]
    v_cvt_pk_bf16_f32 v154, v154, v155
    v_cvt_pk_bf16_f32 v152, v152, v153
    v_and_b32 v155, 0xffff0000, v154
    v_lshlrev_b32 v154, 16, v154
    v_and_b32 v153, 0xffff0000, v152
    v_lshlrev_b32 v152, 16, v152
    v_pk_fma_f32 v[144:145], v[112:113], v[154:155], v[152:153] op_sel_hi:[0,1,1]
    v_lshlrev_b32 v152, 16, v97
    v_and_b32 v153, 0xffff0000, v97
    v_pk_mul_f32 v[154:155], v[152:153], v[118:119]
    v_pk_mul_f32 v[152:153], v[112:113], v[152:153] op_sel:[1,0]
    v_cvt_pk_bf16_f32 v154, v154, v155
    v_cvt_pk_bf16_f32 v152, v152, v153
    v_and_b32 v155, 0xffff0000, v154
    v_lshlrev_b32 v154, 16, v154
    v_and_b32 v153, 0xffff0000, v152
    v_lshlrev_b32 v152, 16, v152
    v_pk_fma_f32 v[146:147], v[112:113], v[154:155], v[152:153] op_sel_hi:[0,1,1]
    v_subrev_u32 v8, s49, v178
    v_lshlrev_b32 v152, v8, 1
    v_cmp_gt_u32 vcc, 32, v8
    s_nop 1
    v_cndmask_b32 v152, 0, v152, vcc
    s_nop 1
    v_or_b32_dpp v152, v152, v152 row_shr:1 row_mask:0xf bank_mask:0xf
    s_nop 1
    v_or_b32_dpp v152, v152, v152 row_shr:2 row_mask:0xf bank_mask:0xf
    s_nop 1
    v_or_b32_dpp v152, v152, v152 row_shr:4 row_mask:0xf bank_mask:0xf
    v_lshlrev_b32 v8, v6, 1
    v_readlane_b32 s33, v152, 7
    s_lshr_b32 s34, s33, 0
    v_and_b32 v170, s34, v8
    s_lshr_b32 s34, s33, 4
    v_and_b32 v171, s34, v8
    s_lshr_b32 s34, s33, 8
    v_and_b32 v172, s34, v8
    s_lshr_b32 s34, s33, 12
    v_and_b32 v173, s34, v8
    s_lshr_b32 s34, s33, 16
    v_and_b32 v174, s34, v8
    s_lshr_b32 s34, s33, 20
    v_and_b32 v175, s34, v8
    s_lshr_b32 s34, s33, 24
    v_and_b32 v176, s34, v8
    s_lshr_b32 s34, s33, 28
    v_and_b32 v177, s34, v8
    s_waitcnt vmcnt(10)
    s_barrier
    s_add_u32 m0, s60, 32768
    s_nop 0
    buffer_load_dwordx4 v14, s[8:11], s61 offen offset:0 lds
    buffer_load_dwordx4 v15, s[8:11], s61 offen offset:1024 lds
    buffer_load_dwordx4 v16, s[8:11], s61 offen offset:2048 lds
    buffer_load_dwordx4 v17, s[8:11], s61 offen offset:3072 lds
    s_add_u32 s61, s61, 128
    s_and_b32 s61, s61, 2047
    s_add_u32 s33, s30, 4
    v_readlane_b32 s66, v178, s30
    v_readlane_b32 s67, v179, s30
    v_readlane_b32 s68, v178, s33
    v_readlane_b32 s69, v179, s33
    v_mov_b32 v10, s66
    v_mov_b32 v168, s67
    s_mov_b32 exec_lo, 0
    v_mov_b32 v10, s68
    v_mov_b32 v168, s69
    s_mov_b32 exec_lo, -1
    v_subrev_u32 v3, s48, v10
    v_cmp_gt_u32 vcc, 0x80, v3
    v_lshrrev_b32 v11, 5, v1
    v_lshlrev_b32 v11, 19, v11
    v_and_b32 v13, 1, v6
    v_lshl_add_u32 v11, v13, 12, v11
    v_lshl_add_u32 v11, v7, 5, v11
    s_mov_b64 s[52:53], vcc
    v_cndmask_b32 v11, v2, v11, vcc
    v_lshl_add_u32 v13, v10, 11, v12
    v_cndmask_b32 v13, v2, v13, vcc
    v_lshlrev_b32 v12, 3, v10
    v_cndmask_b32 v12, v2, v12, vcc
    v_mov_b32 v9, s65
    v_cndmask_b32 v9, 0, v9, vcc
    s_lshl_b32 s54, s30, 17
    s_lshl_b32 s66, s27, 13
    s_add_u32 s54, s54, s66
    s_add_u32 s54, s54, 2621440
    s_mov_b32 s66, 8192
    s_waitcnt vmcnt(10)
    s_barrier
    s_add_u32 m0, s60, 49152
    s_nop 0
    buffer_load_dwordx4 v14, s[8:11], s61 offen offset:0 lds
    buffer_load_dwordx4 v15, s[8:11], s61 offen offset:1024 lds
    buffer_load_dwordx4 v16, s[8:11], s61 offen offset:2048 lds
    buffer_load_dwordx4 v17, s[8:11], s61 offen offset:3072 lds
    v_lshlrev_b32 v152, 16, v98
    v_and_b32 v153, 0xffff0000, v98
    v_pk_mul_f32 v[154:155], v[152:153], v[116:117]
    v_pk_mul_f32 v[152:153], v[114:115], v[152:153] op_sel:[1,0]
    v_cvt_pk_bf16_f32 v154, v154, v155
    v_cvt_pk_bf16_f32 v152, v152, v153
    v_and_b32 v155, 0xffff0000, v154
    v_lshlrev_b32 v154, 16, v154
    v_and_b32 v153, 0xffff0000, v152
    v_lshlrev_b32 v152, 16, v152
    v_pk_fma_f32 v[148:149], v[114:115], v[154:155], v[152:153] op_sel_hi:[0,1,1]
    v_lshlrev_b32 v152, 16, v99
    v_and_b32 v153, 0xffff0000, v99
    v_pk_mul_f32 v[154:155], v[152:153], v[118:119]
    v_pk_mul_f32 v[152:153], v[114:115], v[152:153] op_sel:[1,0]
    v_cvt_pk_bf16_f32 v154, v154, v155
    v_cvt_pk_bf16_f32 v152, v152, v153
    v_and_b32 v155, 0xffff0000, v154
    v_lshlrev_b32 v154, 16, v154
    v_and_b32 v153, 0xffff0000, v152
    v_lshlrev_b32 v152, 16, v152
    v_pk_fma_f32 v[150:151], v[114:115], v[154:155], v[152:153] op_sel_hi:[0,1,1]
    s_waitcnt vmcnt(8)
    s_barrier
    s_cmp_eq_u64 s[52:53], 0
    s_cbranch_scc1 L_noy
    buffer_load_dwordx4 v[20:23], v11, s[16:19], s54 offen offset:0 sc1
    buffer_load_dwordx4 v[24:27], v11, s[16:19], s54 offen offset:16 sc1
    buffer_load_dwordx4 v[28:31], v11, s[16:19], s54 offen offset:512 sc1
    buffer_load_dwordx4 v[32:35], v11, s[16:19], s54 offen offset:528 sc1
    buffer_load_dwordx4 v[36:39], v11, s[16:19], s54 offen offset:1024 sc1
    buffer_load_dwordx4 v[40:43], v11, s[16:19], s54 offen offset:1040 sc1
    buffer_load_dwordx4 v[44:47], v11, s[16:19], s54 offen offset:1536 sc1
    buffer_load_dwordx4 v[48:51], v11, s[16:19], s54 offen offset:1552 sc1
    buffer_load_dwordx4 v[52:55], v11, s[16:19], s54 offen offset:2048 sc1
    buffer_load_dwordx4 v[56:59], v11, s[16:19], s54 offen offset:2064 sc1
    buffer_load_dwordx4 v[60:63], v11, s[16:19], s54 offen offset:2560 sc1
    buffer_load_dwordx4 v[64:67], v11, s[16:19], s54 offen offset:2576 sc1
    buffer_load_dwordx4 v[68:71], v11, s[16:19], s54 offen offset:3072 sc1
    buffer_load_dwordx4 v[72:75], v11, s[16:19], s54 offen offset:3088 sc1
    buffer_load_dwordx4 v[76:79], v11, s[16:19], s54 offen offset:3584 sc1
    buffer_load_dwordx4 v[80:83], v11, s[16:19], s54 offen offset:3600 sc1
    buffer_load_dwordx2 v[160:161], v13, s[56:59], s55 offen
    buffer_load_dword v162, v12, s[16:19], s66 offen sc1
    s_waitcnt vmcnt(22)
    s_barrier
    s_waitcnt vmcnt(18)
    s_barrier
    s_branch L_yjoin
L_noy:
    s_waitcnt vmcnt(4)
    s_barrier
    s_waitcnt vmcnt(0)
    s_barrier
L_yjoin:
    v_lshlrev_b32 v14, 4, v7
    v_lshl_add_u32 v15, v10, 12, v14
    v_lshl_add_u32 v14, v6, 12, v14
    v_xor_b32 v16, v7, v6
    v_lshlrev_b32 v16, 4, v16
    v_lshl_add_u32 v16, v6, 8, v16
    s_lshl_b32 s33, s30, 13
    s_add_u32 s33, s33, 32768
    v_add_u32 v16, s33, v16
    v_xor_b32 v17, 64, v16
    v_and_b32 v8, 7, v3
    v_xor_b32 v8, v8, v7
    v_lshlrev_b32 v8, 4, v8
    v_and_b32 v5, 0x7f, v3
    v_lshl_add_u32 v8, v5, 8, v8
    s_lshl_b32 s67, s27, 8
    s_lshl_b32 s69, s49, 12
    s_add_u32 s69, s69, s67
    s_cmp_eq_u64 s[52:53], 0
    s_cbranch_scc1 L_notok
    s_mov_b32 s68, 32768
L_ypoll:
    s_waitcnt vmcnt(0)
    v_xor_b32 v152, v9, v21
    v_xor_b32 v153, v9, v23
    v_or_b32 v152, v152, v153
    v_xor_b32 v153, v9, v25
    v_or_b32 v152, v152, v153
    v_xor_b32 v153, v9, v27
    v_or_b32 v152, v152, v153
    v_xor_b32 v153, v9, v29
    v_or_b32 v152, v152, v153
    v_xor_b32 v153, v9, v31
    v_or_b32 v152, v152, v153
    v_xor_b32 v153, v9, v33
    v_or_b32 v152, v152, v153
    v_xor_b32 v153, v9, v35
    v_or_b32 v152, v152, v153
    v_xor_b32 v153, v9, v37
    v_or_b32 v152, v152, v153
    v_xor_b32 v153, v9, v39
    v_or_b32 v152, v152, v153
    v_xor_b32 v153, v9, v41
    v_or_b32 v152, v152, v153
    v_xor_b32 v153, v9, v43
    v_or_b32 v152, v152, v153
    v_xor_b32 v153, v9, v45
    v_or_b32 v152, v152, v153
    v_xor_b32 v153, v9, v47
    v_or_b32 v152, v152, v153
    v_xor_b32 v153, v9, v49
    v_or_b32 v152, v152, v153
    v_xor_b32 v153, v9, v51
    v_or_b32 v152, v152, v153
    v_xor_b32 v153, v9, v53
    v_or_b32 v152, v152, v153
    v_xor_b32 v153, v9, v55
    v_or_b32 v152, v152, v153
    v_xor_b32 v153, v9, v57
    v_or_b32 v152, v152, v153
    v_xor_b32 v153, v9, v59
    v_or_b32 v152, v152, v153
    v_xor_b32 v153, v9, v61
    v_or_b32 v152, v152, v153
    v_xor_b32 v153, v9, v63
    v_or_b32 v152, v152, v153
    v_xor_b32 v153, v9, v65
    v_or_b32 v152, v152, v153
    v_xor_b32 v153, v9, v67
    v_or_b32 v152, v152, v153
    v_xor_b32 v153, v9, v69
    v_or_b32 v152, v152, v153
    v_xor_b32 v153, v9, v71
    v_or_b32 v152, v152, v153
    v_xor_b32 v153, v9, v73
    v_or_b32 v152, v152, v153
    v_xor_b32 v153, v9, v75
    v_or_b32 v152, v152, v153
    v_xor_b32 v153, v9, v77
    v_or_b32 v152, v152, v153
    v_xor_b32 v153, v9, v79
    v_or_b32 v152, v152, v153
    v_xor_b32 v153, v9, v81
    v_or_b32 v152, v152, v153
    v_xor_b32 v153, v9, v83
    v_or_b32 v152, v152, v153
    v_cmp_ne_u32 vcc, 0, v152
    s_cbranch_vccz L_yok
    s_sub_u32 s68, s68, 1
    s_cbranch_scc1 L_yok
    buffer_load_dwordx4 v[20:23], v11, s[16:19], s54 offen offset:0 sc1
    buffer_load_dwordx4 v[24:27], v11, s[16:19], s54 offen offset:16 sc1
    buffer_load_dwordx4 v[28:31], v11, s[16:19], s54 offen offset:512 sc1
    buffer_load_dwordx4 v[32:35], v11, s[16:19], s54 offen offset:528 sc1
    buffer_load_dwordx4 v[36:39], v11, s[16:19], s54 offen offset:1024 sc1
    buffer_load_dwordx4 v[40:43], v11, s[16:19], s54 offen offset:1040 sc1
    buffer_load_dwordx4 v[44:47], v11, s[16:19], s54 offen offset:1536 sc1
    buffer_load_dwordx4 v[48:51], v11, s[16:19], s54 offen offset:1552 sc1
    buffer_load_dwordx4 v[52:55], v11, s[16:19], s54 offen offset:2048 sc1
    buffer_load_dwordx4 v[56:59], v11, s[16:19], s54 offen offset:2064 sc1
    buffer_load_dwordx4 v[60:63], v11, s[16:19], s54 offen offset:2560 sc1
    buffer_load_dwordx4 v[64:67], v11, s[16:19], s54 offen offset:2576 sc1
    buffer_load_dwordx4 v[68:71], v11, s[16:19], s54 offen offset:3072 sc1
    buffer_load_dwordx4 v[72:75], v11, s[16:19], s54 offen offset:3088 sc1
    buffer_load_dwordx4 v[76:79], v11, s[16:19], s54 offen offset:3584 sc1
    buffer_load_dwordx4 v[80:83], v11, s[16:19], s54 offen offset:3600 sc1
    s_branch L_ypoll
L_yok:
    v_add_f32 v20, v20, v28
    v_add_f32 v22, v22, v30
    v_add_f32 v24, v24, v32
    v_add_f32 v26, v26, v34
    v_add_f32 v20, v20, v36
    v_add_f32 v22, v22, v38
    v_add_f32 v24, v24, v40
    v_add_f32 v26, v26, v42
    v_add_f32 v20, v20, v44
    v_add_f32 v22, v22, v46
    v_add_f32 v24, v24, v48
    v_add_f32 v26, v26, v50
    v_add_f32 v20, v20, v52
    v_add_f32 v22, v22, v54
    v_add_f32 v24, v24, v56
    v_add_f32 v26, v26, v58
    v_add_f32 v20, v20, v60
    v_add_f32 v22, v22, v62
    v_add_f32 v24, v24, v64
    v_add_f32 v26, v26, v66
    v_add_f32 v20, v20, v68
    v_add_f32 v22, v22, v70
    v_add_f32 v24, v24, v72
    v_add_f32 v26, v26, v74
    v_add_f32 v20, v20, v76
    v_add_f32 v22, v22, v78
    v_add_f32 v24, v24, v80
    v_add_f32 v26, v26, v82
    v_mov_b32 v21, v20
    v_mov_b32 v23, v22
    v_mov_b32 v25, v24
    v_mov_b32 v27, v26
    v_permlane16_swap_b32 v20, v21
    v_permlane16_swap_b32 v22, v23
    v_permlane16_swap_b32 v24, v25
    v_permlane16_swap_b32 v26, v27
    v_add_f32 v28, v20, v21
    v_add_f32 v29, v22, v23
    v_add_f32 v30, v24, v25
    v_add_f32 v31, v26, v27
    v_and_b32 v163, 0xffff0000, v162
    v_lshlrev_b32 v162, 16, v162
    v_cvt_pk_bf16_f32 v28, v28, v29
    v_and_b32 v29, 0xffff0000, v28
    v_lshlrev_b32 v28, 16, v28
    v_mul_f32 v28, v28, v168
    v_mul_f32 v29, v29, v168
    v_cvt_pk_bf16_f32 v28, v28, v29
    v_and_b32 v29, 0xffff0000, v28
    v_lshlrev_b32 v28, 16, v28
    v_lshlrev_b32 v152, 16, v160
    v_and_b32 v153, 0xffff0000, v160
    v_pk_add_f32 v[28:29], v[28:29], v[152:153]
    v_cvt_pk_bf16_f32 v28, v28, v29
    v_and_b32 v29, 0xffff0000, v28
    v_lshlrev_b32 v28, 16, v28
    v_cvt_pk_bf16_f32 v30, v30, v31
    v_and_b32 v31, 0xffff0000, v30
    v_lshlrev_b32 v30, 16, v30
    v_mul_f32 v30, v30, v168
    v_mul_f32 v31, v31, v168
    v_cvt_pk_bf16_f32 v30, v30, v31
    v_and_b32 v31, 0xffff0000, v30
    v_lshlrev_b32 v30, 16, v30
    v_lshlrev_b32 v152, 16, v161
    v_and_b32 v153, 0xffff0000, v161
    v_pk_add_f32 v[30:31], v[30:31], v[152:153]
    v_cvt_pk_bf16_f32 v30, v30, v31
    v_and_b32 v31, 0xffff0000, v30
    v_lshlrev_b32 v30, 16, v30
    v_lshlrev_b32 v152, 16, v160
    v_and_b32 v153, 0xffff0000, v160
    v_pk_mul_f32 v[154:155], v[152:153], v[116:117]
    v_pk_mul_f32 v[152:153], v[162:163], v[28:29] op_sel:[1,0]
    v_cvt_pk_bf16_f32 v154, v154, v155
    v_cvt_pk_bf16_f32 v152, v152, v153
    v_and_b32 v155, 0xffff0000, v154
    v_lshlrev_b32 v154, 16, v154
    v_and_b32 v153, 0xffff0000, v152
    v_lshlrev_b32 v152, 16, v152
    v_pk_fma_f32 v[164:165], v[162:163], v[154:155], v[152:153] op_sel_hi:[0,1,1]
    v_lshlrev_b32 v152, 16, v161
    v_and_b32 v153, 0xffff0000, v161
    v_pk_mul_f32 v[154:155], v[152:153], v[118:119]
    v_pk_mul_f32 v[152:153], v[162:163], v[30:31] op_sel:[1,0]
    v_cvt_pk_bf16_f32 v154, v154, v155
    v_cvt_pk_bf16_f32 v152, v152, v153
    v_and_b32 v155, 0xffff0000, v154
    v_lshlrev_b32 v154, 16, v154
    v_and_b32 v153, 0xffff0000, v152
    v_lshlrev_b32 v152, 16, v152
    v_pk_fma_f32 v[166:167], v[162:163], v[154:155], v[152:153] op_sel_hi:[0,1,1]
L_notok:
    s_barrier
    ds_read_b128 v[20:23], v16 offset:0
    ds_read_b128 v[24:27], v17 offset:1024
    ds_read_b128 v[28:31], v16 offset:2048
    ds_read_b128 v[32:35], v17 offset:3072
    ds_read_b128 v[36:39], v16 offset:4096
    ds_read_b128 v[40:43], v17 offset:5120
    ds_read_b128 v[44:47], v16 offset:6144
    ds_read_b128 v[48:51], v17 offset:7168
    ds_read_b128 v[52:55], v8 offset:32768
    v_cmp_eq_u32 vcc, 0, v170
    s_waitcnt lgkmcnt(8)
    v_pk_fma_f32 v[20:21], v[100:101], v[20:21], v[120:121] op_sel_hi:[0,1,1]
    v_pk_fma_f32 v[22:23], v[100:101], v[22:23], v[122:123] op_sel_hi:[0,1,1]
    s_mov_b64 exec, vcc
    buffer_store_dwordx4 v[20:23], v14, s[40:43], s69 offen
    s_mov_b64 exec, -1
    s_add_u32 s69, s69, 16384
    v_cmp_eq_u32 vcc, 0, v171
    s_waitcnt lgkmcnt(7)
    v_pk_fma_f32 v[24:25], v[102:103], v[24:25], v[124:125] op_sel_hi:[0,1,1]
    v_pk_fma_f32 v[26:27], v[102:103], v[26:27], v[126:127] op_sel_hi:[0,1,1]
    s_mov_b64 exec, vcc
    buffer_store_dwordx4 v[24:27], v14, s[40:43], s69 offen
    s_mov_b64 exec, -1
    s_add_u32 s69, s69, 16384
    v_cmp_eq_u32 vcc, 0, v172
    s_waitcnt lgkmcnt(6)
    v_pk_fma_f32 v[28:29], v[104:105], v[28:29], v[128:129] op_sel_hi:[0,1,1]
    v_pk_fma_f32 v[30:31], v[104:105], v[30:31], v[130:131] op_sel_hi:[0,1,1]
    s_mov_b64 exec, vcc
    buffer_store_dwordx4 v[28:31], v14, s[40:43], s69 offen
    s_mov_b64 exec, -1
    s_add_u32 s69, s69, 16384
    v_cmp_eq_u32 vcc, 0, v173
    s_waitcnt lgkmcnt(5)
    v_pk_fma_f32 v[32:33], v[106:107], v[32:33], v[132:133] op_sel_hi:[0,1,1]
    v_pk_fma_f32 v[34:35], v[106:107], v[34:35], v[134:135] op_sel_hi:[0,1,1]
    s_mov_b64 exec, vcc
    buffer_store_dwordx4 v[32:35], v14, s[40:43], s69 offen
    s_mov_b64 exec, -1
    s_add_u32 s69, s69, 16384
    v_cmp_eq_u32 vcc, 0, v174
    s_waitcnt lgkmcnt(4)
    v_pk_fma_f32 v[36:37], v[108:109], v[36:37], v[136:137] op_sel_hi:[0,1,1]
    v_pk_fma_f32 v[38:39], v[108:109], v[38:39], v[138:139] op_sel_hi:[0,1,1]
    s_mov_b64 exec, vcc
    buffer_store_dwordx4 v[36:39], v14, s[40:43], s69 offen
    s_mov_b64 exec, -1
    s_add_u32 s69, s69, 16384
    v_cmp_eq_u32 vcc, 0, v175
    s_waitcnt lgkmcnt(3)
    v_pk_fma_f32 v[40:41], v[110:111], v[40:41], v[140:141] op_sel_hi:[0,1,1]
    v_pk_fma_f32 v[42:43], v[110:111], v[42:43], v[142:143] op_sel_hi:[0,1,1]
    s_mov_b64 exec, vcc
    buffer_store_dwordx4 v[40:43], v14, s[40:43], s69 offen
    s_mov_b64 exec, -1
    s_add_u32 s69, s69, 16384
    v_cmp_eq_u32 vcc, 0, v176
    s_waitcnt lgkmcnt(2)
    v_pk_fma_f32 v[44:45], v[112:113], v[44:45], v[144:145] op_sel_hi:[0,1,1]
    v_pk_fma_f32 v[46:47], v[112:113], v[46:47], v[146:147] op_sel_hi:[0,1,1]
    s_mov_b64 exec, vcc
    buffer_store_dwordx4 v[44:47], v14, s[40:43], s69 offen
    s_mov_b64 exec, -1
    s_add_u32 s69, s69, 16384
    v_cmp_eq_u32 vcc, 0, v177
    s_waitcnt lgkmcnt(1)
    v_pk_fma_f32 v[48:49], v[114:115], v[48:49], v[148:149] op_sel_hi:[0,1,1]
    v_pk_fma_f32 v[50:51], v[114:115], v[50:51], v[150:151] op_sel_hi:[0,1,1]
    s_mov_b64 exec, vcc
    buffer_store_dwordx4 v[48:51], v14, s[40:43], s69 offen
    s_mov_b64 exec, -1
    s_add_u32 s69, s69, 16384
    s_waitcnt lgkmcnt(0)
    v_pk_fma_f32 v[52:53], v[162:163], v[52:53], v[164:165] op_sel_hi:[0,1,1]
    v_pk_fma_f32 v[54:55], v[162:163], v[54:55], v[166:167] op_sel_hi:[0,1,1]
    s_and_b32 exec_lo, s52, 0xffff
    s_and_b32 exec_hi, s53, 0xffff
    s_cbranch_execz L_aend
    buffer_store_dwordx4 v[52:55], v15, s[40:43], s67 offen
L_aend:
    s_endpgm
L_compute:
    s_load_dwordx2 s[64:65], s[0:1], 0
    s_load_dwordx2 s[68:69], s[0:1], 80
    s_load_dwordx2 s[72:73], s[0:1], 112
    s_load_dwordx2 s[8:9], s[0:1], 8
    s_load_dwordx2 s[12:13], s[0:1], 16
    s_load_dwordx2 s[16:17], s[0:1], 56
    s_load_dwordx2 s[20:21], s[0:1], 136
    s_load_dwordx4 s[76:79], s[0:1], 40
    s_lshr_b32 s30, s29, 1
    s_and_b32 s31, s29, 1
    v_and_b32 v6, 15, v1
    v_lshrrev_b32 v7, 4, v1
    s_lshl_b32 s32, s27, 6
    s_lshl_b32 s33, s31, 5
    s_add_u32 s32, s32, s33
    s_lshl_b32 s32, s32, 1
    v_lshlrev_b32 v8, 1, v6
    v_lshlrev_b32 v196, 4, v1
    s_lshl_b32 s46, s26, 7
    s_lshl_b32 s47, s27, 3
    s_add_u32 s46, s46, s47
    s_lshl_b32 s47, s29, 1
    s_add_u32 s46, s46, s47
    s_lshl_b32 s48, s46, 11
    s_mov_b32 s66, 4194304
    s_mov_b32 s67, 0x20000
    s_mov_b32 s10, 2048
    s_mov_b32 s11, 0x20000
    s_mov_b32 s14, 2048
    s_mov_b32 s15, 0x20000
    s_mov_b32 s18, 2048
    s_mov_b32 s19, 0x20000
    s_mov_b32 s70, 2048
    s_mov_b32 s71, 0x20000
    s_mov_b32 s74, 2048
    s_mov_b32 s75, 0x20000
    s_waitcnt lgkmcnt(0)
    s_load_dword s44, s[20:21], 0
    buffer_load_ushort v26, v8, s[16:19], s32 offen offset:0
    buffer_load_ushort v32, v8, s[8:11], s32 offen offset:0
    buffer_load_ushort v34, v8, s[12:15], s32 offen offset:0
    buffer_load_ushort v27, v8, s[16:19], s32 offen offset:32
    buffer_load_ushort v33, v8, s[8:11], s32 offen offset:32
    buffer_load_ushort v35, v8, s[12:15], s32 offen offset:32
    buffer_load_dwordx4 v[184:187], v196, s[72:75], 0 offen offset:0
    buffer_load_dwordx4 v[176:179], v196, s[68:71], 0 offen offset:0
    buffer_load_dwordx4 v[188:191], v196, s[72:75], 0 offen offset:1024
    buffer_load_dwordx4 v[180:183], v196, s[68:71], 0 offen offset:1024
    buffer_load_dwordx4 v[160:163], v196, s[64:67], s48 offen offset:0
    buffer_load_dwordx4 v[164:167], v196, s[64:67], s48 offen offset:1024
    buffer_load_dwordx4 v[168:171], v196, s[64:67], s48 offen offset:2048
    buffer_load_dwordx4 v[172:175], v196, s[64:67], s48 offen offset:3072
    s_getpc_b64 s[8:9]
Lc_pc:
    s_sub_u32 s8, s8, Lc_pc - gated_mix__ssm_conv_s5__moe_arch_mod__prompt_kernel
    s_subb_u32 s9, s9, 0
    s_mov_b32 s10, L_end - gated_mix__ssm_conv_s5__moe_arch_mod__prompt_kernel
    s_lshl_b32 s33, s25, 10
    s_cmp_lg_u32 s29, 0
    s_cbranch_scc1 Lc_nopf
    buffer_load_dwordx4 v[192:195], v196, s[8:11], s33 offen
Lc_nopf:
    v_lshrrev_b32 v8, 1, v6
    v_xor_b32 v8, v8, v7
    v_lshlrev_b32 v8, 4, v8
    v_lshl_add_u32 v8, v6, 7, v8
    s_lshl_b32 s33, s30, 13
    s_lshl_b32 s34, s31, 13
    s_add_u32 s34, s34, 16384
    v_add_u32 v2, s33, v8
    v_add_u32 v4, s34, v8
    v_xor_b32 v3, 64, v2
    v_xor_b32 v5, 64, v4
    s_lshl_b32 s33, s27, 14
    s_add_u32 s33, s33, 65536
    s_add_u32 s36, s20, s33
    s_addc_u32 s37, s21, 0
    s_mov_b32 s38, 16384
    s_mov_b32 s39, 0x20000
    s_add_u32 s33, s27, s26
    s_and_b32 s33, s33, 15
    s_lshl_b32 s33, s33, 2
    s_add_u32 s33, s33, s31
    s_lshl_b32 s33, s33, 3
    s_lshl_b32 s34, s26, 9
    s_add_u32 s33, s33, s34
    s_lshl_b32 s34, s30, 2
    s_add_u32 s33, s33, s34
    s_lshl_b32 s33, s33, 10
    s_add_u32 s33, s33, 4194304
    s_add_u32 s40, s20, s33
    s_addc_u32 s41, s21, 0
    s_mov_b32 s42, 20480
    s_mov_b32 s43, 0x20000
    s_lshl_b32 s33, s27, 6
    s_lshl_b32 s34, s30, 5
    s_add_u32 s33, s33, s34
    s_lshl_b32 s33, s33, 11
    s_cmp_eq_u32 s31, 1
    s_cselect_b32 s76, s78, s76
    s_cselect_b32 s77, s79, s77
    s_add_u32 s76, s76, s33
    s_addc_u32 s77, s77, 0
    s_sub_u32 s78, 2097152, s33
    s_mov_b32 s79, 0x20000
    v_mov_b32 v96, 0
    v_mov_b32 v97, 0
    v_mov_b32 v98, 0
    v_mov_b32 v99, 0
    v_mov_b32 v100, 0
    v_mov_b32 v101, 0
    v_mov_b32 v102, 0
    v_mov_b32 v103, 0
    v_mov_b32 v104, 0
    v_mov_b32 v105, 0
    v_mov_b32 v106, 0
    v_mov_b32 v107, 0
    v_mov_b32 v108, 0
    v_mov_b32 v109, 0
    v_mov_b32 v110, 0
    v_mov_b32 v111, 0
    v_mov_b32 v112, 0
    v_mov_b32 v113, 0
    v_mov_b32 v114, 0
    v_mov_b32 v115, 0
    v_mov_b32 v116, 0
    v_mov_b32 v117, 0
    v_mov_b32 v118, 0
    v_mov_b32 v119, 0
    v_mov_b32 v120, 0
    v_mov_b32 v121, 0
    v_mov_b32 v122, 0
    v_mov_b32 v123, 0
    v_mov_b32 v124, 0
    v_mov_b32 v125, 0
    v_mov_b32 v126, 0
    v_mov_b32 v127, 0
    v_mov_b32 v128, 0
    v_mov_b32 v129, 0
    v_mov_b32 v130, 0
    v_mov_b32 v131, 0
    v_mov_b32 v132, 0
    v_mov_b32 v133, 0
    v_mov_b32 v134, 0
    v_mov_b32 v135, 0
    v_mov_b32 v136, 0
    v_mov_b32 v137, 0
    v_mov_b32 v138, 0
    v_mov_b32 v139, 0
    v_mov_b32 v140, 0
    v_mov_b32 v141, 0
    v_mov_b32 v142, 0
    v_mov_b32 v143, 0
    v_mov_b32 v144, 0
    v_mov_b32 v145, 0
    v_mov_b32 v146, 0
    v_mov_b32 v147, 0
    v_mov_b32 v148, 0
    v_mov_b32 v149, 0
    v_mov_b32 v150, 0
    v_mov_b32 v151, 0
    v_mov_b32 v152, 0
    v_mov_b32 v153, 0
    v_mov_b32 v154, 0
    v_mov_b32 v155, 0
    v_mov_b32 v156, 0
    v_mov_b32 v157, 0
    v_mov_b32 v158, 0
    v_mov_b32 v159, 0
    s_waitcnt vmcnt(8)
    v_lshlrev_b32 v26, 16, v26
    v_lshlrev_b32 v32, 16, v32
    v_lshlrev_b32 v34, 16, v34
    v_mul_f32 v26, 0x3fb8aa3b, v26
    v_exp_f32 v26, v26
    v_lshlrev_b32 v27, 16, v27
    v_lshlrev_b32 v33, 16, v33
    v_lshlrev_b32 v35, 16, v35
    v_mul_f32 v27, 0x3fb8aa3b, v27
    v_exp_f32 v27, v27
    s_nop 0
    v_cvt_pk_bf16_f32 v26, v26, v27
    v_and_b32 v27, 0xffff0000, v26
    v_lshlrev_b32 v26, 16, v26
    v_pk_mul_f32 v[28:29], v[26:27], v[34:35]
    v_pk_mul_f32 v[26:27], v[26:27], v[32:33]
    v_mul_f32 v26, 0x3fb8aa3b, v26
    v_mul_f32 v28, 0x3e22f983, v28
    v_exp_f32 v26, v26
    v_rndne_f32 v10, v28
    v_sub_f32 v28, v28, v10
    v_cos_f32 v10, v28
    v_sin_f32 v12, v28
    v_mul_f32 v27, 0x3fb8aa3b, v27
    v_mul_f32 v29, 0x3e22f983, v29
    v_exp_f32 v27, v27
    v_rndne_f32 v11, v29
    v_sub_f32 v29, v29, v11
    v_cos_f32 v11, v29
    v_sin_f32 v13, v29
    v_pk_mul_f32 v[10:11], v[10:11], v[26:27]
    v_pk_mul_f32 v[12:13], v[12:13], v[26:27]
    v_pk_mul_f32 v[26:27], v[10:11], v[12:13]
    v_pk_mul_f32 v[14:15], v[10:11], v[10:11]
    v_pk_fma_f32 v[14:15], v[12:13], v[12:13], v[14:15] neg_lo:[1,0,0] neg_hi:[1,0,0]
    v_pk_add_f32 v[16:17], v[26:27], v[26:27]
    v_pk_mul_f32 v[26:27], v[14:15], v[16:17]
    v_pk_mul_f32 v[18:19], v[14:15], v[14:15]
    v_pk_fma_f32 v[18:19], v[16:17], v[16:17], v[18:19] neg_lo:[1,0,0] neg_hi:[1,0,0]
    v_pk_add_f32 v[20:21], v[26:27], v[26:27]
    v_pk_mul_f32 v[26:27], v[18:19], v[20:21]
    v_pk_mul_f32 v[14:15], v[18:19], v[18:19]
    v_pk_fma_f32 v[14:15], v[20:21], v[20:21], v[14:15] neg_lo:[1,0,0] neg_hi:[1,0,0]
    v_pk_add_f32 v[16:17], v[26:27], v[26:27]
    v_pk_mul_f32 v[26:27], v[14:15], v[16:17]
    v_pk_mul_f32 v[18:19], v[14:15], v[14:15]
    v_pk_fma_f32 v[18:19], v[16:17], v[16:17], v[18:19] neg_lo:[1,0,0] neg_hi:[1,0,0]
    v_pk_add_f32 v[20:21], v[26:27], v[26:27]
    s_lshl_b32 s33, s30, 2
    v_add_u32 v8, s33, v7
    v_and_b32 v9, 1, v8
    v_cmp_ne_u32 vcc, 0, v9
    s_nop 1
    v_cndmask_b32 v44, 1.0, v18, vcc
    v_cndmask_b32 v46, 0, v20, vcc
    v_cndmask_b32 v45, 1.0, v19, vcc
    v_cndmask_b32 v47, 0, v21, vcc
    v_pk_mul_f32 v[52:53], v[18:19], v[20:21]
    v_pk_mul_f32 v[36:37], v[18:19], v[18:19]
    v_pk_fma_f32 v[36:37], v[20:21], v[20:21], v[36:37] neg_lo:[1,0,0] neg_hi:[1,0,0]
    v_pk_add_f32 v[38:39], v[52:53], v[52:53]
    v_and_b32 v9, 2, v8
    v_cmp_ne_u32 vcc, 0, v9
    s_nop 1
    v_cndmask_b32 v22, 1.0, v36, vcc
    v_cndmask_b32 v24, 0, v38, vcc
    v_cndmask_b32 v23, 1.0, v37, vcc
    v_cndmask_b32 v25, 0, v39, vcc
    v_pk_mul_f32 v[240:241], v[44:45], v[22:23]
    v_pk_mul_f32 v[242:243], v[44:45], v[24:25]
    v_pk_fma_f32 v[240:241], v[46:47], v[24:25], v[240:241] neg_lo:[1,0,0] neg_hi:[1,0,0]
    v_pk_fma_f32 v[242:243], v[46:47], v[22:23], v[242:243]
    v_pk_mul_f32 v[52:53], v[36:37], v[38:39]
    v_pk_mul_f32 v[40:41], v[36:37], v[36:37]
    v_pk_fma_f32 v[40:41], v[38:39], v[38:39], v[40:41] neg_lo:[1,0,0] neg_hi:[1,0,0]
    v_pk_add_f32 v[42:43], v[52:53], v[52:53]
    v_and_b32 v9, 4, v8
    v_cmp_ne_u32 vcc, 0, v9
    s_nop 1
    v_cndmask_b32 v22, 1.0, v40, vcc
    v_cndmask_b32 v24, 0, v42, vcc
    v_cndmask_b32 v23, 1.0, v41, vcc
    v_cndmask_b32 v25, 0, v43, vcc
    v_pk_mul_f32 v[44:45], v[240:241], v[22:23]
    v_pk_mul_f32 v[46:47], v[240:241], v[24:25]
    v_pk_fma_f32 v[44:45], v[242:243], v[24:25], v[44:45] neg_lo:[1,0,0] neg_hi:[1,0,0]
    v_pk_fma_f32 v[46:47], v[242:243], v[22:23], v[46:47]
    v_pk_mul_f32 v[52:53], v[40:41], v[42:43]
    v_pk_mul_f32 v[36:37], v[40:41], v[40:41]
    v_pk_fma_f32 v[36:37], v[42:43], v[42:43], v[36:37] neg_lo:[1,0,0] neg_hi:[1,0,0]
    v_pk_add_f32 v[38:39], v[52:53], v[52:53]
    v_and_b32 v9, 1, v7
    v_cmp_ne_u32 vcc, 0, v9
    s_nop 1
    v_cndmask_b32 v48, 1.0, v36, vcc
    v_cndmask_b32 v50, 0, v38, vcc
    v_cndmask_b32 v49, 1.0, v37, vcc
    v_cndmask_b32 v51, 0, v39, vcc
    v_pk_mul_f32 v[52:53], v[36:37], v[38:39]
    v_pk_mul_f32 v[40:41], v[36:37], v[36:37]
    v_pk_fma_f32 v[40:41], v[38:39], v[38:39], v[40:41] neg_lo:[1,0,0] neg_hi:[1,0,0]
    v_pk_add_f32 v[42:43], v[52:53], v[52:53]
    v_and_b32 v9, 2, v7
    v_cmp_ne_u32 vcc, 0, v9
    s_nop 1
    v_cndmask_b32 v22, 1.0, v40, vcc
    v_cndmask_b32 v24, 0, v42, vcc
    v_cndmask_b32 v23, 1.0, v41, vcc
    v_cndmask_b32 v25, 0, v43, vcc
    v_pk_mul_f32 v[240:241], v[48:49], v[22:23]
    v_pk_mul_f32 v[242:243], v[48:49], v[24:25]
    v_pk_fma_f32 v[240:241], v[50:51], v[24:25], v[240:241] neg_lo:[1,0,0] neg_hi:[1,0,0]
    v_pk_fma_f32 v[242:243], v[50:51], v[22:23], v[242:243]
    v_pk_mul_f32 v[52:53], v[40:41], v[42:43]
    v_pk_mul_f32 v[244:245], v[40:41], v[40:41]
    v_pk_fma_f32 v[244:245], v[42:43], v[42:43], v[244:245] neg_lo:[1,0,0] neg_hi:[1,0,0]
    v_pk_add_f32 v[246:247], v[52:53], v[52:53]
    v_pk_mul_f32 v[36:37], v[44:45], v[14:15]
    v_pk_mul_f32 v[38:39], v[44:45], v[16:17]
    v_pk_fma_f32 v[36:37], v[46:47], v[16:17], v[36:37] neg_lo:[1,0,0] neg_hi:[1,0,0]
    v_pk_fma_f32 v[38:39], v[46:47], v[14:15], v[38:39]
    v_mov_b32 v232, v44
    v_mov_b32 v233, v36
    v_mov_b32 v236, v46
    v_mov_b32 v237, v38
    v_mov_b32 v234, v45
    v_mov_b32 v235, v37
    v_mov_b32 v238, v47
    v_mov_b32 v239, v39
    v_max_f32 v26, |v32|, |v34|
    v_rcp_f32 v28, v26
    v_max_f32 v27, |v33|, |v35|
    v_rcp_f32 v29, v27
    s_nop 0
    v_pk_mul_f32 v[32:33], v[32:33], v[28:29]
    v_pk_mul_f32 v[34:35], v[34:35], v[28:29]
    v_pk_mul_f32 v[28:29], v[32:33], v[32:33]
    v_pk_fma_f32 v[28:29], v[34:35], v[34:35], v[28:29]
    v_pk_mul_f32 v[28:29], v[28:29], v[26:27]
    v_rcp_f32 v28, v28
    v_add_f32 v26, -1.0, v10
    v_rcp_f32 v29, v29
    v_add_f32 v27, -1.0, v11
    v_pk_add_f32 v[28:29], v[28:29], v[28:29]
    v_pk_mul_f32 v[22:23], v[26:27], v[32:33]
    v_pk_mul_f32 v[24:25], v[12:13], v[32:33]
    v_pk_fma_f32 v[22:23], v[12:13], v[34:35], v[22:23]
    v_pk_fma_f32 v[24:25], v[26:27], v[34:35], v[24:25] neg_lo:[1,0,0] neg_hi:[1,0,0]
    v_pk_mul_f32 v[22:23], v[22:23], v[28:29]
    v_pk_mul_f32 v[24:25], v[24:25], v[28:29]
    v_mov_b32 v26, v22
    v_mov_b32 v27, v24
    v_mov_b32 v28, v23
    v_mov_b32 v29, v25
    v_pk_mul_f32 v[200:201], v[10:11], v[26:27] op_sel_hi:[0,1]
    v_pk_mul_f32 v[202:203], v[10:11], v[28:29] op_sel:[1,0]
    v_pk_fma_f32 v[200:201], v[26:27], v[12:13], v[200:201] op_sel:[1,0,0] op_sel_hi:[0,0,1] neg_lo:[1,0,0]
    v_pk_fma_f32 v[202:203], v[12:13], v[28:29], v[202:203] op_sel:[1,1,0] op_sel_hi:[1,0,1] neg_lo:[0,1,0]
    v_pk_mul_f32 v[204:205], v[10:11], v[200:201] op_sel_hi:[0,1]
    v_pk_mul_f32 v[206:207], v[10:11], v[202:203] op_sel:[1,0]
    v_pk_fma_f32 v[204:205], v[200:201], v[12:13], v[204:205] op_sel:[1,0,0] op_sel_hi:[0,0,1] neg_lo:[1,0,0]
    v_pk_fma_f32 v[206:207], v[12:13], v[202:203], v[206:207] op_sel:[1,1,0] op_sel_hi:[1,0,1] neg_lo:[0,1,0]
    v_pk_mul_f32 v[208:209], v[10:11], v[204:205] op_sel_hi:[0,1]
    v_pk_mul_f32 v[210:211], v[10:11], v[206:207] op_sel:[1,0]
    v_pk_fma_f32 v[208:209], v[204:205], v[12:13], v[208:209] op_sel:[1,0,0] op_sel_hi:[0,0,1] neg_lo:[1,0,0]
    v_pk_fma_f32 v[210:211], v[12:13], v[206:207], v[210:211] op_sel:[1,1,0] op_sel_hi:[1,0,1] neg_lo:[0,1,0]
    v_pk_mul_f32 v[212:213], v[10:11], v[208:209] op_sel_hi:[0,1]
    v_pk_mul_f32 v[214:215], v[10:11], v[210:211] op_sel:[1,0]
    v_pk_fma_f32 v[212:213], v[208:209], v[12:13], v[212:213] op_sel:[1,0,0] op_sel_hi:[0,0,1] neg_lo:[1,0,0]
    v_pk_fma_f32 v[214:215], v[12:13], v[210:211], v[214:215] op_sel:[1,1,0] op_sel_hi:[1,0,1] neg_lo:[0,1,0]
    v_pk_mul_f32 v[216:217], v[10:11], v[212:213] op_sel_hi:[0,1]
    v_pk_mul_f32 v[218:219], v[10:11], v[214:215] op_sel:[1,0]
    v_pk_fma_f32 v[216:217], v[212:213], v[12:13], v[216:217] op_sel:[1,0,0] op_sel_hi:[0,0,1] neg_lo:[1,0,0]
    v_pk_fma_f32 v[218:219], v[12:13], v[214:215], v[218:219] op_sel:[1,1,0] op_sel_hi:[1,0,1] neg_lo:[0,1,0]
    v_pk_mul_f32 v[220:221], v[10:11], v[216:217] op_sel_hi:[0,1]
    v_pk_mul_f32 v[222:223], v[10:11], v[218:219] op_sel:[1,0]
    v_pk_fma_f32 v[220:221], v[216:217], v[12:13], v[220:221] op_sel:[1,0,0] op_sel_hi:[0,0,1] neg_lo:[1,0,0]
    v_pk_fma_f32 v[222:223], v[12:13], v[218:219], v[222:223] op_sel:[1,1,0] op_sel_hi:[1,0,1] neg_lo:[0,1,0]
    v_pk_mul_f32 v[224:225], v[10:11], v[220:221] op_sel_hi:[0,1]
    v_pk_mul_f32 v[226:227], v[10:11], v[222:223] op_sel:[1,0]
    v_pk_fma_f32 v[224:225], v[220:221], v[12:13], v[224:225] op_sel:[1,0,0] op_sel_hi:[0,0,1] neg_lo:[1,0,0]
    v_pk_fma_f32 v[226:227], v[12:13], v[222:223], v[226:227] op_sel:[1,1,0] op_sel_hi:[1,0,1] neg_lo:[0,1,0]
    v_pk_mul_f32 v[228:229], v[10:11], v[224:225] op_sel_hi:[0,1]
    v_pk_mul_f32 v[230:231], v[10:11], v[226:227] op_sel:[1,0]
    v_pk_fma_f32 v[228:229], v[224:225], v[12:13], v[228:229] op_sel:[1,0,0] op_sel_hi:[0,0,1] neg_lo:[1,0,0]
    v_pk_fma_f32 v[230:231], v[12:13], v[226:227], v[230:231] op_sel:[1,1,0] op_sel_hi:[1,0,1] neg_lo:[0,1,0]
    v_mov_b32 v92, 0x3f803f80
    v_mov_b32 v80, 0
    v_mov_b32 v81, 0
    v_mov_b32 v82, 0
    v_mov_b32 v83, 0
    s_waitcnt vmcnt(0)
    v_and_b32 v64, 0xffff, v184
    v_and_b32 v72, 0xffff0000, v184
    v_and_b32 v65, 0xffff, v185
    v_and_b32 v73, 0xffff0000, v185
    v_and_b32 v66, 0xffff, v186
    v_and_b32 v74, 0xffff0000, v186
    v_and_b32 v67, 0xffff, v187
    v_and_b32 v75, 0xffff0000, v187
    v_and_b32 v68, 0xffff, v188
    v_and_b32 v76, 0xffff0000, v188
    v_and_b32 v69, 0xffff, v189
    v_and_b32 v77, 0xffff0000, v189
    v_and_b32 v70, 0xffff, v190
    v_and_b32 v78, 0xffff0000, v190
    v_and_b32 v71, 0xffff, v191
    v_and_b32 v79, 0xffff0000, v191
    v_dot2_f32_bf16 v84, v160, v64, 0
    v_dot2_f32_bf16 v85, v160, v72, 0
    v_dot2_f32_bf16 v86, v168, v64, 0
    v_dot2_f32_bf16 v87, v168, v72, 0
    v_dot2c_f32_bf16 v80, v160, v176
    v_dot2c_f32_bf16 v81, v168, v176
    v_cvt_pk_bf16_f32 v84, v84, v85
    v_cvt_pk_bf16_f32 v86, v86, v87
    v_dot2_f32_bf16 v88, v161, v65, 0
    v_dot2_f32_bf16 v89, v161, v73, 0
    v_dot2_f32_bf16 v90, v169, v65, 0
    v_dot2_f32_bf16 v91, v169, v73, 0
    v_dot2c_f32_bf16 v80, v161, v177
    v_dot2c_f32_bf16 v81, v169, v177
    v_dot2c_f32_bf16 v82, v84, v92
    v_dot2c_f32_bf16 v83, v86, v92
    v_cvt_pk_bf16_f32 v88, v88, v89
    v_cvt_pk_bf16_f32 v90, v90, v91
    v_dot2_f32_bf16 v84, v162, v66, 0
    v_dot2_f32_bf16 v85, v162, v74, 0
    v_dot2_f32_bf16 v86, v170, v66, 0
    v_dot2_f32_bf16 v87, v170, v74, 0
    v_dot2c_f32_bf16 v80, v162, v178
    v_dot2c_f32_bf16 v81, v170, v178
    v_dot2c_f32_bf16 v82, v88, v92
    v_dot2c_f32_bf16 v83, v90, v92
    v_cvt_pk_bf16_f32 v84, v84, v85
    v_cvt_pk_bf16_f32 v86, v86, v87
    v_dot2_f32_bf16 v88, v163, v67, 0
    v_dot2_f32_bf16 v89, v163, v75, 0
    v_dot2_f32_bf16 v90, v171, v67, 0
    v_dot2_f32_bf16 v91, v171, v75, 0
    v_dot2c_f32_bf16 v80, v163, v179
    v_dot2c_f32_bf16 v81, v171, v179
    v_dot2c_f32_bf16 v82, v84, v92
    v_dot2c_f32_bf16 v83, v86, v92
    v_cvt_pk_bf16_f32 v88, v88, v89
    v_cvt_pk_bf16_f32 v90, v90, v91
    v_dot2_f32_bf16 v84, v164, v68, 0
    v_dot2_f32_bf16 v85, v164, v76, 0
    v_dot2_f32_bf16 v86, v172, v68, 0
    v_dot2_f32_bf16 v87, v172, v76, 0
    v_dot2c_f32_bf16 v80, v164, v180
    v_dot2c_f32_bf16 v81, v172, v180
    v_dot2c_f32_bf16 v82, v88, v92
    v_dot2c_f32_bf16 v83, v90, v92
    v_cvt_pk_bf16_f32 v84, v84, v85
    v_cvt_pk_bf16_f32 v86, v86, v87
    v_dot2_f32_bf16 v88, v165, v69, 0
    v_dot2_f32_bf16 v89, v165, v77, 0
    v_dot2_f32_bf16 v90, v173, v69, 0
    v_dot2_f32_bf16 v91, v173, v77, 0
    v_dot2c_f32_bf16 v80, v165, v181
    v_dot2c_f32_bf16 v81, v173, v181
    v_dot2c_f32_bf16 v82, v84, v92
    v_dot2c_f32_bf16 v83, v86, v92
    v_cvt_pk_bf16_f32 v88, v88, v89
    v_cvt_pk_bf16_f32 v90, v90, v91
    v_dot2_f32_bf16 v84, v166, v70, 0
    v_dot2_f32_bf16 v85, v166, v78, 0
    v_dot2_f32_bf16 v86, v174, v70, 0
    v_dot2_f32_bf16 v87, v174, v78, 0
    v_dot2c_f32_bf16 v80, v166, v182
    v_dot2c_f32_bf16 v81, v174, v182
    v_dot2c_f32_bf16 v82, v88, v92
    v_dot2c_f32_bf16 v83, v90, v92
    v_cvt_pk_bf16_f32 v84, v84, v85
    v_cvt_pk_bf16_f32 v86, v86, v87
    v_dot2_f32_bf16 v88, v167, v71, 0
    v_dot2_f32_bf16 v89, v167, v79, 0
    v_dot2_f32_bf16 v90, v175, v71, 0
    v_dot2_f32_bf16 v91, v175, v79, 0
    v_dot2c_f32_bf16 v80, v167, v183
    v_dot2c_f32_bf16 v81, v175, v183
    v_dot2c_f32_bf16 v82, v84, v92
    v_dot2c_f32_bf16 v83, v86, v92
    v_cvt_pk_bf16_f32 v88, v88, v89
    v_cvt_pk_bf16_f32 v90, v90, v91
    v_dot2c_f32_bf16 v82, v88, v92
    v_dot2c_f32_bf16 v83, v90, v92
    v_add_f32_dpp v80, v80, v80 row_shr:1 row_mask:0xf bank_mask:0xf
    v_add_f32_dpp v81, v81, v81 row_shr:1 row_mask:0xf bank_mask:0xf
    v_add_f32_dpp v82, v82, v82 row_shr:1 row_mask:0xf bank_mask:0xf
    v_add_f32_dpp v83, v83, v83 row_shr:1 row_mask:0xf bank_mask:0xf
    v_add_f32_dpp v80, v80, v80 row_shr:2 row_mask:0xf bank_mask:0xf
    v_add_f32_dpp v81, v81, v81 row_shr:2 row_mask:0xf bank_mask:0xf
    v_add_f32_dpp v82, v82, v82 row_shr:2 row_mask:0xf bank_mask:0xf
    v_add_f32_dpp v83, v83, v83 row_shr:2 row_mask:0xf bank_mask:0xf
    v_add_f32_dpp v80, v80, v80 row_shr:4 row_mask:0xf bank_mask:0xf
    v_add_f32_dpp v81, v81, v81 row_shr:4 row_mask:0xf bank_mask:0xf
    v_add_f32_dpp v82, v82, v82 row_shr:4 row_mask:0xf bank_mask:0xf
    v_add_f32_dpp v83, v83, v83 row_shr:4 row_mask:0xf bank_mask:0xf
    v_add_f32_dpp v80, v80, v80 row_shr:8 row_mask:0xf bank_mask:0xf
    v_add_f32_dpp v81, v81, v81 row_shr:8 row_mask:0xf bank_mask:0xf
    v_add_f32_dpp v82, v82, v82 row_shr:8 row_mask:0xf bank_mask:0xf
    v_add_f32_dpp v83, v83, v83 row_shr:8 row_mask:0xf bank_mask:0xf
    v_add_f32_dpp v80, v80, v80 row_bcast:15 row_mask:0xa bank_mask:0xf
    v_add_f32_dpp v81, v81, v81 row_bcast:15 row_mask:0xa bank_mask:0xf
    v_add_f32_dpp v82, v82, v82 row_bcast:15 row_mask:0xa bank_mask:0xf
    v_add_f32_dpp v83, v83, v83 row_bcast:15 row_mask:0xa bank_mask:0xf
    v_add_f32_dpp v80, v80, v80 row_bcast:31 row_mask:0xc bank_mask:0xf
    v_add_f32_dpp v81, v81, v81 row_bcast:31 row_mask:0xc bank_mask:0xf
    v_add_f32_dpp v82, v82, v82 row_bcast:31 row_mask:0xc bank_mask:0xf
    v_add_f32_dpp v83, v83, v83 row_bcast:31 row_mask:0xc bank_mask:0xf
    v_readlane_b32 s33, v81, 63
    v_readlane_b32 s34, v83, 63
    v_sub_u32 v86, 63, v1
    v_add_u32 v87, s46, v86
    v_sub_u32 v87, 2047, v87
    v_add_u32 v86, s47, v86
    v_lshlrev_b32 v86, 3, v86
    v_add_u32 v86, 147520, v86
    v_writelane_b32 v80, s33, 62
    v_writelane_b32 v82, s34, 62
    v_cvt_pk_bf16_f32 v80, v80, v82
    v_and_b32 v82, 0xffff0000, v80
    v_lshlrev_b32 v80, 16, v80
    v_ashrrev_i32 v84, 31, v80
    v_or_b32 v84, 0x80000000, v84
    v_xor_b32 v84, v84, v80
    v_and_b32 v84, 0xffff0000, v84
    v_or_b32 v84, v84, v87
    v_mul_f32 v87, 0xbfb8aa3b, v82
    v_exp_f32 v87, v87
    s_nop 0
    v_add_f32 v87, 1.0, v87
    v_rcp_f32 v87, v87
    s_nop 0
    v_cvt_pk_bf16_f32 v88, v87, v87
    v_lshlrev_b32 v88, 16, v88
    v_sub_f32 v89, 1.0, v88
    v_cvt_pk_bf16_f32 v85, v88, v89
    s_mov_b32 exec_lo, 0
    s_mov_b32 exec_hi, 0xc0000000
    ds_write_b64 v86, v[84:85]
    s_mov_b64 exec, -1
    s_waitcnt lgkmcnt(0)
    s_mul_i32 s44, s44, 1664525
    s_add_u32 s44, s44, 1013904223
    s_barrier
    ds_read_b128 v[32:35], v2 offset:0
    ds_read_b128 v[48:51], v4 offset:0
    ds_read_b128 v[52:55], v4 offset:2048
    ds_read_b128 v[56:59], v4 offset:4096
    ds_read_b128 v[60:63], v4 offset:6144
    ds_read_b128 v[36:39], v2 offset:2048
    ds_read_b128 v[40:43], v2 offset:4096
    ds_read_b128 v[44:47], v2 offset:6144
    s_mov_b32 s35, 0
Lc_loop:
    s_waitcnt lgkmcnt(0)
    v_mfma_f32_16x16x32_bf16 v[96:99], v[32:35], v[48:51], v[96:99]
    ds_read_b128 v[64:67], v3 offset:0
    v_mfma_f32_16x16x32_bf16 v[128:131], v[32:35], v[52:55], v[128:131]
    ds_read_b128 v[80:83], v5 offset:0
    v_mfma_f32_16x16x32_bf16 v[112:115], v[32:35], v[56:59], v[112:115]
    ds_read_b128 v[84:87], v5 offset:2048
    v_mfma_f32_16x16x32_bf16 v[144:147], v[32:35], v[60:63], v[144:147]
    ds_read_b128 v[88:91], v5 offset:4096
    v_mfma_f32_16x16x32_bf16 v[148:151], v[36:39], v[60:63], v[148:151]
    ds_read_b128 v[92:95], v5 offset:6144
    v_mfma_f32_16x16x32_bf16 v[116:119], v[36:39], v[56:59], v[116:119]
    ds_read_b128 v[68:71], v3 offset:2048
    v_mfma_f32_16x16x32_bf16 v[132:135], v[36:39], v[52:55], v[132:135]
    ds_read_b128 v[72:75], v3 offset:4096
    v_mfma_f32_16x16x32_bf16 v[100:103], v[36:39], v[48:51], v[100:103]
    ds_read_b128 v[76:79], v3 offset:6144
    v_mfma_f32_16x16x32_bf16 v[104:107], v[40:43], v[48:51], v[104:107]
    v_mfma_f32_16x16x32_bf16 v[136:139], v[40:43], v[52:55], v[136:139]
    v_mfma_f32_16x16x32_bf16 v[120:123], v[40:43], v[56:59], v[120:123]
    v_mfma_f32_16x16x32_bf16 v[152:155], v[40:43], v[60:63], v[152:155]
    v_mfma_f32_16x16x32_bf16 v[156:159], v[44:47], v[60:63], v[156:159]
    v_mfma_f32_16x16x32_bf16 v[124:127], v[44:47], v[56:59], v[124:127]
    v_mfma_f32_16x16x32_bf16 v[140:143], v[44:47], v[52:55], v[140:143]
    v_mfma_f32_16x16x32_bf16 v[108:111], v[44:47], v[48:51], v[108:111]
    s_waitcnt lgkmcnt(0)
    v_mfma_f32_16x16x32_bf16 v[96:99], v[64:67], v[80:83], v[96:99]
    s_barrier
    v_mfma_f32_16x16x32_bf16 v[128:131], v[64:67], v[84:87], v[128:131]
    ds_read_b128 v[32:35], v2 offset:32768
    v_mfma_f32_16x16x32_bf16 v[112:115], v[64:67], v[88:91], v[112:115]
    ds_read_b128 v[48:51], v4 offset:32768
    v_mfma_f32_16x16x32_bf16 v[144:147], v[64:67], v[92:95], v[144:147]
    ds_read_b128 v[52:55], v4 offset:34816
    v_mfma_f32_16x16x32_bf16 v[148:151], v[68:71], v[92:95], v[148:151]
    ds_read_b128 v[56:59], v4 offset:36864
    v_mfma_f32_16x16x32_bf16 v[116:119], v[68:71], v[88:91], v[116:119]
    ds_read_b128 v[60:63], v4 offset:38912
    v_mfma_f32_16x16x32_bf16 v[132:135], v[68:71], v[84:87], v[132:135]
    ds_read_b128 v[36:39], v2 offset:34816
    v_mfma_f32_16x16x32_bf16 v[100:103], v[68:71], v[80:83], v[100:103]
    ds_read_b128 v[40:43], v2 offset:36864
    v_mfma_f32_16x16x32_bf16 v[104:107], v[72:75], v[80:83], v[104:107]
    ds_read_b128 v[44:47], v2 offset:38912
    v_mfma_f32_16x16x32_bf16 v[136:139], v[72:75], v[84:87], v[136:139]
    v_mfma_f32_16x16x32_bf16 v[120:123], v[72:75], v[88:91], v[120:123]
    v_mfma_f32_16x16x32_bf16 v[152:155], v[72:75], v[92:95], v[152:155]
    v_mfma_f32_16x16x32_bf16 v[156:159], v[76:79], v[92:95], v[156:159]
    v_mfma_f32_16x16x32_bf16 v[124:127], v[76:79], v[88:91], v[124:127]
    v_mfma_f32_16x16x32_bf16 v[140:143], v[76:79], v[84:87], v[140:143]
    v_mfma_f32_16x16x32_bf16 v[108:111], v[76:79], v[80:83], v[108:111]
    s_waitcnt lgkmcnt(0)
    v_mfma_f32_16x16x32_bf16 v[96:99], v[32:35], v[48:51], v[96:99]
    ds_read_b128 v[64:67], v3 offset:32768
    v_mfma_f32_16x16x32_bf16 v[128:131], v[32:35], v[52:55], v[128:131]
    ds_read_b128 v[80:83], v5 offset:32768
    v_mfma_f32_16x16x32_bf16 v[112:115], v[32:35], v[56:59], v[112:115]
    ds_read_b128 v[84:87], v5 offset:34816
    v_mfma_f32_16x16x32_bf16 v[144:147], v[32:35], v[60:63], v[144:147]
    ds_read_b128 v[88:91], v5 offset:36864
    v_mfma_f32_16x16x32_bf16 v[148:151], v[36:39], v[60:63], v[148:151]
    ds_read_b128 v[92:95], v5 offset:38912
    v_mfma_f32_16x16x32_bf16 v[116:119], v[36:39], v[56:59], v[116:119]
    ds_read_b128 v[68:71], v3 offset:34816
    v_mfma_f32_16x16x32_bf16 v[132:135], v[36:39], v[52:55], v[132:135]
    ds_read_b128 v[72:75], v3 offset:36864
    v_mfma_f32_16x16x32_bf16 v[100:103], v[36:39], v[48:51], v[100:103]
    ds_read_b128 v[76:79], v3 offset:38912
    v_mfma_f32_16x16x32_bf16 v[104:107], v[40:43], v[48:51], v[104:107]
    v_mfma_f32_16x16x32_bf16 v[136:139], v[40:43], v[52:55], v[136:139]
    v_mfma_f32_16x16x32_bf16 v[120:123], v[40:43], v[56:59], v[120:123]
    v_mfma_f32_16x16x32_bf16 v[152:155], v[40:43], v[60:63], v[152:155]
    v_mfma_f32_16x16x32_bf16 v[156:159], v[44:47], v[60:63], v[156:159]
    v_mfma_f32_16x16x32_bf16 v[124:127], v[44:47], v[56:59], v[124:127]
    v_mfma_f32_16x16x32_bf16 v[140:143], v[44:47], v[52:55], v[140:143]
    v_mfma_f32_16x16x32_bf16 v[108:111], v[44:47], v[48:51], v[108:111]
    s_waitcnt lgkmcnt(0)
    v_mfma_f32_16x16x32_bf16 v[96:99], v[64:67], v[80:83], v[96:99]
    v_xor_b32 v2, 0x10000, v2
    v_xor_b32 v3, 0x10000, v3
    v_xor_b32 v4, 0x10000, v4
    v_xor_b32 v5, 0x10000, v5
    s_cmp_eq_u32 s35, 7
    s_cbranch_scc1 Lc_nobar
    s_barrier
Lc_nobar:
    v_mfma_f32_16x16x32_bf16 v[128:131], v[64:67], v[84:87], v[128:131]
    ds_read_b128 v[32:35], v2 offset:0
    v_mfma_f32_16x16x32_bf16 v[112:115], v[64:67], v[88:91], v[112:115]
    ds_read_b128 v[48:51], v4 offset:0
    v_mfma_f32_16x16x32_bf16 v[144:147], v[64:67], v[92:95], v[144:147]
    ds_read_b128 v[52:55], v4 offset:2048
    v_mfma_f32_16x16x32_bf16 v[148:151], v[68:71], v[92:95], v[148:151]
    ds_read_b128 v[56:59], v4 offset:4096
    v_mfma_f32_16x16x32_bf16 v[116:119], v[68:71], v[88:91], v[116:119]
    ds_read_b128 v[60:63], v4 offset:6144
    v_mfma_f32_16x16x32_bf16 v[132:135], v[68:71], v[84:87], v[132:135]
    ds_read_b128 v[36:39], v2 offset:2048
    v_mfma_f32_16x16x32_bf16 v[100:103], v[68:71], v[80:83], v[100:103]
    ds_read_b128 v[40:43], v2 offset:4096
    v_mfma_f32_16x16x32_bf16 v[104:107], v[72:75], v[80:83], v[104:107]
    ds_read_b128 v[44:47], v2 offset:6144
    v_mfma_f32_16x16x32_bf16 v[136:139], v[72:75], v[84:87], v[136:139]
    v_mfma_f32_16x16x32_bf16 v[120:123], v[72:75], v[88:91], v[120:123]
    v_mfma_f32_16x16x32_bf16 v[152:155], v[72:75], v[92:95], v[152:155]
    v_mfma_f32_16x16x32_bf16 v[156:159], v[76:79], v[92:95], v[156:159]
    v_mfma_f32_16x16x32_bf16 v[124:127], v[76:79], v[88:91], v[124:127]
    v_mfma_f32_16x16x32_bf16 v[140:143], v[76:79], v[84:87], v[140:143]
    v_mfma_f32_16x16x32_bf16 v[108:111], v[76:79], v[80:83], v[108:111]
    s_add_u32 s35, s35, 1
    s_cmp_lt_u32 s35, 8
    s_cbranch_scc1 Lc_loop
    s_sub_u32 s33, s26, 1
    v_sub_u32 v8, s33, v7
    v_lshlrev_b32 v8, 10, v8
    v_lshl_add_u32 v8, v6, 4, v8
    s_lshl_b32 s33, s31, 9
    v_add_u32 v192, s33, v8
    v_add_u32 v193, -4096, v192
    v_add_u32 v194, -8192, v192
    v_add_u32 v195, -12288, v192
    v_mov_b32 v9, 147456
    buffer_load_dwordx4 v[160:163], v192, s[36:39], 0 offen offset:0 sc1
    buffer_load_dwordx4 v[164:167], v192, s[36:39], 0 offen offset:256 sc1
    buffer_load_dwordx4 v[168:171], v193, s[36:39], 0 offen offset:0 sc1
    buffer_load_dwordx4 v[172:175], v193, s[36:39], 0 offen offset:256 sc1
    buffer_load_dwordx4 v[176:179], v194, s[36:39], 0 offen offset:0 sc1
    buffer_load_dwordx4 v[180:183], v194, s[36:39], 0 offen offset:256 sc1
    buffer_load_dwordx4 v[184:187], v195, s[36:39], 0 offen offset:0 sc1
    buffer_load_dwordx4 v[188:191], v195, s[36:39], 0 offen offset:256 sc1
    s_waitcnt lgkmcnt(0)
    v_pk_fma_f32 v[98:99], v[10:11], v[96:97], v[98:99] op_sel_hi:[0,1,1]
    v_pk_fma_f32 v[130:131], v[10:11], v[128:129], v[130:131] op_sel:[1,0,0]
    v_pk_fma_f32 v[114:115], v[10:11], v[112:113], v[114:115] op_sel_hi:[0,1,1]
    v_pk_fma_f32 v[146:147], v[10:11], v[144:145], v[146:147] op_sel:[1,0,0]
    v_pk_fma_f32 v[98:99], v[12:13], v[112:113], v[98:99] op_sel_hi:[0,1,1] neg_lo:[1,0,0] neg_hi:[1,0,0]
    v_pk_fma_f32 v[130:131], v[12:13], v[144:145], v[130:131] op_sel:[1,0,0] neg_lo:[1,0,0] neg_hi:[1,0,0]
    v_pk_fma_f32 v[114:115], v[12:13], v[96:97], v[114:115] op_sel_hi:[0,1,1]
    v_pk_fma_f32 v[146:147], v[12:13], v[128:129], v[146:147] op_sel:[1,0,0]
    v_pk_fma_f32 v[100:101], v[10:11], v[98:99], v[100:101] op_sel_hi:[0,1,1]
    v_pk_fma_f32 v[132:133], v[10:11], v[130:131], v[132:133] op_sel:[1,0,0]
    v_pk_fma_f32 v[116:117], v[10:11], v[114:115], v[116:117] op_sel_hi:[0,1,1]
    v_pk_fma_f32 v[148:149], v[10:11], v[146:147], v[148:149] op_sel:[1,0,0]
    v_pk_fma_f32 v[100:101], v[12:13], v[114:115], v[100:101] op_sel_hi:[0,1,1] neg_lo:[1,0,0] neg_hi:[1,0,0]
    v_pk_fma_f32 v[132:133], v[12:13], v[146:147], v[132:133] op_sel:[1,0,0] neg_lo:[1,0,0] neg_hi:[1,0,0]
    v_pk_fma_f32 v[116:117], v[12:13], v[98:99], v[116:117] op_sel_hi:[0,1,1]
    v_pk_fma_f32 v[148:149], v[12:13], v[130:131], v[148:149] op_sel:[1,0,0]
    v_pk_fma_f32 v[102:103], v[10:11], v[100:101], v[102:103] op_sel_hi:[0,1,1]
    v_pk_fma_f32 v[134:135], v[10:11], v[132:133], v[134:135] op_sel:[1,0,0]
    v_pk_fma_f32 v[118:119], v[10:11], v[116:117], v[118:119] op_sel_hi:[0,1,1]
    v_pk_fma_f32 v[150:151], v[10:11], v[148:149], v[150:151] op_sel:[1,0,0]
    v_pk_fma_f32 v[102:103], v[12:13], v[116:117], v[102:103] op_sel_hi:[0,1,1] neg_lo:[1,0,0] neg_hi:[1,0,0]
    v_pk_fma_f32 v[134:135], v[12:13], v[148:149], v[134:135] op_sel:[1,0,0] neg_lo:[1,0,0] neg_hi:[1,0,0]
    v_pk_fma_f32 v[118:119], v[12:13], v[100:101], v[118:119] op_sel_hi:[0,1,1]
    v_pk_fma_f32 v[150:151], v[12:13], v[132:133], v[150:151] op_sel:[1,0,0]
    v_pk_fma_f32 v[104:105], v[10:11], v[102:103], v[104:105] op_sel_hi:[0,1,1]
    v_pk_fma_f32 v[136:137], v[10:11], v[134:135], v[136:137] op_sel:[1,0,0]
    v_pk_fma_f32 v[120:121], v[10:11], v[118:119], v[120:121] op_sel_hi:[0,1,1]
    v_pk_fma_f32 v[152:153], v[10:11], v[150:151], v[152:153] op_sel:[1,0,0]
    v_pk_fma_f32 v[104:105], v[12:13], v[118:119], v[104:105] op_sel_hi:[0,1,1] neg_lo:[1,0,0] neg_hi:[1,0,0]
    v_pk_fma_f32 v[136:137], v[12:13], v[150:151], v[136:137] op_sel:[1,0,0] neg_lo:[1,0,0] neg_hi:[1,0,0]
    v_pk_fma_f32 v[120:121], v[12:13], v[102:103], v[120:121] op_sel_hi:[0,1,1]
    v_pk_fma_f32 v[152:153], v[12:13], v[134:135], v[152:153] op_sel:[1,0,0]
    v_pk_fma_f32 v[106:107], v[10:11], v[104:105], v[106:107] op_sel_hi:[0,1,1]
    v_pk_fma_f32 v[138:139], v[10:11], v[136:137], v[138:139] op_sel:[1,0,0]
    v_pk_fma_f32 v[122:123], v[10:11], v[120:121], v[122:123] op_sel_hi:[0,1,1]
    v_pk_fma_f32 v[154:155], v[10:11], v[152:153], v[154:155] op_sel:[1,0,0]
    v_pk_fma_f32 v[106:107], v[12:13], v[120:121], v[106:107] op_sel_hi:[0,1,1] neg_lo:[1,0,0] neg_hi:[1,0,0]
    v_pk_fma_f32 v[138:139], v[12:13], v[152:153], v[138:139] op_sel:[1,0,0] neg_lo:[1,0,0] neg_hi:[1,0,0]
    v_pk_fma_f32 v[122:123], v[12:13], v[104:105], v[122:123] op_sel_hi:[0,1,1]
    v_pk_fma_f32 v[154:155], v[12:13], v[136:137], v[154:155] op_sel:[1,0,0]
    v_pk_fma_f32 v[108:109], v[10:11], v[106:107], v[108:109] op_sel_hi:[0,1,1]
    v_pk_fma_f32 v[140:141], v[10:11], v[138:139], v[140:141] op_sel:[1,0,0]
    v_pk_fma_f32 v[124:125], v[10:11], v[122:123], v[124:125] op_sel_hi:[0,1,1]
    v_pk_fma_f32 v[156:157], v[10:11], v[154:155], v[156:157] op_sel:[1,0,0]
    v_pk_fma_f32 v[108:109], v[12:13], v[122:123], v[108:109] op_sel_hi:[0,1,1] neg_lo:[1,0,0] neg_hi:[1,0,0]
    v_pk_fma_f32 v[140:141], v[12:13], v[154:155], v[140:141] op_sel:[1,0,0] neg_lo:[1,0,0] neg_hi:[1,0,0]
    v_pk_fma_f32 v[124:125], v[12:13], v[106:107], v[124:125] op_sel_hi:[0,1,1]
    v_pk_fma_f32 v[156:157], v[12:13], v[138:139], v[156:157] op_sel:[1,0,0]
    v_pk_fma_f32 v[110:111], v[10:11], v[108:109], v[110:111] op_sel_hi:[0,1,1]
    v_pk_fma_f32 v[142:143], v[10:11], v[140:141], v[142:143] op_sel:[1,0,0]
    v_pk_fma_f32 v[126:127], v[10:11], v[124:125], v[126:127] op_sel_hi:[0,1,1]
    v_pk_fma_f32 v[158:159], v[10:11], v[156:157], v[158:159] op_sel:[1,0,0]
    v_pk_fma_f32 v[110:111], v[12:13], v[124:125], v[110:111] op_sel_hi:[0,1,1] neg_lo:[1,0,0] neg_hi:[1,0,0]
    v_pk_fma_f32 v[142:143], v[12:13], v[156:157], v[142:143] op_sel:[1,0,0] neg_lo:[1,0,0] neg_hi:[1,0,0]
    v_pk_fma_f32 v[126:127], v[12:13], v[108:109], v[126:127] op_sel_hi:[0,1,1]
    v_pk_fma_f32 v[158:159], v[12:13], v[140:141], v[158:159] op_sel:[1,0,0]
    v_fma_f32 v26, v14, v110, v111
    v_fma_f32 v27, v14, v126, v127
    v_fma_f32 v26, -v16, v126, v26
    v_fma_f32 v27, v16, v110, v27
    v_fma_f32 v28, v15, v142, v143
    v_fma_f32 v29, v15, v158, v159
    v_fma_f32 v28, -v17, v158, v28
    v_fma_f32 v29, v17, v142, v29
    s_lshl_b32 s33, s31, 8
    s_add_u32 s33, s33, 148480
    v_lshl_add_u32 v30, v6, 3, s33
    s_lshl_b32 s33, s30, 11
    v_lshl_add_u32 v31, v7, 9, s33
    v_add_u32 v31, v31, v30
    ds_write_b64 v31, v[26:27]
    ds_write_b64 v31, v[28:29] offset:128
    s_lshl_b32 s33, s29, 2
    v_add_u32 v31, s33, v9
    s_xor_b32 s33, s33, 8
    v_add_u32 v9, s33, v9
    v_mov_b32 v8, 1
    ds_write_b32 v31, v8
    s_mov_b32 s45, 32768
Lc_expoll:
    ds_read_b32 v8, v9
    ds_read_b64 v[32:33], v30 offset:0
    ds_read_b64 v[34:35], v30 offset:128
    ds_read_b64 v[36:37], v30 offset:512
    ds_read_b64 v[38:39], v30 offset:640
    ds_read_b64 v[40:41], v30 offset:1024
    ds_read_b64 v[42:43], v30 offset:1152
    ds_read_b64 v[44:45], v30 offset:1536
    ds_read_b64 v[46:47], v30 offset:1664
    ds_read_b64 v[48:49], v30 offset:2048
    ds_read_b64 v[50:51], v30 offset:2176
    ds_read_b64 v[52:53], v30 offset:2560
    ds_read_b64 v[54:55], v30 offset:2688
    ds_read_b64 v[56:57], v30 offset:3072
    ds_read_b64 v[58:59], v30 offset:3200
    ds_read_b64 v[60:61], v30 offset:3584
    ds_read_b64 v[62:63], v30 offset:3712
    s_waitcnt lgkmcnt(0)
    v_readfirstlane_b32 s33, v8
    s_sub_u32 s45, s45, 1
    s_cbranch_scc1 Lc_exok
    s_cmp_eq_u32 s33, 0
    s_cbranch_scc1 Lc_expoll
Lc_exok:
    v_pk_fma_f32 v[36:37], v[18:19], v[32:33], v[36:37] op_sel_hi:[0,1,1]
    v_pk_fma_f32 v[36:37], v[32:33], v[20:21], v[36:37] op_sel:[1,0,0] op_sel_hi:[0,0,1] neg_lo:[1,0,0]
    v_pk_fma_f32 v[38:39], v[18:19], v[34:35], v[38:39] op_sel:[1,0,0]
    v_pk_fma_f32 v[38:39], v[20:21], v[34:35], v[38:39] op_sel:[1,1,0] op_sel_hi:[1,0,1] neg_lo:[0,1,0]
    v_pk_fma_f32 v[40:41], v[18:19], v[36:37], v[40:41] op_sel_hi:[0,1,1]
    v_pk_fma_f32 v[40:41], v[36:37], v[20:21], v[40:41] op_sel:[1,0,0] op_sel_hi:[0,0,1] neg_lo:[1,0,0]
    v_pk_fma_f32 v[42:43], v[18:19], v[38:39], v[42:43] op_sel:[1,0,0]
    v_pk_fma_f32 v[42:43], v[20:21], v[38:39], v[42:43] op_sel:[1,1,0] op_sel_hi:[1,0,1] neg_lo:[0,1,0]
    v_pk_fma_f32 v[44:45], v[18:19], v[40:41], v[44:45] op_sel_hi:[0,1,1]
    v_pk_fma_f32 v[44:45], v[40:41], v[20:21], v[44:45] op_sel:[1,0,0] op_sel_hi:[0,0,1] neg_lo:[1,0,0]
    v_pk_fma_f32 v[46:47], v[18:19], v[42:43], v[46:47] op_sel:[1,0,0]
    v_pk_fma_f32 v[46:47], v[20:21], v[42:43], v[46:47] op_sel:[1,1,0] op_sel_hi:[1,0,1] neg_lo:[0,1,0]
    v_pk_fma_f32 v[48:49], v[18:19], v[44:45], v[48:49] op_sel_hi:[0,1,1]
    v_pk_fma_f32 v[48:49], v[44:45], v[20:21], v[48:49] op_sel:[1,0,0] op_sel_hi:[0,0,1] neg_lo:[1,0,0]
    v_pk_fma_f32 v[50:51], v[18:19], v[46:47], v[50:51] op_sel:[1,0,0]
    v_pk_fma_f32 v[50:51], v[20:21], v[46:47], v[50:51] op_sel:[1,1,0] op_sel_hi:[1,0,1] neg_lo:[0,1,0]
    v_pk_fma_f32 v[52:53], v[18:19], v[48:49], v[52:53] op_sel_hi:[0,1,1]
    v_pk_fma_f32 v[52:53], v[48:49], v[20:21], v[52:53] op_sel:[1,0,0] op_sel_hi:[0,0,1] neg_lo:[1,0,0]
    v_pk_fma_f32 v[54:55], v[18:19], v[50:51], v[54:55] op_sel:[1,0,0]
    v_pk_fma_f32 v[54:55], v[20:21], v[50:51], v[54:55] op_sel:[1,1,0] op_sel_hi:[1,0,1] neg_lo:[0,1,0]
    v_pk_fma_f32 v[56:57], v[18:19], v[52:53], v[56:57] op_sel_hi:[0,1,1]
    v_pk_fma_f32 v[56:57], v[52:53], v[20:21], v[56:57] op_sel:[1,0,0] op_sel_hi:[0,0,1] neg_lo:[1,0,0]
    v_pk_fma_f32 v[58:59], v[18:19], v[54:55], v[58:59] op_sel:[1,0,0]
    v_pk_fma_f32 v[58:59], v[20:21], v[54:55], v[58:59] op_sel:[1,1,0] op_sel_hi:[1,0,1] neg_lo:[0,1,0]
    v_pk_fma_f32 v[60:61], v[18:19], v[56:57], v[60:61] op_sel_hi:[0,1,1]
    v_pk_fma_f32 v[60:61], v[56:57], v[20:21], v[60:61] op_sel:[1,0,0] op_sel_hi:[0,0,1] neg_lo:[1,0,0]
    v_pk_fma_f32 v[62:63], v[18:19], v[58:59], v[62:63] op_sel:[1,0,0]
    v_pk_fma_f32 v[62:63], v[20:21], v[58:59], v[62:63] op_sel:[1,1,0] op_sel_hi:[1,0,1] neg_lo:[0,1,0]
    s_cmp_eq_u32 s30, 0
    s_cbranch_scc1 Lc_nopub
    s_cmp_eq_u32 s26, 15
    s_cbranch_scc1 Lc_nopub
    v_mov_b32 v26, v60
    v_mov_b32 v27, v61
    v_mov_b32 v28, s44
    v_mov_b32 v29, s44
    s_lshl_b32 s33, s26, 10
    s_lshl_b32 s34, s31, 9
    s_add_u32 s33, s33, s34
    v_lshlrev_b32 v8, 4, v1
    s_mov_b64 exec, 0xffff0000
    v_mov_b32 v26, v62
    v_mov_b32 v27, v63
    s_mov_b64 exec, 0xffffffff
    buffer_store_dwordx4 v[26:29], v8, s[36:39], s33 offen sc1
    s_mov_b64 exec, -1
Lc_nopub:
    v_mov_b32 v60, 0
    v_mov_b32 v61, 0
    v_mov_b32 v62, 0
    v_mov_b32 v63, 0
    s_lshl_b32 s33, s30, 2
    v_add_u32 v8, s33, v7
    v_cmp_eq_u32 vcc, 1, v8
    s_nop 1
    v_cndmask_b32 v60, v60, v32, vcc
    v_cndmask_b32 v61, v61, v33, vcc
    v_cndmask_b32 v62, v62, v34, vcc
    v_cndmask_b32 v63, v63, v35, vcc
    v_cmp_eq_u32 vcc, 2, v8
    s_nop 1
    v_cndmask_b32 v60, v60, v36, vcc
    v_cndmask_b32 v61, v61, v37, vcc
    v_cndmask_b32 v62, v62, v38, vcc
    v_cndmask_b32 v63, v63, v39, vcc
    v_cmp_eq_u32 vcc, 3, v8
    s_nop 1
    v_cndmask_b32 v60, v60, v40, vcc
    v_cndmask_b32 v61, v61, v41, vcc
    v_cndmask_b32 v62, v62, v42, vcc
    v_cndmask_b32 v63, v63, v43, vcc
    v_cmp_eq_u32 vcc, 4, v8
    s_nop 1
    v_cndmask_b32 v60, v60, v44, vcc
    v_cndmask_b32 v61, v61, v45, vcc
    v_cndmask_b32 v62, v62, v46, vcc
    v_cndmask_b32 v63, v63, v47, vcc
    v_cmp_eq_u32 vcc, 5, v8
    s_nop 1
    v_cndmask_b32 v60, v60, v48, vcc
    v_cndmask_b32 v61, v61, v49, vcc
    v_cndmask_b32 v62, v62, v50, vcc
    v_cndmask_b32 v63, v63, v51, vcc
    v_cmp_eq_u32 vcc, 6, v8
    s_nop 1
    v_cndmask_b32 v60, v60, v52, vcc
    v_cndmask_b32 v61, v61, v53, vcc
    v_cndmask_b32 v62, v62, v54, vcc
    v_cndmask_b32 v63, v63, v55, vcc
    v_cmp_eq_u32 vcc, 7, v8
    s_nop 1
    v_cndmask_b32 v60, v60, v56, vcc
    v_cndmask_b32 v61, v61, v57, vcc
    v_cndmask_b32 v62, v62, v58, vcc
    v_cndmask_b32 v63, v63, v59, vcc
    v_fma_f32 v33, v14, v60, v110
    v_fma_f32 v35, v14, v61, v126
    v_mov_b32 v32, v60
    v_mov_b32 v34, v61
    v_fma_f32 v33, -v16, v61, v33
    v_fma_f32 v35, v16, v60, v35
    v_fma_f32 v37, v15, v62, v142
    v_fma_f32 v39, v15, v63, v158
    v_mov_b32 v36, v62
    v_mov_b32 v38, v63
    v_fma_f32 v37, -v17, v63, v37
    v_fma_f32 v39, v17, v62, v39
    v_pk_mul_f32 v[26:27], v[24:25], v[96:97] op_sel_hi:[0,1] neg_lo:[1,0] neg_hi:[1,0]
    v_pk_mul_f32 v[96:97], v[22:23], v[96:97] op_sel_hi:[0,1]
    v_pk_fma_f32 v[96:97], v[24:25], v[112:113], v[96:97] op_sel_hi:[0,1,1] neg_lo:[1,0,0] neg_hi:[1,0,0]
    v_pk_fma_f32 v[112:113], v[22:23], v[112:113], v[26:27] op_sel_hi:[0,1,1] neg_lo:[1,0,0] neg_hi:[1,0,0]
    v_pk_mul_f32 v[28:29], v[24:25], v[128:129] op_sel:[1,0] neg_lo:[1,0] neg_hi:[1,0]
    v_pk_mul_f32 v[128:129], v[22:23], v[128:129] op_sel:[1,0]
    v_pk_fma_f32 v[128:129], v[24:25], v[144:145], v[128:129] op_sel:[1,0,0] neg_lo:[1,0,0] neg_hi:[1,0,0]
    v_pk_fma_f32 v[144:145], v[22:23], v[144:145], v[28:29] op_sel:[1,0,0] neg_lo:[1,0,0] neg_hi:[1,0,0]
    v_pk_mul_f32 v[26:27], v[24:25], v[98:99] op_sel_hi:[0,1] neg_lo:[1,0] neg_hi:[1,0]
    v_pk_mul_f32 v[98:99], v[22:23], v[98:99] op_sel_hi:[0,1]
    v_pk_fma_f32 v[98:99], v[24:25], v[114:115], v[98:99] op_sel_hi:[0,1,1] neg_lo:[1,0,0] neg_hi:[1,0,0]
    v_pk_fma_f32 v[114:115], v[22:23], v[114:115], v[26:27] op_sel_hi:[0,1,1] neg_lo:[1,0,0] neg_hi:[1,0,0]
    v_pk_mul_f32 v[28:29], v[24:25], v[130:131] op_sel:[1,0] neg_lo:[1,0] neg_hi:[1,0]
    v_pk_mul_f32 v[130:131], v[22:23], v[130:131] op_sel:[1,0]
    v_pk_fma_f32 v[130:131], v[24:25], v[146:147], v[130:131] op_sel:[1,0,0] neg_lo:[1,0,0] neg_hi:[1,0,0]
    v_pk_fma_f32 v[146:147], v[22:23], v[146:147], v[28:29] op_sel:[1,0,0] neg_lo:[1,0,0] neg_hi:[1,0,0]
    v_pk_mul_f32 v[26:27], v[24:25], v[100:101] op_sel_hi:[0,1] neg_lo:[1,0] neg_hi:[1,0]
    v_pk_mul_f32 v[100:101], v[22:23], v[100:101] op_sel_hi:[0,1]
    v_pk_fma_f32 v[100:101], v[24:25], v[116:117], v[100:101] op_sel_hi:[0,1,1] neg_lo:[1,0,0] neg_hi:[1,0,0]
    v_pk_fma_f32 v[116:117], v[22:23], v[116:117], v[26:27] op_sel_hi:[0,1,1] neg_lo:[1,0,0] neg_hi:[1,0,0]
    v_pk_mul_f32 v[28:29], v[24:25], v[132:133] op_sel:[1,0] neg_lo:[1,0] neg_hi:[1,0]
    v_pk_mul_f32 v[132:133], v[22:23], v[132:133] op_sel:[1,0]
    v_pk_fma_f32 v[132:133], v[24:25], v[148:149], v[132:133] op_sel:[1,0,0] neg_lo:[1,0,0] neg_hi:[1,0,0]
    v_pk_fma_f32 v[148:149], v[22:23], v[148:149], v[28:29] op_sel:[1,0,0] neg_lo:[1,0,0] neg_hi:[1,0,0]
    v_pk_mul_f32 v[26:27], v[24:25], v[102:103] op_sel_hi:[0,1] neg_lo:[1,0] neg_hi:[1,0]
    v_pk_mul_f32 v[102:103], v[22:23], v[102:103] op_sel_hi:[0,1]
    v_pk_fma_f32 v[102:103], v[24:25], v[118:119], v[102:103] op_sel_hi:[0,1,1] neg_lo:[1,0,0] neg_hi:[1,0,0]
    v_pk_fma_f32 v[118:119], v[22:23], v[118:119], v[26:27] op_sel_hi:[0,1,1] neg_lo:[1,0,0] neg_hi:[1,0,0]
    v_pk_mul_f32 v[28:29], v[24:25], v[134:135] op_sel:[1,0] neg_lo:[1,0] neg_hi:[1,0]
    v_pk_mul_f32 v[134:135], v[22:23], v[134:135] op_sel:[1,0]
    v_pk_fma_f32 v[134:135], v[24:25], v[150:151], v[134:135] op_sel:[1,0,0] neg_lo:[1,0,0] neg_hi:[1,0,0]
    v_pk_fma_f32 v[150:151], v[22:23], v[150:151], v[28:29] op_sel:[1,0,0] neg_lo:[1,0,0] neg_hi:[1,0,0]
    v_pk_mul_f32 v[26:27], v[24:25], v[104:105] op_sel_hi:[0,1] neg_lo:[1,0] neg_hi:[1,0]
    v_pk_mul_f32 v[104:105], v[22:23], v[104:105] op_sel_hi:[0,1]
    v_pk_fma_f32 v[104:105], v[24:25], v[120:121], v[104:105] op_sel_hi:[0,1,1] neg_lo:[1,0,0] neg_hi:[1,0,0]
    v_pk_fma_f32 v[120:121], v[22:23], v[120:121], v[26:27] op_sel_hi:[0,1,1] neg_lo:[1,0,0] neg_hi:[1,0,0]
    v_pk_mul_f32 v[28:29], v[24:25], v[136:137] op_sel:[1,0] neg_lo:[1,0] neg_hi:[1,0]
    v_pk_mul_f32 v[136:137], v[22:23], v[136:137] op_sel:[1,0]
    v_pk_fma_f32 v[136:137], v[24:25], v[152:153], v[136:137] op_sel:[1,0,0] neg_lo:[1,0,0] neg_hi:[1,0,0]
    v_pk_fma_f32 v[152:153], v[22:23], v[152:153], v[28:29] op_sel:[1,0,0] neg_lo:[1,0,0] neg_hi:[1,0,0]
    v_pk_mul_f32 v[26:27], v[24:25], v[106:107] op_sel_hi:[0,1] neg_lo:[1,0] neg_hi:[1,0]
    v_pk_mul_f32 v[106:107], v[22:23], v[106:107] op_sel_hi:[0,1]
    v_pk_fma_f32 v[106:107], v[24:25], v[122:123], v[106:107] op_sel_hi:[0,1,1] neg_lo:[1,0,0] neg_hi:[1,0,0]
    v_pk_fma_f32 v[122:123], v[22:23], v[122:123], v[26:27] op_sel_hi:[0,1,1] neg_lo:[1,0,0] neg_hi:[1,0,0]
    v_pk_mul_f32 v[28:29], v[24:25], v[138:139] op_sel:[1,0] neg_lo:[1,0] neg_hi:[1,0]
    v_pk_mul_f32 v[138:139], v[22:23], v[138:139] op_sel:[1,0]
    v_pk_fma_f32 v[138:139], v[24:25], v[154:155], v[138:139] op_sel:[1,0,0] neg_lo:[1,0,0] neg_hi:[1,0,0]
    v_pk_fma_f32 v[154:155], v[22:23], v[154:155], v[28:29] op_sel:[1,0,0] neg_lo:[1,0,0] neg_hi:[1,0,0]
    v_pk_mul_f32 v[26:27], v[24:25], v[108:109] op_sel_hi:[0,1] neg_lo:[1,0] neg_hi:[1,0]
    v_pk_mul_f32 v[108:109], v[22:23], v[108:109] op_sel_hi:[0,1]
    v_pk_fma_f32 v[108:109], v[24:25], v[124:125], v[108:109] op_sel_hi:[0,1,1] neg_lo:[1,0,0] neg_hi:[1,0,0]
    v_pk_fma_f32 v[124:125], v[22:23], v[124:125], v[26:27] op_sel_hi:[0,1,1] neg_lo:[1,0,0] neg_hi:[1,0,0]
    v_pk_mul_f32 v[28:29], v[24:25], v[140:141] op_sel:[1,0] neg_lo:[1,0] neg_hi:[1,0]
    v_pk_mul_f32 v[140:141], v[22:23], v[140:141] op_sel:[1,0]
    v_pk_fma_f32 v[140:141], v[24:25], v[156:157], v[140:141] op_sel:[1,0,0] neg_lo:[1,0,0] neg_hi:[1,0,0]
    v_pk_fma_f32 v[156:157], v[22:23], v[156:157], v[28:29] op_sel:[1,0,0] neg_lo:[1,0,0] neg_hi:[1,0,0]
    v_pk_mul_f32 v[26:27], v[24:25], v[110:111] op_sel_hi:[0,1] neg_lo:[1,0] neg_hi:[1,0]
    v_pk_mul_f32 v[110:111], v[22:23], v[110:111] op_sel_hi:[0,1]
    v_pk_fma_f32 v[110:111], v[24:25], v[126:127], v[110:111] op_sel_hi:[0,1,1] neg_lo:[1,0,0] neg_hi:[1,0,0]
    v_pk_fma_f32 v[126:127], v[22:23], v[126:127], v[26:27] op_sel_hi:[0,1,1] neg_lo:[1,0,0] neg_hi:[1,0,0]
    v_pk_mul_f32 v[28:29], v[24:25], v[142:143] op_sel:[1,0] neg_lo:[1,0] neg_hi:[1,0]
    v_pk_mul_f32 v[142:143], v[22:23], v[142:143] op_sel:[1,0]
    v_pk_fma_f32 v[142:143], v[24:25], v[158:159], v[142:143] op_sel:[1,0,0] neg_lo:[1,0,0] neg_hi:[1,0,0]
    v_pk_fma_f32 v[158:159], v[22:23], v[158:159], v[28:29] op_sel:[1,0,0] neg_lo:[1,0,0] neg_hi:[1,0,0]
    v_mov_b32 v9, s44
    v_cmp_le_i32 vcc, 0, v192
    s_nop 1
    v_cndmask_b32 v248, 0, v9, vcc
    v_cndmask_b32 v249, 0, v9, vcc
    v_cmp_le_i32 vcc, 0, v193
    s_nop 1
    v_cndmask_b32 v250, 0, v9, vcc
    v_cndmask_b32 v251, 0, v9, vcc
    v_cmp_le_i32 vcc, 0, v194
    s_nop 1
    v_cndmask_b32 v252, 0, v9, vcc
    v_cndmask_b32 v253, 0, v9, vcc
    v_cmp_le_i32 vcc, 0, v195
    s_nop 1
    v_cndmask_b32 v254, 0, v9, vcc
    v_cndmask_b32 v255, 0, v9, vcc
    s_lshl_b32 s33, s29, 12
    s_add_u32 s33, s33, 131072
    v_lshrrev_b32 v8, 1, v6
    v_and_b32 v8, 4, v8
    v_and_b32 v9, 7, v6
    v_xor_b32 v8, v8, v9
    v_lshlrev_b32 v9, 1, v7
    v_xor_b32 v8, v8, v9
    v_lshlrev_b32 v8, 4, v8
    v_lshl_add_u32 v8, v6, 7, v8
    v_add_u32 v2, s33, v8
    v_xor_b32 v3, 16, v2
    v_bfe_u32 v8, v1, 2, 2
    v_bfe_u32 v9, v1, 1, 1
    v_xor_b32 v9, v9, v8
    v_and_b32 v4, 1, v7
    v_lshlrev_b32 v4, 2, v4
    v_xor_b32 v9, v9, v4
    v_lshlrev_b32 v9, 4, v9
    v_lshl_add_u32 v8, v7, 3, v8
    v_lshl_add_u32 v9, v8, 7, v9
    v_and_b32 v8, 1, v1
    v_lshl_add_u32 v9, v8, 3, v9
    v_add_u32 v4, s33, v9
    v_xor_b32 v5, 32, v4
    v_xor_b32 v30, 64, v4
    v_xor_b32 v31, 96, v4
    s_mov_b32 s45, 32768
Lc_lbpoll:
    s_waitcnt vmcnt(0)
    v_cmp_ne_u64 s[46:47], v[162:163], v[248:249]
    v_cmp_ne_u64 s[48:49], v[166:167], v[248:249]
    v_cmp_ne_u64 s[50:51], v[170:171], v[250:251]
    v_cmp_ne_u64 s[52:53], v[174:175], v[250:251]
    v_cmp_ne_u64 s[54:55], v[178:179], v[252:253]
    v_cmp_ne_u64 s[56:57], v[182:183], v[252:253]
    v_cmp_ne_u64 s[58:59], v[186:187], v[254:255]
    v_cmp_ne_u64 s[60:61], v[190:191], v[254:255]
    s_or_b64 s[46:47], s[46:47], s[48:49]
    s_or_b64 s[50:51], s[50:51], s[52:53]
    s_or_b64 s[54:55], s[54:55], s[56:57]
    s_or_b64 s[58:59], s[58:59], s[60:61]
    s_or_b64 s[46:47], s[46:47], s[50:51]
    s_or_b64 s[54:55], s[54:55], s[58:59]
    s_or_b64 s[46:47], s[46:47], s[54:55]
    s_cbranch_scc0 Lc_lbok
    s_sub_u32 s45, s45, 1
    s_cbranch_scc1 Lc_lbok
    buffer_load_dwordx4 v[160:163], v192, s[36:39], 0 offen offset:0 sc1
    buffer_load_dwordx4 v[164:167], v192, s[36:39], 0 offen offset:256 sc1
    buffer_load_dwordx4 v[168:171], v193, s[36:39], 0 offen offset:0 sc1
    buffer_load_dwordx4 v[172:175], v193, s[36:39], 0 offen offset:256 sc1
    buffer_load_dwordx4 v[176:179], v194, s[36:39], 0 offen offset:0 sc1
    buffer_load_dwordx4 v[180:183], v194, s[36:39], 0 offen offset:256 sc1
    buffer_load_dwordx4 v[184:187], v195, s[36:39], 0 offen offset:0 sc1
    buffer_load_dwordx4 v[188:191], v195, s[36:39], 0 offen offset:256 sc1
    s_branch Lc_lbpoll
Lc_lbok:
    v_pk_fma_f32 v[176:177], v[244:245], v[184:185], v[176:177] op_sel_hi:[0,1,1]
    v_pk_fma_f32 v[176:177], v[184:185], v[246:247], v[176:177] op_sel:[1,0,0] op_sel_hi:[0,0,1] neg_lo:[1,0,0]
    v_pk_fma_f32 v[180:181], v[244:245], v[188:189], v[180:181] op_sel:[1,0,0]
    v_pk_fma_f32 v[180:181], v[246:247], v[188:189], v[180:181] op_sel:[1,1,0] op_sel_hi:[1,0,1] neg_lo:[0,1,0]
    v_pk_fma_f32 v[168:169], v[244:245], v[176:177], v[168:169] op_sel_hi:[0,1,1]
    v_pk_fma_f32 v[168:169], v[176:177], v[246:247], v[168:169] op_sel:[1,0,0] op_sel_hi:[0,0,1] neg_lo:[1,0,0]
    v_pk_fma_f32 v[172:173], v[244:245], v[180:181], v[172:173] op_sel:[1,0,0]
    v_pk_fma_f32 v[172:173], v[246:247], v[180:181], v[172:173] op_sel:[1,1,0] op_sel_hi:[1,0,1] neg_lo:[0,1,0]
    v_pk_fma_f32 v[160:161], v[244:245], v[168:169], v[160:161] op_sel_hi:[0,1,1]
    v_pk_fma_f32 v[160:161], v[168:169], v[246:247], v[160:161] op_sel:[1,0,0] op_sel_hi:[0,0,1] neg_lo:[1,0,0]
    v_pk_fma_f32 v[164:165], v[244:245], v[172:173], v[164:165] op_sel:[1,0,0]
    v_pk_fma_f32 v[164:165], v[246:247], v[172:173], v[164:165] op_sel:[1,1,0] op_sel_hi:[1,0,1] neg_lo:[0,1,0]
    v_pk_mul_f32 v[168:169], v[240:241], v[160:161] op_sel_hi:[0,1]
    v_pk_mul_f32 v[172:173], v[240:241], v[164:165] op_sel:[1,0]
    v_pk_fma_f32 v[168:169], v[160:161], v[242:243], v[168:169] op_sel:[1,0,0] op_sel_hi:[0,0,1] neg_lo:[1,0,0]
    v_pk_fma_f32 v[172:173], v[242:243], v[164:165], v[172:173] op_sel:[1,1,0] op_sel_hi:[1,0,1] neg_lo:[0,1,0]
    v_mov_b32 v170, v168
    v_mov_b32 v171, v169
    v_mov_b32 v174, v172
    v_mov_b32 v175, v173
    v_permlane16_swap_b32 v168, v170
    v_permlane16_swap_b32 v169, v171
    v_permlane16_swap_b32 v172, v174
    v_permlane16_swap_b32 v173, v175
    v_pk_add_f32 v[168:169], v[168:169], v[170:171]
    v_pk_add_f32 v[172:173], v[172:173], v[174:175]
    v_mov_b32 v170, v168
    v_mov_b32 v171, v169
    v_mov_b32 v174, v172
    v_mov_b32 v175, v173
    v_permlane32_swap_b32 v168, v170
    v_permlane32_swap_b32 v169, v171
    v_permlane32_swap_b32 v172, v174
    v_permlane32_swap_b32 v173, v175
    v_pk_add_f32 v[168:169], v[168:169], v[170:171]
    v_pk_add_f32 v[172:173], v[172:173], v[174:175]
    v_pk_fma_f32 v[32:33], v[232:233], v[168:169], v[32:33] op_sel_hi:[1,0,1]
    v_pk_fma_f32 v[34:35], v[168:169], v[232:233], v[34:35] op_sel:[1,0,0]
    v_pk_fma_f32 v[36:37], v[234:235], v[172:173], v[36:37] op_sel_hi:[1,0,1]
    v_pk_fma_f32 v[38:39], v[172:173], v[234:235], v[38:39] op_sel:[1,0,0]
    v_pk_fma_f32 v[32:33], v[168:169], v[236:237], v[32:33] op_sel:[1,0,0] neg_lo:[1,0,0] neg_hi:[1,0,0]
    v_pk_fma_f32 v[34:35], v[236:237], v[168:169], v[34:35] op_sel_hi:[1,0,1]
    v_pk_fma_f32 v[36:37], v[172:173], v[238:239], v[36:37] op_sel:[1,0,0] neg_lo:[1,0,0] neg_hi:[1,0,0]
    v_pk_fma_f32 v[38:39], v[238:239], v[172:173], v[38:39] op_sel_hi:[1,0,1]
    s_mov_b32 s33, 16384
    v_pk_fma_f32 v[96:97], v[200:201], v[32:33], v[96:97] op_sel_hi:[0,1,1]
    v_pk_fma_f32 v[96:97], v[200:201], v[34:35], v[96:97] op_sel:[1,0,0] neg_lo:[1,0,0] neg_hi:[1,0,0]
    v_pk_fma_f32 v[98:99], v[204:205], v[32:33], v[98:99] op_sel_hi:[0,1,1]
    v_pk_fma_f32 v[98:99], v[204:205], v[34:35], v[98:99] op_sel:[1,0,0] neg_lo:[1,0,0] neg_hi:[1,0,0]
    v_pk_fma_f32 v[100:101], v[208:209], v[32:33], v[100:101] op_sel_hi:[0,1,1]
    v_pk_fma_f32 v[100:101], v[208:209], v[34:35], v[100:101] op_sel:[1,0,0] neg_lo:[1,0,0] neg_hi:[1,0,0]
    v_pk_fma_f32 v[102:103], v[212:213], v[32:33], v[102:103] op_sel_hi:[0,1,1]
    v_pk_fma_f32 v[102:103], v[212:213], v[34:35], v[102:103] op_sel:[1,0,0] neg_lo:[1,0,0] neg_hi:[1,0,0]
    v_pk_fma_f32 v[104:105], v[216:217], v[32:33], v[104:105] op_sel_hi:[0,1,1]
    v_pk_fma_f32 v[104:105], v[216:217], v[34:35], v[104:105] op_sel:[1,0,0] neg_lo:[1,0,0] neg_hi:[1,0,0]
    v_pk_fma_f32 v[106:107], v[220:221], v[32:33], v[106:107] op_sel_hi:[0,1,1]
    v_pk_fma_f32 v[106:107], v[220:221], v[34:35], v[106:107] op_sel:[1,0,0] neg_lo:[1,0,0] neg_hi:[1,0,0]
    v_pk_fma_f32 v[108:109], v[224:225], v[32:33], v[108:109] op_sel_hi:[0,1,1]
    v_pk_fma_f32 v[108:109], v[224:225], v[34:35], v[108:109] op_sel:[1,0,0] neg_lo:[1,0,0] neg_hi:[1,0,0]
    v_pk_fma_f32 v[110:111], v[228:229], v[32:33], v[110:111] op_sel_hi:[0,1,1]
    v_pk_fma_f32 v[110:111], v[228:229], v[34:35], v[110:111] op_sel:[1,0,0] neg_lo:[1,0,0] neg_hi:[1,0,0]
    v_cvt_pk_bf16_f32 v160, v96, v98
    v_cvt_pk_bf16_f32 v161, v100, v102
    v_cvt_pk_bf16_f32 v162, v104, v106
    v_cvt_pk_bf16_f32 v163, v108, v110
    ds_write_b128 v2, v[160:163] offset:0
    v_cvt_pk_bf16_f32 v164, v97, v99
    v_cvt_pk_bf16_f32 v165, v101, v103
    v_cvt_pk_bf16_f32 v166, v105, v107
    v_cvt_pk_bf16_f32 v167, v109, v111
    ds_write_b128 v3, v[164:167] offset:0
    v_pk_fma_f32 v[128:129], v[202:203], v[36:37], v[128:129] op_sel_hi:[0,1,1]
    v_pk_fma_f32 v[128:129], v[202:203], v[38:39], v[128:129] op_sel:[1,0,0] neg_lo:[1,0,0] neg_hi:[1,0,0]
    v_pk_fma_f32 v[130:131], v[206:207], v[36:37], v[130:131] op_sel_hi:[0,1,1]
    v_pk_fma_f32 v[130:131], v[206:207], v[38:39], v[130:131] op_sel:[1,0,0] neg_lo:[1,0,0] neg_hi:[1,0,0]
    v_pk_fma_f32 v[132:133], v[210:211], v[36:37], v[132:133] op_sel_hi:[0,1,1]
    v_pk_fma_f32 v[132:133], v[210:211], v[38:39], v[132:133] op_sel:[1,0,0] neg_lo:[1,0,0] neg_hi:[1,0,0]
    v_pk_fma_f32 v[134:135], v[214:215], v[36:37], v[134:135] op_sel_hi:[0,1,1]
    v_pk_fma_f32 v[134:135], v[214:215], v[38:39], v[134:135] op_sel:[1,0,0] neg_lo:[1,0,0] neg_hi:[1,0,0]
    v_pk_fma_f32 v[136:137], v[218:219], v[36:37], v[136:137] op_sel_hi:[0,1,1]
    v_pk_fma_f32 v[136:137], v[218:219], v[38:39], v[136:137] op_sel:[1,0,0] neg_lo:[1,0,0] neg_hi:[1,0,0]
    v_pk_fma_f32 v[138:139], v[222:223], v[36:37], v[138:139] op_sel_hi:[0,1,1]
    v_pk_fma_f32 v[138:139], v[222:223], v[38:39], v[138:139] op_sel:[1,0,0] neg_lo:[1,0,0] neg_hi:[1,0,0]
    v_pk_fma_f32 v[140:141], v[226:227], v[36:37], v[140:141] op_sel_hi:[0,1,1]
    v_pk_fma_f32 v[140:141], v[226:227], v[38:39], v[140:141] op_sel:[1,0,0] neg_lo:[1,0,0] neg_hi:[1,0,0]
    v_pk_fma_f32 v[142:143], v[230:231], v[36:37], v[142:143] op_sel_hi:[0,1,1]
    v_pk_fma_f32 v[142:143], v[230:231], v[38:39], v[142:143] op_sel:[1,0,0] neg_lo:[1,0,0] neg_hi:[1,0,0]
    v_cvt_pk_bf16_f32 v168, v128, v130
    v_cvt_pk_bf16_f32 v169, v132, v134
    v_cvt_pk_bf16_f32 v170, v136, v138
    v_cvt_pk_bf16_f32 v171, v140, v142
    ds_write_b128 v2, v[168:171] offset:2048
    v_cvt_pk_bf16_f32 v172, v129, v131
    v_cvt_pk_bf16_f32 v173, v133, v135
    v_cvt_pk_bf16_f32 v174, v137, v139
    v_cvt_pk_bf16_f32 v175, v141, v143
    ds_write_b128 v3, v[172:175] offset:2048
    ds_read_b64_tr_b16 v[96:97], v4 offset:0
    ds_read_b64_tr_b16 v[98:99], v30 offset:512
    ds_read_b64_tr_b16 v[100:101], v5 offset:0
    ds_read_b64_tr_b16 v[102:103], v31 offset:512
    ds_read_b64_tr_b16 v[104:105], v30 offset:0
    ds_read_b64_tr_b16 v[106:107], v4 offset:512
    ds_read_b64_tr_b16 v[108:109], v31 offset:0
    ds_read_b64_tr_b16 v[110:111], v5 offset:512
    v_pk_fma_f32 v[112:113], v[200:201], v[34:35], v[112:113] op_sel_hi:[0,1,1] neg_lo:[1,0,0] neg_hi:[1,0,0]
    v_pk_fma_f32 v[112:113], v[200:201], v[32:33], v[112:113] op_sel:[1,0,0] neg_lo:[1,0,0] neg_hi:[1,0,0]
    v_pk_fma_f32 v[114:115], v[204:205], v[34:35], v[114:115] op_sel_hi:[0,1,1] neg_lo:[1,0,0] neg_hi:[1,0,0]
    v_pk_fma_f32 v[114:115], v[204:205], v[32:33], v[114:115] op_sel:[1,0,0] neg_lo:[1,0,0] neg_hi:[1,0,0]
    v_pk_fma_f32 v[116:117], v[208:209], v[34:35], v[116:117] op_sel_hi:[0,1,1] neg_lo:[1,0,0] neg_hi:[1,0,0]
    v_pk_fma_f32 v[116:117], v[208:209], v[32:33], v[116:117] op_sel:[1,0,0] neg_lo:[1,0,0] neg_hi:[1,0,0]
    v_pk_fma_f32 v[118:119], v[212:213], v[34:35], v[118:119] op_sel_hi:[0,1,1] neg_lo:[1,0,0] neg_hi:[1,0,0]
    v_pk_fma_f32 v[118:119], v[212:213], v[32:33], v[118:119] op_sel:[1,0,0] neg_lo:[1,0,0] neg_hi:[1,0,0]
    v_pk_fma_f32 v[120:121], v[216:217], v[34:35], v[120:121] op_sel_hi:[0,1,1] neg_lo:[1,0,0] neg_hi:[1,0,0]
    v_pk_fma_f32 v[120:121], v[216:217], v[32:33], v[120:121] op_sel:[1,0,0] neg_lo:[1,0,0] neg_hi:[1,0,0]
    v_pk_fma_f32 v[122:123], v[220:221], v[34:35], v[122:123] op_sel_hi:[0,1,1] neg_lo:[1,0,0] neg_hi:[1,0,0]
    v_pk_fma_f32 v[122:123], v[220:221], v[32:33], v[122:123] op_sel:[1,0,0] neg_lo:[1,0,0] neg_hi:[1,0,0]
    v_pk_fma_f32 v[124:125], v[224:225], v[34:35], v[124:125] op_sel_hi:[0,1,1] neg_lo:[1,0,0] neg_hi:[1,0,0]
    v_pk_fma_f32 v[124:125], v[224:225], v[32:33], v[124:125] op_sel:[1,0,0] neg_lo:[1,0,0] neg_hi:[1,0,0]
    v_pk_fma_f32 v[126:127], v[228:229], v[34:35], v[126:127] op_sel_hi:[0,1,1] neg_lo:[1,0,0] neg_hi:[1,0,0]
    v_pk_fma_f32 v[126:127], v[228:229], v[32:33], v[126:127] op_sel:[1,0,0] neg_lo:[1,0,0] neg_hi:[1,0,0]
    v_cvt_pk_bf16_f32 v176, v112, v114
    v_cvt_pk_bf16_f32 v177, v116, v118
    v_cvt_pk_bf16_f32 v178, v120, v122
    v_cvt_pk_bf16_f32 v179, v124, v126
    ds_write_b128 v2, v[176:179] offset:0
    v_cvt_pk_bf16_f32 v180, v113, v115
    v_cvt_pk_bf16_f32 v181, v117, v119
    v_cvt_pk_bf16_f32 v182, v121, v123
    v_cvt_pk_bf16_f32 v183, v125, v127
    ds_write_b128 v3, v[180:183] offset:0
    s_waitcnt lgkmcnt(8)
    buffer_store_dwordx4 v[96:99], v196, s[40:43], 0 offen offset:0 sc1
    s_waitcnt lgkmcnt(6)
    buffer_store_dwordx4 v[100:103], v196, s[40:43], 0 offen offset:1024 sc1
    s_waitcnt lgkmcnt(4)
    buffer_store_dwordx4 v[104:107], v196, s[40:43], 0 offen offset:2048 sc1
    s_waitcnt lgkmcnt(2)
    buffer_store_dwordx4 v[108:111], v196, s[40:43], 0 offen offset:3072 sc1
    v_pk_fma_f32 v[144:145], v[202:203], v[38:39], v[144:145] op_sel_hi:[0,1,1] neg_lo:[1,0,0] neg_hi:[1,0,0]
    v_pk_fma_f32 v[144:145], v[202:203], v[36:37], v[144:145] op_sel:[1,0,0] neg_lo:[1,0,0] neg_hi:[1,0,0]
    v_pk_fma_f32 v[146:147], v[206:207], v[38:39], v[146:147] op_sel_hi:[0,1,1] neg_lo:[1,0,0] neg_hi:[1,0,0]
    v_pk_fma_f32 v[146:147], v[206:207], v[36:37], v[146:147] op_sel:[1,0,0] neg_lo:[1,0,0] neg_hi:[1,0,0]
    v_pk_fma_f32 v[148:149], v[210:211], v[38:39], v[148:149] op_sel_hi:[0,1,1] neg_lo:[1,0,0] neg_hi:[1,0,0]
    v_pk_fma_f32 v[148:149], v[210:211], v[36:37], v[148:149] op_sel:[1,0,0] neg_lo:[1,0,0] neg_hi:[1,0,0]
    v_pk_fma_f32 v[150:151], v[214:215], v[38:39], v[150:151] op_sel_hi:[0,1,1] neg_lo:[1,0,0] neg_hi:[1,0,0]
    v_pk_fma_f32 v[150:151], v[214:215], v[36:37], v[150:151] op_sel:[1,0,0] neg_lo:[1,0,0] neg_hi:[1,0,0]
    v_pk_fma_f32 v[152:153], v[218:219], v[38:39], v[152:153] op_sel_hi:[0,1,1] neg_lo:[1,0,0] neg_hi:[1,0,0]
    v_pk_fma_f32 v[152:153], v[218:219], v[36:37], v[152:153] op_sel:[1,0,0] neg_lo:[1,0,0] neg_hi:[1,0,0]
    v_pk_fma_f32 v[154:155], v[222:223], v[38:39], v[154:155] op_sel_hi:[0,1,1] neg_lo:[1,0,0] neg_hi:[1,0,0]
    v_pk_fma_f32 v[154:155], v[222:223], v[36:37], v[154:155] op_sel:[1,0,0] neg_lo:[1,0,0] neg_hi:[1,0,0]
    v_pk_fma_f32 v[156:157], v[226:227], v[38:39], v[156:157] op_sel_hi:[0,1,1] neg_lo:[1,0,0] neg_hi:[1,0,0]
    v_pk_fma_f32 v[156:157], v[226:227], v[36:37], v[156:157] op_sel:[1,0,0] neg_lo:[1,0,0] neg_hi:[1,0,0]
    v_pk_fma_f32 v[158:159], v[230:231], v[38:39], v[158:159] op_sel_hi:[0,1,1] neg_lo:[1,0,0] neg_hi:[1,0,0]
    v_pk_fma_f32 v[158:159], v[230:231], v[36:37], v[158:159] op_sel:[1,0,0] neg_lo:[1,0,0] neg_hi:[1,0,0]
    v_cvt_pk_bf16_f32 v184, v144, v146
    v_cvt_pk_bf16_f32 v185, v148, v150
    v_cvt_pk_bf16_f32 v186, v152, v154
    v_cvt_pk_bf16_f32 v187, v156, v158
    ds_write_b128 v2, v[184:187] offset:2048
    v_cvt_pk_bf16_f32 v188, v145, v147
    v_cvt_pk_bf16_f32 v189, v149, v151
    v_cvt_pk_bf16_f32 v190, v153, v155
    v_cvt_pk_bf16_f32 v191, v157, v159
    ds_write_b128 v3, v[188:191] offset:2048
    ds_read_b64_tr_b16 v[128:129], v4 offset:0
    ds_read_b64_tr_b16 v[130:131], v30 offset:512
    ds_read_b64_tr_b16 v[132:133], v5 offset:0
    ds_read_b64_tr_b16 v[134:135], v31 offset:512
    ds_read_b64_tr_b16 v[136:137], v30 offset:0
    ds_read_b64_tr_b16 v[138:139], v4 offset:512
    ds_read_b64_tr_b16 v[140:141], v31 offset:0
    ds_read_b64_tr_b16 v[142:143], v5 offset:512
    s_waitcnt lgkmcnt(6)
    buffer_store_dwordx4 v[128:131], v196, s[40:43], s33 offen offset:0 sc1
    s_waitcnt lgkmcnt(4)
    buffer_store_dwordx4 v[132:135], v196, s[40:43], s33 offen offset:1024 sc1
    s_waitcnt lgkmcnt(2)
    buffer_store_dwordx4 v[136:139], v196, s[40:43], s33 offen offset:2048 sc1
    s_waitcnt lgkmcnt(0)
    buffer_store_dwordx4 v[140:143], v196, s[40:43], s33 offen offset:3072 sc1
    s_lshl_b32 s33, s26, 13
    s_add_u32 s33, s33, 3932160
    s_add_u32 s36, s20, s33
    s_addc_u32 s37, s21, 0
    s_mov_b32 s38, 8192
    s_lshl_b32 s46, s30, 12
    s_lshl_b32 s47, s27, 8
    s_add_u32 s47, s47, s46
    s_lshl_b32 s33, s31, 7
    s_add_u32 s47, s47, s33
    v_mov_b32 v190, s44
    v_lshlrev_b32 v191, 2, v1
    v_and_b32 v192, 31, v1
    v_lshlrev_b32 v192, 7, v192
    v_lshrrev_b32 v2, 1, v6
    v_xor_b32 v2, v2, v7
    v_lshlrev_b32 v2, 4, v2
    v_lshl_add_u32 v2, v6, 7, v2
    v_add_u32 v2, 65536, v2
    v_xor_b32 v3, 64, v2
    v_and_b32 v5, 7, v6
    v_xor_b32 v5, v5, v7
    v_lshlrev_b32 v5, 4, v5
    v_lshl_add_u32 v5, v6, 8, v5
    s_lshl_b32 s33, s29, 13
    s_add_u32 s33, s33, 32768
    v_add_u32 v186, s33, v5
    v_xor_b32 v187, 64, v186
    v_xor_b32 v188, 128, v186
    v_xor_b32 v189, 192, v186
    s_lshl_b32 s61, s24, 1
    s_and_b32 s61, s61, 15
    s_add_u32 s62, s61, s26
    s_and_b32 s62, s62, 15
    s_lshl_b32 s62, s62, 15
    s_lshl_b32 s32, s29, 11
    s_lshl_b32 s33, s26, 19
    s_add_u32 s33, s33, s32
    s_add_u32 s33, s33, 4194304
    v_lshrrev_b32 v8, 3, v1
    v_and_b32 v9, 7, v1
    v_lshrrev_b32 v10, 1, v8
    v_xor_b32 v9, v9, v10
    v_lshlrev_b32 v9, 4, v9
    v_lshl_add_u32 v10, v8, 11, v9
    v_xor_b32 v11, 64, v10
    v_add_u32 v12, 30720, v10
    v_add_u32 v13, 46080, v11
    v_add_u32 v11, 15360, v11
    s_lshl_b32 s48, s31, 13
    s_lshl_b32 s49, s30, 12
    s_add_u32 s48, s48, s49
    s_add_u32 s48, s48, 65536
    s_lshl_b32 s49, s61, 7
    s_add_u32 s50, s49, 128
    s_and_b32 s50, s50, 2047
    s_mov_b32 m0, s48
    s_waitcnt vmcnt(0)
    s_mov_b64 exec, 0xffffffff
    buffer_store_dword v190, v191, s[36:39], s47 offen sc1
    s_mov_b64 exec, -1
    buffer_load_dwordx4 v10, s[76:79], s49 offen offset:0 lds
    buffer_load_dwordx4 v11, s[76:79], s49 offen offset:1024 lds
    buffer_load_dwordx4 v12, s[76:79], s49 offen offset:2048 lds
    buffer_load_dwordx4 v13, s[76:79], s49 offen offset:3072 lds
    s_add_u32 m0, s48, 16384
    s_nop 0
    buffer_load_dwordx4 v10, s[76:79], s50 offen offset:0 lds
    buffer_load_dwordx4 v11, s[76:79], s50 offen offset:1024 lds
    buffer_load_dwordx4 v12, s[76:79], s50 offen offset:2048 lds
    buffer_load_dwordx4 v13, s[76:79], s50 offen offset:3072 lds
    s_add_u32 s40, s20, s33
    s_addc_u32 s41, s21, 0
    s_sub_u32 s42, 524288, s32
    buffer_load_dword v193, v192, s[36:39], s46 offen sc1
    v_mov_b32 v104, 0
    v_mov_b32 v105, 0
    v_mov_b32 v106, 0
    v_mov_b32 v107, 0
    v_mov_b32 v108, 0
    v_mov_b32 v109, 0
    v_mov_b32 v110, 0
    v_mov_b32 v111, 0
    v_mov_b32 v112, 0
    v_mov_b32 v113, 0
    v_mov_b32 v114, 0
    v_mov_b32 v115, 0
    v_mov_b32 v116, 0
    v_mov_b32 v117, 0
    v_mov_b32 v118, 0
    v_mov_b32 v119, 0
    v_mov_b32 v120, 0
    v_mov_b32 v121, 0
    v_mov_b32 v122, 0
    v_mov_b32 v123, 0
    v_mov_b32 v124, 0
    v_mov_b32 v125, 0
    v_mov_b32 v126, 0
    v_mov_b32 v127, 0
    v_mov_b32 v128, 0
    v_mov_b32 v129, 0
    v_mov_b32 v130, 0
    v_mov_b32 v131, 0
    v_mov_b32 v132, 0
    v_mov_b32 v133, 0
    v_mov_b32 v134, 0
    v_mov_b32 v135, 0
    s_mov_b32 s45, 32768
Lc_hpoll:
    s_waitcnt vmcnt(0)
    v_cmp_ne_u32 vcc, s44, v193
    s_cbranch_vccz Lc_hok
    s_sub_u32 s45, s45, 1
    s_cbranch_scc1 Lc_hok
    s_sleep 2
    buffer_load_dword v193, v192, s[36:39], s46 offen sc1
    s_branch Lc_hpoll
Lc_hok:
    buffer_load_dwordx4 v[40:43], v196, s[40:43], s62 offen offset:0 sc1
    buffer_load_dwordx4 v[44:47], v196, s[40:43], s62 offen offset:1024 sc1
    s_add_u32 s62, s62, 8192
    s_and_b32 s62, s62, 524287
    buffer_load_dwordx4 v[48:51], v196, s[40:43], s62 offen offset:0 sc1
    buffer_load_dwordx4 v[52:55], v196, s[40:43], s62 offen offset:1024 sc1
    s_add_u32 s62, s62, 8192
    s_and_b32 s62, s62, 524287
    buffer_load_dwordx4 v[56:59], v196, s[40:43], s62 offen offset:0 sc1
    buffer_load_dwordx4 v[60:63], v196, s[40:43], s62 offen offset:1024 sc1
    s_add_u32 s62, s62, 8192
    s_and_b32 s62, s62, 524287
    buffer_load_dwordx4 v[64:67], v196, s[40:43], s62 offen offset:0 sc1
    buffer_load_dwordx4 v[68:71], v196, s[40:43], s62 offen offset:1024 sc1
    s_add_u32 s62, s62, 8192
    s_and_b32 s62, s62, 524287
    buffer_load_dwordx4 v[72:75], v196, s[40:43], s62 offen offset:0 sc1
    buffer_load_dwordx4 v[76:79], v196, s[40:43], s62 offen offset:1024 sc1
    s_add_u32 s62, s62, 8192
    s_and_b32 s62, s62, 524287
    buffer_load_dwordx4 v[80:83], v196, s[40:43], s62 offen offset:0 sc1
    buffer_load_dwordx4 v[84:87], v196, s[40:43], s62 offen offset:1024 sc1
    s_add_u32 s62, s62, 8192
    s_and_b32 s62, s62, 524287
    s_barrier
    ds_read_b128 v[8:11], v2 offset:0
    ds_read_b128 v[12:15], v2 offset:2048
    ds_read_b128 v[16:19], v2 offset:4096
    ds_read_b128 v[20:23], v2 offset:6144
    s_mov_b32 s35, 0
Lc2_loop:
    s_waitcnt vmcnt(11) lgkmcnt(0)
    v_mfma_f32_16x16x32_bf16 v[104:107], v[8:11], v[40:43], v[104:107]
    ds_read_b128 v[24:27], v3 offset:0
    v_mfma_f32_16x16x32_bf16 v[108:111], v[12:15], v[40:43], v[108:111]
    ds_read_b128 v[28:31], v3 offset:2048
    v_mfma_f32_16x16x32_bf16 v[112:115], v[16:19], v[40:43], v[112:115]
    ds_read_b128 v[32:35], v3 offset:4096
    v_mfma_f32_16x16x32_bf16 v[116:119], v[20:23], v[40:43], v[116:119]
    ds_read_b128 v[36:39], v3 offset:6144
    buffer_load_dwordx4 v[88:91], v196, s[40:43], s62 offen offset:0 sc1
    s_waitcnt vmcnt(11)
    v_mfma_f32_16x16x32_bf16 v[132:135], v[20:23], v[44:47], v[132:135]
    v_mfma_f32_16x16x32_bf16 v[128:131], v[16:19], v[44:47], v[128:131]
    v_mfma_f32_16x16x32_bf16 v[124:127], v[12:15], v[44:47], v[124:127]
    v_mfma_f32_16x16x32_bf16 v[120:123], v[8:11], v[44:47], v[120:123]
    buffer_load_dwordx4 v[92:95], v196, s[40:43], s62 offen offset:1024 sc1
    s_add_u32 s62, s62, 8192
    s_and_b32 s62, s62, 524287
    s_waitcnt vmcnt(11) lgkmcnt(0)
    v_mfma_f32_16x16x32_bf16 v[104:107], v[24:27], v[48:51], v[104:107]
    ds_read_b128 v[8:11], v2 offset:8192
    v_mfma_f32_16x16x32_bf16 v[108:111], v[28:31], v[48:51], v[108:111]
    ds_read_b128 v[12:15], v2 offset:10240
    v_mfma_f32_16x16x32_bf16 v[112:115], v[32:35], v[48:51], v[112:115]
    ds_read_b128 v[16:19], v2 offset:12288
    v_mfma_f32_16x16x32_bf16 v[116:119], v[36:39], v[48:51], v[116:119]
    ds_read_b128 v[20:23], v2 offset:14336
    buffer_load_dwordx4 v[96:99], v196, s[40:43], s62 offen offset:0 sc1
    s_waitcnt vmcnt(11)
    v_mfma_f32_16x16x32_bf16 v[132:135], v[36:39], v[52:55], v[132:135]
    v_mfma_f32_16x16x32_bf16 v[128:131], v[32:35], v[52:55], v[128:131]
    v_mfma_f32_16x16x32_bf16 v[124:127], v[28:31], v[52:55], v[124:127]
    v_mfma_f32_16x16x32_bf16 v[120:123], v[24:27], v[52:55], v[120:123]
    buffer_load_dwordx4 v[100:103], v196, s[40:43], s62 offen offset:1024 sc1
    s_add_u32 s62, s62, 8192
    s_and_b32 s62, s62, 524287
    s_cmp_eq_u32 s35, 7
    s_cselect_b32 s42, 0, s42
    s_waitcnt vmcnt(11) lgkmcnt(0)
    v_mfma_f32_16x16x32_bf16 v[104:107], v[8:11], v[56:59], v[104:107]
    ds_read_b128 v[24:27], v3 offset:8192
    v_mfma_f32_16x16x32_bf16 v[108:111], v[12:15], v[56:59], v[108:111]
    ds_read_b128 v[28:31], v3 offset:10240
    v_mfma_f32_16x16x32_bf16 v[112:115], v[16:19], v[56:59], v[112:115]
    ds_read_b128 v[32:35], v3 offset:12288
    v_mfma_f32_16x16x32_bf16 v[116:119], v[20:23], v[56:59], v[116:119]
    ds_read_b128 v[36:39], v3 offset:14336
    buffer_load_dwordx4 v[40:43], v196, s[40:43], s62 offen offset:0 sc1
    s_waitcnt vmcnt(11)
    v_mfma_f32_16x16x32_bf16 v[132:135], v[20:23], v[60:63], v[132:135]
    v_mfma_f32_16x16x32_bf16 v[128:131], v[16:19], v[60:63], v[128:131]
    v_mfma_f32_16x16x32_bf16 v[124:127], v[12:15], v[60:63], v[124:127]
    v_mfma_f32_16x16x32_bf16 v[120:123], v[8:11], v[60:63], v[120:123]
    buffer_load_dwordx4 v[44:47], v196, s[40:43], s62 offen offset:1024 sc1
    s_add_u32 s62, s62, 8192
    s_and_b32 s62, s62, 524287
    s_waitcnt vmcnt(11) lgkmcnt(0)
    v_mfma_f32_16x16x32_bf16 v[104:107], v[24:27], v[64:67], v[104:107]
    s_barrier
    v_mfma_f32_16x16x32_bf16 v[108:111], v[28:31], v[64:67], v[108:111]
    ds_read_b128 v[8:11], v2 offset:16384
    v_mfma_f32_16x16x32_bf16 v[112:115], v[32:35], v[64:67], v[112:115]
    ds_read_b128 v[12:15], v2 offset:18432
    v_mfma_f32_16x16x32_bf16 v[116:119], v[36:39], v[64:67], v[116:119]
    ds_read_b128 v[16:19], v2 offset:20480
    buffer_load_dwordx4 v[48:51], v196, s[40:43], s62 offen offset:0 sc1
    s_waitcnt vmcnt(11)
    v_mfma_f32_16x16x32_bf16 v[132:135], v[36:39], v[68:71], v[132:135]
    ds_read_b128 v[20:23], v2 offset:22528
    v_mfma_f32_16x16x32_bf16 v[128:131], v[32:35], v[68:71], v[128:131]
    v_mfma_f32_16x16x32_bf16 v[124:127], v[28:31], v[68:71], v[124:127]
    v_mfma_f32_16x16x32_bf16 v[120:123], v[24:27], v[68:71], v[120:123]
    buffer_load_dwordx4 v[52:55], v196, s[40:43], s62 offen offset:1024 sc1
    s_add_u32 s62, s62, 8192
    s_and_b32 s62, s62, 524287
    s_waitcnt vmcnt(11) lgkmcnt(0)
    v_mfma_f32_16x16x32_bf16 v[104:107], v[8:11], v[72:75], v[104:107]
    ds_read_b128 v[24:27], v3 offset:16384
    v_mfma_f32_16x16x32_bf16 v[108:111], v[12:15], v[72:75], v[108:111]
    ds_read_b128 v[28:31], v3 offset:18432
    v_mfma_f32_16x16x32_bf16 v[112:115], v[16:19], v[72:75], v[112:115]
    ds_read_b128 v[32:35], v3 offset:20480
    v_mfma_f32_16x16x32_bf16 v[116:119], v[20:23], v[72:75], v[116:119]
    ds_read_b128 v[36:39], v3 offset:22528
    buffer_load_dwordx4 v[56:59], v196, s[40:43], s62 offen offset:0 sc1
    s_waitcnt vmcnt(11)
    v_mfma_f32_16x16x32_bf16 v[132:135], v[20:23], v[76:79], v[132:135]
    v_mfma_f32_16x16x32_bf16 v[128:131], v[16:19], v[76:79], v[128:131]
    v_mfma_f32_16x16x32_bf16 v[124:127], v[12:15], v[76:79], v[124:127]
    v_mfma_f32_16x16x32_bf16 v[120:123], v[8:11], v[76:79], v[120:123]
    buffer_load_dwordx4 v[60:63], v196, s[40:43], s62 offen offset:1024 sc1
    s_add_u32 s62, s62, 8192
    s_and_b32 s62, s62, 524287
    s_waitcnt vmcnt(11) lgkmcnt(0)
    v_mfma_f32_16x16x32_bf16 v[104:107], v[24:27], v[80:83], v[104:107]
    ds_read_b128 v[8:11], v2 offset:24576
    v_mfma_f32_16x16x32_bf16 v[108:111], v[28:31], v[80:83], v[108:111]
    ds_read_b128 v[12:15], v2 offset:26624
    v_mfma_f32_16x16x32_bf16 v[112:115], v[32:35], v[80:83], v[112:115]
    ds_read_b128 v[16:19], v2 offset:28672
    v_mfma_f32_16x16x32_bf16 v[116:119], v[36:39], v[80:83], v[116:119]
    ds_read_b128 v[20:23], v2 offset:30720
    buffer_load_dwordx4 v[64:67], v196, s[40:43], s62 offen offset:0 sc1
    s_waitcnt vmcnt(11)
    v_mfma_f32_16x16x32_bf16 v[132:135], v[36:39], v[84:87], v[132:135]
    v_mfma_f32_16x16x32_bf16 v[128:131], v[32:35], v[84:87], v[128:131]
    v_mfma_f32_16x16x32_bf16 v[124:127], v[28:31], v[84:87], v[124:127]
    v_mfma_f32_16x16x32_bf16 v[120:123], v[24:27], v[84:87], v[120:123]
    buffer_load_dwordx4 v[68:71], v196, s[40:43], s62 offen offset:1024 sc1
    s_add_u32 s62, s62, 8192
    s_and_b32 s62, s62, 524287
    s_waitcnt vmcnt(11) lgkmcnt(0)
    v_mfma_f32_16x16x32_bf16 v[104:107], v[8:11], v[88:91], v[104:107]
    ds_read_b128 v[24:27], v3 offset:24576
    v_mfma_f32_16x16x32_bf16 v[108:111], v[12:15], v[88:91], v[108:111]
    ds_read_b128 v[28:31], v3 offset:26624
    v_mfma_f32_16x16x32_bf16 v[112:115], v[16:19], v[88:91], v[112:115]
    ds_read_b128 v[32:35], v3 offset:28672
    v_mfma_f32_16x16x32_bf16 v[116:119], v[20:23], v[88:91], v[116:119]
    ds_read_b128 v[36:39], v3 offset:30720
    buffer_load_dwordx4 v[72:75], v196, s[40:43], s62 offen offset:0 sc1
    s_waitcnt vmcnt(11)
    v_mfma_f32_16x16x32_bf16 v[132:135], v[20:23], v[92:95], v[132:135]
    v_mfma_f32_16x16x32_bf16 v[128:131], v[16:19], v[92:95], v[128:131]
    v_mfma_f32_16x16x32_bf16 v[124:127], v[12:15], v[92:95], v[124:127]
    v_mfma_f32_16x16x32_bf16 v[120:123], v[8:11], v[92:95], v[120:123]
    buffer_load_dwordx4 v[76:79], v196, s[40:43], s62 offen offset:1024 sc1
    s_add_u32 s62, s62, 8192
    s_and_b32 s62, s62, 524287
    s_cmp_eq_u32 s35, 7
    s_waitcnt vmcnt(11) lgkmcnt(0)
    v_mfma_f32_16x16x32_bf16 v[104:107], v[24:27], v[96:99], v[104:107]
    v_xor_b32 v2, 0x8000, v2
    v_xor_b32 v3, 0x8000, v3
    s_cbranch_scc1 Lc2_nobar
    s_barrier
Lc2_nobar:
    v_mfma_f32_16x16x32_bf16 v[108:111], v[28:31], v[96:99], v[108:111]
    ds_read_b128 v[8:11], v2 offset:0
    v_mfma_f32_16x16x32_bf16 v[112:115], v[32:35], v[96:99], v[112:115]
    ds_read_b128 v[12:15], v2 offset:2048
    v_mfma_f32_16x16x32_bf16 v[116:119], v[36:39], v[96:99], v[116:119]
    ds_read_b128 v[16:19], v2 offset:4096
    buffer_load_dwordx4 v[80:83], v196, s[40:43], s62 offen offset:0 sc1
    s_waitcnt vmcnt(11)
    v_mfma_f32_16x16x32_bf16 v[132:135], v[36:39], v[100:103], v[132:135]
    ds_read_b128 v[20:23], v2 offset:6144
    v_mfma_f32_16x16x32_bf16 v[128:131], v[32:35], v[100:103], v[128:131]
    v_mfma_f32_16x16x32_bf16 v[124:127], v[28:31], v[100:103], v[124:127]
    v_mfma_f32_16x16x32_bf16 v[120:123], v[24:27], v[100:103], v[120:123]
    buffer_load_dwordx4 v[84:87], v196, s[40:43], s62 offen offset:1024 sc1
    s_add_u32 s62, s62, 8192
    s_and_b32 s62, s62, 524287
    s_add_u32 s35, s35, 1
    s_cmp_lt_u32 s35, 8
    s_cbranch_scc1 Lc2_loop
    ds_write_b128 v186, v[104:107] offset:0
    ds_write_b128 v187, v[108:111] offset:0
    ds_write_b128 v188, v[112:115] offset:0
    ds_write_b128 v189, v[116:119] offset:0
    ds_write_b128 v186, v[120:123] offset:4096
    ds_write_b128 v187, v[124:127] offset:4096
    ds_write_b128 v188, v[128:131] offset:4096
    ds_write_b128 v189, v[132:135] offset:4096
    s_waitcnt lgkmcnt(0)
    s_barrier
L_end:
    s_endpgm
.section .rodata,"a"
.p2align 6
.amdhsa_kernel gated_mix__ssm_conv_s5__moe_arch_mod__prompt_kernel
  .amdhsa_next_free_vgpr 256
  .amdhsa_next_free_sgpr 102
  .amdhsa_accum_offset 256
  .amdhsa_group_segment_fixed_size 0
  .amdhsa_kernarg_size 144
  .amdhsa_user_sgpr_count 2
  .amdhsa_user_sgpr_kernarg_segment_ptr 1
  .amdhsa_system_sgpr_workgroup_id_x 1
  .amdhsa_float_denorm_mode_32 3
.end_amdhsa_kernel
```

```asm
; @launch grid=(256,1,1) block=(512,1,1) lds=163840
.amdgcn_target "amdgcn-amd-amdhsa--gfx950"
.text
.globl gated_mix__ssm_conv_s5__moe_arch_mod__prompt_kernel
.p2align 8
.type gated_mix__ssm_conv_s5__moe_arch_mod__prompt_kernel,@function
gated_mix__ssm_conv_s5__moe_arch_mod__prompt_kernel:
    s_cmp_ge_u32 s2, 256
    s_cbranch_scc1 L_end
    v_lshrrev_b32 v2, 6, v0
    v_and_b32 v1, 63, v0
    s_nop 0
    v_readfirstlane_b32 s29, v2
    s_and_b32 s24, s2, 7
    s_lshr_b32 s25, s2, 3
    s_lshr_b32 s26, s25, 3
    s_lshl_b32 s26, s26, 2
    s_lshr_b32 s27, s24, 1
    s_add_u32 s26, s26, s27
    s_and_b32 s27, s24, 1
    s_lshl_b32 s27, s27, 3
    s_and_b32 s28, s25, 7
    s_add_u32 s27, s27, s28
    s_cmp_lt_u32 s29, 4
    s_cbranch_scc1 L_compute
    s_load_dwordx2 s[56:57], s[0:1], 0
    s_load_dwordx4 s[12:15], s[0:1], 24
    s_load_dwordx2 s[36:37], s[0:1], 64
    s_load_dwordx2 s[40:41], s[0:1], 120
    s_load_dwordx2 s[16:17], s[0:1], 136
    s_load_dwordx2 s[44:45], s[0:1], 104
    s_load_dwordx2 s[48:49], s[0:1], 88
    s_load_dwordx2 s[52:53], s[0:1], 96
    s_and_b32 s30, s29, 3
    v_lshrrev_b32 v3, 3, v1
    v_and_b32 v4, 7, v1
    v_lshrrev_b32 v5, 1, v3
    v_xor_b32 v2, v4, v5
    v_lshlrev_b32 v2, 4, v2
    v_lshl_add_u32 v14, v3, 11, v2
    v_xor_b32 v15, 64, v14
    v_add_u32 v16, 30720, v14
    v_add_u32 v17, 46080, v15
    v_add_u32 v15, 15360, v15
    v_lshrrev_b32 v6, 2, v3
    v_lshlrev_b32 v6, 4, v6
    v_and_b32 v7, 1, v3
    v_lshl_add_u32 v6, v7, 3, v6
    v_and_b32 v7, 1, v5
    v_add_u32 v6, v6, v7
    v_lshl_add_u32 v10, v6, 11, v2
    v_xor_b32 v11, 64, v10
    v_add_u32 v12, 2048, v10
    v_add_u32 v13, 66560, v11
    v_add_u32 v11, 64512, v11
    s_lshr_b32 s31, s30, 1
    s_and_b32 s32, s30, 1
    s_lshl_b32 s33, s26, 7
    s_lshl_b32 s34, s31, 6
    s_add_u32 s33, s33, s34
    s_lshl_b32 s34, s32, 2
    s_add_u32 s33, s33, s34
    s_lshl_b32 s33, s33, 11
    s_lshl_b32 s34, s27, 6
    s_lshl_b32 s35, s31, 5
    s_add_u32 s34, s34, s35
    s_lshl_b32 s64, s34, 11
    s_lshl_b32 s60, s30, 12
    s_add_u32 s61, s26, s27
    s_and_b32 s61, s61, 15
    s_lshl_b32 s61, s61, 7
    s_cmp_eq_u32 s32, 1
    s_waitcnt lgkmcnt(0)
    s_cselect_b32 s12, s14, s12
    s_cselect_b32 s13, s15, s13
    s_add_u32 s12, s12, s64
    s_addc_u32 s13, s13, 0
    s_sub_u32 s14, 2097152, s64
    s_mov_b32 s15, 0x20000
    s_add_u32 s8, s56, s33
    s_addc_u32 s9, s57, 0
    s_sub_u32 s10, 4194304, s33
    s_mov_b32 s11, 0x20000
    s_add_u32 m0, s60, 0
    s_nop 0
    buffer_load_dwordx4 v10, s[8:11], s61 offen offset:0 lds
    buffer_load_dwordx4 v11, s[8:11], s61 offen offset:1024 lds
    buffer_load_dwordx4 v12, s[8:11], s61 offen offset:2048 lds
    buffer_load_dwordx4 v13, s[8:11], s61 offen offset:3072 lds
    s_add_u32 m0, s60, 16384
    s_nop 0
    buffer_load_dwordx4 v14, s[12:15], s61 offen offset:0 lds
    buffer_load_dwordx4 v15, s[12:15], s61 offen offset:1024 lds
    buffer_load_dwordx4 v16, s[12:15], s61 offen offset:2048 lds
    buffer_load_dwordx4 v17, s[12:15], s61 offen offset:3072 lds
    s_add_u32 s61, s61, 128
    s_and_b32 s61, s61, 2047
    s_add_u32 m0, s60, 32768
    s_nop 0
    buffer_load_dwordx4 v10, s[8:11], s61 offen offset:0 lds
    buffer_load_dwordx4 v11, s[8:11], s61 offen offset:1024 lds
    buffer_load_dwordx4 v12, s[8:11], s61 offen offset:2048 lds
    buffer_load_dwordx4 v13, s[8:11], s61 offen offset:3072 lds
    s_add_u32 m0, s60, 49152
    s_nop 0
    buffer_load_dwordx4 v14, s[12:15], s61 offen offset:0 lds
    buffer_load_dwordx4 v15, s[12:15], s61 offen offset:1024 lds
    buffer_load_dwordx4 v16, s[12:15], s61 offen offset:2048 lds
    buffer_load_dwordx4 v17, s[12:15], s61 offen offset:3072 lds
    s_add_u32 s61, s61, 128
    s_and_b32 s61, s61, 2047
    v_mov_b32 v9, 0
    v_mov_b32 v8, 0
    v_mov_b32 v7, 147456
    ds_write_b64 v7, v[8:9]
    ds_write_b64 v7, v[8:9] offset:8
    ds_write_b64 v7, v[8:9] offset:16
    ds_write_b64 v7, v[8:9] offset:24
    s_mov_b32 s58, 4194304
    s_mov_b32 s59, 0x20000
    s_mov_b32 s38, 2048
    s_mov_b32 s39, 0x20000
    s_mov_b32 s42, 8388608
    s_mov_b32 s43, 0x20000
    s_mov_b32 s18, 268435456
    s_mov_b32 s19, 0x20000
    s_mov_b32 s46, 7340032
    s_mov_b32 s47, 0x20000
    s_mov_b32 s50, 7340032
    s_mov_b32 s51, 0x20000
    s_mov_b32 s54, 7340032
    s_mov_b32 s55, 0x20000
    s_lshl_b32 s62, s26, 7
    s_lshl_b32 s63, s27, 3
    s_add_u32 s62, s62, s63
    s_lshl_b32 s62, s62, 3
    v_lshlrev_b32 v18, 4, v1
    v_lshlrev_b32 v19, 3, v4
    s_load_dword s65, s[16:17], 0
    s_waitcnt vmcnt(8) lgkmcnt(0)
    s_barrier
    s_add_u32 m0, s60, 65536
    s_nop 0
    buffer_load_dwordx4 v10, s[8:11], s61 offen offset:0 lds
    buffer_load_dwordx4 v11, s[8:11], s61 offen offset:1024 lds
    buffer_load_dwordx4 v12, s[8:11], s61 offen offset:2048 lds
    buffer_load_dwordx4 v13, s[8:11], s61 offen offset:3072 lds
    s_add_u32 m0, s60, 81920
    s_nop 0
    buffer_load_dwordx4 v14, s[12:15], s61 offen offset:0 lds
    buffer_load_dwordx4 v15, s[12:15], s61 offen offset:1024 lds
    buffer_load_dwordx4 v16, s[12:15], s61 offen offset:2048 lds
    buffer_load_dwordx4 v17, s[12:15], s61 offen offset:3072 lds
    s_add_u32 s61, s61, 128
    s_and_b32 s61, s61, 2047
    s_add_u32 m0, s60, 98304
    s_nop 0
    buffer_load_dwordx4 v10, s[8:11], s61 offen offset:0 lds
    buffer_load_dwordx4 v11, s[8:11], s61 offen offset:1024 lds
    buffer_load_dwordx4 v12, s[8:11], s61 offen offset:2048 lds
    buffer_load_dwordx4 v13, s[8:11], s61 offen offset:3072 lds
    s_add_u32 m0, s60, 114688
    s_nop 0
    buffer_load_dwordx4 v14, s[12:15], s61 offen offset:0 lds
    buffer_load_dwordx4 v15, s[12:15], s61 offen offset:1024 lds
    buffer_load_dwordx4 v16, s[12:15], s61 offen offset:2048 lds
    buffer_load_dwordx4 v17, s[12:15], s61 offen offset:3072 lds
    s_add_u32 s61, s61, 128
    s_and_b32 s61, s61, 2047
    v_add_u32 v21, 147520, v19
    ds_read_b64 v[72:73], v21
    s_load_dwordx4 s[84:87], s[0:1], 40
    s_mul_hi_u32 s70, s2, 76695845
    s_mul_i32 s71, s70, 56
    s_sub_u32 s71, s2, s71
    s_lshl_b32 s72, s70, 8
    s_lshl_b32 s73, s30, 6
    s_add_u32 s72, s72, s73
    s_mul_i32 s73, s72, 7168
    s_lshl_b32 s74, s71, 7
    s_add_u32 s73, s73, s74
    s_cmp_ge_u32 s2, 224
    s_cselect_b32 s50, 0, s50
    s_cselect_b32 s54, 0, s54
    s_lshl_b32 s75, s30, 13
    s_lshl_b32 s69, s30, 12
    s_add_u32 s69, s69, 32768
    s_mov_b32 s76, 0
    v_mul_u32_u24 v31, 7168, v3
    v_lshl_add_u32 v31, v4, 4, v31
    s_mul_i32 s63, s25, 16384
    s_lshr_b32 s63, s63, 16
    s_mul_i32 s63, s63, 4
    s_sub_u32 s63, s25, s63
    s_mul_i32 s65, s65, 1664525
    s_add_u32 s65, s65, 1013904223
    s_waitcnt lgkmcnt(0)
    v_mov_b32 v74, v73
    v_mov_b32 v73, s65
    v_mov_b32 v75, s65
    s_add_u32 s66, s62, 32768
    s_add_u32 s67, s62, 8192
    s_cmp_lg_u32 s30, 0
    s_cbranch_scc1 L_nopub
    s_mov_b64 exec, 0xff
    buffer_store_dwordx2 v[72:73], v19, s[16:19], s66 offen sc1
    buffer_store_dwordx2 v[74:75], v19, s[16:19], s67 offen sc1
    s_mov_b64 exec, -1
L_nopub:
    s_cmp_eq_u32 s32, 1
    s_cselect_b32 s84, s86, s84
    s_cselect_b32 s85, s87, s85
    s_mov_b32 s20, s84
    s_mov_b32 s21, s85
    s_mov_b32 s22, 2097152
    s_mov_b32 s23, 0x20000
    s_lshl_b32 s33, s2, 13
    s_lshl_b32 s34, s31, 12
    s_add_u32 s33, s33, s34
    s_add_u32 s84, s84, s64
    s_addc_u32 s85, s85, 0
    s_waitcnt vmcnt(16)
    s_barrier
    s_mul_i32 s80, s63, 2
    s_add_u32 s80, s80, 3
    s_mov_b32 s81, 1
    s_mov_b32 s82, 0
L_ld1:
    s_add_u32 m0, s60, s82
    s_add_u32 s83, s60, s82
    buffer_load_dwordx4 v10, s[8:11], s61 offen offset:0 lds
    buffer_load_dwordx4 v11, s[8:11], s61 offen offset:1024 lds
    buffer_load_dwordx4 v12, s[8:11], s61 offen offset:2048 lds
    buffer_load_dwordx4 v13, s[8:11], s61 offen offset:3072 lds
    s_add_u32 m0, s83, 16384
    s_add_u32 s82, s82, 32768
    buffer_load_dwordx4 v14, s[12:15], s61 offen offset:0 lds
    buffer_load_dwordx4 v15, s[12:15], s61 offen offset:1024 lds
    buffer_load_dwordx4 v16, s[12:15], s61 offen offset:2048 lds
    buffer_load_dwordx4 v17, s[12:15], s61 offen offset:3072 lds
    s_and_b32 s82, s82, 131071
    s_add_u32 s61, s61, 128
    s_and_b32 s61, s61, 2047
    s_cmp_lg_u32 s80, s81
    s_cbranch_scc1 L_nowu
    s_add_u32 s74, s73, 0
    buffer_load_dwordx4 v[128:131], v31, s[52:55], s74 offen
    s_add_u32 s74, s73, 57344
    buffer_load_dwordx4 v[132:135], v31, s[52:55], s74 offen
    s_add_u32 s74, s73, 114688
    buffer_load_dwordx4 v[136:139], v31, s[52:55], s74 offen
    s_add_u32 s74, s73, 172032
    buffer_load_dwordx4 v[140:143], v31, s[52:55], s74 offen
    s_add_u32 s74, s73, 229376
    buffer_load_dwordx4 v[144:147], v31, s[52:55], s74 offen
    s_add_u32 s74, s73, 286720
    buffer_load_dwordx4 v[148:151], v31, s[52:55], s74 offen
    s_add_u32 s74, s73, 344064
    buffer_load_dwordx4 v[152:155], v31, s[52:55], s74 offen
    s_add_u32 s74, s73, 401408
    buffer_load_dwordx4 v[156:159], v31, s[52:55], s74 offen
L_nowu:
    s_add_u32 s81, s81, 1
    s_cmp_lt_u32 s81, 13
    s_waitcnt vmcnt(16)
    s_barrier
    s_cbranch_scc1 L_ld1
    buffer_load_dwordx4 v[80:83], v18, s[16:19], s69 offen offset:0 sc1
    buffer_load_dwordx4 v[84:87], v18, s[16:19], s69 offen offset:1024 sc1
    buffer_load_dwordx4 v[88:91], v18, s[16:19], s69 offen offset:2048 sc1
    buffer_load_dwordx4 v[92:95], v18, s[16:19], s69 offen offset:3072 sc1
    v_mov_b32 v10, v31
    s_add_u32 m0, s75, 0
    s_add_u32 s74, s73, 0
    buffer_load_dwordx4 v10, s[48:51], s74 offen lds
    s_add_u32 m0, s75, 1024
    s_add_u32 s74, s73, 57344
    buffer_load_dwordx4 v10, s[48:51], s74 offen lds
    s_add_u32 m0, s75, 2048
    s_add_u32 s74, s73, 114688
    buffer_load_dwordx4 v10, s[48:51], s74 offen lds
    s_add_u32 m0, s75, 3072
    s_add_u32 s74, s73, 172032
    buffer_load_dwordx4 v10, s[48:51], s74 offen lds
    s_add_u32 m0, s75, 4096
    s_add_u32 s74, s73, 229376
    buffer_load_dwordx4 v10, s[48:51], s74 offen lds
    s_add_u32 m0, s75, 5120
    s_add_u32 s74, s73, 286720
    buffer_load_dwordx4 v10, s[48:51], s74 offen lds
    s_add_u32 m0, s75, 6144
    s_add_u32 s74, s73, 344064
    buffer_load_dwordx4 v10, s[48:51], s74 offen lds
    s_add_u32 m0, s75, 7168
    s_add_u32 s74, s73, 401408
    buffer_load_dwordx4 v10, s[48:51], s74 offen lds
    s_waitcnt vmcnt(20)
    s_barrier
    v_add_u32 v33, s75, v18
    ds_write_b128 v33, v[128:131] offset:32768
    ds_write_b128 v33, v[132:135] offset:33792
    ds_write_b128 v33, v[136:139] offset:34816
    ds_write_b128 v33, v[140:143] offset:35840
    ds_write_b128 v33, v[144:147] offset:36864
    ds_write_b128 v33, v[148:151] offset:37888
    ds_write_b128 v33, v[152:155] offset:38912
    ds_write_b128 v33, v[156:159] offset:39936
    s_waitcnt vmcnt(12)
    s_barrier
    s_mov_b32 s8, s84
    s_mov_b32 s9, s85
    s_sub_u32 s10, 2097152, s64
    s_lshl_b32 s60, s32, 13
    s_lshl_b32 s35, s31, 12
    s_add_u32 s60, s60, s35
    s_add_u32 s60, s60, 65536
    s_lshr_b32 s61, s25, 3
    s_lshl_b32 s62, s24, 1
    s_add_u32 s61, s61, s62
    s_add_u32 s61, s61, 0
    s_and_b32 s61, s61, 15
    s_lshl_b32 s61, s61, 7
    s_add_u32 m0, s60, 0
    s_nop 0
    buffer_load_dwordx4 v14, s[8:11], s61 offen offset:0 lds
    buffer_load_dwordx4 v15, s[8:11], s61 offen offset:1024 lds
    buffer_load_dwordx4 v16, s[8:11], s61 offen offset:2048 lds
    buffer_load_dwordx4 v17, s[8:11], s61 offen offset:3072 lds
    s_add_u32 s61, s61, 128
    s_and_b32 s61, s61, 2047
    s_add_u32 m0, s60, 16384
    s_nop 0
    buffer_load_dwordx4 v14, s[8:11], s61 offen offset:0 lds
    buffer_load_dwordx4 v15, s[8:11], s61 offen offset:1024 lds
    buffer_load_dwordx4 v16, s[8:11], s61 offen offset:2048 lds
    buffer_load_dwordx4 v17, s[8:11], s61 offen offset:3072 lds
    s_add_u32 s61, s61, 128
    s_and_b32 s61, s61, 2047
    s_waitcnt vmcnt(16)
    s_mov_b32 s68, 32768
L_keypoll:
    v_xor_b32 v20, s65, v81
    v_xor_b32 v21, s65, v83
    v_or_b32 v20, v20, v21
    v_xor_b32 v21, s65, v85
    v_or_b32 v20, v20, v21
    v_xor_b32 v21, s65, v87
    v_or_b32 v20, v20, v21
    v_xor_b32 v21, s65, v89
    v_or_b32 v20, v20, v21
    v_xor_b32 v21, s65, v91
    v_or_b32 v20, v20, v21
    v_xor_b32 v21, s65, v93
    v_or_b32 v20, v20, v21
    v_xor_b32 v21, s65, v95
    v_or_b32 v20, v20, v21
    v_cmp_ne_u32 vcc, 0, v20
    s_cbranch_vccz L_keyok
    s_sub_u32 s68, s68, 1
    s_cbranch_scc1 L_keyok
    buffer_load_dwordx4 v[80:83], v18, s[16:19], s69 offen offset:0 sc1
    buffer_load_dwordx4 v[84:87], v18, s[16:19], s69 offen offset:1024 sc1
    buffer_load_dwordx4 v[88:91], v18, s[16:19], s69 offen offset:2048 sc1
    buffer_load_dwordx4 v[92:95], v18, s[16:19], s69 offen offset:3072 sc1
    s_waitcnt vmcnt(0)
    s_branch L_keypoll
L_keyok:
    s_or_b32 s66, s2, s30
    s_cmp_lg_u32 s66, 0
    s_cbranch_scc1 L_nogen
    v_mov_b32 v20, s65
    s_mov_b64 exec, 1
    buffer_store_dword v20, v9, s[16:19], 0 offen offset:0 sc1
    s_mov_b64 exec, -1
L_nogen:
    s_mov_b64 s[78:79], 1
L_top:
    v_subrev_u32 v22, s76, v80
    v_subrev_u32 v23, s76, v82
    v_subrev_u32 v24, s76, v84
    v_subrev_u32 v25, s76, v86
    v_subrev_u32 v26, s76, v88
    v_subrev_u32 v27, s76, v90
    v_subrev_u32 v28, s76, v92
    v_subrev_u32 v29, s76, v94
    v_max3_u32 v22, v22, v23, v24
    v_max3_u32 v25, v25, v26, v27
    v_max3_u32 v22, v22, v28, v29
    v_max_u32 v22, v22, v25
    s_nop 1
    v_max_u32_dpp v22, v22, v22 row_shr:1 row_mask:0xf bank_mask:0xf
    s_nop 1
    v_max_u32_dpp v22, v22, v22 row_shr:2 row_mask:0xf bank_mask:0xf
    s_nop 1
    v_max_u32_dpp v22, v22, v22 row_shr:4 row_mask:0xf bank_mask:0xf
    s_nop 1
    v_max_u32_dpp v22, v22, v22 row_shr:8 row_mask:0xf bank_mask:0xf
    s_nop 1
    v_max_u32_dpp v22, v22, v22 row_bcast:15 row_mask:0xa bank_mask:0xf
    s_nop 1
    v_max_u32_dpp v22, v22, v22 row_bcast:31 row_mask:0xc bank_mask:0xf
    s_nop 0
    v_readlane_b32 s77, v22, 63
    s_mov_b64 exec, s[78:79]
    s_add_u32 s76, s76, s77
    v_mov_b32 v30, s76
    s_mov_b64 exec, -1
    s_lshl_b32 s78, s78, 1
    s_cmp_lg_u32 s78, 256
    s_cbranch_scc1 L_top
    s_lshl_b32 s76, s30, 5
    v_lshl_add_u32 v32, v1, 2, s76
    v_add_u32 v32, 147712, v32
    v_mov_b32 v35, 1
    s_mov_b64 exec, 0xff
    ds_write_b32 v32, v30
    s_mov_b64 exec, 1
    ds_add_u32 v7, v35 offset:20
    s_mov_b64 exec, -1
    v_and_b32 v32, 31, v1
    v_lshlrev_b32 v32, 2, v32
    v_add_u32 v32, 147712, v32
    v_lshrrev_b32 v33, 5, v1
    v_lshlrev_b32 v33, 6, v33
    v_add_u32 v33, 147712, v33
    s_add_u32 s76, s76, 147968
    s_mov_b32 s68, 32768
L_candpoll:
    ds_read_b32 v35, v7 offset:20
    ds_read_b32 v34, v32
    ds_read_b128 v[36:39], v33 offset:0
    ds_read_b128 v[40:43], v33 offset:16
    ds_read_b128 v[44:47], v33 offset:32
    ds_read_b128 v[48:51], v33 offset:48
    s_waitcnt lgkmcnt(0)
    v_readfirstlane_b32 s77, v35
    s_sub_u32 s68, s68, 1
    s_cbranch_scc1 L_candok
    s_cmp_lg_u32 s77, 4
    s_cbranch_scc1 L_candpoll
L_candok:
    v_mov_b32 v35, 0
    v_cmp_gt_u32 s[78:79], v36, v34
    v_cmp_gt_u32 s[80:81], v37, v34
    v_cmp_gt_u32 s[82:83], v38, v34
    v_addc_co_u32 v35, vcc, 0, v35, s[78:79]
    v_cmp_gt_u32 s[78:79], v39, v34
    v_addc_co_u32 v35, vcc, 0, v35, s[80:81]
    v_cmp_gt_u32 s[80:81], v40, v34
    v_addc_co_u32 v35, vcc, 0, v35, s[82:83]
    v_cmp_gt_u32 s[82:83], v41, v34
    v_addc_co_u32 v35, vcc, 0, v35, s[78:79]
    v_cmp_gt_u32 s[78:79], v42, v34
    v_addc_co_u32 v35, vcc, 0, v35, s[80:81]
    v_cmp_gt_u32 s[80:81], v43, v34
    v_addc_co_u32 v35, vcc, 0, v35, s[82:83]
    v_cmp_gt_u32 s[82:83], v44, v34
    v_addc_co_u32 v35, vcc, 0, v35, s[78:79]
    v_cmp_gt_u32 s[78:79], v45, v34
    v_addc_co_u32 v35, vcc, 0, v35, s[80:81]
    v_cmp_gt_u32 s[80:81], v46, v34
    v_addc_co_u32 v35, vcc, 0, v35, s[82:83]
    v_cmp_gt_u32 s[82:83], v47, v34
    v_addc_co_u32 v35, vcc, 0, v35, s[78:79]
    v_cmp_gt_u32 s[78:79], v48, v34
    v_addc_co_u32 v35, vcc, 0, v35, s[80:81]
    v_cmp_gt_u32 s[80:81], v49, v34
    v_addc_co_u32 v35, vcc, 0, v35, s[82:83]
    v_cmp_gt_u32 s[82:83], v50, v34
    v_addc_co_u32 v35, vcc, 0, v35, s[78:79]
    v_cmp_gt_u32 s[78:79], v51, v34
    v_addc_co_u32 v35, vcc, 0, v35, s[80:81]
    v_addc_co_u32 v35, vcc, 0, v35, s[82:83]
    v_addc_co_u32 v35, vcc, 0, v35, s[78:79]
    v_mov_b32 v36, v35
    v_lshrrev_b32 v6, 4, v1
    v_lshlrev_b32 v32, 4, v6
    v_permlane32_swap_b32 v35, v36
    v_add_u32 v35, v35, v36
    v_cmp_gt_u32 vcc, 8, v35
    v_lshl_add_u32 v35, v35, 2, s76
    v_lshl_add_u32 v36, v4, 2, s76
    s_and_saveexec_b64 s[66:67], vcc
    ds_write_b32 v35, v34
    s_mov_b64 exec, -1
    ds_read_b32 v30, v36
    s_lshl_b32 s76, s72, 1
    s_waitcnt lgkmcnt(0)
    v_and_b32 v31, 0x7ff, v30
    v_sub_u32 v31, 2047, v31
    v_lshl_add_u32 v32, v31, 11, v32
    buffer_load_dwordx4 v[36:39], v32, s[56:59], s76 offen offset:0
    buffer_load_dwordx4 v[40:43], v32, s[56:59], s76 offen offset:64
    v_ashrrev_i32 v33, 31, v30
    v_not_b32 v33, v33
    v_or_b32 v33, 0x80000000, v33
    v_xor_b32 v33, v33, v30
    v_and_b32 v33, 0xffff0000, v33
    v_mul_f32 v35, 0xbfb8aa3b, v33
    v_exp_f32 v35, v35
    s_nop 0
    v_add_f32 v35, 1.0, v35
    v_rcp_f32 v35, v35
    s_nop 0
    v_cvt_pk_bf16_f32 v30, v35, v35
    v_lshlrev_b32 v30, 16, v30
    v_bfe_u32 v34, v1, 2, 2
    v_lshl_add_u32 v33, v6, 3, v34
    v_lshlrev_b32 v33, 7, v33
    v_and_b32 v34, 3, v1
    v_lshl_add_u32 v5, v34, 3, v33
    v_add_u32 v33, s75, v5
    s_cmp_ge_u32 s2, 224
    s_cbranch_scc1 L_gudone
    ds_read_b64_tr_b16 v[160:161], v33 offset:32768
    ds_read_b64_tr_b16 v[162:163], v33 offset:33280
    ds_read_b64_tr_b16 v[164:165], v33 offset:32800
    ds_read_b64_tr_b16 v[166:167], v33 offset:33312
    ds_read_b64_tr_b16 v[168:169], v33 offset:32832
    ds_read_b64_tr_b16 v[170:171], v33 offset:33344
    ds_read_b64_tr_b16 v[172:173], v33 offset:32864
    ds_read_b64_tr_b16 v[174:175], v33 offset:33376
    ds_read_b64_tr_b16 v[176:177], v33 offset:36864
    ds_read_b64_tr_b16 v[178:179], v33 offset:37376
    ds_read_b64_tr_b16 v[180:181], v33 offset:36896
    ds_read_b64_tr_b16 v[182:183], v33 offset:37408
    ds_read_b64_tr_b16 v[184:185], v33 offset:36928
    ds_read_b64_tr_b16 v[186:187], v33 offset:37440
    ds_read_b64_tr_b16 v[188:189], v33 offset:36960
    ds_read_b64_tr_b16 v[190:191], v33 offset:37472
    s_waitcnt vmcnt(0)
    s_waitcnt lgkmcnt(8)
    v_mfma_f32_16x16x32_bf16 v[112:115], v[36:39], v[160:163], 0
    v_mfma_f32_16x16x32_bf16 v[116:119], v[36:39], v[164:167], 0
    v_mfma_f32_16x16x32_bf16 v[120:123], v[36:39], v[168:171], 0
    v_mfma_f32_16x16x32_bf16 v[124:127], v[36:39], v[172:175], 0
    s_waitcnt lgkmcnt(0)
    v_mfma_f32_16x16x32_bf16 v[112:115], v[40:43], v[176:179], v[112:115]
    v_mfma_f32_16x16x32_bf16 v[116:119], v[40:43], v[180:183], v[116:119]
    v_mfma_f32_16x16x32_bf16 v[120:123], v[40:43], v[184:187], v[120:123]
    v_mfma_f32_16x16x32_bf16 v[124:127], v[40:43], v[188:191], v[124:127]
    ds_read_b64_tr_b16 v[160:161], v33 offset:0
    ds_read_b64_tr_b16 v[162:163], v33 offset:512
    ds_read_b64_tr_b16 v[164:165], v33 offset:32
    ds_read_b64_tr_b16 v[166:167], v33 offset:544
    ds_read_b64_tr_b16 v[168:169], v33 offset:64
    ds_read_b64_tr_b16 v[170:171], v33 offset:576
    ds_read_b64_tr_b16 v[172:173], v33 offset:96
    ds_read_b64_tr_b16 v[174:175], v33 offset:608
    ds_read_b64_tr_b16 v[176:177], v33 offset:4096
    ds_read_b64_tr_b16 v[178:179], v33 offset:4608
    ds_read_b64_tr_b16 v[180:181], v33 offset:4128
    ds_read_b64_tr_b16 v[182:183], v33 offset:4640
    ds_read_b64_tr_b16 v[184:185], v33 offset:4160
    ds_read_b64_tr_b16 v[186:187], v33 offset:4672
    ds_read_b64_tr_b16 v[188:189], v33 offset:4192
    ds_read_b64_tr_b16 v[190:191], v33 offset:4704
    s_waitcnt lgkmcnt(8)
    v_mfma_f32_16x16x32_bf16 v[96:99], v[36:39], v[160:163], 0
    v_mfma_f32_16x16x32_bf16 v[100:103], v[36:39], v[164:167], 0
    v_mfma_f32_16x16x32_bf16 v[104:107], v[36:39], v[168:171], 0
    v_mfma_f32_16x16x32_bf16 v[108:111], v[36:39], v[172:175], 0
    s_waitcnt lgkmcnt(0)
    v_mfma_f32_16x16x32_bf16 v[96:99], v[40:43], v[176:179], v[96:99]
    v_mfma_f32_16x16x32_bf16 v[100:103], v[40:43], v[180:183], v[100:103]
    v_mfma_f32_16x16x32_bf16 v[104:107], v[40:43], v[184:187], v[104:107]
    v_mfma_f32_16x16x32_bf16 v[108:111], v[40:43], v[188:191], v[108:111]
    v_lshl_add_u32 v34, v1, 4, s75
    s_mov_b64 exec, 0xffffffff
    s_nop 2
    ds_write_b128 v34, v[96:99] offset:0
    ds_write_b128 v34, v[100:103] offset:512
    ds_write_b128 v34, v[104:107] offset:1024
    ds_write_b128 v34, v[108:111] offset:1536
    ds_write_b128 v34, v[112:115] offset:2048
    ds_write_b128 v34, v[116:119] offset:2560
    ds_write_b128 v34, v[120:123] offset:3072
    ds_write_b128 v34, v[124:127] offset:3584
    s_mov_b64 exec, 1
    v_mov_b32 v35, 1
    ds_add_rtn_u32 v35, v7, v35 offset:16
    s_mov_b64 exec, -1
    s_waitcnt lgkmcnt(0)
    v_readfirstlane_b32 s76, v35
    s_cmp_lg_u32 s76, 3
    s_cbranch_scc1 L_gudone
    ds_read_b128 v[96:99], v18 offset:0
    ds_read_b128 v[100:103], v18 offset:1024
    ds_read_b128 v[104:107], v18 offset:2048
    ds_read_b128 v[108:111], v18 offset:3072
    ds_read_b128 v[112:115], v18 offset:8192
    ds_read_b128 v[116:119], v18 offset:9216
    ds_read_b128 v[120:123], v18 offset:10240
    ds_read_b128 v[124:127], v18 offset:11264
    ds_read_b128 v[128:131], v18 offset:16384
    ds_read_b128 v[132:135], v18 offset:17408
    ds_read_b128 v[136:139], v18 offset:18432
    ds_read_b128 v[140:143], v18 offset:19456
    ds_read_b128 v[144:147], v18 offset:24576
    ds_read_b128 v[148:151], v18 offset:25600
    ds_read_b128 v[152:155], v18 offset:26624
    ds_read_b128 v[156:159], v18 offset:27648
    v_lshrrev_b32 v35, 5, v1
    v_lshlrev_b32 v35, 13, v35
    v_and_b32 v36, 31, v1
    v_lshl_add_u32 v35, v36, 4, v35
    s_lshl_b32 s76, s71, 15
    s_lshl_b32 s77, s70, 11
    s_add_u32 s76, s76, s77
    s_add_u32 s76, s76, 524288
    s_add_u32 s77, s76, 16384
    v_mov_b32 v42, s65
    v_mov_b32 v43, s65
    v_mov_b32 v46, s65
    v_mov_b32 v47, s65
    s_waitcnt lgkmcnt(0)
    v_pk_add_f32 v[96:97], v[96:97], v[112:113]
    v_pk_add_f32 v[128:129], v[128:129], v[144:145]
    v_pk_add_f32 v[40:41], v[96:97], v[128:129]
    buffer_store_dwordx4 v[40:43], v35, s[16:19], s76 offen offset:0 sc1
    v_pk_add_f32 v[98:99], v[98:99], v[114:115]
    v_pk_add_f32 v[130:131], v[130:131], v[146:147]
    v_pk_add_f32 v[44:45], v[98:99], v[130:131]
    buffer_store_dwordx4 v[44:47], v35, s[16:19], s76 offen offset:1024 sc1
    v_pk_add_f32 v[100:101], v[100:101], v[116:117]
    v_pk_add_f32 v[132:133], v[132:133], v[148:149]
    v_pk_add_f32 v[40:41], v[100:101], v[132:133]
    buffer_store_dwordx4 v[40:43], v35, s[16:19], s77 offen offset:0 sc1
    v_pk_add_f32 v[102:103], v[102:103], v[118:119]
    v_pk_add_f32 v[134:135], v[134:135], v[150:151]
    v_pk_add_f32 v[44:45], v[102:103], v[134:135]
    buffer_store_dwordx4 v[44:47], v35, s[16:19], s77 offen offset:1024 sc1
    v_pk_add_f32 v[104:105], v[104:105], v[120:121]
    v_pk_add_f32 v[136:137], v[136:137], v[152:153]
    v_pk_add_f32 v[40:41], v[104:105], v[136:137]
    buffer_store_dwordx4 v[40:43], v35, s[16:19], s76 offen offset:512 sc1
    v_pk_add_f32 v[106:107], v[106:107], v[122:123]
    v_pk_add_f32 v[138:139], v[138:139], v[154:155]
    v_pk_add_f32 v[44:45], v[106:107], v[138:139]
    buffer_store_dwordx4 v[44:47], v35, s[16:19], s76 offen offset:1536 sc1
    v_pk_add_f32 v[108:109], v[108:109], v[124:125]
    v_pk_add_f32 v[140:141], v[140:141], v[156:157]
    v_pk_add_f32 v[40:41], v[108:109], v[140:141]
    buffer_store_dwordx4 v[40:43], v35, s[16:19], s77 offen offset:512 sc1
    v_pk_add_f32 v[110:111], v[110:111], v[126:127]
    v_pk_add_f32 v[142:143], v[142:143], v[158:159]
    v_pk_add_f32 v[44:45], v[110:111], v[142:143]
    buffer_store_dwordx4 v[44:47], v35, s[16:19], s77 offen offset:1536 sc1
L_gudone:
    v_mov_b32 v178, v31
    v_mov_b32 v179, v30
    v_bfrev_b32 v2, 1
    v_mov_b32 v8, v7
    v_and_b32 v7, 15, v1
    v_lshlrev_b32 v11, 4, v4
    v_lshl_add_u32 v11, v3, 11, v11
    s_mul_i32 s50, s26, 28
    s_mul_i32 s51, s30, 7
    s_add_u32 s50, s50, s51
    s_lshl_b32 s50, s50, 14
    s_lshl_b32 s55, s27, 7
    s_add_u32 s50, s50, s55
    s_lshl_b32 s51, s51, 10
    s_lshl_b32 s48, s26, 7
    s_lshl_b32 s49, s30, 5
    s_add_u32 s49, s48, s49
    v_lshlrev_b32 v12, 3, v7
    v_lshl_add_u32 v19, v6, 11, v12
    v_lshlrev_b32 v9, 3, v1
    s_mov_b32 s68, 32768
    s_cmp_ge_u32 s2, 224
    s_cselect_b32 s67, 0, 4
L_winpoll:
    ds_read_b32 v20, v8 offset:16
    ds_read_b32 v21, v8 offset:28
    s_waitcnt lgkmcnt(0)
    v_readfirstlane_b32 s33, v20
    v_readfirstlane_b32 s34, v21
    s_sub_u32 s68, s68, 1
    s_cbranch_scc1 L_winok
    s_cmp_lg_u32 s33, s67
    s_cbranch_scc1 L_winpoll
    s_cmp_eq_u32 s34, 0
    s_cbranch_scc1 L_winpoll
L_winok:
    s_lshl_b32 s33, s49, 11
    s_add_u32 s33, s33, s55
    s_lshl_b32 s74, s49, 3
    s_add_u32 s74, s74, 8192
    buffer_load_dwordx2 v[156:157], v9, s[16:19], s74 offen sc1
    buffer_load_dwordx2 v[116:117], v12, s[36:39], s55 offen
    buffer_load_dwordx2 v[84:85], v19, s[56:59], s33 offen
    s_add_u32 s33, s33, 8192
    buffer_load_dwordx2 v[86:87], v19, s[56:59], s33 offen
    s_add_u32 s33, s33, 8192
    buffer_load_dwordx2 v[88:89], v19, s[56:59], s33 offen
    s_add_u32 s33, s33, 8192
    buffer_load_dwordx2 v[90:91], v19, s[56:59], s33 offen
    s_add_u32 s33, s33, 8192
    buffer_load_dwordx2 v[92:93], v19, s[56:59], s33 offen
    s_add_u32 s33, s33, 8192
    buffer_load_dwordx2 v[94:95], v19, s[56:59], s33 offen
    s_add_u32 s33, s33, 8192
    buffer_load_dwordx2 v[96:97], v19, s[56:59], s33 offen
    s_add_u32 s33, s33, 8192
    buffer_load_dwordx2 v[98:99], v19, s[56:59], s33 offen
    s_add_u32 m0, s51, 32768
    s_nop 0
    buffer_load_dwordx4 v11, s[44:47], s50 offen lds
    s_add_u32 m0, s51, 33792
    s_add_u32 s50, s50, 16384
    buffer_load_dwordx4 v11, s[44:47], s50 offen lds
    s_add_u32 m0, s51, 34816
    s_add_u32 s50, s50, 16384
    buffer_load_dwordx4 v11, s[44:47], s50 offen lds
    s_add_u32 m0, s51, 35840
    s_add_u32 s50, s50, 16384
    buffer_load_dwordx4 v11, s[44:47], s50 offen lds
    s_add_u32 m0, s51, 36864
    s_add_u32 s50, s50, 16384
    buffer_load_dwordx4 v11, s[44:47], s50 offen lds
    s_add_u32 m0, s51, 37888
    s_add_u32 s50, s50, 16384
    buffer_load_dwordx4 v11, s[44:47], s50 offen lds
    s_add_u32 m0, s51, 38912
    s_add_u32 s50, s50, 16384
    buffer_load_dwordx4 v11, s[44:47], s50 offen lds
    s_waitcnt vmcnt(23)
    s_barrier
    s_add_u32 m0, s60, 32768
    s_nop 0
    buffer_load_dwordx4 v14, s[8:11], s61 offen offset:0 lds
    buffer_load_dwordx4 v15, s[8:11], s61 offen offset:1024 lds
    buffer_load_dwordx4 v16, s[8:11], s61 offen offset:2048 lds
    buffer_load_dwordx4 v17, s[8:11], s61 offen offset:3072 lds
    s_add_u32 s61, s61, 128
    s_and_b32 s61, s61, 2047
    s_add_u32 m0, s60, 49152
    s_nop 0
    buffer_load_dwordx4 v14, s[8:11], s61 offen offset:0 lds
    buffer_load_dwordx4 v15, s[8:11], s61 offen offset:1024 lds
    buffer_load_dwordx4 v16, s[8:11], s61 offen offset:2048 lds
    buffer_load_dwordx4 v17, s[8:11], s61 offen offset:3072 lds
    s_add_u32 s61, s61, 128
    s_and_b32 s61, s61, 2047
    s_waitcnt vmcnt(27)
    s_barrier
    s_add_u32 m0, s60, 0
    s_nop 0
    buffer_load_dwordx4 v14, s[8:11], s61 offen offset:0 lds
    buffer_load_dwordx4 v15, s[8:11], s61 offen offset:1024 lds
    buffer_load_dwordx4 v16, s[8:11], s61 offen offset:2048 lds
    buffer_load_dwordx4 v17, s[8:11], s61 offen offset:3072 lds
    s_add_u32 s61, s61, 128
    s_and_b32 s61, s61, 2047
    s_lshl_b32 s70, s2, 13
    s_add_u32 s70, s70, 524288
    s_add_u32 s71, s70, 4096
    s_cmp_lt_u32 s2, 224
    s_cselect_b32 s73, s30, 1
    s_cmp_lg_u32 s73, 0
    s_cbranch_scc1 L_nogu1
    buffer_load_dwordx4 v[20:23], v18, s[16:19], s70 offen offset:0 sc1
    buffer_load_dwordx4 v[24:27], v18, s[16:19], s70 offen offset:1024 sc1
    buffer_load_dwordx4 v[28:31], v18, s[16:19], s70 offen offset:2048 sc1
    buffer_load_dwordx4 v[32:35], v18, s[16:19], s70 offen offset:3072 sc1
    buffer_load_dwordx4 v[36:39], v18, s[16:19], s71 offen offset:0 sc1
    buffer_load_dwordx4 v[40:43], v18, s[16:19], s71 offen offset:1024 sc1
    buffer_load_dwordx4 v[44:47], v18, s[16:19], s71 offen offset:2048 sc1
    buffer_load_dwordx4 v[48:51], v18, s[16:19], s71 offen offset:3072 sc1
L_nogu1:
    s_waitcnt vmcnt(8)
    s_barrier
    s_add_u32 m0, s60, 16384
    s_nop 0
    buffer_load_dwordx4 v14, s[8:11], s61 offen offset:0 lds
    buffer_load_dwordx4 v15, s[8:11], s61 offen offset:1024 lds
    buffer_load_dwordx4 v16, s[8:11], s61 offen offset:2048 lds
    buffer_load_dwordx4 v17, s[8:11], s61 offen offset:3072 lds
    s_add_u32 s61, s61, 128
    s_and_b32 s61, s61, 2047
    s_waitcnt vmcnt(8)
    s_barrier
    s_add_u32 m0, s60, 32768
    s_nop 0
    buffer_load_dwordx4 v14, s[8:11], s61 offen offset:0 lds
    buffer_load_dwordx4 v15, s[8:11], s61 offen offset:1024 lds
    buffer_load_dwordx4 v16, s[8:11], s61 offen offset:2048 lds
    buffer_load_dwordx4 v17, s[8:11], s61 offen offset:3072 lds
    s_add_u32 s61, s61, 128
    s_and_b32 s61, s61, 2047
    s_cmp_lg_u32 s73, 0
    s_cbranch_scc1 L_nogu2
    v_mov_b32 v152, s65
    v_mov_b32 v153, s65
    s_mov_b32 s68, 32768
    s_waitcnt vmcnt(8)
L_gupoll:
    v_cmp_ne_u64 vcc, v[22:23], v[152:153]
    v_cmp_ne_u64 s[66:67], v[26:27], v[152:153]
    s_or_b64 vcc, vcc, s[66:67]
    v_cmp_ne_u64 s[66:67], v[30:31], v[152:153]
    s_or_b64 vcc, vcc, s[66:67]
    v_cmp_ne_u64 s[66:67], v[34:35], v[152:153]
    s_or_b64 vcc, vcc, s[66:67]
    v_cmp_ne_u64 s[66:67], v[38:39], v[152:153]
    s_or_b64 vcc, vcc, s[66:67]
    v_cmp_ne_u64 s[66:67], v[42:43], v[152:153]
    s_or_b64 vcc, vcc, s[66:67]
    v_cmp_ne_u64 s[66:67], v[46:47], v[152:153]
    s_or_b64 vcc, vcc, s[66:67]
    v_cmp_ne_u64 s[66:67], v[50:51], v[152:153]
    s_or_b64 vcc, vcc, s[66:67]
    s_cbranch_vccz L_guok
    s_sub_u32 s68, s68, 1
    s_cbranch_scc1 L_guok
    buffer_load_dwordx4 v[20:23], v18, s[16:19], s70 offen offset:0 sc1
    buffer_load_dwordx4 v[24:27], v18, s[16:19], s70 offen offset:1024 sc1
    buffer_load_dwordx4 v[28:31], v18, s[16:19], s70 offen offset:2048 sc1
    buffer_load_dwordx4 v[32:35], v18, s[16:19], s70 offen offset:3072 sc1
    buffer_load_dwordx4 v[36:39], v18, s[16:19], s71 offen offset:0 sc1
    buffer_load_dwordx4 v[40:43], v18, s[16:19], s71 offen offset:1024 sc1
    buffer_load_dwordx4 v[44:47], v18, s[16:19], s71 offen offset:2048 sc1
    buffer_load_dwordx4 v[48:51], v18, s[16:19], s71 offen offset:3072 sc1
    s_waitcnt vmcnt(0)
    s_branch L_gupoll
L_guok:
    v_pk_add_f32 v[20:21], v[20:21], v[28:29]
    v_pk_add_f32 v[36:37], v[36:37], v[44:45]
    v_pk_add_f32 v[20:21], v[20:21], v[36:37]
    v_pk_add_f32 v[24:25], v[24:25], v[32:33]
    v_pk_add_f32 v[40:41], v[40:41], v[48:49]
    v_pk_add_f32 v[24:25], v[24:25], v[40:41]
    v_cvt_pk_bf16_f32 v20, v20, v21
    v_mov_b32 v22, v20
    s_nop 1
    v_permlane32_swap_b32 v20, v22
    v_and_b32 v21, 0xffff0000, v20
    v_lshlrev_b32 v20, 16, v20
    v_and_b32 v23, 0xffff0000, v22
    v_lshlrev_b32 v22, 16, v22
    v_mul_f32 v154, 0xbfb8aa3b, v20
    v_mul_f32 v155, 0xbfb8aa3b, v21
    v_exp_f32 v154, v154
    v_exp_f32 v155, v155
    v_add_f32 v154, 1.0, v154
    v_add_f32 v155, 1.0, v155
    v_rcp_f32 v154, v154
    v_rcp_f32 v155, v155
    s_nop 0
    v_pk_mul_f32 v[20:21], v[20:21], v[154:155]
    v_cvt_pk_bf16_f32 v20, v20, v21
    v_and_b32 v21, 0xffff0000, v20
    v_lshlrev_b32 v20, 16, v20
    v_pk_mul_f32 v[20:21], v[20:21], v[22:23]
    v_cvt_pk_bf16_f32 v150, v20, v21
    v_cvt_pk_bf16_f32 v24, v24, v25
    v_mov_b32 v26, v24
    s_nop 1
    v_permlane32_swap_b32 v24, v26
    v_and_b32 v25, 0xffff0000, v24
    v_lshlrev_b32 v24, 16, v24
    v_and_b32 v27, 0xffff0000, v26
    v_lshlrev_b32 v26, 16, v26
    v_mul_f32 v154, 0xbfb8aa3b, v24
    v_mul_f32 v155, 0xbfb8aa3b, v25
    v_exp_f32 v154, v154
    v_exp_f32 v155, v155
    v_add_f32 v154, 1.0, v154
    v_add_f32 v155, 1.0, v155
    v_rcp_f32 v154, v154
    v_rcp_f32 v155, v155
    s_nop 0
    v_pk_mul_f32 v[24:25], v[24:25], v[154:155]
    v_cvt_pk_bf16_f32 v24, v24, v25
    v_and_b32 v25, 0xffff0000, v24
    v_lshlrev_b32 v24, 16, v24
    v_pk_mul_f32 v[24:25], v[24:25], v[26:27]
    v_cvt_pk_bf16_f32 v151, v24, v25
    s_lshl_b32 s33, s2, 9
    s_add_u32 s33, s33, 393216
    s_mov_b64 exec, 0xffffffff
    buffer_store_dwordx4 v[150:153], v18, s[16:19], s33 offen sc1
    s_mov_b64 exec, -1
L_nogu2:
    s_waitcnt vmcnt(8)
    s_barrier
    s_add_u32 m0, s60, 49152
    s_nop 0
    buffer_load_dwordx4 v14, s[8:11], s61 offen offset:0 lds
    buffer_load_dwordx4 v15, s[8:11], s61 offen offset:1024 lds
    buffer_load_dwordx4 v16, s[8:11], s61 offen offset:2048 lds
    buffer_load_dwordx4 v17, s[8:11], s61 offen offset:3072 lds
    s_add_u32 s61, s61, 128
    s_and_b32 s61, s61, 2047
    s_mov_b32 s68, 32768
L_gpoll:
    v_cmp_ne_u32 vcc, s65, v157
    s_and_b32 vcc_hi, vcc_hi, 0
    s_cbranch_vccz L_gok
    s_sub_u32 s68, s68, 1
    s_cbranch_scc1 L_gok
    buffer_load_dwordx2 v[156:157], v9, s[16:19], s74 offen sc1
    s_waitcnt vmcnt(0)
    s_branch L_gpoll
L_gok:
    v_lshlrev_b32 v8, 2, v6
    ds_bpermute_b32 v100, v8, v156 offset:0
    ds_bpermute_b32 v102, v8, v156 offset:16
    ds_bpermute_b32 v104, v8, v156 offset:32
    ds_bpermute_b32 v106, v8, v156 offset:48
    ds_bpermute_b32 v108, v8, v156 offset:64
    ds_bpermute_b32 v110, v8, v156 offset:80
    ds_bpermute_b32 v112, v8, v156 offset:96
    ds_bpermute_b32 v114, v8, v156 offset:112
    v_and_b32 v119, 0xffff0000, v117
    v_lshlrev_b32 v118, 16, v117
    v_and_b32 v117, 0xffff0000, v116
    v_lshlrev_b32 v116, 16, v116
    s_mul_i32 s72, s26, 7168
    s_mul_i32 s33, s30, 1792
    s_add_u32 s72, s72, s33
    s_add_u32 s72, s72, 393216
    v_cmp_gt_u32 vcc, 48, v1
    s_nop 1
    v_cndmask_b32 v13, v2, v18, vcc
    s_waitcnt lgkmcnt(0)
    v_and_b32 v101, 0xffff0000, v100
    v_lshlrev_b32 v100, 16, v100
    v_and_b32 v103, 0xffff0000, v102
    v_lshlrev_b32 v102, 16, v102
    v_and_b32 v105, 0xffff0000, v104
    v_lshlrev_b32 v104, 16, v104
    v_and_b32 v107, 0xffff0000, v106
    v_lshlrev_b32 v106, 16, v106
    v_and_b32 v109, 0xffff0000, v108
    v_lshlrev_b32 v108, 16, v108
    v_and_b32 v111, 0xffff0000, v110
    v_lshlrev_b32 v110, 16, v110
    v_and_b32 v113, 0xffff0000, v112
    v_lshlrev_b32 v112, 16, v112
    v_and_b32 v115, 0xffff0000, v114
    v_lshlrev_b32 v114, 16, v114
    s_waitcnt vmcnt(8)
    s_barrier
    s_add_u32 m0, s60, 0
    s_nop 0
    buffer_load_dwordx4 v14, s[8:11], s61 offen offset:0 lds
    buffer_load_dwordx4 v15, s[8:11], s61 offen offset:1024 lds
    buffer_load_dwordx4 v16, s[8:11], s61 offen offset:2048 lds
    buffer_load_dwordx4 v17, s[8:11], s61 offen offset:3072 lds
    s_add_u32 s61, s61, 128
    s_and_b32 s61, s61, 2047
    v_lshlrev_b32 v152, 16, v84
    v_and_b32 v153, 0xffff0000, v84
    v_pk_mul_f32 v[154:155], v[152:153], v[116:117]
    v_pk_mul_f32 v[152:153], v[100:101], v[152:153] op_sel:[1,0]
    v_cvt_pk_bf16_f32 v154, v154, v155
    v_cvt_pk_bf16_f32 v152, v152, v153
    v_and_b32 v155, 0xffff0000, v154
    v_lshlrev_b32 v154, 16, v154
    v_and_b32 v153, 0xffff0000, v152
    v_lshlrev_b32 v152, 16, v152
    v_pk_fma_f32 v[120:121], v[100:101], v[154:155], v[152:153] op_sel_hi:[0,1,1]
    v_lshlrev_b32 v152, 16, v85
    v_and_b32 v153, 0xffff0000, v85
    v_pk_mul_f32 v[154:155], v[152:153], v[118:119]
    v_pk_mul_f32 v[152:153], v[100:101], v[152:153] op_sel:[1,0]
    v_cvt_pk_bf16_f32 v154, v154, v155
    v_cvt_pk_bf16_f32 v152, v152, v153
    v_and_b32 v155, 0xffff0000, v154
    v_lshlrev_b32 v154, 16, v154
    v_and_b32 v153, 0xffff0000, v152
    v_lshlrev_b32 v152, 16, v152
    v_pk_fma_f32 v[122:123], v[100:101], v[154:155], v[152:153] op_sel_hi:[0,1,1]
    v_lshlrev_b32 v152, 16, v86
    v_and_b32 v153, 0xffff0000, v86
    v_pk_mul_f32 v[154:155], v[152:153], v[116:117]
    v_pk_mul_f32 v[152:153], v[102:103], v[152:153] op_sel:[1,0]
    v_cvt_pk_bf16_f32 v154, v154, v155
    v_cvt_pk_bf16_f32 v152, v152, v153
    v_and_b32 v155, 0xffff0000, v154
    v_lshlrev_b32 v154, 16, v154
    v_and_b32 v153, 0xffff0000, v152
    v_lshlrev_b32 v152, 16, v152
    v_pk_fma_f32 v[124:125], v[102:103], v[154:155], v[152:153] op_sel_hi:[0,1,1]
    v_lshlrev_b32 v152, 16, v87
    v_and_b32 v153, 0xffff0000, v87
    v_pk_mul_f32 v[154:155], v[152:153], v[118:119]
    v_pk_mul_f32 v[152:153], v[102:103], v[152:153] op_sel:[1,0]
    v_cvt_pk_bf16_f32 v154, v154, v155
    v_cvt_pk_bf16_f32 v152, v152, v153
    v_and_b32 v155, 0xffff0000, v154
    v_lshlrev_b32 v154, 16, v154
    v_and_b32 v153, 0xffff0000, v152
    v_lshlrev_b32 v152, 16, v152
    v_pk_fma_f32 v[126:127], v[102:103], v[154:155], v[152:153] op_sel_hi:[0,1,1]
    s_waitcnt vmcnt(8)
    s_barrier
    s_add_u32 m0, s60, 16384
    s_nop 0
    buffer_load_dwordx4 v14, s[8:11], s61 offen offset:0 lds
    buffer_load_dwordx4 v15, s[8:11], s61 offen offset:1024 lds
    buffer_load_dwordx4 v16, s[8:11], s61 offen offset:2048 lds
    buffer_load_dwordx4 v17, s[8:11], s61 offen offset:3072 lds
    s_add_u32 s61, s61, 128
    s_and_b32 s61, s61, 2047
    buffer_load_dwordx4 v[52:55], v18, s[16:19], s72 offen offset:0 sc1
    buffer_load_dwordx4 v[56:59], v13, s[16:19], s72 offen offset:1024 sc1
    v_lshlrev_b32 v152, 16, v88
    v_and_b32 v153, 0xffff0000, v88
    v_pk_mul_f32 v[154:155], v[152:153], v[116:117]
    v_pk_mul_f32 v[152:153], v[104:105], v[152:153] op_sel:[1,0]
    v_cvt_pk_bf16_f32 v154, v154, v155
    v_cvt_pk_bf16_f32 v152, v152, v153
    v_and_b32 v155, 0xffff0000, v154
    v_lshlrev_b32 v154, 16, v154
    v_and_b32 v153, 0xffff0000, v152
    v_lshlrev_b32 v152, 16, v152
    v_pk_fma_f32 v[128:129], v[104:105], v[154:155], v[152:153] op_sel_hi:[0,1,1]
    v_lshlrev_b32 v152, 16, v89
    v_and_b32 v153, 0xffff0000, v89
    v_pk_mul_f32 v[154:155], v[152:153], v[118:119]
    v_pk_mul_f32 v[152:153], v[104:105], v[152:153] op_sel:[1,0]
    v_cvt_pk_bf16_f32 v154, v154, v155
    v_cvt_pk_bf16_f32 v152, v152, v153
    v_and_b32 v155, 0xffff0000, v154
    v_lshlrev_b32 v154, 16, v154
    v_and_b32 v153, 0xffff0000, v152
    v_lshlrev_b32 v152, 16, v152
    v_pk_fma_f32 v[130:131], v[104:105], v[154:155], v[152:153] op_sel_hi:[0,1,1]
    s_waitcnt vmcnt(10)
    s_barrier
    s_add_u32 m0, s60, 32768
    s_nop 0
    buffer_load_dwordx4 v14, s[8:11], s61 offen offset:0 lds
    buffer_load_dwordx4 v15, s[8:11], s61 offen offset:1024 lds
    buffer_load_dwordx4 v16, s[8:11], s61 offen offset:2048 lds
    buffer_load_dwordx4 v17, s[8:11], s61 offen offset:3072 lds
    s_add_u32 s61, s61, 128
    s_and_b32 s61, s61, 2047
    v_lshlrev_b32 v152, 16, v90
    v_and_b32 v153, 0xffff0000, v90
    v_pk_mul_f32 v[154:155], v[152:153], v[116:117]
    v_pk_mul_f32 v[152:153], v[106:107], v[152:153] op_sel:[1,0]
    v_cvt_pk_bf16_f32 v154, v154, v155
    v_cvt_pk_bf16_f32 v152, v152, v153
    v_and_b32 v155, 0xffff0000, v154
    v_lshlrev_b32 v154, 16, v154
    v_and_b32 v153, 0xffff0000, v152
    v_lshlrev_b32 v152, 16, v152
    v_pk_fma_f32 v[132:133], v[106:107], v[154:155], v[152:153] op_sel_hi:[0,1,1]
    v_lshlrev_b32 v152, 16, v91
    v_and_b32 v153, 0xffff0000, v91
    v_pk_mul_f32 v[154:155], v[152:153], v[118:119]
    v_pk_mul_f32 v[152:153], v[106:107], v[152:153] op_sel:[1,0]
    v_cvt_pk_bf16_f32 v154, v154, v155
    v_cvt_pk_bf16_f32 v152, v152, v153
    v_and_b32 v155, 0xffff0000, v154
    v_lshlrev_b32 v154, 16, v154
    v_and_b32 v153, 0xffff0000, v152
    v_lshlrev_b32 v152, 16, v152
    v_pk_fma_f32 v[134:135], v[106:107], v[154:155], v[152:153] op_sel_hi:[0,1,1]
    v_lshlrev_b32 v152, 16, v92
    v_and_b32 v153, 0xffff0000, v92
    v_pk_mul_f32 v[154:155], v[152:153], v[116:117]
    v_pk_mul_f32 v[152:153], v[108:109], v[152:153] op_sel:[1,0]
    v_cvt_pk_bf16_f32 v154, v154, v155
    v_cvt_pk_bf16_f32 v152, v152, v153
    v_and_b32 v155, 0xffff0000, v154
    v_lshlrev_b32 v154, 16, v154
    v_and_b32 v153, 0xffff0000, v152
    v_lshlrev_b32 v152, 16, v152
    v_pk_fma_f32 v[136:137], v[108:109], v[154:155], v[152:153] op_sel_hi:[0,1,1]
    v_lshlrev_b32 v152, 16, v93
    v_and_b32 v153, 0xffff0000, v93
    v_pk_mul_f32 v[154:155], v[152:153], v[118:119]
    v_pk_mul_f32 v[152:153], v[108:109], v[152:153] op_sel:[1,0]
    v_cvt_pk_bf16_f32 v154, v154, v155
    v_cvt_pk_bf16_f32 v152, v152, v153
    v_and_b32 v155, 0xffff0000, v154
    v_lshlrev_b32 v154, 16, v154
    v_and_b32 v153, 0xffff0000, v152
    v_lshlrev_b32 v152, 16, v152
    v_pk_fma_f32 v[138:139], v[108:109], v[154:155], v[152:153] op_sel_hi:[0,1,1]
    s_waitcnt vmcnt(10)
    s_barrier
    s_add_u32 m0, s60, 49152
    s_nop 0
    buffer_load_dwordx4 v14, s[8:11], s61 offen offset:0 lds
    buffer_load_dwordx4 v15, s[8:11], s61 offen offset:1024 lds
    buffer_load_dwordx4 v16, s[8:11], s61 offen offset:2048 lds
    buffer_load_dwordx4 v17, s[8:11], s61 offen offset:3072 lds
    s_add_u32 s61, s61, 128
    s_and_b32 s61, s61, 2047
    v_lshlrev_b32 v152, 16, v94
    v_and_b32 v153, 0xffff0000, v94
    v_pk_mul_f32 v[154:155], v[152:153], v[116:117]
    v_pk_mul_f32 v[152:153], v[110:111], v[152:153] op_sel:[1,0]
    v_cvt_pk_bf16_f32 v154, v154, v155
    v_cvt_pk_bf16_f32 v152, v152, v153
    v_and_b32 v155, 0xffff0000, v154
    v_lshlrev_b32 v154, 16, v154
    v_and_b32 v153, 0xffff0000, v152
    v_lshlrev_b32 v152, 16, v152
    v_pk_fma_f32 v[140:141], v[110:111], v[154:155], v[152:153] op_sel_hi:[0,1,1]
    v_lshlrev_b32 v152, 16, v95
    v_and_b32 v153, 0xffff0000, v95
    v_pk_mul_f32 v[154:155], v[152:153], v[118:119]
    v_pk_mul_f32 v[152:153], v[110:111], v[152:153] op_sel:[1,0]
    v_cvt_pk_bf16_f32 v154, v154, v155
    v_cvt_pk_bf16_f32 v152, v152, v153
    v_and_b32 v155, 0xffff0000, v154
    v_lshlrev_b32 v154, 16, v154
    v_and_b32 v153, 0xffff0000, v152
    v_lshlrev_b32 v152, 16, v152
    v_pk_fma_f32 v[142:143], v[110:111], v[154:155], v[152:153] op_sel_hi:[0,1,1]
    s_waitcnt vmcnt(8)
    v_mov_b32 v152, s65
    v_mov_b32 v153, s65
    s_mov_b32 s68, 32768
L_actpoll:
    v_cmp_ne_u64 vcc, v[54:55], v[152:153]
    v_cmp_ne_u64 s[66:67], v[58:59], v[152:153]
    s_and_b32 s67, s67, 0xffff
    s_or_b64 vcc, vcc, s[66:67]
    s_cbranch_vccz L_actok
    s_sub_u32 s68, s68, 1
    s_cbranch_scc1 L_actok
    buffer_load_dwordx4 v[52:55], v18, s[16:19], s72 offen offset:0 sc1
    buffer_load_dwordx4 v[56:59], v13, s[16:19], s72 offen offset:1024 sc1
    s_waitcnt vmcnt(0)
    s_branch L_actpoll
L_actok:
    s_mul_i32 s33, s30, 112
    v_add_u32 v8, s33, v1
    v_bfe_u32 v152, v8, 4, 1
    v_mul_u32_u24 v152, 1856, v152
    v_and_b32 v153, 15, v8
    v_lshl_add_u32 v152, v153, 1, v152
    v_and_b32 v8, 0x1e0, v8
    v_add_u32 v8, v8, v152
    v_add_u32 v8, 152576, v8
    ds_write_b16 v8, v52 offset:0
    ds_write_b16_d16_hi v8, v52 offset:464
    ds_write_b16 v8, v53 offset:928
    ds_write_b16_d16_hi v8, v53 offset:1392
    s_mov_b32 exec_hi, 0xffff
    ds_write_b16 v8, v56 offset:64
    ds_write_b16_d16_hi v8, v56 offset:528
    ds_write_b16 v8, v57 offset:992
    ds_write_b16_d16_hi v8, v57 offset:1456
    s_mov_b32 exec_hi, -1
    s_waitcnt lgkmcnt(0)
    s_barrier
    s_add_u32 m0, s60, 0
    s_nop 0
    buffer_load_dwordx4 v14, s[8:11], s61 offen offset:0 lds
    buffer_load_dwordx4 v15, s[8:11], s61 offen offset:1024 lds
    buffer_load_dwordx4 v16, s[8:11], s61 offen offset:2048 lds
    buffer_load_dwordx4 v17, s[8:11], s61 offen offset:3072 lds
    s_add_u32 s61, s61, 128
    s_and_b32 s61, s61, 2047
    v_mul_u32_u24 v8, 464, v4
    v_lshl_add_u32 v8, v6, 4, v8
    v_add_u32 v8, 152576, v8
    s_lshl_b32 s33, s30, 5
    v_add_u32 v5, s33, v5
    ds_read_b128 v[48:51], v8 offset:0
    ds_read_b64_tr_b16 v[20:21], v5 offset:32768
    ds_read_b64_tr_b16 v[22:23], v5 offset:33280
    ds_read_b128 v[52:55], v8 offset:64
    ds_read_b64_tr_b16 v[24:25], v5 offset:36864
    ds_read_b64_tr_b16 v[26:27], v5 offset:37376
    ds_read_b128 v[56:59], v8 offset:128
    ds_read_b64_tr_b16 v[28:29], v5 offset:40960
    ds_read_b64_tr_b16 v[30:31], v5 offset:41472
    ds_read_b128 v[60:63], v8 offset:192
    ds_read_b64_tr_b16 v[32:33], v5 offset:45056
    ds_read_b64_tr_b16 v[34:35], v5 offset:45568
    ds_read_b128 v[64:67], v8 offset:256
    ds_read_b64_tr_b16 v[36:37], v5 offset:49152
    ds_read_b64_tr_b16 v[38:39], v5 offset:49664
    ds_read_b128 v[68:71], v8 offset:320
    ds_read_b64_tr_b16 v[40:41], v5 offset:53248
    ds_read_b64_tr_b16 v[42:43], v5 offset:53760
    ds_read_b128 v[72:75], v8 offset:384
    ds_read_b64_tr_b16 v[44:45], v5 offset:57344
    ds_read_b64_tr_b16 v[46:47], v5 offset:57856
    s_waitcnt lgkmcnt(15)
    v_mfma_f32_16x16x32_bf16 v[76:79], v[48:51], v[20:23], 0
    s_waitcnt lgkmcnt(15)
    v_mfma_f32_16x16x32_bf16 v[76:79], v[52:55], v[24:27], v[76:79]
    s_waitcnt lgkmcnt(12)
    v_mfma_f32_16x16x32_bf16 v[76:79], v[56:59], v[28:31], v[76:79]
    s_waitcnt lgkmcnt(9)
    v_mfma_f32_16x16x32_bf16 v[76:79], v[60:63], v[32:35], v[76:79]
    s_waitcnt lgkmcnt(6)
    v_mfma_f32_16x16x32_bf16 v[76:79], v[64:67], v[36:39], v[76:79]
    s_waitcnt lgkmcnt(3)
    v_mfma_f32_16x16x32_bf16 v[76:79], v[68:71], v[40:43], v[76:79]
    s_waitcnt lgkmcnt(0)
    v_mfma_f32_16x16x32_bf16 v[76:79], v[72:75], v[44:47], v[76:79]
    v_and_b32 v8, 1, v6
    v_lshlrev_b32 v8, 1, v8
    v_lshrrev_b32 v20, 1, v6
    v_add_u32 v8, v8, v20
    v_lshlrev_b32 v8, 18, v8
    v_lshl_add_u32 v8, v7, 3, v8
    s_lshl_b32 s33, s27, 13
    s_lshl_b32 s34, s26, 9
    s_add_u32 s33, s33, s34
    s_lshl_b32 s34, s30, 7
    s_add_u32 s33, s33, s34
    s_add_u32 s33, s33, 2621440
    s_add_u32 s34, s33, 131072
    v_mov_b32 v21, s65
    v_mov_b32 v23, s65
    v_mov_b32 v20, v76
    v_mov_b32 v22, v77
    s_mov_b32 exec_lo, 0
    v_mov_b32 v20, v78
    v_mov_b32 v22, v79
    s_mov_b32 exec_lo, -1
    buffer_store_dwordx2 v[20:21], v8, s[16:19], s33 offen sc1
    buffer_store_dwordx2 v[22:23], v8, s[16:19], s34 offen sc1
    s_waitcnt vmcnt(10)
    s_barrier
    s_add_u32 m0, s60, 16384
    s_nop 0
    buffer_load_dwordx4 v14, s[8:11], s61 offen offset:0 lds
    buffer_load_dwordx4 v15, s[8:11], s61 offen offset:1024 lds
    buffer_load_dwordx4 v16, s[8:11], s61 offen offset:2048 lds
    buffer_load_dwordx4 v17, s[8:11], s61 offen offset:3072 lds
    s_add_u32 s61, s61, 128
    s_and_b32 s61, s61, 2047
    v_lshlrev_b32 v152, 16, v96
    v_and_b32 v153, 0xffff0000, v96
    v_pk_mul_f32 v[154:155], v[152:153], v[116:117]
    v_pk_mul_f32 v[152:153], v[112:113], v[152:153] op_sel:[1,0]
    v_cvt_pk_bf16_f32 v154, v154, v155
    v_cvt_pk_bf16_f32 v152, v152, v153
    v_and_b32 v155, 0xffff0000, v154
    v_lshlrev_b32 v154, 16, v154
    v_and_b32 v153, 0xffff0000, v152
    v_lshlrev_b32 v152, 16, v152
    v_pk_fma_f32 v[144:145], v[112:113], v[154:155], v[152:153] op_sel_hi:[0,1,1]
    v_lshlrev_b32 v152, 16, v97
    v_and_b32 v153, 0xffff0000, v97
    v_pk_mul_f32 v[154:155], v[152:153], v[118:119]
    v_pk_mul_f32 v[152:153], v[112:113], v[152:153] op_sel:[1,0]
    v_cvt_pk_bf16_f32 v154, v154, v155
    v_cvt_pk_bf16_f32 v152, v152, v153
    v_and_b32 v155, 0xffff0000, v154
    v_lshlrev_b32 v154, 16, v154
    v_and_b32 v153, 0xffff0000, v152
    v_lshlrev_b32 v152, 16, v152
    v_pk_fma_f32 v[146:147], v[112:113], v[154:155], v[152:153] op_sel_hi:[0,1,1]
    v_subrev_u32 v8, s49, v178
    v_lshlrev_b32 v152, v8, 1
    v_cmp_gt_u32 vcc, 32, v8
    s_nop 1
    v_cndmask_b32 v152, 0, v152, vcc
    s_nop 1
    v_or_b32_dpp v152, v152, v152 row_shr:1 row_mask:0xf bank_mask:0xf
    s_nop 1
    v_or_b32_dpp v152, v152, v152 row_shr:2 row_mask:0xf bank_mask:0xf
    s_nop 1
    v_or_b32_dpp v152, v152, v152 row_shr:4 row_mask:0xf bank_mask:0xf
    v_lshlrev_b32 v8, v6, 1
    v_readlane_b32 s33, v152, 7
    s_lshr_b32 s34, s33, 0
    v_and_b32 v170, s34, v8
    s_lshr_b32 s34, s33, 4
    v_and_b32 v171, s34, v8
    s_lshr_b32 s34, s33, 8
    v_and_b32 v172, s34, v8
    s_lshr_b32 s34, s33, 12
    v_and_b32 v173, s34, v8
    s_lshr_b32 s34, s33, 16
    v_and_b32 v174, s34, v8
    s_lshr_b32 s34, s33, 20
    v_and_b32 v175, s34, v8
    s_lshr_b32 s34, s33, 24
    v_and_b32 v176, s34, v8
    s_lshr_b32 s34, s33, 28
    v_and_b32 v177, s34, v8
    s_waitcnt vmcnt(10)
    s_barrier
    s_add_u32 m0, s60, 32768
    s_nop 0
    buffer_load_dwordx4 v14, s[8:11], s61 offen offset:0 lds
    buffer_load_dwordx4 v15, s[8:11], s61 offen offset:1024 lds
    buffer_load_dwordx4 v16, s[8:11], s61 offen offset:2048 lds
    buffer_load_dwordx4 v17, s[8:11], s61 offen offset:3072 lds
    s_add_u32 s61, s61, 128
    s_and_b32 s61, s61, 2047
    s_add_u32 s33, s30, 4
    v_readlane_b32 s66, v178, s30
    v_readlane_b32 s67, v179, s30
    v_readlane_b32 s68, v178, s33
    v_readlane_b32 s69, v179, s33
    v_mov_b32 v10, s66
    v_mov_b32 v168, s67
    s_mov_b32 exec_lo, 0
    v_mov_b32 v10, s68
    v_mov_b32 v168, s69
    s_mov_b32 exec_lo, -1
    v_subrev_u32 v3, s48, v10
    v_cmp_gt_u32 vcc, 0x80, v3
    v_lshrrev_b32 v11, 5, v1
    v_lshlrev_b32 v11, 19, v11
    v_and_b32 v13, 1, v6
    v_lshl_add_u32 v11, v13, 12, v11
    v_lshl_add_u32 v11, v7, 5, v11
    s_mov_b64 s[52:53], vcc
    v_cndmask_b32 v11, v2, v11, vcc
    v_lshl_add_u32 v13, v10, 11, v12
    v_cndmask_b32 v13, v2, v13, vcc
    v_lshlrev_b32 v12, 3, v10
    v_cndmask_b32 v12, v2, v12, vcc
    v_mov_b32 v9, s65
    v_cndmask_b32 v9, 0, v9, vcc
    s_lshl_b32 s54, s30, 17
    s_lshl_b32 s66, s27, 13
    s_add_u32 s54, s54, s66
    s_add_u32 s54, s54, 2621440
    s_mov_b32 s66, 8192
    s_waitcnt vmcnt(10)
    s_barrier
    s_add_u32 m0, s60, 49152
    s_nop 0
    buffer_load_dwordx4 v14, s[8:11], s61 offen offset:0 lds
    buffer_load_dwordx4 v15, s[8:11], s61 offen offset:1024 lds
    buffer_load_dwordx4 v16, s[8:11], s61 offen offset:2048 lds
    buffer_load_dwordx4 v17, s[8:11], s61 offen offset:3072 lds
    v_lshlrev_b32 v152, 16, v98
    v_and_b32 v153, 0xffff0000, v98
    v_pk_mul_f32 v[154:155], v[152:153], v[116:117]
    v_pk_mul_f32 v[152:153], v[114:115], v[152:153] op_sel:[1,0]
    v_cvt_pk_bf16_f32 v154, v154, v155
    v_cvt_pk_bf16_f32 v152, v152, v153
    v_and_b32 v155, 0xffff0000, v154
    v_lshlrev_b32 v154, 16, v154
    v_and_b32 v153, 0xffff0000, v152
    v_lshlrev_b32 v152, 16, v152
    v_pk_fma_f32 v[148:149], v[114:115], v[154:155], v[152:153] op_sel_hi:[0,1,1]
    v_lshlrev_b32 v152, 16, v99
    v_and_b32 v153, 0xffff0000, v99
    v_pk_mul_f32 v[154:155], v[152:153], v[118:119]
    v_pk_mul_f32 v[152:153], v[114:115], v[152:153] op_sel:[1,0]
    v_cvt_pk_bf16_f32 v154, v154, v155
    v_cvt_pk_bf16_f32 v152, v152, v153
    v_and_b32 v155, 0xffff0000, v154
    v_lshlrev_b32 v154, 16, v154
    v_and_b32 v153, 0xffff0000, v152
    v_lshlrev_b32 v152, 16, v152
    v_pk_fma_f32 v[150:151], v[114:115], v[154:155], v[152:153] op_sel_hi:[0,1,1]
    s_waitcnt vmcnt(8)
    s_barrier
    s_cmp_eq_u64 s[52:53], 0
    s_cbranch_scc1 L_noy
    buffer_load_dwordx4 v[20:23], v11, s[16:19], s54 offen offset:0 sc1
    buffer_load_dwordx4 v[24:27], v11, s[16:19], s54 offen offset:16 sc1
    buffer_load_dwordx4 v[28:31], v11, s[16:19], s54 offen offset:512 sc1
    buffer_load_dwordx4 v[32:35], v11, s[16:19], s54 offen offset:528 sc1
    buffer_load_dwordx4 v[36:39], v11, s[16:19], s54 offen offset:1024 sc1
    buffer_load_dwordx4 v[40:43], v11, s[16:19], s54 offen offset:1040 sc1
    buffer_load_dwordx4 v[44:47], v11, s[16:19], s54 offen offset:1536 sc1
    buffer_load_dwordx4 v[48:51], v11, s[16:19], s54 offen offset:1552 sc1
    buffer_load_dwordx4 v[52:55], v11, s[16:19], s54 offen offset:2048 sc1
    buffer_load_dwordx4 v[56:59], v11, s[16:19], s54 offen offset:2064 sc1
    buffer_load_dwordx4 v[60:63], v11, s[16:19], s54 offen offset:2560 sc1
    buffer_load_dwordx4 v[64:67], v11, s[16:19], s54 offen offset:2576 sc1
    buffer_load_dwordx4 v[68:71], v11, s[16:19], s54 offen offset:3072 sc1
    buffer_load_dwordx4 v[72:75], v11, s[16:19], s54 offen offset:3088 sc1
    buffer_load_dwordx4 v[76:79], v11, s[16:19], s54 offen offset:3584 sc1
    buffer_load_dwordx4 v[80:83], v11, s[16:19], s54 offen offset:3600 sc1
    buffer_load_dwordx2 v[160:161], v13, s[56:59], s55 offen
    buffer_load_dword v162, v12, s[16:19], s66 offen sc1
    s_waitcnt vmcnt(22)
    s_barrier
    s_waitcnt vmcnt(18)
    s_barrier
    s_branch L_yjoin
L_noy:
    s_waitcnt vmcnt(4)
    s_barrier
    s_waitcnt vmcnt(0)
    s_barrier
L_yjoin:
    v_lshlrev_b32 v14, 4, v7
    v_lshl_add_u32 v15, v10, 12, v14
    v_lshl_add_u32 v14, v6, 12, v14
    v_xor_b32 v16, v7, v6
    v_lshlrev_b32 v16, 4, v16
    v_lshl_add_u32 v16, v6, 8, v16
    s_lshl_b32 s33, s30, 13
    s_add_u32 s33, s33, 0
    v_add_u32 v16, s33, v16
    v_xor_b32 v17, 64, v16
    v_and_b32 v8, 7, v3
    v_xor_b32 v8, v8, v7
    v_lshlrev_b32 v8, 4, v8
    v_and_b32 v5, 0x7f, v3
    v_lshl_add_u32 v8, v5, 8, v8
    s_lshl_b32 s67, s27, 8
    s_lshl_b32 s69, s49, 12
    s_add_u32 s69, s69, s67
    s_cmp_eq_u64 s[52:53], 0
    s_cbranch_scc1 L_notok
    s_mov_b32 s68, 32768
L_ypoll:
    s_waitcnt vmcnt(0)
    v_xor_b32 v152, v9, v21
    v_xor_b32 v153, v9, v23
    v_or_b32 v152, v152, v153
    v_xor_b32 v153, v9, v25
    v_or_b32 v152, v152, v153
    v_xor_b32 v153, v9, v27
    v_or_b32 v152, v152, v153
    v_xor_b32 v153, v9, v29
    v_or_b32 v152, v152, v153
    v_xor_b32 v153, v9, v31
    v_or_b32 v152, v152, v153
    v_xor_b32 v153, v9, v33
    v_or_b32 v152, v152, v153
    v_xor_b32 v153, v9, v35
    v_or_b32 v152, v152, v153
    v_xor_b32 v153, v9, v37
    v_or_b32 v152, v152, v153
    v_xor_b32 v153, v9, v39
    v_or_b32 v152, v152, v153
    v_xor_b32 v153, v9, v41
    v_or_b32 v152, v152, v153
    v_xor_b32 v153, v9, v43
    v_or_b32 v152, v152, v153
    v_xor_b32 v153, v9, v45
    v_or_b32 v152, v152, v153
    v_xor_b32 v153, v9, v47
    v_or_b32 v152, v152, v153
    v_xor_b32 v153, v9, v49
    v_or_b32 v152, v152, v153
    v_xor_b32 v153, v9, v51
    v_or_b32 v152, v152, v153
    v_xor_b32 v153, v9, v53
    v_or_b32 v152, v152, v153
    v_xor_b32 v153, v9, v55
    v_or_b32 v152, v152, v153
    v_xor_b32 v153, v9, v57
    v_or_b32 v152, v152, v153
    v_xor_b32 v153, v9, v59
    v_or_b32 v152, v152, v153
    v_xor_b32 v153, v9, v61
    v_or_b32 v152, v152, v153
    v_xor_b32 v153, v9, v63
    v_or_b32 v152, v152, v153
    v_xor_b32 v153, v9, v65
    v_or_b32 v152, v152, v153
    v_xor_b32 v153, v9, v67
    v_or_b32 v152, v152, v153
    v_xor_b32 v153, v9, v69
    v_or_b32 v152, v152, v153
    v_xor_b32 v153, v9, v71
    v_or_b32 v152, v152, v153
    v_xor_b32 v153, v9, v73
    v_or_b32 v152, v152, v153
    v_xor_b32 v153, v9, v75
    v_or_b32 v152, v152, v153
    v_xor_b32 v153, v9, v77
    v_or_b32 v152, v152, v153
    v_xor_b32 v153, v9, v79
    v_or_b32 v152, v152, v153
    v_xor_b32 v153, v9, v81
    v_or_b32 v152, v152, v153
    v_xor_b32 v153, v9, v83
    v_or_b32 v152, v152, v153
    v_cmp_ne_u32 vcc, 0, v152
    s_cbranch_vccz L_yok
    s_sub_u32 s68, s68, 1
    s_cbranch_scc1 L_yok
    buffer_load_dwordx4 v[20:23], v11, s[16:19], s54 offen offset:0 sc1
    buffer_load_dwordx4 v[24:27], v11, s[16:19], s54 offen offset:16 sc1
    buffer_load_dwordx4 v[28:31], v11, s[16:19], s54 offen offset:512 sc1
    buffer_load_dwordx4 v[32:35], v11, s[16:19], s54 offen offset:528 sc1
    buffer_load_dwordx4 v[36:39], v11, s[16:19], s54 offen offset:1024 sc1
    buffer_load_dwordx4 v[40:43], v11, s[16:19], s54 offen offset:1040 sc1
    buffer_load_dwordx4 v[44:47], v11, s[16:19], s54 offen offset:1536 sc1
    buffer_load_dwordx4 v[48:51], v11, s[16:19], s54 offen offset:1552 sc1
    buffer_load_dwordx4 v[52:55], v11, s[16:19], s54 offen offset:2048 sc1
    buffer_load_dwordx4 v[56:59], v11, s[16:19], s54 offen offset:2064 sc1
    buffer_load_dwordx4 v[60:63], v11, s[16:19], s54 offen offset:2560 sc1
    buffer_load_dwordx4 v[64:67], v11, s[16:19], s54 offen offset:2576 sc1
    buffer_load_dwordx4 v[68:71], v11, s[16:19], s54 offen offset:3072 sc1
    buffer_load_dwordx4 v[72:75], v11, s[16:19], s54 offen offset:3088 sc1
    buffer_load_dwordx4 v[76:79], v11, s[16:19], s54 offen offset:3584 sc1
    buffer_load_dwordx4 v[80:83], v11, s[16:19], s54 offen offset:3600 sc1
    s_branch L_ypoll
L_yok:
    v_add_f32 v20, v20, v28
    v_add_f32 v22, v22, v30
    v_add_f32 v24, v24, v32
    v_add_f32 v26, v26, v34
    v_add_f32 v20, v20, v36
    v_add_f32 v22, v22, v38
    v_add_f32 v24, v24, v40
    v_add_f32 v26, v26, v42
    v_add_f32 v20, v20, v44
    v_add_f32 v22, v22, v46
    v_add_f32 v24, v24, v48
    v_add_f32 v26, v26, v50
    v_add_f32 v20, v20, v52
    v_add_f32 v22, v22, v54
    v_add_f32 v24, v24, v56
    v_add_f32 v26, v26, v58
    v_add_f32 v20, v20, v60
    v_add_f32 v22, v22, v62
    v_add_f32 v24, v24, v64
    v_add_f32 v26, v26, v66
    v_add_f32 v20, v20, v68
    v_add_f32 v22, v22, v70
    v_add_f32 v24, v24, v72
    v_add_f32 v26, v26, v74
    v_add_f32 v20, v20, v76
    v_add_f32 v22, v22, v78
    v_add_f32 v24, v24, v80
    v_add_f32 v26, v26, v82
    v_mov_b32 v21, v20
    v_mov_b32 v23, v22
    v_mov_b32 v25, v24
    v_mov_b32 v27, v26
    v_permlane16_swap_b32 v20, v21
    v_permlane16_swap_b32 v22, v23
    v_permlane16_swap_b32 v24, v25
    v_permlane16_swap_b32 v26, v27
    v_add_f32 v28, v20, v21
    v_add_f32 v29, v22, v23
    v_add_f32 v30, v24, v25
    v_add_f32 v31, v26, v27
    v_and_b32 v163, 0xffff0000, v162
    v_lshlrev_b32 v162, 16, v162
    v_cvt_pk_bf16_f32 v28, v28, v29
    v_and_b32 v29, 0xffff0000, v28
    v_lshlrev_b32 v28, 16, v28
    v_mul_f32 v28, v28, v168
    v_mul_f32 v29, v29, v168
    v_cvt_pk_bf16_f32 v28, v28, v29
    v_and_b32 v29, 0xffff0000, v28
    v_lshlrev_b32 v28, 16, v28
    v_lshlrev_b32 v152, 16, v160
    v_and_b32 v153, 0xffff0000, v160
    v_pk_add_f32 v[28:29], v[28:29], v[152:153]
    v_cvt_pk_bf16_f32 v28, v28, v29
    v_and_b32 v29, 0xffff0000, v28
    v_lshlrev_b32 v28, 16, v28
    v_cvt_pk_bf16_f32 v30, v30, v31
    v_and_b32 v31, 0xffff0000, v30
    v_lshlrev_b32 v30, 16, v30
    v_mul_f32 v30, v30, v168
    v_mul_f32 v31, v31, v168
    v_cvt_pk_bf16_f32 v30, v30, v31
    v_and_b32 v31, 0xffff0000, v30
    v_lshlrev_b32 v30, 16, v30
    v_lshlrev_b32 v152, 16, v161
    v_and_b32 v153, 0xffff0000, v161
    v_pk_add_f32 v[30:31], v[30:31], v[152:153]
    v_cvt_pk_bf16_f32 v30, v30, v31
    v_and_b32 v31, 0xffff0000, v30
    v_lshlrev_b32 v30, 16, v30
    v_lshlrev_b32 v152, 16, v160
    v_and_b32 v153, 0xffff0000, v160
    v_pk_mul_f32 v[154:155], v[152:153], v[116:117]
    v_pk_mul_f32 v[152:153], v[162:163], v[28:29] op_sel:[1,0]
    v_cvt_pk_bf16_f32 v154, v154, v155
    v_cvt_pk_bf16_f32 v152, v152, v153
    v_and_b32 v155, 0xffff0000, v154
    v_lshlrev_b32 v154, 16, v154
    v_and_b32 v153, 0xffff0000, v152
    v_lshlrev_b32 v152, 16, v152
    v_pk_fma_f32 v[164:165], v[162:163], v[154:155], v[152:153] op_sel_hi:[0,1,1]
    v_lshlrev_b32 v152, 16, v161
    v_and_b32 v153, 0xffff0000, v161
    v_pk_mul_f32 v[154:155], v[152:153], v[118:119]
    v_pk_mul_f32 v[152:153], v[162:163], v[30:31] op_sel:[1,0]
    v_cvt_pk_bf16_f32 v154, v154, v155
    v_cvt_pk_bf16_f32 v152, v152, v153
    v_and_b32 v155, 0xffff0000, v154
    v_lshlrev_b32 v154, 16, v154
    v_and_b32 v153, 0xffff0000, v152
    v_lshlrev_b32 v152, 16, v152
    v_pk_fma_f32 v[166:167], v[162:163], v[154:155], v[152:153] op_sel_hi:[0,1,1]
L_notok:
    s_barrier
    ds_read_b128 v[20:23], v16 offset:0
    ds_read_b128 v[24:27], v17 offset:1024
    ds_read_b128 v[28:31], v16 offset:2048
    ds_read_b128 v[32:35], v17 offset:3072
    ds_read_b128 v[36:39], v16 offset:4096
    ds_read_b128 v[40:43], v17 offset:5120
    ds_read_b128 v[44:47], v16 offset:6144
    ds_read_b128 v[48:51], v17 offset:7168
    ds_read_b128 v[52:55], v8 offset:0
    v_cmp_eq_u32 vcc, 0, v170
    s_waitcnt lgkmcnt(8)
    v_pk_fma_f32 v[20:21], v[100:101], v[20:21], v[120:121] op_sel_hi:[0,1,1]
    v_pk_fma_f32 v[22:23], v[100:101], v[22:23], v[122:123] op_sel_hi:[0,1,1]
    s_mov_b64 exec, vcc
    buffer_store_dwordx4 v[20:23], v14, s[40:43], s69 offen nt
    s_mov_b64 exec, -1
    s_add_u32 s69, s69, 16384
    v_cmp_eq_u32 vcc, 0, v171
    s_waitcnt lgkmcnt(7)
    v_pk_fma_f32 v[24:25], v[102:103], v[24:25], v[124:125] op_sel_hi:[0,1,1]
    v_pk_fma_f32 v[26:27], v[102:103], v[26:27], v[126:127] op_sel_hi:[0,1,1]
    s_mov_b64 exec, vcc
    buffer_store_dwordx4 v[24:27], v14, s[40:43], s69 offen nt
    s_mov_b64 exec, -1
    s_add_u32 s69, s69, 16384
    v_cmp_eq_u32 vcc, 0, v172
    s_waitcnt lgkmcnt(6)
    v_pk_fma_f32 v[28:29], v[104:105], v[28:29], v[128:129] op_sel_hi:[0,1,1]
    v_pk_fma_f32 v[30:31], v[104:105], v[30:31], v[130:131] op_sel_hi:[0,1,1]
    s_mov_b64 exec, vcc
    buffer_store_dwordx4 v[28:31], v14, s[40:43], s69 offen nt
    s_mov_b64 exec, -1
    s_add_u32 s69, s69, 16384
    v_cmp_eq_u32 vcc, 0, v173
    s_waitcnt lgkmcnt(5)
    v_pk_fma_f32 v[32:33], v[106:107], v[32:33], v[132:133] op_sel_hi:[0,1,1]
    v_pk_fma_f32 v[34:35], v[106:107], v[34:35], v[134:135] op_sel_hi:[0,1,1]
    s_mov_b64 exec, vcc
    buffer_store_dwordx4 v[32:35], v14, s[40:43], s69 offen nt
    s_mov_b64 exec, -1
    s_add_u32 s69, s69, 16384
    v_cmp_eq_u32 vcc, 0, v174
    s_waitcnt lgkmcnt(4)
    v_pk_fma_f32 v[36:37], v[108:109], v[36:37], v[136:137] op_sel_hi:[0,1,1]
    v_pk_fma_f32 v[38:39], v[108:109], v[38:39], v[138:139] op_sel_hi:[0,1,1]
    s_mov_b64 exec, vcc
    buffer_store_dwordx4 v[36:39], v14, s[40:43], s69 offen nt
    s_mov_b64 exec, -1
    s_add_u32 s69, s69, 16384
    v_cmp_eq_u32 vcc, 0, v175
    s_waitcnt lgkmcnt(3)
    v_pk_fma_f32 v[40:41], v[110:111], v[40:41], v[140:141] op_sel_hi:[0,1,1]
    v_pk_fma_f32 v[42:43], v[110:111], v[42:43], v[142:143] op_sel_hi:[0,1,1]
    s_mov_b64 exec, vcc
    buffer_store_dwordx4 v[40:43], v14, s[40:43], s69 offen nt
    s_mov_b64 exec, -1
    s_add_u32 s69, s69, 16384
    v_cmp_eq_u32 vcc, 0, v176
    s_waitcnt lgkmcnt(2)
    v_pk_fma_f32 v[44:45], v[112:113], v[44:45], v[144:145] op_sel_hi:[0,1,1]
    v_pk_fma_f32 v[46:47], v[112:113], v[46:47], v[146:147] op_sel_hi:[0,1,1]
    s_mov_b64 exec, vcc
    buffer_store_dwordx4 v[44:47], v14, s[40:43], s69 offen nt
    s_mov_b64 exec, -1
    s_add_u32 s69, s69, 16384
    v_cmp_eq_u32 vcc, 0, v177
    s_waitcnt lgkmcnt(1)
    v_pk_fma_f32 v[48:49], v[114:115], v[48:49], v[148:149] op_sel_hi:[0,1,1]
    v_pk_fma_f32 v[50:51], v[114:115], v[50:51], v[150:151] op_sel_hi:[0,1,1]
    s_mov_b64 exec, vcc
    buffer_store_dwordx4 v[48:51], v14, s[40:43], s69 offen nt
    s_mov_b64 exec, -1
    s_add_u32 s69, s69, 16384
    s_waitcnt lgkmcnt(0)
    v_pk_fma_f32 v[52:53], v[162:163], v[52:53], v[164:165] op_sel_hi:[0,1,1]
    v_pk_fma_f32 v[54:55], v[162:163], v[54:55], v[166:167] op_sel_hi:[0,1,1]
    s_and_b32 exec_lo, s52, 0xffff
    s_and_b32 exec_hi, s53, 0xffff
    s_cbranch_execz L_aend
    buffer_store_dwordx4 v[52:55], v15, s[40:43], s67 offen nt
L_aend:
    s_endpgm
L_compute:
    s_load_dwordx2 s[64:65], s[0:1], 0
    s_load_dwordx2 s[68:69], s[0:1], 80
    s_load_dwordx2 s[72:73], s[0:1], 112
    s_load_dwordx2 s[8:9], s[0:1], 8
    s_load_dwordx2 s[12:13], s[0:1], 16
    s_load_dwordx2 s[16:17], s[0:1], 56
    s_load_dwordx2 s[20:21], s[0:1], 136
    s_lshr_b32 s30, s29, 1
    s_and_b32 s31, s29, 1
    v_and_b32 v6, 15, v1
    v_lshrrev_b32 v7, 4, v1
    s_lshl_b32 s32, s27, 6
    s_lshl_b32 s33, s31, 5
    s_add_u32 s32, s32, s33
    s_lshl_b32 s32, s32, 1
    v_lshlrev_b32 v8, 1, v6
    v_lshlrev_b32 v196, 4, v1
    s_lshl_b32 s46, s26, 7
    s_lshl_b32 s47, s27, 3
    s_add_u32 s46, s46, s47
    s_lshl_b32 s47, s29, 1
    s_add_u32 s46, s46, s47
    s_lshl_b32 s48, s46, 11
    s_mov_b32 s66, 4194304
    s_mov_b32 s67, 0x20000
    s_mov_b32 s10, 2048
    s_mov_b32 s11, 0x20000
    s_mov_b32 s14, 2048
    s_mov_b32 s15, 0x20000
    s_mov_b32 s18, 2048
    s_mov_b32 s19, 0x20000
    s_mov_b32 s70, 2048
    s_mov_b32 s71, 0x20000
    s_mov_b32 s74, 2048
    s_mov_b32 s75, 0x20000
    s_waitcnt lgkmcnt(0)
    s_load_dword s44, s[20:21], 0
    buffer_load_ushort v26, v8, s[16:19], s32 offen offset:0
    buffer_load_ushort v32, v8, s[8:11], s32 offen offset:0
    buffer_load_ushort v34, v8, s[12:15], s32 offen offset:0
    buffer_load_ushort v27, v8, s[16:19], s32 offen offset:32
    buffer_load_ushort v33, v8, s[8:11], s32 offen offset:32
    buffer_load_ushort v35, v8, s[12:15], s32 offen offset:32
    buffer_load_dwordx4 v[184:187], v196, s[72:75], 0 offen offset:0
    buffer_load_dwordx4 v[176:179], v196, s[68:71], 0 offen offset:0
    buffer_load_dwordx4 v[188:191], v196, s[72:75], 0 offen offset:1024
    buffer_load_dwordx4 v[180:183], v196, s[68:71], 0 offen offset:1024
    buffer_load_dwordx4 v[160:163], v196, s[64:67], s48 offen offset:0
    buffer_load_dwordx4 v[164:167], v196, s[64:67], s48 offen offset:1024
    buffer_load_dwordx4 v[168:171], v196, s[64:67], s48 offen offset:2048
    buffer_load_dwordx4 v[172:175], v196, s[64:67], s48 offen offset:3072
    s_getpc_b64 s[8:9]
Lc_pc:
    s_sub_u32 s8, s8, Lc_pc - gated_mix__ssm_conv_s5__moe_arch_mod__prompt_kernel
    s_subb_u32 s9, s9, 0
    s_mov_b32 s10, L_end - gated_mix__ssm_conv_s5__moe_arch_mod__prompt_kernel
    s_lshl_b32 s33, s25, 10
    s_cmp_lg_u32 s29, 0
    s_cbranch_scc1 Lc_nopf
    buffer_load_dwordx4 v[192:195], v196, s[8:11], s33 offen
Lc_nopf:
    v_lshrrev_b32 v8, 1, v6
    v_xor_b32 v8, v8, v7
    v_lshlrev_b32 v8, 4, v8
    v_lshl_add_u32 v8, v6, 7, v8
    s_lshl_b32 s33, s30, 13
    s_lshl_b32 s34, s31, 13
    s_add_u32 s34, s34, 16384
    v_add_u32 v2, s33, v8
    v_add_u32 v4, s34, v8
    v_xor_b32 v3, 64, v2
    v_xor_b32 v5, 64, v4
    s_lshl_b32 s33, s27, 14
    s_add_u32 s33, s33, 65536
    s_add_u32 s36, s20, s33
    s_addc_u32 s37, s21, 0
    s_mov_b32 s38, 16384
    s_mov_b32 s39, 0x20000
    s_add_u32 s33, s27, s26
    s_and_b32 s33, s33, 15
    s_lshl_b32 s33, s33, 2
    s_add_u32 s33, s33, s31
    s_lshl_b32 s33, s33, 3
    s_lshl_b32 s34, s26, 9
    s_add_u32 s33, s33, s34
    s_lshl_b32 s34, s30, 2
    s_add_u32 s33, s33, s34
    s_lshl_b32 s33, s33, 10
    s_add_u32 s33, s33, 4194304
    s_add_u32 s40, s20, s33
    s_addc_u32 s41, s21, 0
    s_mov_b32 s42, 20480
    s_mov_b32 s43, 0x20000
    v_mov_b32 v96, 0
    v_mov_b32 v97, 0
    v_mov_b32 v98, 0
    v_mov_b32 v99, 0
    v_mov_b32 v100, 0
    v_mov_b32 v101, 0
    v_mov_b32 v102, 0
    v_mov_b32 v103, 0
    v_mov_b32 v104, 0
    v_mov_b32 v105, 0
    v_mov_b32 v106, 0
    v_mov_b32 v107, 0
    v_mov_b32 v108, 0
    v_mov_b32 v109, 0
    v_mov_b32 v110, 0
    v_mov_b32 v111, 0
    v_mov_b32 v112, 0
    v_mov_b32 v113, 0
    v_mov_b32 v114, 0
    v_mov_b32 v115, 0
    v_mov_b32 v116, 0
    v_mov_b32 v117, 0
    v_mov_b32 v118, 0
    v_mov_b32 v119, 0
    v_mov_b32 v120, 0
    v_mov_b32 v121, 0
    v_mov_b32 v122, 0
    v_mov_b32 v123, 0
    v_mov_b32 v124, 0
    v_mov_b32 v125, 0
    v_mov_b32 v126, 0
    v_mov_b32 v127, 0
    v_mov_b32 v128, 0
    v_mov_b32 v129, 0
    v_mov_b32 v130, 0
    v_mov_b32 v131, 0
    v_mov_b32 v132, 0
    v_mov_b32 v133, 0
    v_mov_b32 v134, 0
    v_mov_b32 v135, 0
    v_mov_b32 v136, 0
    v_mov_b32 v137, 0
    v_mov_b32 v138, 0
    v_mov_b32 v139, 0
    v_mov_b32 v140, 0
    v_mov_b32 v141, 0
    v_mov_b32 v142, 0
    v_mov_b32 v143, 0
    v_mov_b32 v144, 0
    v_mov_b32 v145, 0
    v_mov_b32 v146, 0
    v_mov_b32 v147, 0
    v_mov_b32 v148, 0
    v_mov_b32 v149, 0
    v_mov_b32 v150, 0
    v_mov_b32 v151, 0
    v_mov_b32 v152, 0
    v_mov_b32 v153, 0
    v_mov_b32 v154, 0
    v_mov_b32 v155, 0
    v_mov_b32 v156, 0
    v_mov_b32 v157, 0
    v_mov_b32 v158, 0
    v_mov_b32 v159, 0
    s_waitcnt vmcnt(8)
    v_lshlrev_b32 v26, 16, v26
    v_lshlrev_b32 v32, 16, v32
    v_lshlrev_b32 v34, 16, v34
    v_mul_f32 v26, 0x3fb8aa3b, v26
    v_exp_f32 v26, v26
    v_lshlrev_b32 v27, 16, v27
    v_lshlrev_b32 v33, 16, v33
    v_lshlrev_b32 v35, 16, v35
    v_mul_f32 v27, 0x3fb8aa3b, v27
    v_exp_f32 v27, v27
    s_nop 0
    v_cvt_pk_bf16_f32 v26, v26, v27
    v_and_b32 v27, 0xffff0000, v26
    v_lshlrev_b32 v26, 16, v26
    v_pk_mul_f32 v[28:29], v[26:27], v[34:35]
    v_pk_mul_f32 v[26:27], v[26:27], v[32:33]
    v_mul_f32 v26, 0x3fb8aa3b, v26
    v_mul_f32 v28, 0x3e22f983, v28
    v_exp_f32 v26, v26
    v_rndne_f32 v10, v28
    v_sub_f32 v28, v28, v10
    v_cos_f32 v10, v28
    v_sin_f32 v12, v28
    v_mul_f32 v27, 0x3fb8aa3b, v27
    v_mul_f32 v29, 0x3e22f983, v29
    v_exp_f32 v27, v27
    v_rndne_f32 v11, v29
    v_sub_f32 v29, v29, v11
    v_cos_f32 v11, v29
    v_sin_f32 v13, v29
    v_pk_mul_f32 v[10:11], v[10:11], v[26:27]
    v_pk_mul_f32 v[12:13], v[12:13], v[26:27]
    v_pk_mul_f32 v[26:27], v[10:11], v[12:13]
    v_pk_mul_f32 v[14:15], v[10:11], v[10:11]
    v_pk_fma_f32 v[14:15], v[12:13], v[12:13], v[14:15] neg_lo:[1,0,0] neg_hi:[1,0,0]
    v_pk_add_f32 v[16:17], v[26:27], v[26:27]
    v_pk_mul_f32 v[26:27], v[14:15], v[16:17]
    v_pk_mul_f32 v[18:19], v[14:15], v[14:15]
    v_pk_fma_f32 v[18:19], v[16:17], v[16:17], v[18:19] neg_lo:[1,0,0] neg_hi:[1,0,0]
    v_pk_add_f32 v[20:21], v[26:27], v[26:27]
    v_pk_mul_f32 v[26:27], v[18:19], v[20:21]
    v_pk_mul_f32 v[14:15], v[18:19], v[18:19]
    v_pk_fma_f32 v[14:15], v[20:21], v[20:21], v[14:15] neg_lo:[1,0,0] neg_hi:[1,0,0]
    v_pk_add_f32 v[16:17], v[26:27], v[26:27]
    v_pk_mul_f32 v[26:27], v[14:15], v[16:17]
    v_pk_mul_f32 v[18:19], v[14:15], v[14:15]
    v_pk_fma_f32 v[18:19], v[16:17], v[16:17], v[18:19] neg_lo:[1,0,0] neg_hi:[1,0,0]
    v_pk_add_f32 v[20:21], v[26:27], v[26:27]
    s_lshl_b32 s33, s30, 2
    v_add_u32 v8, s33, v7
    v_and_b32 v9, 1, v8
    v_cmp_ne_u32 vcc, 0, v9
    s_nop 1
    v_cndmask_b32 v44, 1.0, v18, vcc
    v_cndmask_b32 v46, 0, v20, vcc
    v_cndmask_b32 v45, 1.0, v19, vcc
    v_cndmask_b32 v47, 0, v21, vcc
    v_pk_mul_f32 v[52:53], v[18:19], v[20:21]
    v_pk_mul_f32 v[36:37], v[18:19], v[18:19]
    v_pk_fma_f32 v[36:37], v[20:21], v[20:21], v[36:37] neg_lo:[1,0,0] neg_hi:[1,0,0]
    v_pk_add_f32 v[38:39], v[52:53], v[52:53]
    v_and_b32 v9, 2, v8
    v_cmp_ne_u32 vcc, 0, v9
    s_nop 1
    v_cndmask_b32 v22, 1.0, v36, vcc
    v_cndmask_b32 v24, 0, v38, vcc
    v_cndmask_b32 v23, 1.0, v37, vcc
    v_cndmask_b32 v25, 0, v39, vcc
    v_pk_mul_f32 v[240:241], v[44:45], v[22:23]
    v_pk_mul_f32 v[242:243], v[44:45], v[24:25]
    v_pk_fma_f32 v[240:241], v[46:47], v[24:25], v[240:241] neg_lo:[1,0,0] neg_hi:[1,0,0]
    v_pk_fma_f32 v[242:243], v[46:47], v[22:23], v[242:243]
    v_pk_mul_f32 v[52:53], v[36:37], v[38:39]
    v_pk_mul_f32 v[40:41], v[36:37], v[36:37]
    v_pk_fma_f32 v[40:41], v[38:39], v[38:39], v[40:41] neg_lo:[1,0,0] neg_hi:[1,0,0]
    v_pk_add_f32 v[42:43], v[52:53], v[52:53]
    v_and_b32 v9, 4, v8
    v_cmp_ne_u32 vcc, 0, v9
    s_nop 1
    v_cndmask_b32 v22, 1.0, v40, vcc
    v_cndmask_b32 v24, 0, v42, vcc
    v_cndmask_b32 v23, 1.0, v41, vcc
    v_cndmask_b32 v25, 0, v43, vcc
    v_pk_mul_f32 v[44:45], v[240:241], v[22:23]
    v_pk_mul_f32 v[46:47], v[240:241], v[24:25]
    v_pk_fma_f32 v[44:45], v[242:243], v[24:25], v[44:45] neg_lo:[1,0,0] neg_hi:[1,0,0]
    v_pk_fma_f32 v[46:47], v[242:243], v[22:23], v[46:47]
    v_pk_mul_f32 v[52:53], v[40:41], v[42:43]
    v_pk_mul_f32 v[36:37], v[40:41], v[40:41]
    v_pk_fma_f32 v[36:37], v[42:43], v[42:43], v[36:37] neg_lo:[1,0,0] neg_hi:[1,0,0]
    v_pk_add_f32 v[38:39], v[52:53], v[52:53]
    v_and_b32 v9, 1, v7
    v_cmp_ne_u32 vcc, 0, v9
    s_nop 1
    v_cndmask_b32 v48, 1.0, v36, vcc
    v_cndmask_b32 v50, 0, v38, vcc
    v_cndmask_b32 v49, 1.0, v37, vcc
    v_cndmask_b32 v51, 0, v39, vcc
    v_pk_mul_f32 v[52:53], v[36:37], v[38:39]
    v_pk_mul_f32 v[40:41], v[36:37], v[36:37]
    v_pk_fma_f32 v[40:41], v[38:39], v[38:39], v[40:41] neg_lo:[1,0,0] neg_hi:[1,0,0]
    v_pk_add_f32 v[42:43], v[52:53], v[52:53]
    v_and_b32 v9, 2, v7
    v_cmp_ne_u32 vcc, 0, v9
    s_nop 1
    v_cndmask_b32 v22, 1.0, v40, vcc
    v_cndmask_b32 v24, 0, v42, vcc
    v_cndmask_b32 v23, 1.0, v41, vcc
    v_cndmask_b32 v25, 0, v43, vcc
    v_pk_mul_f32 v[240:241], v[48:49], v[22:23]
    v_pk_mul_f32 v[242:243], v[48:49], v[24:25]
    v_pk_fma_f32 v[240:241], v[50:51], v[24:25], v[240:241] neg_lo:[1,0,0] neg_hi:[1,0,0]
    v_pk_fma_f32 v[242:243], v[50:51], v[22:23], v[242:243]
    v_pk_mul_f32 v[52:53], v[40:41], v[42:43]
    v_pk_mul_f32 v[244:245], v[40:41], v[40:41]
    v_pk_fma_f32 v[244:245], v[42:43], v[42:43], v[244:245] neg_lo:[1,0,0] neg_hi:[1,0,0]
    v_pk_add_f32 v[246:247], v[52:53], v[52:53]
    v_pk_mul_f32 v[36:37], v[44:45], v[14:15]
    v_pk_mul_f32 v[38:39], v[44:45], v[16:17]
    v_pk_fma_f32 v[36:37], v[46:47], v[16:17], v[36:37] neg_lo:[1,0,0] neg_hi:[1,0,0]
    v_pk_fma_f32 v[38:39], v[46:47], v[14:15], v[38:39]
    v_mov_b32 v232, v44
    v_mov_b32 v233, v36
    v_mov_b32 v236, v46
    v_mov_b32 v237, v38
    v_mov_b32 v234, v45
    v_mov_b32 v235, v37
    v_mov_b32 v238, v47
    v_mov_b32 v239, v39
    v_max_f32 v26, |v32|, |v34|
    v_rcp_f32 v28, v26
    v_max_f32 v27, |v33|, |v35|
    v_rcp_f32 v29, v27
    s_nop 0
    v_pk_mul_f32 v[32:33], v[32:33], v[28:29]
    v_pk_mul_f32 v[34:35], v[34:35], v[28:29]
    v_pk_mul_f32 v[28:29], v[32:33], v[32:33]
    v_pk_fma_f32 v[28:29], v[34:35], v[34:35], v[28:29]
    v_pk_mul_f32 v[28:29], v[28:29], v[26:27]
    v_rcp_f32 v28, v28
    v_add_f32 v26, -1.0, v10
    v_rcp_f32 v29, v29
    v_add_f32 v27, -1.0, v11
    v_pk_add_f32 v[28:29], v[28:29], v[28:29]
    v_pk_mul_f32 v[22:23], v[26:27], v[32:33]
    v_pk_mul_f32 v[24:25], v[12:13], v[32:33]
    v_pk_fma_f32 v[22:23], v[12:13], v[34:35], v[22:23]
    v_pk_fma_f32 v[24:25], v[26:27], v[34:35], v[24:25] neg_lo:[1,0,0] neg_hi:[1,0,0]
    v_pk_mul_f32 v[22:23], v[22:23], v[28:29]
    v_pk_mul_f32 v[24:25], v[24:25], v[28:29]
    v_mov_b32 v26, v22
    v_mov_b32 v27, v24
    v_mov_b32 v28, v23
    v_mov_b32 v29, v25
    v_pk_mul_f32 v[200:201], v[10:11], v[26:27] op_sel_hi:[0,1]
    v_pk_mul_f32 v[202:203], v[10:11], v[28:29] op_sel:[1,0]
    v_pk_fma_f32 v[200:201], v[26:27], v[12:13], v[200:201] op_sel:[1,0,0] op_sel_hi:[0,0,1] neg_lo:[1,0,0]
    v_pk_fma_f32 v[202:203], v[12:13], v[28:29], v[202:203] op_sel:[1,1,0] op_sel_hi:[1,0,1] neg_lo:[0,1,0]
    v_pk_mul_f32 v[204:205], v[10:11], v[200:201] op_sel_hi:[0,1]
    v_pk_mul_f32 v[206:207], v[10:11], v[202:203] op_sel:[1,0]
    v_pk_fma_f32 v[204:205], v[200:201], v[12:13], v[204:205] op_sel:[1,0,0] op_sel_hi:[0,0,1] neg_lo:[1,0,0]
    v_pk_fma_f32 v[206:207], v[12:13], v[202:203], v[206:207] op_sel:[1,1,0] op_sel_hi:[1,0,1] neg_lo:[0,1,0]
    v_pk_mul_f32 v[208:209], v[10:11], v[204:205] op_sel_hi:[0,1]
    v_pk_mul_f32 v[210:211], v[10:11], v[206:207] op_sel:[1,0]
    v_pk_fma_f32 v[208:209], v[204:205], v[12:13], v[208:209] op_sel:[1,0,0] op_sel_hi:[0,0,1] neg_lo:[1,0,0]
    v_pk_fma_f32 v[210:211], v[12:13], v[206:207], v[210:211] op_sel:[1,1,0] op_sel_hi:[1,0,1] neg_lo:[0,1,0]
    v_pk_mul_f32 v[212:213], v[10:11], v[208:209] op_sel_hi:[0,1]
    v_pk_mul_f32 v[214:215], v[10:11], v[210:211] op_sel:[1,0]
    v_pk_fma_f32 v[212:213], v[208:209], v[12:13], v[212:213] op_sel:[1,0,0] op_sel_hi:[0,0,1] neg_lo:[1,0,0]
    v_pk_fma_f32 v[214:215], v[12:13], v[210:211], v[214:215] op_sel:[1,1,0] op_sel_hi:[1,0,1] neg_lo:[0,1,0]
    v_pk_mul_f32 v[216:217], v[10:11], v[212:213] op_sel_hi:[0,1]
    v_pk_mul_f32 v[218:219], v[10:11], v[214:215] op_sel:[1,0]
    v_pk_fma_f32 v[216:217], v[212:213], v[12:13], v[216:217] op_sel:[1,0,0] op_sel_hi:[0,0,1] neg_lo:[1,0,0]
    v_pk_fma_f32 v[218:219], v[12:13], v[214:215], v[218:219] op_sel:[1,1,0] op_sel_hi:[1,0,1] neg_lo:[0,1,0]
    v_pk_mul_f32 v[220:221], v[10:11], v[216:217] op_sel_hi:[0,1]
    v_pk_mul_f32 v[222:223], v[10:11], v[218:219] op_sel:[1,0]
    v_pk_fma_f32 v[220:221], v[216:217], v[12:13], v[220:221] op_sel:[1,0,0] op_sel_hi:[0,0,1] neg_lo:[1,0,0]
    v_pk_fma_f32 v[222:223], v[12:13], v[218:219], v[222:223] op_sel:[1,1,0] op_sel_hi:[1,0,1] neg_lo:[0,1,0]
    v_pk_mul_f32 v[224:225], v[10:11], v[220:221] op_sel_hi:[0,1]
    v_pk_mul_f32 v[226:227], v[10:11], v[222:223] op_sel:[1,0]
    v_pk_fma_f32 v[224:225], v[220:221], v[12:13], v[224:225] op_sel:[1,0,0] op_sel_hi:[0,0,1] neg_lo:[1,0,0]
    v_pk_fma_f32 v[226:227], v[12:13], v[222:223], v[226:227] op_sel:[1,1,0] op_sel_hi:[1,0,1] neg_lo:[0,1,0]
    v_pk_mul_f32 v[228:229], v[10:11], v[224:225] op_sel_hi:[0,1]
    v_pk_mul_f32 v[230:231], v[10:11], v[226:227] op_sel:[1,0]
    v_pk_fma_f32 v[228:229], v[224:225], v[12:13], v[228:229] op_sel:[1,0,0] op_sel_hi:[0,0,1] neg_lo:[1,0,0]
    v_pk_fma_f32 v[230:231], v[12:13], v[226:227], v[230:231] op_sel:[1,1,0] op_sel_hi:[1,0,1] neg_lo:[0,1,0]
    v_mov_b32 v92, 0x3f803f80
    v_mov_b32 v80, 0
    v_mov_b32 v81, 0
    v_mov_b32 v82, 0
    v_mov_b32 v83, 0
    s_waitcnt vmcnt(0)
    v_and_b32 v64, 0xffff, v184
    v_and_b32 v72, 0xffff0000, v184
    v_and_b32 v65, 0xffff, v185
    v_and_b32 v73, 0xffff0000, v185
    v_and_b32 v66, 0xffff, v186
    v_and_b32 v74, 0xffff0000, v186
    v_and_b32 v67, 0xffff, v187
    v_and_b32 v75, 0xffff0000, v187
    v_and_b32 v68, 0xffff, v188
    v_and_b32 v76, 0xffff0000, v188
    v_and_b32 v69, 0xffff, v189
    v_and_b32 v77, 0xffff0000, v189
    v_and_b32 v70, 0xffff, v190
    v_and_b32 v78, 0xffff0000, v190
    v_and_b32 v71, 0xffff, v191
    v_and_b32 v79, 0xffff0000, v191
    v_dot2_f32_bf16 v84, v160, v64, 0
    v_dot2_f32_bf16 v85, v160, v72, 0
    v_dot2_f32_bf16 v86, v168, v64, 0
    v_dot2_f32_bf16 v87, v168, v72, 0
    v_dot2c_f32_bf16 v80, v160, v176
    v_dot2c_f32_bf16 v81, v168, v176
    v_cvt_pk_bf16_f32 v84, v84, v85
    v_cvt_pk_bf16_f32 v86, v86, v87
    v_dot2_f32_bf16 v88, v161, v65, 0
    v_dot2_f32_bf16 v89, v161, v73, 0
    v_dot2_f32_bf16 v90, v169, v65, 0
    v_dot2_f32_bf16 v91, v169, v73, 0
    v_dot2c_f32_bf16 v80, v161, v177
    v_dot2c_f32_bf16 v81, v169, v177
    v_dot2c_f32_bf16 v82, v84, v92
    v_dot2c_f32_bf16 v83, v86, v92
    v_cvt_pk_bf16_f32 v88, v88, v89
    v_cvt_pk_bf16_f32 v90, v90, v91
    v_dot2_f32_bf16 v84, v162, v66, 0
    v_dot2_f32_bf16 v85, v162, v74, 0
    v_dot2_f32_bf16 v86, v170, v66, 0
    v_dot2_f32_bf16 v87, v170, v74, 0
    v_dot2c_f32_bf16 v80, v162, v178
    v_dot2c_f32_bf16 v81, v170, v178
    v_dot2c_f32_bf16 v82, v88, v92
    v_dot2c_f32_bf16 v83, v90, v92
    v_cvt_pk_bf16_f32 v84, v84, v85
    v_cvt_pk_bf16_f32 v86, v86, v87
    v_dot2_f32_bf16 v88, v163, v67, 0
    v_dot2_f32_bf16 v89, v163, v75, 0
    v_dot2_f32_bf16 v90, v171, v67, 0
    v_dot2_f32_bf16 v91, v171, v75, 0
    v_dot2c_f32_bf16 v80, v163, v179
    v_dot2c_f32_bf16 v81, v171, v179
    v_dot2c_f32_bf16 v82, v84, v92
    v_dot2c_f32_bf16 v83, v86, v92
    v_cvt_pk_bf16_f32 v88, v88, v89
    v_cvt_pk_bf16_f32 v90, v90, v91
    v_dot2_f32_bf16 v84, v164, v68, 0
    v_dot2_f32_bf16 v85, v164, v76, 0
    v_dot2_f32_bf16 v86, v172, v68, 0
    v_dot2_f32_bf16 v87, v172, v76, 0
    v_dot2c_f32_bf16 v80, v164, v180
    v_dot2c_f32_bf16 v81, v172, v180
    v_dot2c_f32_bf16 v82, v88, v92
    v_dot2c_f32_bf16 v83, v90, v92
    v_cvt_pk_bf16_f32 v84, v84, v85
    v_cvt_pk_bf16_f32 v86, v86, v87
    v_dot2_f32_bf16 v88, v165, v69, 0
    v_dot2_f32_bf16 v89, v165, v77, 0
    v_dot2_f32_bf16 v90, v173, v69, 0
    v_dot2_f32_bf16 v91, v173, v77, 0
    v_dot2c_f32_bf16 v80, v165, v181
    v_dot2c_f32_bf16 v81, v173, v181
    v_dot2c_f32_bf16 v82, v84, v92
    v_dot2c_f32_bf16 v83, v86, v92
    v_cvt_pk_bf16_f32 v88, v88, v89
    v_cvt_pk_bf16_f32 v90, v90, v91
    v_dot2_f32_bf16 v84, v166, v70, 0
    v_dot2_f32_bf16 v85, v166, v78, 0
    v_dot2_f32_bf16 v86, v174, v70, 0
    v_dot2_f32_bf16 v87, v174, v78, 0
    v_dot2c_f32_bf16 v80, v166, v182
    v_dot2c_f32_bf16 v81, v174, v182
    v_dot2c_f32_bf16 v82, v88, v92
    v_dot2c_f32_bf16 v83, v90, v92
    v_cvt_pk_bf16_f32 v84, v84, v85
    v_cvt_pk_bf16_f32 v86, v86, v87
    v_dot2_f32_bf16 v88, v167, v71, 0
    v_dot2_f32_bf16 v89, v167, v79, 0
    v_dot2_f32_bf16 v90, v175, v71, 0
    v_dot2_f32_bf16 v91, v175, v79, 0
    v_dot2c_f32_bf16 v80, v167, v183
    v_dot2c_f32_bf16 v81, v175, v183
    v_dot2c_f32_bf16 v82, v84, v92
    v_dot2c_f32_bf16 v83, v86, v92
    v_cvt_pk_bf16_f32 v88, v88, v89
    v_cvt_pk_bf16_f32 v90, v90, v91
    v_dot2c_f32_bf16 v82, v88, v92
    v_dot2c_f32_bf16 v83, v90, v92
    v_add_f32_dpp v80, v80, v80 row_shr:1 row_mask:0xf bank_mask:0xf
    v_add_f32_dpp v81, v81, v81 row_shr:1 row_mask:0xf bank_mask:0xf
    v_add_f32_dpp v82, v82, v82 row_shr:1 row_mask:0xf bank_mask:0xf
    v_add_f32_dpp v83, v83, v83 row_shr:1 row_mask:0xf bank_mask:0xf
    v_add_f32_dpp v80, v80, v80 row_shr:2 row_mask:0xf bank_mask:0xf
    v_add_f32_dpp v81, v81, v81 row_shr:2 row_mask:0xf bank_mask:0xf
    v_add_f32_dpp v82, v82, v82 row_shr:2 row_mask:0xf bank_mask:0xf
    v_add_f32_dpp v83, v83, v83 row_shr:2 row_mask:0xf bank_mask:0xf
    v_add_f32_dpp v80, v80, v80 row_shr:4 row_mask:0xf bank_mask:0xf
    v_add_f32_dpp v81, v81, v81 row_shr:4 row_mask:0xf bank_mask:0xf
    v_add_f32_dpp v82, v82, v82 row_shr:4 row_mask:0xf bank_mask:0xf
    v_add_f32_dpp v83, v83, v83 row_shr:4 row_mask:0xf bank_mask:0xf
    v_add_f32_dpp v80, v80, v80 row_shr:8 row_mask:0xf bank_mask:0xf
    v_add_f32_dpp v81, v81, v81 row_shr:8 row_mask:0xf bank_mask:0xf
    v_add_f32_dpp v82, v82, v82 row_shr:8 row_mask:0xf bank_mask:0xf
    v_add_f32_dpp v83, v83, v83 row_shr:8 row_mask:0xf bank_mask:0xf
    v_add_f32_dpp v80, v80, v80 row_bcast:15 row_mask:0xa bank_mask:0xf
    v_add_f32_dpp v81, v81, v81 row_bcast:15 row_mask:0xa bank_mask:0xf
    v_add_f32_dpp v82, v82, v82 row_bcast:15 row_mask:0xa bank_mask:0xf
    v_add_f32_dpp v83, v83, v83 row_bcast:15 row_mask:0xa bank_mask:0xf
    v_add_f32_dpp v80, v80, v80 row_bcast:31 row_mask:0xc bank_mask:0xf
    v_add_f32_dpp v81, v81, v81 row_bcast:31 row_mask:0xc bank_mask:0xf
    v_add_f32_dpp v82, v82, v82 row_bcast:31 row_mask:0xc bank_mask:0xf
    v_add_f32_dpp v83, v83, v83 row_bcast:31 row_mask:0xc bank_mask:0xf
    v_readlane_b32 s33, v81, 63
    v_readlane_b32 s34, v83, 63
    v_sub_u32 v86, 63, v1
    v_add_u32 v87, s46, v86
    v_sub_u32 v87, 2047, v87
    v_add_u32 v86, s47, v86
    v_lshlrev_b32 v86, 3, v86
    v_add_u32 v86, 147520, v86
    v_writelane_b32 v80, s33, 62
    v_writelane_b32 v82, s34, 62
    v_cvt_pk_bf16_f32 v80, v80, v82
    v_and_b32 v82, 0xffff0000, v80
    v_lshlrev_b32 v80, 16, v80
    v_ashrrev_i32 v84, 31, v80
    v_or_b32 v84, 0x80000000, v84
    v_xor_b32 v84, v84, v80
    v_and_b32 v84, 0xffff0000, v84
    v_or_b32 v84, v84, v87
    v_mul_f32 v87, 0xbfb8aa3b, v82
    v_exp_f32 v87, v87
    s_nop 0
    v_add_f32 v87, 1.0, v87
    v_rcp_f32 v87, v87
    s_nop 0
    v_cvt_pk_bf16_f32 v88, v87, v87
    v_lshlrev_b32 v88, 16, v88
    v_sub_f32 v89, 1.0, v88
    v_cvt_pk_bf16_f32 v85, v88, v89
    s_mov_b32 exec_lo, 0
    s_mov_b32 exec_hi, 0xc0000000
    ds_write_b64 v86, v[84:85]
    s_mov_b64 exec, -1
    s_waitcnt lgkmcnt(0)
    s_mul_i32 s44, s44, 1664525
    s_add_u32 s44, s44, 1013904223
    s_setprio 1
    s_barrier
    ds_read_b128 v[32:35], v2 offset:0
    ds_read_b128 v[48:51], v4 offset:0
    ds_read_b128 v[52:55], v4 offset:2048
    ds_read_b128 v[56:59], v4 offset:4096
    ds_read_b128 v[60:63], v4 offset:6144
    ds_read_b128 v[36:39], v2 offset:2048
    ds_read_b128 v[40:43], v2 offset:4096
    ds_read_b128 v[44:47], v2 offset:6144
    s_mov_b32 s35, 0
Lc_loop:
    s_waitcnt lgkmcnt(0)
    v_mfma_f32_16x16x32_bf16 v[96:99], v[32:35], v[48:51], v[96:99]
    ds_read_b128 v[64:67], v3 offset:0
    v_mfma_f32_16x16x32_bf16 v[128:131], v[32:35], v[52:55], v[128:131]
    ds_read_b128 v[80:83], v5 offset:0
    v_mfma_f32_16x16x32_bf16 v[112:115], v[32:35], v[56:59], v[112:115]
    ds_read_b128 v[84:87], v5 offset:2048
    v_mfma_f32_16x16x32_bf16 v[144:147], v[32:35], v[60:63], v[144:147]
    ds_read_b128 v[88:91], v5 offset:4096
    v_mfma_f32_16x16x32_bf16 v[148:151], v[36:39], v[60:63], v[148:151]
    ds_read_b128 v[92:95], v5 offset:6144
    v_mfma_f32_16x16x32_bf16 v[116:119], v[36:39], v[56:59], v[116:119]
    ds_read_b128 v[68:71], v3 offset:2048
    v_mfma_f32_16x16x32_bf16 v[132:135], v[36:39], v[52:55], v[132:135]
    ds_read_b128 v[72:75], v3 offset:4096
    v_mfma_f32_16x16x32_bf16 v[100:103], v[36:39], v[48:51], v[100:103]
    ds_read_b128 v[76:79], v3 offset:6144
    v_mfma_f32_16x16x32_bf16 v[104:107], v[40:43], v[48:51], v[104:107]
    v_mfma_f32_16x16x32_bf16 v[136:139], v[40:43], v[52:55], v[136:139]
    v_mfma_f32_16x16x32_bf16 v[120:123], v[40:43], v[56:59], v[120:123]
    v_mfma_f32_16x16x32_bf16 v[152:155], v[40:43], v[60:63], v[152:155]
    v_mfma_f32_16x16x32_bf16 v[156:159], v[44:47], v[60:63], v[156:159]
    v_mfma_f32_16x16x32_bf16 v[124:127], v[44:47], v[56:59], v[124:127]
    v_mfma_f32_16x16x32_bf16 v[140:143], v[44:47], v[52:55], v[140:143]
    v_mfma_f32_16x16x32_bf16 v[108:111], v[44:47], v[48:51], v[108:111]
    s_waitcnt lgkmcnt(0)
    v_mfma_f32_16x16x32_bf16 v[96:99], v[64:67], v[80:83], v[96:99]
    v_mfma_f32_16x16x32_bf16 v[128:131], v[64:67], v[84:87], v[128:131]
    v_mfma_f32_16x16x32_bf16 v[112:115], v[64:67], v[88:91], v[112:115]
    s_barrier
    v_mfma_f32_16x16x32_bf16 v[144:147], v[64:67], v[92:95], v[144:147]
    ds_read_b128 v[32:35], v2 offset:32768
    v_mfma_f32_16x16x32_bf16 v[148:151], v[68:71], v[92:95], v[148:151]
    ds_read_b128 v[48:51], v4 offset:32768
    v_mfma_f32_16x16x32_bf16 v[116:119], v[68:71], v[88:91], v[116:119]
    ds_read_b128 v[52:55], v4 offset:34816
    v_mfma_f32_16x16x32_bf16 v[132:135], v[68:71], v[84:87], v[132:135]
    ds_read_b128 v[56:59], v4 offset:36864
    v_mfma_f32_16x16x32_bf16 v[100:103], v[68:71], v[80:83], v[100:103]
    ds_read_b128 v[60:63], v4 offset:38912
    v_mfma_f32_16x16x32_bf16 v[104:107], v[72:75], v[80:83], v[104:107]
    ds_read_b128 v[36:39], v2 offset:34816
    v_mfma_f32_16x16x32_bf16 v[136:139], v[72:75], v[84:87], v[136:139]
    ds_read_b128 v[40:43], v2 offset:36864
    v_mfma_f32_16x16x32_bf16 v[120:123], v[72:75], v[88:91], v[120:123]
    ds_read_b128 v[44:47], v2 offset:38912
    v_mfma_f32_16x16x32_bf16 v[152:155], v[72:75], v[92:95], v[152:155]
    v_mfma_f32_16x16x32_bf16 v[156:159], v[76:79], v[92:95], v[156:159]
    v_mfma_f32_16x16x32_bf16 v[124:127], v[76:79], v[88:91], v[124:127]
    v_mfma_f32_16x16x32_bf16 v[140:143], v[76:79], v[84:87], v[140:143]
    v_mfma_f32_16x16x32_bf16 v[108:111], v[76:79], v[80:83], v[108:111]
    s_waitcnt lgkmcnt(0)
    v_mfma_f32_16x16x32_bf16 v[96:99], v[32:35], v[48:51], v[96:99]
    ds_read_b128 v[64:67], v3 offset:32768
    v_mfma_f32_16x16x32_bf16 v[128:131], v[32:35], v[52:55], v[128:131]
    ds_read_b128 v[80:83], v5 offset:32768
    v_mfma_f32_16x16x32_bf16 v[112:115], v[32:35], v[56:59], v[112:115]
    ds_read_b128 v[84:87], v5 offset:34816
    v_mfma_f32_16x16x32_bf16 v[144:147], v[32:35], v[60:63], v[144:147]
    ds_read_b128 v[88:91], v5 offset:36864
    v_mfma_f32_16x16x32_bf16 v[148:151], v[36:39], v[60:63], v[148:151]
    ds_read_b128 v[92:95], v5 offset:38912
    v_mfma_f32_16x16x32_bf16 v[116:119], v[36:39], v[56:59], v[116:119]
    ds_read_b128 v[68:71], v3 offset:34816
    v_mfma_f32_16x16x32_bf16 v[132:135], v[36:39], v[52:55], v[132:135]
    ds_read_b128 v[72:75], v3 offset:36864
    v_mfma_f32_16x16x32_bf16 v[100:103], v[36:39], v[48:51], v[100:103]
    ds_read_b128 v[76:79], v3 offset:38912
    v_mfma_f32_16x16x32_bf16 v[104:107], v[40:43], v[48:51], v[104:107]
    v_mfma_f32_16x16x32_bf16 v[136:139], v[40:43], v[52:55], v[136:139]
    v_mfma_f32_16x16x32_bf16 v[120:123], v[40:43], v[56:59], v[120:123]
    v_mfma_f32_16x16x32_bf16 v[152:155], v[40:43], v[60:63], v[152:155]
    v_mfma_f32_16x16x32_bf16 v[156:159], v[44:47], v[60:63], v[156:159]
    v_mfma_f32_16x16x32_bf16 v[124:127], v[44:47], v[56:59], v[124:127]
    v_mfma_f32_16x16x32_bf16 v[140:143], v[44:47], v[52:55], v[140:143]
    v_mfma_f32_16x16x32_bf16 v[108:111], v[44:47], v[48:51], v[108:111]
    s_waitcnt lgkmcnt(0)
    v_mfma_f32_16x16x32_bf16 v[96:99], v[64:67], v[80:83], v[96:99]
    v_xor_b32 v2, 0x10000, v2
    v_xor_b32 v3, 0x10000, v3
    v_xor_b32 v4, 0x10000, v4
    v_xor_b32 v5, 0x10000, v5
    v_mfma_f32_16x16x32_bf16 v[128:131], v[64:67], v[84:87], v[128:131]
    v_mfma_f32_16x16x32_bf16 v[112:115], v[64:67], v[88:91], v[112:115]
    s_cmp_eq_u32 s35, 7
    s_cbranch_scc1 Lc_nobar
    s_barrier
Lc_nobar:
    v_mfma_f32_16x16x32_bf16 v[144:147], v[64:67], v[92:95], v[144:147]
    ds_read_b128 v[32:35], v2 offset:0
    v_mfma_f32_16x16x32_bf16 v[148:151], v[68:71], v[92:95], v[148:151]
    ds_read_b128 v[48:51], v4 offset:0
    v_mfma_f32_16x16x32_bf16 v[116:119], v[68:71], v[88:91], v[116:119]
    ds_read_b128 v[52:55], v4 offset:2048
    v_mfma_f32_16x16x32_bf16 v[132:135], v[68:71], v[84:87], v[132:135]
    ds_read_b128 v[56:59], v4 offset:4096
    v_mfma_f32_16x16x32_bf16 v[100:103], v[68:71], v[80:83], v[100:103]
    ds_read_b128 v[60:63], v4 offset:6144
    v_mfma_f32_16x16x32_bf16 v[104:107], v[72:75], v[80:83], v[104:107]
    ds_read_b128 v[36:39], v2 offset:2048
    v_mfma_f32_16x16x32_bf16 v[136:139], v[72:75], v[84:87], v[136:139]
    ds_read_b128 v[40:43], v2 offset:4096
    v_mfma_f32_16x16x32_bf16 v[120:123], v[72:75], v[88:91], v[120:123]
    ds_read_b128 v[44:47], v2 offset:6144
    v_mfma_f32_16x16x32_bf16 v[152:155], v[72:75], v[92:95], v[152:155]
    v_mfma_f32_16x16x32_bf16 v[156:159], v[76:79], v[92:95], v[156:159]
    v_mfma_f32_16x16x32_bf16 v[124:127], v[76:79], v[88:91], v[124:127]
    v_mfma_f32_16x16x32_bf16 v[140:143], v[76:79], v[84:87], v[140:143]
    v_mfma_f32_16x16x32_bf16 v[108:111], v[76:79], v[80:83], v[108:111]
    s_add_u32 s35, s35, 1
    s_cmp_lt_u32 s35, 8
    s_cbranch_scc1 Lc_loop
    s_sub_u32 s33, s26, 1
    v_sub_u32 v8, s33, v7
    v_lshlrev_b32 v8, 10, v8
    v_lshl_add_u32 v8, v6, 4, v8
    s_lshl_b32 s33, s31, 9
    v_add_u32 v192, s33, v8
    v_add_u32 v193, -4096, v192
    v_add_u32 v194, -8192, v192
    v_add_u32 v195, -12288, v192
    v_mov_b32 v9, 147456
    s_waitcnt lgkmcnt(0)
    v_pk_fma_f32 v[98:99], v[10:11], v[96:97], v[98:99] op_sel_hi:[0,1,1]
    v_pk_fma_f32 v[130:131], v[10:11], v[128:129], v[130:131] op_sel:[1,0,0]
    v_pk_fma_f32 v[114:115], v[10:11], v[112:113], v[114:115] op_sel_hi:[0,1,1]
    v_pk_fma_f32 v[146:147], v[10:11], v[144:145], v[146:147] op_sel:[1,0,0]
    v_pk_fma_f32 v[98:99], v[12:13], v[112:113], v[98:99] op_sel_hi:[0,1,1] neg_lo:[1,0,0] neg_hi:[1,0,0]
    v_pk_fma_f32 v[130:131], v[12:13], v[144:145], v[130:131] op_sel:[1,0,0] neg_lo:[1,0,0] neg_hi:[1,0,0]
    v_pk_fma_f32 v[114:115], v[12:13], v[96:97], v[114:115] op_sel_hi:[0,1,1]
    v_pk_fma_f32 v[146:147], v[12:13], v[128:129], v[146:147] op_sel:[1,0,0]
    v_pk_fma_f32 v[100:101], v[10:11], v[98:99], v[100:101] op_sel_hi:[0,1,1]
    v_pk_fma_f32 v[132:133], v[10:11], v[130:131], v[132:133] op_sel:[1,0,0]
    v_pk_fma_f32 v[116:117], v[10:11], v[114:115], v[116:117] op_sel_hi:[0,1,1]
    v_pk_fma_f32 v[148:149], v[10:11], v[146:147], v[148:149] op_sel:[1,0,0]
    v_pk_fma_f32 v[100:101], v[12:13], v[114:115], v[100:101] op_sel_hi:[0,1,1] neg_lo:[1,0,0] neg_hi:[1,0,0]
    v_pk_fma_f32 v[132:133], v[12:13], v[146:147], v[132:133] op_sel:[1,0,0] neg_lo:[1,0,0] neg_hi:[1,0,0]
    v_pk_fma_f32 v[116:117], v[12:13], v[98:99], v[116:117] op_sel_hi:[0,1,1]
    v_pk_fma_f32 v[148:149], v[12:13], v[130:131], v[148:149] op_sel:[1,0,0]
    v_pk_fma_f32 v[102:103], v[10:11], v[100:101], v[102:103] op_sel_hi:[0,1,1]
    v_pk_fma_f32 v[134:135], v[10:11], v[132:133], v[134:135] op_sel:[1,0,0]
    v_pk_fma_f32 v[118:119], v[10:11], v[116:117], v[118:119] op_sel_hi:[0,1,1]
    v_pk_fma_f32 v[150:151], v[10:11], v[148:149], v[150:151] op_sel:[1,0,0]
    v_pk_fma_f32 v[102:103], v[12:13], v[116:117], v[102:103] op_sel_hi:[0,1,1] neg_lo:[1,0,0] neg_hi:[1,0,0]
    v_pk_fma_f32 v[134:135], v[12:13], v[148:149], v[134:135] op_sel:[1,0,0] neg_lo:[1,0,0] neg_hi:[1,0,0]
    v_pk_fma_f32 v[118:119], v[12:13], v[100:101], v[118:119] op_sel_hi:[0,1,1]
    v_pk_fma_f32 v[150:151], v[12:13], v[132:133], v[150:151] op_sel:[1,0,0]
    v_pk_fma_f32 v[104:105], v[10:11], v[102:103], v[104:105] op_sel_hi:[0,1,1]
    v_pk_fma_f32 v[136:137], v[10:11], v[134:135], v[136:137] op_sel:[1,0,0]
    v_pk_fma_f32 v[120:121], v[10:11], v[118:119], v[120:121] op_sel_hi:[0,1,1]
    v_pk_fma_f32 v[152:153], v[10:11], v[150:151], v[152:153] op_sel:[1,0,0]
    v_pk_fma_f32 v[104:105], v[12:13], v[118:119], v[104:105] op_sel_hi:[0,1,1] neg_lo:[1,0,0] neg_hi:[1,0,0]
    v_pk_fma_f32 v[136:137], v[12:13], v[150:151], v[136:137] op_sel:[1,0,0] neg_lo:[1,0,0] neg_hi:[1,0,0]
    v_pk_fma_f32 v[120:121], v[12:13], v[102:103], v[120:121] op_sel_hi:[0,1,1]
    v_pk_fma_f32 v[152:153], v[12:13], v[134:135], v[152:153] op_sel:[1,0,0]
    v_pk_fma_f32 v[106:107], v[10:11], v[104:105], v[106:107] op_sel_hi:[0,1,1]
    v_pk_fma_f32 v[138:139], v[10:11], v[136:137], v[138:139] op_sel:[1,0,0]
    v_pk_fma_f32 v[122:123], v[10:11], v[120:121], v[122:123] op_sel_hi:[0,1,1]
    v_pk_fma_f32 v[154:155], v[10:11], v[152:153], v[154:155] op_sel:[1,0,0]
    v_pk_fma_f32 v[106:107], v[12:13], v[120:121], v[106:107] op_sel_hi:[0,1,1] neg_lo:[1,0,0] neg_hi:[1,0,0]
    v_pk_fma_f32 v[138:139], v[12:13], v[152:153], v[138:139] op_sel:[1,0,0] neg_lo:[1,0,0] neg_hi:[1,0,0]
    v_pk_fma_f32 v[122:123], v[12:13], v[104:105], v[122:123] op_sel_hi:[0,1,1]
    v_pk_fma_f32 v[154:155], v[12:13], v[136:137], v[154:155] op_sel:[1,0,0]
    v_pk_fma_f32 v[108:109], v[10:11], v[106:107], v[108:109] op_sel_hi:[0,1,1]
    v_pk_fma_f32 v[140:141], v[10:11], v[138:139], v[140:141] op_sel:[1,0,0]
    v_pk_fma_f32 v[124:125], v[10:11], v[122:123], v[124:125] op_sel_hi:[0,1,1]
    v_pk_fma_f32 v[156:157], v[10:11], v[154:155], v[156:157] op_sel:[1,0,0]
    v_pk_fma_f32 v[108:109], v[12:13], v[122:123], v[108:109] op_sel_hi:[0,1,1] neg_lo:[1,0,0] neg_hi:[1,0,0]
    v_pk_fma_f32 v[140:141], v[12:13], v[154:155], v[140:141] op_sel:[1,0,0] neg_lo:[1,0,0] neg_hi:[1,0,0]
    v_pk_fma_f32 v[124:125], v[12:13], v[106:107], v[124:125] op_sel_hi:[0,1,1]
    v_pk_fma_f32 v[156:157], v[12:13], v[138:139], v[156:157] op_sel:[1,0,0]
    v_pk_fma_f32 v[110:111], v[10:11], v[108:109], v[110:111] op_sel_hi:[0,1,1]
    v_pk_fma_f32 v[142:143], v[10:11], v[140:141], v[142:143] op_sel:[1,0,0]
    v_pk_fma_f32 v[126:127], v[10:11], v[124:125], v[126:127] op_sel_hi:[0,1,1]
    v_pk_fma_f32 v[158:159], v[10:11], v[156:157], v[158:159] op_sel:[1,0,0]
    v_pk_fma_f32 v[110:111], v[12:13], v[124:125], v[110:111] op_sel_hi:[0,1,1] neg_lo:[1,0,0] neg_hi:[1,0,0]
    v_pk_fma_f32 v[142:143], v[12:13], v[156:157], v[142:143] op_sel:[1,0,0] neg_lo:[1,0,0] neg_hi:[1,0,0]
    v_pk_fma_f32 v[126:127], v[12:13], v[108:109], v[126:127] op_sel_hi:[0,1,1]
    v_pk_fma_f32 v[158:159], v[12:13], v[140:141], v[158:159] op_sel:[1,0,0]
    v_fma_f32 v26, v14, v110, v111
    v_fma_f32 v27, v14, v126, v127
    v_fma_f32 v26, -v16, v126, v26
    v_fma_f32 v27, v16, v110, v27
    v_fma_f32 v28, v15, v142, v143
    v_fma_f32 v29, v15, v158, v159
    v_fma_f32 v28, -v17, v158, v28
    v_fma_f32 v29, v17, v142, v29
    s_lshl_b32 s33, s31, 8
    s_add_u32 s33, s33, 148480
    v_lshl_add_u32 v30, v6, 3, s33
    s_lshl_b32 s33, s30, 11
    v_lshl_add_u32 v31, v7, 9, s33
    v_add_u32 v31, v31, v30
    ds_write_b64 v31, v[26:27]
    ds_write_b64 v31, v[28:29] offset:128
    s_lshl_b32 s33, s29, 2
    v_add_u32 v31, s33, v9
    s_xor_b32 s33, s33, 8
    v_add_u32 v9, s33, v9
    v_mov_b32 v8, 1
    ds_write_b32 v31, v8
    s_mov_b32 s45, 32768
Lc_expoll:
    ds_read_b32 v8, v9
    ds_read_b64 v[32:33], v30 offset:0
    ds_read_b64 v[34:35], v30 offset:128
    ds_read_b64 v[36:37], v30 offset:512
    ds_read_b64 v[38:39], v30 offset:640
    ds_read_b64 v[40:41], v30 offset:1024
    ds_read_b64 v[42:43], v30 offset:1152
    ds_read_b64 v[44:45], v30 offset:1536
    ds_read_b64 v[46:47], v30 offset:1664
    ds_read_b64 v[48:49], v30 offset:2048
    ds_read_b64 v[50:51], v30 offset:2176
    ds_read_b64 v[52:53], v30 offset:2560
    ds_read_b64 v[54:55], v30 offset:2688
    ds_read_b64 v[56:57], v30 offset:3072
    ds_read_b64 v[58:59], v30 offset:3200
    ds_read_b64 v[60:61], v30 offset:3584
    ds_read_b64 v[62:63], v30 offset:3712
    s_waitcnt lgkmcnt(0)
    v_readfirstlane_b32 s33, v8
    s_sub_u32 s45, s45, 1
    s_cbranch_scc1 Lc_exok
    s_cmp_eq_u32 s33, 0
    s_cbranch_scc1 Lc_expoll
Lc_exok:
    v_pk_fma_f32 v[36:37], v[18:19], v[32:33], v[36:37] op_sel_hi:[0,1,1]
    v_pk_fma_f32 v[36:37], v[32:33], v[20:21], v[36:37] op_sel:[1,0,0] op_sel_hi:[0,0,1] neg_lo:[1,0,0]
    v_pk_fma_f32 v[38:39], v[18:19], v[34:35], v[38:39] op_sel:[1,0,0]
    v_pk_fma_f32 v[38:39], v[20:21], v[34:35], v[38:39] op_sel:[1,1,0] op_sel_hi:[1,0,1] neg_lo:[0,1,0]
    v_pk_fma_f32 v[40:41], v[18:19], v[36:37], v[40:41] op_sel_hi:[0,1,1]
    v_pk_fma_f32 v[40:41], v[36:37], v[20:21], v[40:41] op_sel:[1,0,0] op_sel_hi:[0,0,1] neg_lo:[1,0,0]
    v_pk_fma_f32 v[42:43], v[18:19], v[38:39], v[42:43] op_sel:[1,0,0]
    v_pk_fma_f32 v[42:43], v[20:21], v[38:39], v[42:43] op_sel:[1,1,0] op_sel_hi:[1,0,1] neg_lo:[0,1,0]
    v_pk_fma_f32 v[44:45], v[18:19], v[40:41], v[44:45] op_sel_hi:[0,1,1]
    v_pk_fma_f32 v[44:45], v[40:41], v[20:21], v[44:45] op_sel:[1,0,0] op_sel_hi:[0,0,1] neg_lo:[1,0,0]
    v_pk_fma_f32 v[46:47], v[18:19], v[42:43], v[46:47] op_sel:[1,0,0]
    v_pk_fma_f32 v[46:47], v[20:21], v[42:43], v[46:47] op_sel:[1,1,0] op_sel_hi:[1,0,1] neg_lo:[0,1,0]
    v_pk_fma_f32 v[48:49], v[18:19], v[44:45], v[48:49] op_sel_hi:[0,1,1]
    v_pk_fma_f32 v[48:49], v[44:45], v[20:21], v[48:49] op_sel:[1,0,0] op_sel_hi:[0,0,1] neg_lo:[1,0,0]
    v_pk_fma_f32 v[50:51], v[18:19], v[46:47], v[50:51] op_sel:[1,0,0]
    v_pk_fma_f32 v[50:51], v[20:21], v[46:47], v[50:51] op_sel:[1,1,0] op_sel_hi:[1,0,1] neg_lo:[0,1,0]
    v_pk_fma_f32 v[52:53], v[18:19], v[48:49], v[52:53] op_sel_hi:[0,1,1]
    v_pk_fma_f32 v[52:53], v[48:49], v[20:21], v[52:53] op_sel:[1,0,0] op_sel_hi:[0,0,1] neg_lo:[1,0,0]
    v_pk_fma_f32 v[54:55], v[18:19], v[50:51], v[54:55] op_sel:[1,0,0]
    v_pk_fma_f32 v[54:55], v[20:21], v[50:51], v[54:55] op_sel:[1,1,0] op_sel_hi:[1,0,1] neg_lo:[0,1,0]
    v_pk_fma_f32 v[56:57], v[18:19], v[52:53], v[56:57] op_sel_hi:[0,1,1]
    v_pk_fma_f32 v[56:57], v[52:53], v[20:21], v[56:57] op_sel:[1,0,0] op_sel_hi:[0,0,1] neg_lo:[1,0,0]
    v_pk_fma_f32 v[58:59], v[18:19], v[54:55], v[58:59] op_sel:[1,0,0]
    v_pk_fma_f32 v[58:59], v[20:21], v[54:55], v[58:59] op_sel:[1,1,0] op_sel_hi:[1,0,1] neg_lo:[0,1,0]
    v_pk_fma_f32 v[60:61], v[18:19], v[56:57], v[60:61] op_sel_hi:[0,1,1]
    v_pk_fma_f32 v[60:61], v[56:57], v[20:21], v[60:61] op_sel:[1,0,0] op_sel_hi:[0,0,1] neg_lo:[1,0,0]
    v_pk_fma_f32 v[62:63], v[18:19], v[58:59], v[62:63] op_sel:[1,0,0]
    v_pk_fma_f32 v[62:63], v[20:21], v[58:59], v[62:63] op_sel:[1,1,0] op_sel_hi:[1,0,1] neg_lo:[0,1,0]
    s_cmp_eq_u32 s30, 0
    s_cbranch_scc1 Lc_nopub
    s_cmp_eq_u32 s26, 15
    s_cbranch_scc1 Lc_nopub
    v_mov_b32 v26, v60
    v_mov_b32 v27, v61
    v_mov_b32 v28, s44
    v_mov_b32 v29, s44
    s_lshl_b32 s33, s26, 10
    s_lshl_b32 s34, s31, 9
    s_add_u32 s33, s33, s34
    v_lshlrev_b32 v8, 4, v1
    s_mov_b64 exec, 0xffff0000
    v_mov_b32 v26, v62
    v_mov_b32 v27, v63
    s_mov_b64 exec, 0xffffffff
    buffer_store_dwordx4 v[26:29], v8, s[36:39], s33 offen sc1
    s_mov_b64 exec, -1
Lc_nopub:
    v_mov_b32 v60, 0
    v_mov_b32 v61, 0
    v_mov_b32 v62, 0
    v_mov_b32 v63, 0
    s_lshl_b32 s33, s30, 2
    v_add_u32 v8, s33, v7
    v_cmp_eq_u32 vcc, 1, v8
    s_nop 1
    v_cndmask_b32 v60, v60, v32, vcc
    v_cndmask_b32 v61, v61, v33, vcc
    v_cndmask_b32 v62, v62, v34, vcc
    v_cndmask_b32 v63, v63, v35, vcc
    v_cmp_eq_u32 vcc, 2, v8
    s_nop 1
    v_cndmask_b32 v60, v60, v36, vcc
    v_cndmask_b32 v61, v61, v37, vcc
    v_cndmask_b32 v62, v62, v38, vcc
    v_cndmask_b32 v63, v63, v39, vcc
    v_cmp_eq_u32 vcc, 3, v8
    s_nop 1
    v_cndmask_b32 v60, v60, v40, vcc
    v_cndmask_b32 v61, v61, v41, vcc
    v_cndmask_b32 v62, v62, v42, vcc
    v_cndmask_b32 v63, v63, v43, vcc
    v_cmp_eq_u32 vcc, 4, v8
    s_nop 1
    v_cndmask_b32 v60, v60, v44, vcc
    v_cndmask_b32 v61, v61, v45, vcc
    v_cndmask_b32 v62, v62, v46, vcc
    v_cndmask_b32 v63, v63, v47, vcc
    v_cmp_eq_u32 vcc, 5, v8
    s_nop 1
    v_cndmask_b32 v60, v60, v48, vcc
    v_cndmask_b32 v61, v61, v49, vcc
    v_cndmask_b32 v62, v62, v50, vcc
    v_cndmask_b32 v63, v63, v51, vcc
    v_cmp_eq_u32 vcc, 6, v8
    s_nop 1
    v_cndmask_b32 v60, v60, v52, vcc
    v_cndmask_b32 v61, v61, v53, vcc
    v_cndmask_b32 v62, v62, v54, vcc
    v_cndmask_b32 v63, v63, v55, vcc
    v_cmp_eq_u32 vcc, 7, v8
    s_nop 1
    v_cndmask_b32 v60, v60, v56, vcc
    v_cndmask_b32 v61, v61, v57, vcc
    v_cndmask_b32 v62, v62, v58, vcc
    v_cndmask_b32 v63, v63, v59, vcc
    v_fma_f32 v33, v14, v60, v110
    v_fma_f32 v35, v14, v61, v126
    v_mov_b32 v32, v60
    v_mov_b32 v34, v61
    v_fma_f32 v33, -v16, v61, v33
    v_fma_f32 v35, v16, v60, v35
    v_fma_f32 v37, v15, v62, v142
    v_fma_f32 v39, v15, v63, v158
    v_mov_b32 v36, v62
    v_mov_b32 v38, v63
    v_fma_f32 v37, -v17, v63, v37
    v_fma_f32 v39, v17, v62, v39
    v_pk_mul_f32 v[26:27], v[24:25], v[96:97] op_sel_hi:[0,1] neg_lo:[1,0] neg_hi:[1,0]
    v_pk_mul_f32 v[96:97], v[22:23], v[96:97] op_sel_hi:[0,1]
    v_pk_fma_f32 v[96:97], v[24:25], v[112:113], v[96:97] op_sel_hi:[0,1,1] neg_lo:[1,0,0] neg_hi:[1,0,0]
    v_pk_fma_f32 v[112:113], v[22:23], v[112:113], v[26:27] op_sel_hi:[0,1,1] neg_lo:[1,0,0] neg_hi:[1,0,0]
    v_pk_mul_f32 v[28:29], v[24:25], v[128:129] op_sel:[1,0] neg_lo:[1,0] neg_hi:[1,0]
    v_pk_mul_f32 v[128:129], v[22:23], v[128:129] op_sel:[1,0]
    v_pk_fma_f32 v[128:129], v[24:25], v[144:145], v[128:129] op_sel:[1,0,0] neg_lo:[1,0,0] neg_hi:[1,0,0]
    v_pk_fma_f32 v[144:145], v[22:23], v[144:145], v[28:29] op_sel:[1,0,0] neg_lo:[1,0,0] neg_hi:[1,0,0]
    v_pk_mul_f32 v[26:27], v[24:25], v[98:99] op_sel_hi:[0,1] neg_lo:[1,0] neg_hi:[1,0]
    v_pk_mul_f32 v[98:99], v[22:23], v[98:99] op_sel_hi:[0,1]
    v_pk_fma_f32 v[98:99], v[24:25], v[114:115], v[98:99] op_sel_hi:[0,1,1] neg_lo:[1,0,0] neg_hi:[1,0,0]
    v_pk_fma_f32 v[114:115], v[22:23], v[114:115], v[26:27] op_sel_hi:[0,1,1] neg_lo:[1,0,0] neg_hi:[1,0,0]
    v_pk_mul_f32 v[28:29], v[24:25], v[130:131] op_sel:[1,0] neg_lo:[1,0] neg_hi:[1,0]
    v_pk_mul_f32 v[130:131], v[22:23], v[130:131] op_sel:[1,0]
    v_pk_fma_f32 v[130:131], v[24:25], v[146:147], v[130:131] op_sel:[1,0,0] neg_lo:[1,0,0] neg_hi:[1,0,0]
    v_pk_fma_f32 v[146:147], v[22:23], v[146:147], v[28:29] op_sel:[1,0,0] neg_lo:[1,0,0] neg_hi:[1,0,0]
    v_pk_mul_f32 v[26:27], v[24:25], v[100:101] op_sel_hi:[0,1] neg_lo:[1,0] neg_hi:[1,0]
    v_pk_mul_f32 v[100:101], v[22:23], v[100:101] op_sel_hi:[0,1]
    v_pk_fma_f32 v[100:101], v[24:25], v[116:117], v[100:101] op_sel_hi:[0,1,1] neg_lo:[1,0,0] neg_hi:[1,0,0]
    v_pk_fma_f32 v[116:117], v[22:23], v[116:117], v[26:27] op_sel_hi:[0,1,1] neg_lo:[1,0,0] neg_hi:[1,0,0]
    v_pk_mul_f32 v[28:29], v[24:25], v[132:133] op_sel:[1,0] neg_lo:[1,0] neg_hi:[1,0]
    v_pk_mul_f32 v[132:133], v[22:23], v[132:133] op_sel:[1,0]
    v_pk_fma_f32 v[132:133], v[24:25], v[148:149], v[132:133] op_sel:[1,0,0] neg_lo:[1,0,0] neg_hi:[1,0,0]
    v_pk_fma_f32 v[148:149], v[22:23], v[148:149], v[28:29] op_sel:[1,0,0] neg_lo:[1,0,0] neg_hi:[1,0,0]
    v_pk_mul_f32 v[26:27], v[24:25], v[102:103] op_sel_hi:[0,1] neg_lo:[1,0] neg_hi:[1,0]
    v_pk_mul_f32 v[102:103], v[22:23], v[102:103] op_sel_hi:[0,1]
    v_pk_fma_f32 v[102:103], v[24:25], v[118:119], v[102:103] op_sel_hi:[0,1,1] neg_lo:[1,0,0] neg_hi:[1,0,0]
    v_pk_fma_f32 v[118:119], v[22:23], v[118:119], v[26:27] op_sel_hi:[0,1,1] neg_lo:[1,0,0] neg_hi:[1,0,0]
    v_pk_mul_f32 v[28:29], v[24:25], v[134:135] op_sel:[1,0] neg_lo:[1,0] neg_hi:[1,0]
    v_pk_mul_f32 v[134:135], v[22:23], v[134:135] op_sel:[1,0]
    v_pk_fma_f32 v[134:135], v[24:25], v[150:151], v[134:135] op_sel:[1,0,0] neg_lo:[1,0,0] neg_hi:[1,0,0]
    v_pk_fma_f32 v[150:151], v[22:23], v[150:151], v[28:29] op_sel:[1,0,0] neg_lo:[1,0,0] neg_hi:[1,0,0]
    v_pk_mul_f32 v[26:27], v[24:25], v[104:105] op_sel_hi:[0,1] neg_lo:[1,0] neg_hi:[1,0]
    v_pk_mul_f32 v[104:105], v[22:23], v[104:105] op_sel_hi:[0,1]
    v_pk_fma_f32 v[104:105], v[24:25], v[120:121], v[104:105] op_sel_hi:[0,1,1] neg_lo:[1,0,0] neg_hi:[1,0,0]
    v_pk_fma_f32 v[120:121], v[22:23], v[120:121], v[26:27] op_sel_hi:[0,1,1] neg_lo:[1,0,0] neg_hi:[1,0,0]
    v_pk_mul_f32 v[28:29], v[24:25], v[136:137] op_sel:[1,0] neg_lo:[1,0] neg_hi:[1,0]
    v_pk_mul_f32 v[136:137], v[22:23], v[136:137] op_sel:[1,0]
    v_pk_fma_f32 v[136:137], v[24:25], v[152:153], v[136:137] op_sel:[1,0,0] neg_lo:[1,0,0] neg_hi:[1,0,0]
    v_pk_fma_f32 v[152:153], v[22:23], v[152:153], v[28:29] op_sel:[1,0,0] neg_lo:[1,0,0] neg_hi:[1,0,0]
    v_pk_mul_f32 v[26:27], v[24:25], v[106:107] op_sel_hi:[0,1] neg_lo:[1,0] neg_hi:[1,0]
    v_pk_mul_f32 v[106:107], v[22:23], v[106:107] op_sel_hi:[0,1]
    v_pk_fma_f32 v[106:107], v[24:25], v[122:123], v[106:107] op_sel_hi:[0,1,1] neg_lo:[1,0,0] neg_hi:[1,0,0]
    v_pk_fma_f32 v[122:123], v[22:23], v[122:123], v[26:27] op_sel_hi:[0,1,1] neg_lo:[1,0,0] neg_hi:[1,0,0]
    v_pk_mul_f32 v[28:29], v[24:25], v[138:139] op_sel:[1,0] neg_lo:[1,0] neg_hi:[1,0]
    v_pk_mul_f32 v[138:139], v[22:23], v[138:139] op_sel:[1,0]
    v_pk_fma_f32 v[138:139], v[24:25], v[154:155], v[138:139] op_sel:[1,0,0] neg_lo:[1,0,0] neg_hi:[1,0,0]
    v_pk_fma_f32 v[154:155], v[22:23], v[154:155], v[28:29] op_sel:[1,0,0] neg_lo:[1,0,0] neg_hi:[1,0,0]
    v_pk_mul_f32 v[26:27], v[24:25], v[108:109] op_sel_hi:[0,1] neg_lo:[1,0] neg_hi:[1,0]
    v_pk_mul_f32 v[108:109], v[22:23], v[108:109] op_sel_hi:[0,1]
    v_pk_fma_f32 v[108:109], v[24:25], v[124:125], v[108:109] op_sel_hi:[0,1,1] neg_lo:[1,0,0] neg_hi:[1,0,0]
    v_pk_fma_f32 v[124:125], v[22:23], v[124:125], v[26:27] op_sel_hi:[0,1,1] neg_lo:[1,0,0] neg_hi:[1,0,0]
    v_pk_mul_f32 v[28:29], v[24:25], v[140:141] op_sel:[1,0] neg_lo:[1,0] neg_hi:[1,0]
    v_pk_mul_f32 v[140:141], v[22:23], v[140:141] op_sel:[1,0]
    v_pk_fma_f32 v[140:141], v[24:25], v[156:157], v[140:141] op_sel:[1,0,0] neg_lo:[1,0,0] neg_hi:[1,0,0]
    v_pk_fma_f32 v[156:157], v[22:23], v[156:157], v[28:29] op_sel:[1,0,0] neg_lo:[1,0,0] neg_hi:[1,0,0]
    v_pk_mul_f32 v[26:27], v[24:25], v[110:111] op_sel_hi:[0,1] neg_lo:[1,0] neg_hi:[1,0]
    v_pk_mul_f32 v[110:111], v[22:23], v[110:111] op_sel_hi:[0,1]
    v_pk_fma_f32 v[110:111], v[24:25], v[126:127], v[110:111] op_sel_hi:[0,1,1] neg_lo:[1,0,0] neg_hi:[1,0,0]
    v_pk_fma_f32 v[126:127], v[22:23], v[126:127], v[26:27] op_sel_hi:[0,1,1] neg_lo:[1,0,0] neg_hi:[1,0,0]
    v_pk_mul_f32 v[28:29], v[24:25], v[142:143] op_sel:[1,0] neg_lo:[1,0] neg_hi:[1,0]
    v_pk_mul_f32 v[142:143], v[22:23], v[142:143] op_sel:[1,0]
    v_pk_fma_f32 v[142:143], v[24:25], v[158:159], v[142:143] op_sel:[1,0,0] neg_lo:[1,0,0] neg_hi:[1,0,0]
    v_pk_fma_f32 v[158:159], v[22:23], v[158:159], v[28:29] op_sel:[1,0,0] neg_lo:[1,0,0] neg_hi:[1,0,0]
    v_mov_b32 v9, s44
    v_cmp_le_i32 vcc, 0, v192
    s_nop 1
    v_cndmask_b32 v248, 0, v9, vcc
    v_cndmask_b32 v249, 0, v9, vcc
    v_cmp_le_i32 vcc, 0, v193
    s_nop 1
    v_cndmask_b32 v250, 0, v9, vcc
    v_cndmask_b32 v251, 0, v9, vcc
    v_cmp_le_i32 vcc, 0, v194
    s_nop 1
    v_cndmask_b32 v252, 0, v9, vcc
    v_cndmask_b32 v253, 0, v9, vcc
    v_cmp_le_i32 vcc, 0, v195
    s_nop 1
    v_cndmask_b32 v254, 0, v9, vcc
    v_cndmask_b32 v255, 0, v9, vcc
    s_lshl_b32 s33, s29, 12
    s_add_u32 s33, s33, 131072
    v_lshrrev_b32 v8, 1, v6
    v_and_b32 v8, 4, v8
    v_and_b32 v9, 7, v6
    v_xor_b32 v8, v8, v9
    v_lshlrev_b32 v9, 1, v7
    v_xor_b32 v8, v8, v9
    v_lshlrev_b32 v8, 4, v8
    v_lshl_add_u32 v8, v6, 7, v8
    v_add_u32 v2, s33, v8
    v_xor_b32 v3, 16, v2
    v_bfe_u32 v8, v1, 2, 2
    v_bfe_u32 v9, v1, 1, 1
    v_xor_b32 v9, v9, v8
    v_and_b32 v4, 1, v7
    v_lshlrev_b32 v4, 2, v4
    v_xor_b32 v9, v9, v4
    v_lshlrev_b32 v9, 4, v9
    v_lshl_add_u32 v8, v7, 3, v8
    v_lshl_add_u32 v9, v8, 7, v9
    v_and_b32 v8, 1, v1
    v_lshl_add_u32 v9, v8, 3, v9
    v_add_u32 v4, s33, v9
    v_xor_b32 v5, 32, v4
    v_xor_b32 v30, 64, v4
    v_xor_b32 v31, 96, v4
    s_mov_b32 s45, 32768
    s_sleep 12
    buffer_load_dwordx4 v[160:163], v192, s[36:39], 0 offen offset:0 sc1
    buffer_load_dwordx4 v[164:167], v192, s[36:39], 0 offen offset:256 sc1
    buffer_load_dwordx4 v[168:171], v193, s[36:39], 0 offen offset:0 sc1
    buffer_load_dwordx4 v[172:175], v193, s[36:39], 0 offen offset:256 sc1
    buffer_load_dwordx4 v[176:179], v194, s[36:39], 0 offen offset:0 sc1
    buffer_load_dwordx4 v[180:183], v194, s[36:39], 0 offen offset:256 sc1
    buffer_load_dwordx4 v[184:187], v195, s[36:39], 0 offen offset:0 sc1
    buffer_load_dwordx4 v[188:191], v195, s[36:39], 0 offen offset:256 sc1
Lc_lbpoll:
    s_waitcnt vmcnt(0)
    v_cmp_ne_u64 s[46:47], v[162:163], v[248:249]
    v_cmp_ne_u64 s[48:49], v[166:167], v[248:249]
    v_cmp_ne_u64 s[50:51], v[170:171], v[250:251]
    v_cmp_ne_u64 s[52:53], v[174:175], v[250:251]
    v_cmp_ne_u64 s[54:55], v[178:179], v[252:253]
    v_cmp_ne_u64 s[56:57], v[182:183], v[252:253]
    v_cmp_ne_u64 s[58:59], v[186:187], v[254:255]
    v_cmp_ne_u64 s[60:61], v[190:191], v[254:255]
    s_or_b64 s[46:47], s[46:47], s[48:49]
    s_or_b64 s[50:51], s[50:51], s[52:53]
    s_or_b64 s[54:55], s[54:55], s[56:57]
    s_or_b64 s[58:59], s[58:59], s[60:61]
    s_or_b64 s[46:47], s[46:47], s[50:51]
    s_or_b64 s[54:55], s[54:55], s[58:59]
    s_or_b64 s[46:47], s[46:47], s[54:55]
    s_cbranch_scc0 Lc_lbok
    s_sub_u32 s45, s45, 1
    s_cbranch_scc1 Lc_lbok
    buffer_load_dwordx4 v[160:163], v192, s[36:39], 0 offen offset:0 sc1
    buffer_load_dwordx4 v[164:167], v192, s[36:39], 0 offen offset:256 sc1
    buffer_load_dwordx4 v[168:171], v193, s[36:39], 0 offen offset:0 sc1
    buffer_load_dwordx4 v[172:175], v193, s[36:39], 0 offen offset:256 sc1
    buffer_load_dwordx4 v[176:179], v194, s[36:39], 0 offen offset:0 sc1
    buffer_load_dwordx4 v[180:183], v194, s[36:39], 0 offen offset:256 sc1
    buffer_load_dwordx4 v[184:187], v195, s[36:39], 0 offen offset:0 sc1
    buffer_load_dwordx4 v[188:191], v195, s[36:39], 0 offen offset:256 sc1
    s_branch Lc_lbpoll
Lc_lbok:
    v_pk_fma_f32 v[176:177], v[244:245], v[184:185], v[176:177] op_sel_hi:[0,1,1]
    v_pk_fma_f32 v[176:177], v[184:185], v[246:247], v[176:177] op_sel:[1,0,0] op_sel_hi:[0,0,1] neg_lo:[1,0,0]
    v_pk_fma_f32 v[180:181], v[244:245], v[188:189], v[180:181] op_sel:[1,0,0]
    v_pk_fma_f32 v[180:181], v[246:247], v[188:189], v[180:181] op_sel:[1,1,0] op_sel_hi:[1,0,1] neg_lo:[0,1,0]
    v_pk_fma_f32 v[168:169], v[244:245], v[176:177], v[168:169] op_sel_hi:[0,1,1]
    v_pk_fma_f32 v[168:169], v[176:177], v[246:247], v[168:169] op_sel:[1,0,0] op_sel_hi:[0,0,1] neg_lo:[1,0,0]
    v_pk_fma_f32 v[172:173], v[244:245], v[180:181], v[172:173] op_sel:[1,0,0]
    v_pk_fma_f32 v[172:173], v[246:247], v[180:181], v[172:173] op_sel:[1,1,0] op_sel_hi:[1,0,1] neg_lo:[0,1,0]
    v_pk_fma_f32 v[160:161], v[244:245], v[168:169], v[160:161] op_sel_hi:[0,1,1]
    v_pk_fma_f32 v[160:161], v[168:169], v[246:247], v[160:161] op_sel:[1,0,0] op_sel_hi:[0,0,1] neg_lo:[1,0,0]
    v_pk_fma_f32 v[164:165], v[244:245], v[172:173], v[164:165] op_sel:[1,0,0]
    v_pk_fma_f32 v[164:165], v[246:247], v[172:173], v[164:165] op_sel:[1,1,0] op_sel_hi:[1,0,1] neg_lo:[0,1,0]
    v_pk_mul_f32 v[168:169], v[240:241], v[160:161] op_sel_hi:[0,1]
    v_pk_mul_f32 v[172:173], v[240:241], v[164:165] op_sel:[1,0]
    v_pk_fma_f32 v[168:169], v[160:161], v[242:243], v[168:169] op_sel:[1,0,0] op_sel_hi:[0,0,1] neg_lo:[1,0,0]
    v_pk_fma_f32 v[172:173], v[242:243], v[164:165], v[172:173] op_sel:[1,1,0] op_sel_hi:[1,0,1] neg_lo:[0,1,0]
    v_mov_b32 v170, v168
    v_mov_b32 v171, v169
    v_mov_b32 v174, v172
    v_mov_b32 v175, v173
    v_permlane16_swap_b32 v168, v170
    v_permlane16_swap_b32 v169, v171
    v_permlane16_swap_b32 v172, v174
    v_permlane16_swap_b32 v173, v175
    v_pk_add_f32 v[168:169], v[168:169], v[170:171]
    v_pk_add_f32 v[172:173], v[172:173], v[174:175]
    v_mov_b32 v170, v168
    v_mov_b32 v171, v169
    v_mov_b32 v174, v172
    v_mov_b32 v175, v173
    v_permlane32_swap_b32 v168, v170
    v_permlane32_swap_b32 v169, v171
    v_permlane32_swap_b32 v172, v174
    v_permlane32_swap_b32 v173, v175
    v_pk_add_f32 v[168:169], v[168:169], v[170:171]
    v_pk_add_f32 v[172:173], v[172:173], v[174:175]
    v_pk_fma_f32 v[32:33], v[232:233], v[168:169], v[32:33] op_sel_hi:[1,0,1]
    v_pk_fma_f32 v[34:35], v[168:169], v[232:233], v[34:35] op_sel:[1,0,0]
    v_pk_fma_f32 v[36:37], v[234:235], v[172:173], v[36:37] op_sel_hi:[1,0,1]
    v_pk_fma_f32 v[38:39], v[172:173], v[234:235], v[38:39] op_sel:[1,0,0]
    v_pk_fma_f32 v[32:33], v[168:169], v[236:237], v[32:33] op_sel:[1,0,0] neg_lo:[1,0,0] neg_hi:[1,0,0]
    v_pk_fma_f32 v[34:35], v[236:237], v[168:169], v[34:35] op_sel_hi:[1,0,1]
    v_pk_fma_f32 v[36:37], v[172:173], v[238:239], v[36:37] op_sel:[1,0,0] neg_lo:[1,0,0] neg_hi:[1,0,0]
    v_pk_fma_f32 v[38:39], v[238:239], v[172:173], v[38:39] op_sel_hi:[1,0,1]
    s_mov_b32 s33, 16384
    v_pk_fma_f32 v[96:97], v[200:201], v[32:33], v[96:97] op_sel_hi:[0,1,1]
    v_pk_fma_f32 v[96:97], v[200:201], v[34:35], v[96:97] op_sel:[1,0,0] neg_lo:[1,0,0] neg_hi:[1,0,0]
    v_pk_fma_f32 v[98:99], v[204:205], v[32:33], v[98:99] op_sel_hi:[0,1,1]
    v_pk_fma_f32 v[98:99], v[204:205], v[34:35], v[98:99] op_sel:[1,0,0] neg_lo:[1,0,0] neg_hi:[1,0,0]
    v_pk_fma_f32 v[100:101], v[208:209], v[32:33], v[100:101] op_sel_hi:[0,1,1]
    v_pk_fma_f32 v[100:101], v[208:209], v[34:35], v[100:101] op_sel:[1,0,0] neg_lo:[1,0,0] neg_hi:[1,0,0]
    v_pk_fma_f32 v[102:103], v[212:213], v[32:33], v[102:103] op_sel_hi:[0,1,1]
    v_pk_fma_f32 v[102:103], v[212:213], v[34:35], v[102:103] op_sel:[1,0,0] neg_lo:[1,0,0] neg_hi:[1,0,0]
    v_pk_fma_f32 v[104:105], v[216:217], v[32:33], v[104:105] op_sel_hi:[0,1,1]
    v_pk_fma_f32 v[104:105], v[216:217], v[34:35], v[104:105] op_sel:[1,0,0] neg_lo:[1,0,0] neg_hi:[1,0,0]
    v_pk_fma_f32 v[106:107], v[220:221], v[32:33], v[106:107] op_sel_hi:[0,1,1]
    v_pk_fma_f32 v[106:107], v[220:221], v[34:35], v[106:107] op_sel:[1,0,0] neg_lo:[1,0,0] neg_hi:[1,0,0]
    v_pk_fma_f32 v[108:109], v[224:225], v[32:33], v[108:109] op_sel_hi:[0,1,1]
    v_pk_fma_f32 v[108:109], v[224:225], v[34:35], v[108:109] op_sel:[1,0,0] neg_lo:[1,0,0] neg_hi:[1,0,0]
    v_pk_fma_f32 v[110:111], v[228:229], v[32:33], v[110:111] op_sel_hi:[0,1,1]
    v_pk_fma_f32 v[110:111], v[228:229], v[34:35], v[110:111] op_sel:[1,0,0] neg_lo:[1,0,0] neg_hi:[1,0,0]
    v_cvt_pk_bf16_f32 v160, v96, v98
    v_cvt_pk_bf16_f32 v161, v100, v102
    v_cvt_pk_bf16_f32 v162, v104, v106
    v_cvt_pk_bf16_f32 v163, v108, v110
    ds_write_b128 v2, v[160:163] offset:0
    v_cvt_pk_bf16_f32 v164, v97, v99
    v_cvt_pk_bf16_f32 v165, v101, v103
    v_cvt_pk_bf16_f32 v166, v105, v107
    v_cvt_pk_bf16_f32 v167, v109, v111
    ds_write_b128 v3, v[164:167] offset:0
    v_pk_fma_f32 v[128:129], v[202:203], v[36:37], v[128:129] op_sel_hi:[0,1,1]
    v_pk_fma_f32 v[128:129], v[202:203], v[38:39], v[128:129] op_sel:[1,0,0] neg_lo:[1,0,0] neg_hi:[1,0,0]
    v_pk_fma_f32 v[130:131], v[206:207], v[36:37], v[130:131] op_sel_hi:[0,1,1]
    v_pk_fma_f32 v[130:131], v[206:207], v[38:39], v[130:131] op_sel:[1,0,0] neg_lo:[1,0,0] neg_hi:[1,0,0]
    v_pk_fma_f32 v[132:133], v[210:211], v[36:37], v[132:133] op_sel_hi:[0,1,1]
    v_pk_fma_f32 v[132:133], v[210:211], v[38:39], v[132:133] op_sel:[1,0,0] neg_lo:[1,0,0] neg_hi:[1,0,0]
    v_pk_fma_f32 v[134:135], v[214:215], v[36:37], v[134:135] op_sel_hi:[0,1,1]
    v_pk_fma_f32 v[134:135], v[214:215], v[38:39], v[134:135] op_sel:[1,0,0] neg_lo:[1,0,0] neg_hi:[1,0,0]
    v_pk_fma_f32 v[136:137], v[218:219], v[36:37], v[136:137] op_sel_hi:[0,1,1]
    v_pk_fma_f32 v[136:137], v[218:219], v[38:39], v[136:137] op_sel:[1,0,0] neg_lo:[1,0,0] neg_hi:[1,0,0]
    v_pk_fma_f32 v[138:139], v[222:223], v[36:37], v[138:139] op_sel_hi:[0,1,1]
    v_pk_fma_f32 v[138:139], v[222:223], v[38:39], v[138:139] op_sel:[1,0,0] neg_lo:[1,0,0] neg_hi:[1,0,0]
    v_pk_fma_f32 v[140:141], v[226:227], v[36:37], v[140:141] op_sel_hi:[0,1,1]
    v_pk_fma_f32 v[140:141], v[226:227], v[38:39], v[140:141] op_sel:[1,0,0] neg_lo:[1,0,0] neg_hi:[1,0,0]
    v_pk_fma_f32 v[142:143], v[230:231], v[36:37], v[142:143] op_sel_hi:[0,1,1]
    v_pk_fma_f32 v[142:143], v[230:231], v[38:39], v[142:143] op_sel:[1,0,0] neg_lo:[1,0,0] neg_hi:[1,0,0]
    v_cvt_pk_bf16_f32 v168, v128, v130
    v_cvt_pk_bf16_f32 v169, v132, v134
    v_cvt_pk_bf16_f32 v170, v136, v138
    v_cvt_pk_bf16_f32 v171, v140, v142
    ds_write_b128 v2, v[168:171] offset:2048
    v_cvt_pk_bf16_f32 v172, v129, v131
    v_cvt_pk_bf16_f32 v173, v133, v135
    v_cvt_pk_bf16_f32 v174, v137, v139
    v_cvt_pk_bf16_f32 v175, v141, v143
    ds_write_b128 v3, v[172:175] offset:2048
    ds_read_b64_tr_b16 v[96:97], v4 offset:0
    ds_read_b64_tr_b16 v[98:99], v30 offset:512
    ds_read_b64_tr_b16 v[100:101], v5 offset:0
    ds_read_b64_tr_b16 v[102:103], v31 offset:512
    ds_read_b64_tr_b16 v[104:105], v30 offset:0
    ds_read_b64_tr_b16 v[106:107], v4 offset:512
    ds_read_b64_tr_b16 v[108:109], v31 offset:0
    ds_read_b64_tr_b16 v[110:111], v5 offset:512
    v_pk_fma_f32 v[112:113], v[200:201], v[34:35], v[112:113] op_sel_hi:[0,1,1] neg_lo:[1,0,0] neg_hi:[1,0,0]
    v_pk_fma_f32 v[112:113], v[200:201], v[32:33], v[112:113] op_sel:[1,0,0] neg_lo:[1,0,0] neg_hi:[1,0,0]
    v_pk_fma_f32 v[114:115], v[204:205], v[34:35], v[114:115] op_sel_hi:[0,1,1] neg_lo:[1,0,0] neg_hi:[1,0,0]
    v_pk_fma_f32 v[114:115], v[204:205], v[32:33], v[114:115] op_sel:[1,0,0] neg_lo:[1,0,0] neg_hi:[1,0,0]
    v_pk_fma_f32 v[116:117], v[208:209], v[34:35], v[116:117] op_sel_hi:[0,1,1] neg_lo:[1,0,0] neg_hi:[1,0,0]
    v_pk_fma_f32 v[116:117], v[208:209], v[32:33], v[116:117] op_sel:[1,0,0] neg_lo:[1,0,0] neg_hi:[1,0,0]
    v_pk_fma_f32 v[118:119], v[212:213], v[34:35], v[118:119] op_sel_hi:[0,1,1] neg_lo:[1,0,0] neg_hi:[1,0,0]
    v_pk_fma_f32 v[118:119], v[212:213], v[32:33], v[118:119] op_sel:[1,0,0] neg_lo:[1,0,0] neg_hi:[1,0,0]
    v_pk_fma_f32 v[120:121], v[216:217], v[34:35], v[120:121] op_sel_hi:[0,1,1] neg_lo:[1,0,0] neg_hi:[1,0,0]
    v_pk_fma_f32 v[120:121], v[216:217], v[32:33], v[120:121] op_sel:[1,0,0] neg_lo:[1,0,0] neg_hi:[1,0,0]
    v_pk_fma_f32 v[122:123], v[220:221], v[34:35], v[122:123] op_sel_hi:[0,1,1] neg_lo:[1,0,0] neg_hi:[1,0,0]
    v_pk_fma_f32 v[122:123], v[220:221], v[32:33], v[122:123] op_sel:[1,0,0] neg_lo:[1,0,0] neg_hi:[1,0,0]
    v_pk_fma_f32 v[124:125], v[224:225], v[34:35], v[124:125] op_sel_hi:[0,1,1] neg_lo:[1,0,0] neg_hi:[1,0,0]
    v_pk_fma_f32 v[124:125], v[224:225], v[32:33], v[124:125] op_sel:[1,0,0] neg_lo:[1,0,0] neg_hi:[1,0,0]
    v_pk_fma_f32 v[126:127], v[228:229], v[34:35], v[126:127] op_sel_hi:[0,1,1] neg_lo:[1,0,0] neg_hi:[1,0,0]
    v_pk_fma_f32 v[126:127], v[228:229], v[32:33], v[126:127] op_sel:[1,0,0] neg_lo:[1,0,0] neg_hi:[1,0,0]
    v_cvt_pk_bf16_f32 v176, v112, v114
    v_cvt_pk_bf16_f32 v177, v116, v118
    v_cvt_pk_bf16_f32 v178, v120, v122
    v_cvt_pk_bf16_f32 v179, v124, v126
    ds_write_b128 v2, v[176:179] offset:0
    v_cvt_pk_bf16_f32 v180, v113, v115
    v_cvt_pk_bf16_f32 v181, v117, v119
    v_cvt_pk_bf16_f32 v182, v121, v123
    v_cvt_pk_bf16_f32 v183, v125, v127
    ds_write_b128 v3, v[180:183] offset:0
    s_waitcnt lgkmcnt(8)
    buffer_store_dwordx4 v[96:99], v196, s[40:43], 0 offen offset:0 sc1
    s_waitcnt lgkmcnt(6)
    buffer_store_dwordx4 v[100:103], v196, s[40:43], 0 offen offset:1024 sc1
    s_waitcnt lgkmcnt(4)
    buffer_store_dwordx4 v[104:107], v196, s[40:43], 0 offen offset:2048 sc1
    s_waitcnt lgkmcnt(2)
    buffer_store_dwordx4 v[108:111], v196, s[40:43], 0 offen offset:3072 sc1
    v_pk_fma_f32 v[144:145], v[202:203], v[38:39], v[144:145] op_sel_hi:[0,1,1] neg_lo:[1,0,0] neg_hi:[1,0,0]
    v_pk_fma_f32 v[144:145], v[202:203], v[36:37], v[144:145] op_sel:[1,0,0] neg_lo:[1,0,0] neg_hi:[1,0,0]
    v_pk_fma_f32 v[146:147], v[206:207], v[38:39], v[146:147] op_sel_hi:[0,1,1] neg_lo:[1,0,0] neg_hi:[1,0,0]
    v_pk_fma_f32 v[146:147], v[206:207], v[36:37], v[146:147] op_sel:[1,0,0] neg_lo:[1,0,0] neg_hi:[1,0,0]
    v_pk_fma_f32 v[148:149], v[210:211], v[38:39], v[148:149] op_sel_hi:[0,1,1] neg_lo:[1,0,0] neg_hi:[1,0,0]
    v_pk_fma_f32 v[148:149], v[210:211], v[36:37], v[148:149] op_sel:[1,0,0] neg_lo:[1,0,0] neg_hi:[1,0,0]
    v_pk_fma_f32 v[150:151], v[214:215], v[38:39], v[150:151] op_sel_hi:[0,1,1] neg_lo:[1,0,0] neg_hi:[1,0,0]
    v_pk_fma_f32 v[150:151], v[214:215], v[36:37], v[150:151] op_sel:[1,0,0] neg_lo:[1,0,0] neg_hi:[1,0,0]
    v_pk_fma_f32 v[152:153], v[218:219], v[38:39], v[152:153] op_sel_hi:[0,1,1] neg_lo:[1,0,0] neg_hi:[1,0,0]
    v_pk_fma_f32 v[152:153], v[218:219], v[36:37], v[152:153] op_sel:[1,0,0] neg_lo:[1,0,0] neg_hi:[1,0,0]
    v_pk_fma_f32 v[154:155], v[222:223], v[38:39], v[154:155] op_sel_hi:[0,1,1] neg_lo:[1,0,0] neg_hi:[1,0,0]
    v_pk_fma_f32 v[154:155], v[222:223], v[36:37], v[154:155] op_sel:[1,0,0] neg_lo:[1,0,0] neg_hi:[1,0,0]
    v_pk_fma_f32 v[156:157], v[226:227], v[38:39], v[156:157] op_sel_hi:[0,1,1] neg_lo:[1,0,0] neg_hi:[1,0,0]
    v_pk_fma_f32 v[156:157], v[226:227], v[36:37], v[156:157] op_sel:[1,0,0] neg_lo:[1,0,0] neg_hi:[1,0,0]
    v_pk_fma_f32 v[158:159], v[230:231], v[38:39], v[158:159] op_sel_hi:[0,1,1] neg_lo:[1,0,0] neg_hi:[1,0,0]
    v_pk_fma_f32 v[158:159], v[230:231], v[36:37], v[158:159] op_sel:[1,0,0] neg_lo:[1,0,0] neg_hi:[1,0,0]
    v_cvt_pk_bf16_f32 v184, v144, v146
    v_cvt_pk_bf16_f32 v185, v148, v150
    v_cvt_pk_bf16_f32 v186, v152, v154
    v_cvt_pk_bf16_f32 v187, v156, v158
    ds_write_b128 v2, v[184:187] offset:2048
    v_cvt_pk_bf16_f32 v188, v145, v147
    v_cvt_pk_bf16_f32 v189, v149, v151
    v_cvt_pk_bf16_f32 v190, v153, v155
    v_cvt_pk_bf16_f32 v191, v157, v159
    ds_write_b128 v3, v[188:191] offset:2048
    ds_read_b64_tr_b16 v[128:129], v4 offset:0
    ds_read_b64_tr_b16 v[130:131], v30 offset:512
    ds_read_b64_tr_b16 v[132:133], v5 offset:0
    ds_read_b64_tr_b16 v[134:135], v31 offset:512
    ds_read_b64_tr_b16 v[136:137], v30 offset:0
    ds_read_b64_tr_b16 v[138:139], v4 offset:512
    ds_read_b64_tr_b16 v[140:141], v31 offset:0
    ds_read_b64_tr_b16 v[142:143], v5 offset:512
    s_waitcnt lgkmcnt(6)
    buffer_store_dwordx4 v[128:131], v196, s[40:43], s33 offen offset:0 sc1
    s_waitcnt lgkmcnt(4)
    buffer_store_dwordx4 v[132:135], v196, s[40:43], s33 offen offset:1024 sc1
    s_waitcnt lgkmcnt(2)
    buffer_store_dwordx4 v[136:139], v196, s[40:43], s33 offen offset:2048 sc1
    s_waitcnt lgkmcnt(0)
    buffer_store_dwordx4 v[140:143], v196, s[40:43], s33 offen offset:3072 sc1
    s_lshl_b32 s33, s26, 11
    s_add_u32 s33, s33, 3932160
    s_add_u32 s36, s20, s33
    s_addc_u32 s37, s21, 0
    s_mov_b32 s38, 2048
    s_lshl_b32 s47, s27, 7
    v_mov_b32 v190, s44
    v_lshlrev_b32 v191, 2, v1
    v_lshlrev_b32 v192, 7, v6
    v_mov_b32 v193, 1
    v_mov_b32 v194, 147456
    v_lshrrev_b32 v2, 1, v6
    v_xor_b32 v2, v2, v7
    v_lshlrev_b32 v2, 4, v2
    v_lshl_add_u32 v2, v6, 7, v2
    v_add_u32 v2, 65536, v2
    v_xor_b32 v3, 64, v2
    v_and_b32 v5, 7, v6
    v_xor_b32 v5, v5, v7
    v_lshlrev_b32 v5, 4, v5
    v_lshl_add_u32 v5, v6, 8, v5
    s_lshl_b32 s33, s29, 13
    s_add_u32 s33, s33, 0
    v_add_u32 v186, s33, v5
    v_xor_b32 v187, 64, v186
    v_xor_b32 v188, 128, v186
    v_xor_b32 v189, 192, v186
    v_mov_b32 v200, 0
    v_mov_b32 v201, 0
    v_mov_b32 v202, 0
    v_mov_b32 v203, 0
    v_mov_b32 v204, 0
    v_mov_b32 v205, 0
    v_mov_b32 v206, 0
    v_mov_b32 v207, 0
    v_mov_b32 v208, 0
    v_mov_b32 v209, 0
    v_mov_b32 v210, 0
    v_mov_b32 v211, 0
    v_mov_b32 v212, 0
    v_mov_b32 v213, 0
    v_mov_b32 v214, 0
    v_mov_b32 v215, 0
    v_mov_b32 v216, 0
    v_mov_b32 v217, 0
    v_mov_b32 v218, 0
    v_mov_b32 v219, 0
    v_mov_b32 v220, 0
    v_mov_b32 v221, 0
    v_mov_b32 v222, 0
    v_mov_b32 v223, 0
    v_mov_b32 v224, 0
    v_mov_b32 v225, 0
    v_mov_b32 v226, 0
    v_mov_b32 v227, 0
    v_mov_b32 v228, 0
    v_mov_b32 v229, 0
    v_mov_b32 v230, 0
    v_mov_b32 v231, 0
    s_lshr_b32 s61, s25, 3
    s_lshl_b32 s62, s24, 1
    s_add_u32 s61, s61, s62
    s_and_b32 s61, s61, 15
    s_add_u32 s62, s61, s26
    s_and_b32 s62, s62, 15
    s_lshl_b32 s62, s62, 15
    s_lshl_b32 s32, s29, 11
    s_lshl_b32 s33, s26, 19
    s_add_u32 s33, s33, s32
    s_add_u32 s33, s33, 4194304
    s_waitcnt vmcnt(0)
    s_mov_b64 exec, 1
    ds_add_rtn_u32 v193, v194, v193 offset:24
    s_mov_b64 exec, -1
    s_add_u32 s40, s20, s33
    s_addc_u32 s41, s21, 0
    s_sub_u32 s42, 524288, s32
    s_waitcnt lgkmcnt(0)
    v_readfirstlane_b32 s46, v193
    s_cmp_lg_u32 s46, 3
    s_cbranch_scc1 Lc_hok
    s_mov_b64 exec, 0xffffffff
    buffer_store_dword v190, v191, s[36:39], s47 offen sc1
    ds_write_b32 v194, v194 offset:28
    s_mov_b64 exec, 0xffff
    s_sleep 24
    s_mov_b32 s45, 32768
Lc_hpoll:
    buffer_load_dword v193, v192, s[36:39], 0 offen sc1
    s_waitcnt vmcnt(0)
    v_cmp_ne_u32 vcc, s44, v193
    s_cbranch_vccz Lc_hdone
    s_sub_u32 s45, s45, 1
    s_cbranch_scc1 Lc_hdone
    s_sleep 4
    s_branch Lc_hpoll
Lc_hdone:
    s_mov_b64 exec, -1
Lc_hok:
    s_barrier
    buffer_load_dwordx4 v[40:43], v196, s[40:43], s62 offen offset:0 sc1
    buffer_load_dwordx4 v[44:47], v196, s[40:43], s62 offen offset:1024 sc1
    s_add_u32 s62, s62, 8192
    s_and_b32 s62, s62, 524287
    buffer_load_dwordx4 v[48:51], v196, s[40:43], s62 offen offset:0 sc1
    buffer_load_dwordx4 v[52:55], v196, s[40:43], s62 offen offset:1024 sc1
    s_add_u32 s62, s62, 8192
    s_and_b32 s62, s62, 524287
    buffer_load_dwordx4 v[56:59], v196, s[40:43], s62 offen offset:0 sc1
    buffer_load_dwordx4 v[60:63], v196, s[40:43], s62 offen offset:1024 sc1
    s_add_u32 s62, s62, 8192
    s_and_b32 s62, s62, 524287
    buffer_load_dwordx4 v[64:67], v196, s[40:43], s62 offen offset:0 sc1
    buffer_load_dwordx4 v[68:71], v196, s[40:43], s62 offen offset:1024 sc1
    s_add_u32 s62, s62, 8192
    s_and_b32 s62, s62, 524287
    buffer_load_dwordx4 v[72:75], v196, s[40:43], s62 offen offset:0 sc1
    buffer_load_dwordx4 v[76:79], v196, s[40:43], s62 offen offset:1024 sc1
    s_add_u32 s62, s62, 8192
    s_and_b32 s62, s62, 524287
    buffer_load_dwordx4 v[80:83], v196, s[40:43], s62 offen offset:0 sc1
    buffer_load_dwordx4 v[84:87], v196, s[40:43], s62 offen offset:1024 sc1
    s_add_u32 s62, s62, 8192
    s_and_b32 s62, s62, 524287
    ds_read_b128 v[8:11], v2 offset:0
    ds_read_b128 v[12:15], v2 offset:2048
    ds_read_b128 v[16:19], v2 offset:4096
    ds_read_b128 v[20:23], v2 offset:6144
    s_mov_b32 s35, 0
Lc2_loop:
    s_waitcnt vmcnt(11) lgkmcnt(0)
    v_mfma_f32_16x16x32_bf16 v[200:203], v[8:11], v[40:43], v[200:203]
    ds_read_b128 v[24:27], v3 offset:0
    v_mfma_f32_16x16x32_bf16 v[204:207], v[12:15], v[40:43], v[204:207]
    ds_read_b128 v[28:31], v3 offset:2048
    v_mfma_f32_16x16x32_bf16 v[208:211], v[16:19], v[40:43], v[208:211]
    ds_read_b128 v[32:35], v3 offset:4096
    v_mfma_f32_16x16x32_bf16 v[212:215], v[20:23], v[40:43], v[212:215]
    ds_read_b128 v[36:39], v3 offset:6144
    buffer_load_dwordx4 v[88:91], v196, s[40:43], s62 offen offset:0 sc1
    s_waitcnt vmcnt(11)
    v_mfma_f32_16x16x32_bf16 v[228:231], v[20:23], v[44:47], v[228:231]
    v_mfma_f32_16x16x32_bf16 v[224:227], v[16:19], v[44:47], v[224:227]
    v_mfma_f32_16x16x32_bf16 v[220:223], v[12:15], v[44:47], v[220:223]
    v_mfma_f32_16x16x32_bf16 v[216:219], v[8:11], v[44:47], v[216:219]
    buffer_load_dwordx4 v[92:95], v196, s[40:43], s62 offen offset:1024 sc1
    s_add_u32 s62, s62, 8192
    s_and_b32 s62, s62, 524287
    s_waitcnt vmcnt(11) lgkmcnt(0)
    v_mfma_f32_16x16x32_bf16 v[200:203], v[24:27], v[48:51], v[200:203]
    ds_read_b128 v[8:11], v2 offset:8192
    v_mfma_f32_16x16x32_bf16 v[204:207], v[28:31], v[48:51], v[204:207]
    ds_read_b128 v[12:15], v2 offset:10240
    v_mfma_f32_16x16x32_bf16 v[208:211], v[32:35], v[48:51], v[208:211]
    ds_read_b128 v[16:19], v2 offset:12288
    v_mfma_f32_16x16x32_bf16 v[212:215], v[36:39], v[48:51], v[212:215]
    ds_read_b128 v[20:23], v2 offset:14336
    buffer_load_dwordx4 v[96:99], v196, s[40:43], s62 offen offset:0 sc1
    s_waitcnt vmcnt(11)
    v_mfma_f32_16x16x32_bf16 v[228:231], v[36:39], v[52:55], v[228:231]
    v_mfma_f32_16x16x32_bf16 v[224:227], v[32:35], v[52:55], v[224:227]
    v_mfma_f32_16x16x32_bf16 v[220:223], v[28:31], v[52:55], v[220:223]
    v_mfma_f32_16x16x32_bf16 v[216:219], v[24:27], v[52:55], v[216:219]
    buffer_load_dwordx4 v[100:103], v196, s[40:43], s62 offen offset:1024 sc1
    s_add_u32 s62, s62, 8192
    s_and_b32 s62, s62, 524287
    s_cmp_eq_u32 s35, 7
    s_cselect_b32 s42, 0, s42
    s_waitcnt vmcnt(11) lgkmcnt(0)
    v_mfma_f32_16x16x32_bf16 v[200:203], v[8:11], v[56:59], v[200:203]
    ds_read_b128 v[24:27], v3 offset:8192
    v_mfma_f32_16x16x32_bf16 v[204:207], v[12:15], v[56:59], v[204:207]
    ds_read_b128 v[28:31], v3 offset:10240
    v_mfma_f32_16x16x32_bf16 v[208:211], v[16:19], v[56:59], v[208:211]
    ds_read_b128 v[32:35], v3 offset:12288
    v_mfma_f32_16x16x32_bf16 v[212:215], v[20:23], v[56:59], v[212:215]
    ds_read_b128 v[36:39], v3 offset:14336
    buffer_load_dwordx4 v[40:43], v196, s[40:43], s62 offen offset:0 sc1
    s_waitcnt vmcnt(11)
    v_mfma_f32_16x16x32_bf16 v[228:231], v[20:23], v[60:63], v[228:231]
    v_mfma_f32_16x16x32_bf16 v[224:227], v[16:19], v[60:63], v[224:227]
    v_mfma_f32_16x16x32_bf16 v[220:223], v[12:15], v[60:63], v[220:223]
    v_mfma_f32_16x16x32_bf16 v[216:219], v[8:11], v[60:63], v[216:219]
    buffer_load_dwordx4 v[44:47], v196, s[40:43], s62 offen offset:1024 sc1
    s_add_u32 s62, s62, 8192
    s_and_b32 s62, s62, 524287
    s_waitcnt vmcnt(11) lgkmcnt(0)
    v_mfma_f32_16x16x32_bf16 v[200:203], v[24:27], v[64:67], v[200:203]
    s_barrier
    v_mfma_f32_16x16x32_bf16 v[204:207], v[28:31], v[64:67], v[204:207]
    ds_read_b128 v[8:11], v2 offset:16384
    v_mfma_f32_16x16x32_bf16 v[208:211], v[32:35], v[64:67], v[208:211]
    ds_read_b128 v[12:15], v2 offset:18432
    v_mfma_f32_16x16x32_bf16 v[212:215], v[36:39], v[64:67], v[212:215]
    ds_read_b128 v[16:19], v2 offset:20480
    buffer_load_dwordx4 v[48:51], v196, s[40:43], s62 offen offset:0 sc1
    s_waitcnt vmcnt(11)
    v_mfma_f32_16x16x32_bf16 v[228:231], v[36:39], v[68:71], v[228:231]
    ds_read_b128 v[20:23], v2 offset:22528
    v_mfma_f32_16x16x32_bf16 v[224:227], v[32:35], v[68:71], v[224:227]
    v_mfma_f32_16x16x32_bf16 v[220:223], v[28:31], v[68:71], v[220:223]
    v_mfma_f32_16x16x32_bf16 v[216:219], v[24:27], v[68:71], v[216:219]
    buffer_load_dwordx4 v[52:55], v196, s[40:43], s62 offen offset:1024 sc1
    s_add_u32 s62, s62, 8192
    s_and_b32 s62, s62, 524287
    s_waitcnt vmcnt(11) lgkmcnt(0)
    v_mfma_f32_16x16x32_bf16 v[200:203], v[8:11], v[72:75], v[200:203]
    ds_read_b128 v[24:27], v3 offset:16384
    v_mfma_f32_16x16x32_bf16 v[204:207], v[12:15], v[72:75], v[204:207]
    ds_read_b128 v[28:31], v3 offset:18432
    v_mfma_f32_16x16x32_bf16 v[208:211], v[16:19], v[72:75], v[208:211]
    ds_read_b128 v[32:35], v3 offset:20480
    v_mfma_f32_16x16x32_bf16 v[212:215], v[20:23], v[72:75], v[212:215]
    ds_read_b128 v[36:39], v3 offset:22528
    buffer_load_dwordx4 v[56:59], v196, s[40:43], s62 offen offset:0 sc1
    s_waitcnt vmcnt(11)
    v_mfma_f32_16x16x32_bf16 v[228:231], v[20:23], v[76:79], v[228:231]
    v_mfma_f32_16x16x32_bf16 v[224:227], v[16:19], v[76:79], v[224:227]
    v_mfma_f32_16x16x32_bf16 v[220:223], v[12:15], v[76:79], v[220:223]
    v_mfma_f32_16x16x32_bf16 v[216:219], v[8:11], v[76:79], v[216:219]
    buffer_load_dwordx4 v[60:63], v196, s[40:43], s62 offen offset:1024 sc1
    s_add_u32 s62, s62, 8192
    s_and_b32 s62, s62, 524287
    s_waitcnt vmcnt(11) lgkmcnt(0)
    v_mfma_f32_16x16x32_bf16 v[200:203], v[24:27], v[80:83], v[200:203]
    ds_read_b128 v[8:11], v2 offset:24576
    v_mfma_f32_16x16x32_bf16 v[204:207], v[28:31], v[80:83], v[204:207]
    ds_read_b128 v[12:15], v2 offset:26624
    v_mfma_f32_16x16x32_bf16 v[208:211], v[32:35], v[80:83], v[208:211]
    ds_read_b128 v[16:19], v2 offset:28672
    v_mfma_f32_16x16x32_bf16 v[212:215], v[36:39], v[80:83], v[212:215]
    ds_read_b128 v[20:23], v2 offset:30720
    buffer_load_dwordx4 v[64:67], v196, s[40:43], s62 offen offset:0 sc1
    s_waitcnt vmcnt(11)
    v_mfma_f32_16x16x32_bf16 v[228:231], v[36:39], v[84:87], v[228:231]
    v_mfma_f32_16x16x32_bf16 v[224:227], v[32:35], v[84:87], v[224:227]
    v_mfma_f32_16x16x32_bf16 v[220:223], v[28:31], v[84:87], v[220:223]
    v_mfma_f32_16x16x32_bf16 v[216:219], v[24:27], v[84:87], v[216:219]
    buffer_load_dwordx4 v[68:71], v196, s[40:43], s62 offen offset:1024 sc1
    s_add_u32 s62, s62, 8192
    s_and_b32 s62, s62, 524287
    s_waitcnt vmcnt(11) lgkmcnt(0)
    v_mfma_f32_16x16x32_bf16 v[200:203], v[8:11], v[88:91], v[200:203]
    ds_read_b128 v[24:27], v3 offset:24576
    v_mfma_f32_16x16x32_bf16 v[204:207], v[12:15], v[88:91], v[204:207]
    ds_read_b128 v[28:31], v3 offset:26624
    v_mfma_f32_16x16x32_bf16 v[208:211], v[16:19], v[88:91], v[208:211]
    ds_read_b128 v[32:35], v3 offset:28672
    v_mfma_f32_16x16x32_bf16 v[212:215], v[20:23], v[88:91], v[212:215]
    ds_read_b128 v[36:39], v3 offset:30720
    buffer_load_dwordx4 v[72:75], v196, s[40:43], s62 offen offset:0 sc1
    s_waitcnt vmcnt(11)
    v_mfma_f32_16x16x32_bf16 v[228:231], v[20:23], v[92:95], v[228:231]
    v_mfma_f32_16x16x32_bf16 v[224:227], v[16:19], v[92:95], v[224:227]
    v_mfma_f32_16x16x32_bf16 v[220:223], v[12:15], v[92:95], v[220:223]
    v_mfma_f32_16x16x32_bf16 v[216:219], v[8:11], v[92:95], v[216:219]
    buffer_load_dwordx4 v[76:79], v196, s[40:43], s62 offen offset:1024 sc1
    s_add_u32 s62, s62, 8192
    s_and_b32 s62, s62, 524287
    s_cmp_eq_u32 s35, 7
    s_waitcnt vmcnt(11) lgkmcnt(0)
    v_mfma_f32_16x16x32_bf16 v[200:203], v[24:27], v[96:99], v[200:203]
    v_xor_b32 v2, 0x8000, v2
    v_xor_b32 v3, 0x8000, v3
    s_cbranch_scc1 Lc2_nobar
    s_barrier
Lc2_nobar:
    v_mfma_f32_16x16x32_bf16 v[204:207], v[28:31], v[96:99], v[204:207]
    ds_read_b128 v[8:11], v2 offset:0
    v_mfma_f32_16x16x32_bf16 v[208:211], v[32:35], v[96:99], v[208:211]
    ds_read_b128 v[12:15], v2 offset:2048
    v_mfma_f32_16x16x32_bf16 v[212:215], v[36:39], v[96:99], v[212:215]
    ds_read_b128 v[16:19], v2 offset:4096
    buffer_load_dwordx4 v[80:83], v196, s[40:43], s62 offen offset:0 sc1
    s_waitcnt vmcnt(11)
    v_mfma_f32_16x16x32_bf16 v[228:231], v[36:39], v[100:103], v[228:231]
    ds_read_b128 v[20:23], v2 offset:6144
    v_mfma_f32_16x16x32_bf16 v[224:227], v[32:35], v[100:103], v[224:227]
    v_mfma_f32_16x16x32_bf16 v[220:223], v[28:31], v[100:103], v[220:223]
    v_mfma_f32_16x16x32_bf16 v[216:219], v[24:27], v[100:103], v[216:219]
    buffer_load_dwordx4 v[84:87], v196, s[40:43], s62 offen offset:1024 sc1
    s_add_u32 s62, s62, 8192
    s_and_b32 s62, s62, 524287
    s_add_u32 s35, s35, 1
    s_cmp_lt_u32 s35, 8
    s_cbranch_scc1 Lc2_loop
    ds_write_b128 v186, v[200:203] offset:0
    ds_write_b128 v187, v[204:207] offset:0
    ds_write_b128 v188, v[208:211] offset:0
    ds_write_b128 v189, v[212:215] offset:0
    ds_write_b128 v186, v[216:219] offset:4096
    ds_write_b128 v187, v[220:223] offset:4096
    ds_write_b128 v188, v[224:227] offset:4096
    ds_write_b128 v189, v[228:231] offset:4096
    s_waitcnt lgkmcnt(0)
    s_barrier
L_end:
    s_endpgm
.section .rodata,"a"
.p2align 6
.amdhsa_kernel gated_mix__ssm_conv_s5__moe_arch_mod__prompt_kernel
  .amdhsa_next_free_vgpr 256
  .amdhsa_next_free_sgpr 102
  .amdhsa_accum_offset 256
  .amdhsa_group_segment_fixed_size 0
  .amdhsa_kernarg_size 144
  .amdhsa_user_sgpr_count 2
  .amdhsa_user_sgpr_kernarg_segment_ptr 1
  .amdhsa_system_sgpr_workgroup_id_x 1
  .amdhsa_float_denorm_mode_32 3
.end_amdhsa_kernel
```

```asm
; @launch grid=(256,1,1) block=(512,1,1) lds=163840
.amdgcn_target "amdgcn-amd-amdhsa--gfx950"
.text
.globl gated_mix__ssm_conv_s5__moe_arch_mod__prompt_kernel
.p2align 8
.type gated_mix__ssm_conv_s5__moe_arch_mod__prompt_kernel,@function
gated_mix__ssm_conv_s5__moe_arch_mod__prompt_kernel:
    s_cmp_ge_u32 s2, 256
    s_cbranch_scc1 L_end
    v_lshrrev_b32 v2, 6, v0
    v_and_b32 v1, 63, v0
    s_nop 0
    v_readfirstlane_b32 s29, v2
    s_and_b32 s24, s2, 7
    s_lshr_b32 s25, s2, 3
    s_lshr_b32 s26, s25, 3
    s_lshl_b32 s26, s26, 2
    s_lshr_b32 s27, s24, 1
    s_add_u32 s26, s26, s27
    s_and_b32 s27, s24, 1
    s_lshl_b32 s27, s27, 3
    s_and_b32 s28, s25, 7
    s_add_u32 s27, s27, s28
    s_cmp_lt_u32 s29, 4
    s_cbranch_scc1 L_compute
    s_load_dwordx2 s[56:57], s[0:1], 0
    s_load_dwordx4 s[12:15], s[0:1], 24
    s_load_dwordx2 s[36:37], s[0:1], 80
    s_load_dwordx2 s[40:41], s[0:1], 112
    s_load_dwordx2 s[16:17], s[0:1], 136
    s_load_dwordx2 s[44:45], s[0:1], 104
    s_load_dwordx2 s[48:49], s[0:1], 88
    s_load_dwordx2 s[52:53], s[0:1], 96
    s_and_b32 s30, s29, 3
    v_lshrrev_b32 v3, 3, v1
    v_and_b32 v4, 7, v1
    v_lshrrev_b32 v5, 1, v3
    v_xor_b32 v2, v4, v5
    v_lshlrev_b32 v2, 4, v2
    v_lshl_add_u32 v14, v3, 11, v2
    v_xor_b32 v15, 64, v14
    v_add_u32 v16, 30720, v14
    v_add_u32 v17, 46080, v15
    v_add_u32 v15, 15360, v15
    v_lshrrev_b32 v6, 2, v3
    v_lshlrev_b32 v6, 4, v6
    v_and_b32 v7, 1, v3
    v_lshl_add_u32 v6, v7, 3, v6
    v_and_b32 v7, 1, v5
    v_add_u32 v6, v6, v7
    v_lshl_add_u32 v10, v6, 11, v2
    v_xor_b32 v11, 64, v10
    v_add_u32 v12, 2048, v10
    v_add_u32 v13, 66560, v11
    v_add_u32 v11, 64512, v11
    s_lshr_b32 s31, s30, 1
    s_and_b32 s32, s30, 1
    s_lshl_b32 s33, s26, 7
    s_lshl_b32 s34, s31, 6
    s_add_u32 s33, s33, s34
    s_lshl_b32 s34, s32, 2
    s_add_u32 s33, s33, s34
    s_lshl_b32 s33, s33, 11
    s_lshl_b32 s34, s27, 6
    s_lshl_b32 s35, s31, 5
    s_add_u32 s34, s34, s35
    s_lshl_b32 s64, s34, 11
    s_lshl_b32 s60, s30, 12
    s_add_u32 s61, s26, s27
    s_and_b32 s61, s61, 15
    s_lshl_b32 s61, s61, 7
    s_cmp_eq_u32 s32, 1
    s_waitcnt lgkmcnt(0)
    s_cselect_b32 s12, s14, s12
    s_cselect_b32 s13, s15, s13
    s_add_u32 s12, s12, s64
    s_addc_u32 s13, s13, 0
    s_sub_u32 s14, 2097152, s64
    s_mov_b32 s15, 0x20000
    s_add_u32 s8, s56, s33
    s_addc_u32 s9, s57, 0
    s_sub_u32 s10, 4194304, s33
    s_mov_b32 s11, 0x20000
    s_lshl_b32 s62, s26, 7
    s_lshl_b32 s63, s27, 3
    s_add_u32 s62, s62, s63
    s_lshl_b32 s63, s30, 1
    s_add_u32 s62, s62, s63
    s_lshl_b32 s63, s62, 11
    v_lshlrev_b32 v18, 4, v1
    s_mov_b32 s58, 4194304
    s_mov_b32 s59, 0x20000
    s_mov_b32 s38, 2048
    s_mov_b32 s39, 0x20000
    s_mov_b32 s42, 2048
    s_mov_b32 s43, 0x20000
    buffer_load_dwordx4 v[44:47], v18, s[40:43], 0 offen offset:0
    buffer_load_dwordx4 v[36:39], v18, s[36:39], 0 offen offset:0
    buffer_load_dwordx4 v[48:51], v18, s[40:43], 0 offen offset:1024
    buffer_load_dwordx4 v[40:43], v18, s[36:39], 0 offen offset:1024
    buffer_load_dwordx4 v[20:23], v18, s[56:59], s63 offen offset:0
    buffer_load_dwordx4 v[24:27], v18, s[56:59], s63 offen offset:1024
    buffer_load_dwordx4 v[28:31], v18, s[56:59], s63 offen offset:2048
    buffer_load_dwordx4 v[32:35], v18, s[56:59], s63 offen offset:3072
    s_load_dwordx2 s[36:37], s[0:1], 64
    s_load_dwordx2 s[40:41], s[0:1], 120
    s_mov_b32 s42, 8388608
    s_add_u32 m0, s60, 0
    s_nop 0
    buffer_load_dwordx4 v10, s[8:11], s61 offen offset:0 lds
    buffer_load_dwordx4 v11, s[8:11], s61 offen offset:1024 lds
    buffer_load_dwordx4 v12, s[8:11], s61 offen offset:2048 lds
    buffer_load_dwordx4 v13, s[8:11], s61 offen offset:3072 lds
    s_add_u32 m0, s60, 16384
    s_nop 0
    buffer_load_dwordx4 v14, s[12:15], s61 offen offset:0 lds
    buffer_load_dwordx4 v15, s[12:15], s61 offen offset:1024 lds
    buffer_load_dwordx4 v16, s[12:15], s61 offen offset:2048 lds
    buffer_load_dwordx4 v17, s[12:15], s61 offen offset:3072 lds
    s_add_u32 s61, s61, 128
    s_and_b32 s61, s61, 2047
    v_mov_b32 v9, 0
    v_mov_b32 v8, 0
    v_mov_b32 v7, 147456
    ds_write_b64 v7, v[8:9]
    ds_write_b64 v7, v[8:9] offset:8
    ds_write_b64 v7, v[8:9] offset:16
    ds_write_b64 v7, v[8:9] offset:24
    ds_write_b32 v7, v9 offset:32
    s_mov_b32 s18, 268435456
    s_mov_b32 s19, 0x20000
    s_mov_b32 s46, 7340032
    s_mov_b32 s47, 0x20000
    s_mov_b32 s50, 7340032
    s_mov_b32 s51, 0x20000
    s_mov_b32 s54, 7340032
    s_mov_b32 s55, 0x20000
    s_load_dword s65, s[16:17], 0
    v_mov_b32 v96, 0x3f803f80
    v_mov_b32 v68, 0
    v_mov_b32 v69, 0
    v_mov_b32 v70, 0
    v_mov_b32 v71, 0
    s_waitcnt vmcnt(8)
    v_and_b32 v52, 0xffff, v44
    v_and_b32 v60, 0xffff0000, v44
    v_and_b32 v53, 0xffff, v45
    v_and_b32 v61, 0xffff0000, v45
    v_and_b32 v54, 0xffff, v46
    v_and_b32 v62, 0xffff0000, v46
    v_and_b32 v55, 0xffff, v47
    v_and_b32 v63, 0xffff0000, v47
    v_and_b32 v56, 0xffff, v48
    v_and_b32 v64, 0xffff0000, v48
    v_and_b32 v57, 0xffff, v49
    v_and_b32 v65, 0xffff0000, v49
    v_and_b32 v58, 0xffff, v50
    v_and_b32 v66, 0xffff0000, v50
    v_and_b32 v59, 0xffff, v51
    v_and_b32 v67, 0xffff0000, v51
    v_dot2_f32_bf16 v72, v20, v52, 0
    v_dot2_f32_bf16 v73, v20, v60, 0
    v_dot2_f32_bf16 v74, v28, v52, 0
    v_dot2_f32_bf16 v75, v28, v60, 0
    v_dot2c_f32_bf16 v68, v20, v36
    v_dot2c_f32_bf16 v69, v28, v36
    v_cvt_pk_bf16_f32 v72, v72, v73
    v_cvt_pk_bf16_f32 v74, v74, v75
    v_dot2_f32_bf16 v76, v21, v53, 0
    v_dot2_f32_bf16 v77, v21, v61, 0
    v_dot2_f32_bf16 v78, v29, v53, 0
    v_dot2_f32_bf16 v79, v29, v61, 0
    v_dot2c_f32_bf16 v68, v21, v37
    v_dot2c_f32_bf16 v69, v29, v37
    v_dot2c_f32_bf16 v70, v72, v96
    v_dot2c_f32_bf16 v71, v74, v96
    v_cvt_pk_bf16_f32 v76, v76, v77
    v_cvt_pk_bf16_f32 v78, v78, v79
    v_dot2_f32_bf16 v72, v22, v54, 0
    v_dot2_f32_bf16 v73, v22, v62, 0
    v_dot2_f32_bf16 v74, v30, v54, 0
    v_dot2_f32_bf16 v75, v30, v62, 0
    v_dot2c_f32_bf16 v68, v22, v38
    v_dot2c_f32_bf16 v69, v30, v38
    v_dot2c_f32_bf16 v70, v76, v96
    v_dot2c_f32_bf16 v71, v78, v96
    v_cvt_pk_bf16_f32 v72, v72, v73
    v_cvt_pk_bf16_f32 v74, v74, v75
    v_dot2_f32_bf16 v76, v23, v55, 0
    v_dot2_f32_bf16 v77, v23, v63, 0
    v_dot2_f32_bf16 v78, v31, v55, 0
    v_dot2_f32_bf16 v79, v31, v63, 0
    v_dot2c_f32_bf16 v68, v23, v39
    v_dot2c_f32_bf16 v69, v31, v39
    v_dot2c_f32_bf16 v70, v72, v96
    v_dot2c_f32_bf16 v71, v74, v96
    v_cvt_pk_bf16_f32 v76, v76, v77
    v_cvt_pk_bf16_f32 v78, v78, v79
    v_dot2_f32_bf16 v72, v24, v56, 0
    v_dot2_f32_bf16 v73, v24, v64, 0
    v_dot2_f32_bf16 v74, v32, v56, 0
    v_dot2_f32_bf16 v75, v32, v64, 0
    v_dot2c_f32_bf16 v68, v24, v40
    v_dot2c_f32_bf16 v69, v32, v40
    v_dot2c_f32_bf16 v70, v76, v96
    v_dot2c_f32_bf16 v71, v78, v96
    v_cvt_pk_bf16_f32 v72, v72, v73
    v_cvt_pk_bf16_f32 v74, v74, v75
    v_dot2_f32_bf16 v76, v25, v57, 0
    v_dot2_f32_bf16 v77, v25, v65, 0
    v_dot2_f32_bf16 v78, v33, v57, 0
    v_dot2_f32_bf16 v79, v33, v65, 0
    v_dot2c_f32_bf16 v68, v25, v41
    v_dot2c_f32_bf16 v69, v33, v41
    v_dot2c_f32_bf16 v70, v72, v96
    v_dot2c_f32_bf16 v71, v74, v96
    v_cvt_pk_bf16_f32 v76, v76, v77
    v_cvt_pk_bf16_f32 v78, v78, v79
    v_dot2_f32_bf16 v72, v26, v58, 0
    v_dot2_f32_bf16 v73, v26, v66, 0
    v_dot2_f32_bf16 v74, v34, v58, 0
    v_dot2_f32_bf16 v75, v34, v66, 0
    v_dot2c_f32_bf16 v68, v26, v42
    v_dot2c_f32_bf16 v69, v34, v42
    v_dot2c_f32_bf16 v70, v76, v96
    v_dot2c_f32_bf16 v71, v78, v96
    v_cvt_pk_bf16_f32 v72, v72, v73
    v_cvt_pk_bf16_f32 v74, v74, v75
    v_dot2_f32_bf16 v76, v27, v59, 0
    v_dot2_f32_bf16 v77, v27, v67, 0
    v_dot2_f32_bf16 v78, v35, v59, 0
    v_dot2_f32_bf16 v79, v35, v67, 0
    v_dot2c_f32_bf16 v68, v27, v43
    v_dot2c_f32_bf16 v69, v35, v43
    v_dot2c_f32_bf16 v70, v72, v96
    v_dot2c_f32_bf16 v71, v74, v96
    v_cvt_pk_bf16_f32 v76, v76, v77
    v_cvt_pk_bf16_f32 v78, v78, v79
    v_dot2c_f32_bf16 v70, v76, v96
    v_dot2c_f32_bf16 v71, v78, v96
    v_add_f32_dpp v68, v68, v68 row_shr:1 row_mask:0xf bank_mask:0xf
    v_add_f32_dpp v69, v69, v69 row_shr:1 row_mask:0xf bank_mask:0xf
    v_add_f32_dpp v70, v70, v70 row_shr:1 row_mask:0xf bank_mask:0xf
    v_add_f32_dpp v71, v71, v71 row_shr:1 row_mask:0xf bank_mask:0xf
    v_add_f32_dpp v68, v68, v68 row_shr:2 row_mask:0xf bank_mask:0xf
    v_add_f32_dpp v69, v69, v69 row_shr:2 row_mask:0xf bank_mask:0xf
    v_add_f32_dpp v70, v70, v70 row_shr:2 row_mask:0xf bank_mask:0xf
    v_add_f32_dpp v71, v71, v71 row_shr:2 row_mask:0xf bank_mask:0xf
    v_add_f32_dpp v68, v68, v68 row_shr:4 row_mask:0xf bank_mask:0xf
    v_add_f32_dpp v69, v69, v69 row_shr:4 row_mask:0xf bank_mask:0xf
    v_add_f32_dpp v70, v70, v70 row_shr:4 row_mask:0xf bank_mask:0xf
    v_add_f32_dpp v71, v71, v71 row_shr:4 row_mask:0xf bank_mask:0xf
    v_add_f32_dpp v68, v68, v68 row_shr:8 row_mask:0xf bank_mask:0xf
    v_add_f32_dpp v69, v69, v69 row_shr:8 row_mask:0xf bank_mask:0xf
    v_add_f32_dpp v70, v70, v70 row_shr:8 row_mask:0xf bank_mask:0xf
    v_add_f32_dpp v71, v71, v71 row_shr:8 row_mask:0xf bank_mask:0xf
    v_add_f32_dpp v68, v68, v68 row_bcast:15 row_mask:0xa bank_mask:0xf
    v_add_f32_dpp v69, v69, v69 row_bcast:15 row_mask:0xa bank_mask:0xf
    v_add_f32_dpp v70, v70, v70 row_bcast:15 row_mask:0xa bank_mask:0xf
    v_add_f32_dpp v71, v71, v71 row_bcast:15 row_mask:0xa bank_mask:0xf
    v_add_f32_dpp v68, v68, v68 row_bcast:31 row_mask:0xc bank_mask:0xf
    v_add_f32_dpp v69, v69, v69 row_bcast:31 row_mask:0xc bank_mask:0xf
    v_add_f32_dpp v70, v70, v70 row_bcast:31 row_mask:0xc bank_mask:0xf
    v_add_f32_dpp v71, v71, v71 row_bcast:31 row_mask:0xc bank_mask:0xf
    v_readlane_b32 s66, v69, 63
    v_readlane_b32 s67, v71, 63
    v_sub_u32 v74, 63, v1
    v_add_u32 v75, s62, v74
    v_sub_u32 v75, 2047, v75
    v_lshl_add_u32 v74, s30, 1, v74
    v_lshlrev_b32 v74, 3, v74
    v_add_u32 v74, 147520, v74
    v_writelane_b32 v68, s66, 62
    v_writelane_b32 v70, s67, 62
    v_cvt_pk_bf16_f32 v68, v68, v70
    v_and_b32 v70, 0xffff0000, v68
    v_lshlrev_b32 v68, 16, v68
    v_ashrrev_i32 v72, 31, v68
    v_or_b32 v72, 0x80000000, v72
    v_xor_b32 v72, v72, v68
    v_and_b32 v72, 0xffff0000, v72
    v_or_b32 v72, v72, v75
    v_mul_f32 v75, 0xbfb8aa3b, v70
    v_exp_f32 v75, v75
    s_nop 0
    v_add_f32 v75, 1.0, v75
    v_rcp_f32 v75, v75
    s_nop 0
    v_cvt_pk_bf16_f32 v76, v75, v75
    v_lshlrev_b32 v76, 16, v76
    v_sub_f32 v77, 1.0, v76
    v_cvt_pk_bf16_f32 v73, v76, v77
    s_mov_b32 exec_lo, 0
    s_mov_b32 exec_hi, 0xc0000000
    ds_write_b64 v74, v[72:73]
    s_mov_b64 exec, -1
    v_lshlrev_b32 v19, 3, v4
    s_and_b32 s62, s62, 0xfff8
    s_lshl_b32 s62, s62, 3
    s_add_u32 m0, s60, 32768
    s_nop 0
    buffer_load_dwordx4 v10, s[8:11], s61 offen offset:0 lds
    buffer_load_dwordx4 v11, s[8:11], s61 offen offset:1024 lds
    buffer_load_dwordx4 v12, s[8:11], s61 offen offset:2048 lds
    buffer_load_dwordx4 v13, s[8:11], s61 offen offset:3072 lds
    s_add_u32 m0, s60, 49152
    s_nop 0
    buffer_load_dwordx4 v14, s[12:15], s61 offen offset:0 lds
    buffer_load_dwordx4 v15, s[12:15], s61 offen offset:1024 lds
    buffer_load_dwordx4 v16, s[12:15], s61 offen offset:2048 lds
    buffer_load_dwordx4 v17, s[12:15], s61 offen offset:3072 lds
    s_add_u32 s61, s61, 128
    s_and_b32 s61, s61, 2047
    s_waitcnt vmcnt(8) lgkmcnt(0)
    s_barrier
    s_add_u32 m0, s60, 65536
    s_nop 0
    buffer_load_dwordx4 v10, s[8:11], s61 offen offset:0 lds
    buffer_load_dwordx4 v11, s[8:11], s61 offen offset:1024 lds
    buffer_load_dwordx4 v12, s[8:11], s61 offen offset:2048 lds
    buffer_load_dwordx4 v13, s[8:11], s61 offen offset:3072 lds
    s_add_u32 m0, s60, 81920
    s_nop 0
    buffer_load_dwordx4 v14, s[12:15], s61 offen offset:0 lds
    buffer_load_dwordx4 v15, s[12:15], s61 offen offset:1024 lds
    buffer_load_dwordx4 v16, s[12:15], s61 offen offset:2048 lds
    buffer_load_dwordx4 v17, s[12:15], s61 offen offset:3072 lds
    s_add_u32 s61, s61, 128
    s_and_b32 s61, s61, 2047
    s_add_u32 m0, s60, 98304
    s_nop 0
    buffer_load_dwordx4 v10, s[8:11], s61 offen offset:0 lds
    buffer_load_dwordx4 v11, s[8:11], s61 offen offset:1024 lds
    buffer_load_dwordx4 v12, s[8:11], s61 offen offset:2048 lds
    buffer_load_dwordx4 v13, s[8:11], s61 offen offset:3072 lds
    s_add_u32 m0, s60, 114688
    s_nop 0
    buffer_load_dwordx4 v14, s[12:15], s61 offen offset:0 lds
    buffer_load_dwordx4 v15, s[12:15], s61 offen offset:1024 lds
    buffer_load_dwordx4 v16, s[12:15], s61 offen offset:2048 lds
    buffer_load_dwordx4 v17, s[12:15], s61 offen offset:3072 lds
    s_add_u32 s61, s61, 128
    s_and_b32 s61, s61, 2047
    v_add_u32 v21, 147520, v19
    ds_read_b64 v[72:73], v21
    s_load_dwordx4 s[84:87], s[0:1], 40
    s_mul_hi_u32 s70, s2, 76695845
    s_mul_i32 s71, s70, 56
    s_sub_u32 s71, s2, s71
    s_lshl_b32 s72, s70, 8
    s_lshl_b32 s73, s30, 6
    s_add_u32 s72, s72, s73
    s_mul_i32 s73, s72, 7168
    s_lshl_b32 s74, s71, 7
    s_add_u32 s73, s73, s74
    s_cmp_ge_u32 s2, 224
    s_cselect_b32 s50, 0, s50
    s_cselect_b32 s54, 0, s54
    s_lshl_b32 s75, s30, 13
    s_lshl_b32 s69, s30, 12
    s_add_u32 s69, s69, 32768
    s_mov_b32 s76, 0
    v_mul_u32_u24 v31, 7168, v3
    v_lshl_add_u32 v31, v4, 4, v31
    s_mul_i32 s63, s25, 16384
    s_lshr_b32 s63, s63, 16
    s_mul_i32 s63, s63, 4
    s_sub_u32 s63, s25, s63
    s_mul_i32 s65, s65, 1664525
    s_add_u32 s65, s65, 1013904223
    v_lshlrev_b32 v97, 4, v4
    v_lshl_add_u32 v97, v3, 11, v97
    s_mul_i32 s35, s26, 28
    s_mul_i32 s34, s30, 7
    s_add_u32 s35, s35, s34
    s_lshl_b32 s35, s35, 14
    s_lshl_b32 s34, s27, 7
    s_add_u32 s35, s35, s34
    s_waitcnt lgkmcnt(0)
    v_mov_b32 v74, v73
    v_mov_b32 v73, s65
    v_mov_b32 v75, s65
    s_add_u32 s66, s62, 32768
    s_add_u32 s67, s62, 8192
    s_cmp_lg_u32 s30, 0
    s_cbranch_scc1 L_nopub
    s_mov_b64 exec, 0xff
    buffer_store_dwordx2 v[72:73], v19, s[16:19], s66 offen sc1
    buffer_store_dwordx2 v[74:75], v19, s[16:19], s67 offen sc1
    s_mov_b64 exec, -1
L_nopub:
    s_cmp_eq_u32 s32, 1
    s_cselect_b32 s84, s86, s84
    s_cselect_b32 s85, s87, s85
    s_mov_b32 s20, s84
    s_mov_b32 s21, s85
    s_mov_b32 s22, 2097152
    s_mov_b32 s23, 0x20000
    s_lshl_b32 s33, s2, 13
    s_lshl_b32 s34, s31, 12
    s_add_u32 s33, s33, s34
    s_add_u32 s84, s84, s64
    s_addc_u32 s85, s85, 0
    s_waitcnt vmcnt(16)
    s_barrier
    s_mul_i32 s80, s63, 2
    s_add_u32 s80, s80, 3
    s_mov_b32 s81, 1
    s_mov_b32 s82, 0
L_ld1:
    s_add_u32 m0, s60, s82
    s_add_u32 s83, s60, s82
    buffer_load_dwordx4 v10, s[8:11], s61 offen offset:0 lds
    buffer_load_dwordx4 v11, s[8:11], s61 offen offset:1024 lds
    buffer_load_dwordx4 v12, s[8:11], s61 offen offset:2048 lds
    buffer_load_dwordx4 v13, s[8:11], s61 offen offset:3072 lds
    s_add_u32 m0, s83, 16384
    s_add_u32 s82, s82, 32768
    buffer_load_dwordx4 v14, s[12:15], s61 offen offset:0 lds
    buffer_load_dwordx4 v15, s[12:15], s61 offen offset:1024 lds
    buffer_load_dwordx4 v16, s[12:15], s61 offen offset:2048 lds
    buffer_load_dwordx4 v17, s[12:15], s61 offen offset:3072 lds
    s_and_b32 s82, s82, 131071
    s_add_u32 s61, s61, 128
    s_and_b32 s61, s61, 2047
    s_cmp_lg_u32 s80, s81
    s_cbranch_scc1 L_nowu
    s_add_u32 s74, s73, 0
    buffer_load_dwordx4 v[128:131], v31, s[52:55], s74 offen nt
    s_add_u32 s74, s73, 57344
    buffer_load_dwordx4 v[132:135], v31, s[52:55], s74 offen nt
    s_add_u32 s74, s73, 114688
    buffer_load_dwordx4 v[136:139], v31, s[52:55], s74 offen nt
    s_add_u32 s74, s73, 172032
    buffer_load_dwordx4 v[140:143], v31, s[52:55], s74 offen nt
    s_add_u32 s74, s73, 229376
    buffer_load_dwordx4 v[144:147], v31, s[52:55], s74 offen nt
    s_add_u32 s74, s73, 286720
    buffer_load_dwordx4 v[148:151], v31, s[52:55], s74 offen nt
    s_add_u32 s74, s73, 344064
    buffer_load_dwordx4 v[152:155], v31, s[52:55], s74 offen nt
    s_add_u32 s74, s73, 401408
    buffer_load_dwordx4 v[156:159], v31, s[52:55], s74 offen nt
    buffer_load_dwordx4 v[200:203], v97, s[44:47], s35 offen nt
    s_add_u32 s35, s35, 16384
    buffer_load_dwordx4 v[204:207], v97, s[44:47], s35 offen nt
    s_add_u32 s35, s35, 16384
    buffer_load_dwordx4 v[208:211], v97, s[44:47], s35 offen nt
    s_add_u32 s35, s35, 16384
    buffer_load_dwordx4 v[212:215], v97, s[44:47], s35 offen nt
    s_add_u32 s35, s35, 16384
    buffer_load_dwordx4 v[216:219], v97, s[44:47], s35 offen nt
    s_add_u32 s35, s35, 16384
    buffer_load_dwordx4 v[220:223], v97, s[44:47], s35 offen nt
    s_add_u32 s35, s35, 16384
    buffer_load_dwordx4 v[224:227], v97, s[44:47], s35 offen nt
L_nowu:
    s_add_u32 s81, s81, 1
    s_cmp_lt_u32 s81, 13
    s_waitcnt vmcnt(16)
    s_barrier
    s_cbranch_scc1 L_ld1
    buffer_load_dwordx4 v[80:83], v18, s[16:19], s69 offen offset:0 sc1
    buffer_load_dwordx4 v[84:87], v18, s[16:19], s69 offen offset:1024 sc1
    buffer_load_dwordx4 v[88:91], v18, s[16:19], s69 offen offset:2048 sc1
    buffer_load_dwordx4 v[92:95], v18, s[16:19], s69 offen offset:3072 sc1
    v_mov_b32 v10, v31
    s_add_u32 m0, s75, 0
    s_add_u32 s74, s73, 0
    buffer_load_dwordx4 v10, s[48:51], s74 offen nt lds
    s_add_u32 m0, s75, 1024
    s_add_u32 s74, s73, 57344
    buffer_load_dwordx4 v10, s[48:51], s74 offen nt lds
    s_add_u32 m0, s75, 2048
    s_add_u32 s74, s73, 114688
    buffer_load_dwordx4 v10, s[48:51], s74 offen nt lds
    s_add_u32 m0, s75, 3072
    s_add_u32 s74, s73, 172032
    buffer_load_dwordx4 v10, s[48:51], s74 offen nt lds
    s_add_u32 m0, s75, 4096
    s_add_u32 s74, s73, 229376
    buffer_load_dwordx4 v10, s[48:51], s74 offen nt lds
    s_add_u32 m0, s75, 5120
    s_add_u32 s74, s73, 286720
    buffer_load_dwordx4 v10, s[48:51], s74 offen nt lds
    s_add_u32 m0, s75, 6144
    s_add_u32 s74, s73, 344064
    buffer_load_dwordx4 v10, s[48:51], s74 offen nt lds
    s_add_u32 m0, s75, 7168
    s_add_u32 s74, s73, 401408
    buffer_load_dwordx4 v10, s[48:51], s74 offen nt lds
    s_waitcnt vmcnt(20)
    s_barrier
    v_add_u32 v33, s75, v18
    ds_write_b128 v33, v[128:131] offset:32768
    ds_write_b128 v33, v[132:135] offset:33792
    ds_write_b128 v33, v[136:139] offset:34816
    ds_write_b128 v33, v[140:143] offset:35840
    ds_write_b128 v33, v[144:147] offset:36864
    ds_write_b128 v33, v[148:151] offset:37888
    ds_write_b128 v33, v[152:155] offset:38912
    ds_write_b128 v33, v[156:159] offset:39936
    s_waitcnt vmcnt(12)
    s_barrier
    s_mov_b32 s8, s84
    s_mov_b32 s9, s85
    s_sub_u32 s10, 2097152, s64
    s_lshl_b32 s60, s32, 13
    s_lshl_b32 s35, s31, 12
    s_add_u32 s60, s60, s35
    s_add_u32 s60, s60, 65536
    s_lshr_b32 s61, s25, 3
    s_lshl_b32 s62, s24, 1
    s_add_u32 s61, s61, s62
    s_add_u32 s61, s61, 0
    s_and_b32 s61, s61, 15
    s_lshl_b32 s61, s61, 7
    s_add_u32 m0, s60, 0
    s_nop 0
    buffer_load_dwordx4 v14, s[8:11], s61 offen offset:0 lds
    buffer_load_dwordx4 v15, s[8:11], s61 offen offset:1024 lds
    buffer_load_dwordx4 v16, s[8:11], s61 offen offset:2048 lds
    buffer_load_dwordx4 v17, s[8:11], s61 offen offset:3072 lds
    s_add_u32 s61, s61, 128
    s_and_b32 s61, s61, 2047
    s_add_u32 m0, s60, 16384
    s_nop 0
    buffer_load_dwordx4 v14, s[8:11], s61 offen offset:0 lds
    buffer_load_dwordx4 v15, s[8:11], s61 offen offset:1024 lds
    buffer_load_dwordx4 v16, s[8:11], s61 offen offset:2048 lds
    buffer_load_dwordx4 v17, s[8:11], s61 offen offset:3072 lds
    s_add_u32 s61, s61, 128
    s_and_b32 s61, s61, 2047
    s_waitcnt vmcnt(16)
    s_mov_b32 s68, 32768
L_keypoll:
    v_xor_b32 v20, s65, v81
    v_xor_b32 v21, s65, v83
    v_or_b32 v20, v20, v21
    v_xor_b32 v21, s65, v85
    v_or_b32 v20, v20, v21
    v_xor_b32 v21, s65, v87
    v_or_b32 v20, v20, v21
    v_xor_b32 v21, s65, v89
    v_or_b32 v20, v20, v21
    v_xor_b32 v21, s65, v91
    v_or_b32 v20, v20, v21
    v_xor_b32 v21, s65, v93
    v_or_b32 v20, v20, v21
    v_xor_b32 v21, s65, v95
    v_or_b32 v20, v20, v21
    v_cmp_ne_u32 vcc, 0, v20
    s_cbranch_vccz L_keyok
    s_sub_u32 s68, s68, 1
    s_cbranch_scc1 L_keyok
    buffer_load_dwordx4 v[80:83], v18, s[16:19], s69 offen offset:0 sc1
    buffer_load_dwordx4 v[84:87], v18, s[16:19], s69 offen offset:1024 sc1
    buffer_load_dwordx4 v[88:91], v18, s[16:19], s69 offen offset:2048 sc1
    buffer_load_dwordx4 v[92:95], v18, s[16:19], s69 offen offset:3072 sc1
    s_waitcnt vmcnt(0)
    s_branch L_keypoll
L_keyok:
    s_or_b32 s66, s2, s30
    s_cmp_lg_u32 s66, 0
    s_cbranch_scc1 L_nogen
    v_mov_b32 v20, s65
    s_mov_b64 exec, 1
    buffer_store_dword v20, v9, s[16:19], 0 offen offset:0 sc1
    s_mov_b64 exec, -1
L_nogen:
    s_mov_b64 s[78:79], 1
L_top:
    v_subrev_u32 v22, s76, v80
    v_subrev_u32 v23, s76, v82
    v_subrev_u32 v24, s76, v84
    v_subrev_u32 v25, s76, v86
    v_subrev_u32 v26, s76, v88
    v_subrev_u32 v27, s76, v90
    v_subrev_u32 v28, s76, v92
    v_subrev_u32 v29, s76, v94
    v_max3_u32 v22, v22, v23, v24
    v_max3_u32 v25, v25, v26, v27
    v_max3_u32 v22, v22, v28, v29
    v_max_u32 v22, v22, v25
    s_nop 1
    v_max_u32_dpp v22, v22, v22 row_shr:1 row_mask:0xf bank_mask:0xf
    s_nop 1
    v_max_u32_dpp v22, v22, v22 row_shr:2 row_mask:0xf bank_mask:0xf
    s_nop 1
    v_max_u32_dpp v22, v22, v22 row_shr:4 row_mask:0xf bank_mask:0xf
    s_nop 1
    v_max_u32_dpp v22, v22, v22 row_shr:8 row_mask:0xf bank_mask:0xf
    s_nop 1
    v_max_u32_dpp v22, v22, v22 row_bcast:15 row_mask:0xa bank_mask:0xf
    s_nop 1
    v_max_u32_dpp v22, v22, v22 row_bcast:31 row_mask:0xc bank_mask:0xf
    s_nop 0
    v_readlane_b32 s77, v22, 63
    s_mov_b64 exec, s[78:79]
    s_add_u32 s76, s76, s77
    v_mov_b32 v30, s76
    s_mov_b64 exec, -1
    s_lshl_b32 s78, s78, 1
    s_cmp_lg_u32 s78, 256
    s_cbranch_scc1 L_top
    s_lshl_b32 s76, s30, 5
    v_lshl_add_u32 v32, v1, 2, s76
    v_add_u32 v32, 147712, v32
    v_mov_b32 v35, 1
    s_mov_b64 exec, 0xff
    ds_write_b32 v32, v30
    s_mov_b64 exec, 1
    ds_add_u32 v7, v35 offset:20
    s_mov_b64 exec, -1
    v_and_b32 v32, 31, v1
    v_lshlrev_b32 v32, 2, v32
    v_add_u32 v32, 147712, v32
    v_lshrrev_b32 v33, 5, v1
    v_lshlrev_b32 v33, 6, v33
    v_add_u32 v33, 147712, v33
    s_add_u32 s76, s76, 147968
    s_mov_b32 s68, 32768
L_candpoll:
    ds_read_b32 v35, v7 offset:20
    ds_read_b32 v34, v32
    ds_read_b128 v[36:39], v33 offset:0
    ds_read_b128 v[40:43], v33 offset:16
    ds_read_b128 v[44:47], v33 offset:32
    ds_read_b128 v[48:51], v33 offset:48
    s_waitcnt lgkmcnt(0)
    v_readfirstlane_b32 s77, v35
    s_sub_u32 s68, s68, 1
    s_cbranch_scc1 L_candok
    s_cmp_lg_u32 s77, 4
    s_cbranch_scc1 L_candpoll
L_candok:
    v_mov_b32 v35, 0
    v_cmp_gt_u32 s[78:79], v36, v34
    v_cmp_gt_u32 s[80:81], v37, v34
    v_cmp_gt_u32 s[82:83], v38, v34
    v_addc_co_u32 v35, vcc, 0, v35, s[78:79]
    v_cmp_gt_u32 s[78:79], v39, v34
    v_addc_co_u32 v35, vcc, 0, v35, s[80:81]
    v_cmp_gt_u32 s[80:81], v40, v34
    v_addc_co_u32 v35, vcc, 0, v35, s[82:83]
    v_cmp_gt_u32 s[82:83], v41, v34
    v_addc_co_u32 v35, vcc, 0, v35, s[78:79]
    v_cmp_gt_u32 s[78:79], v42, v34
    v_addc_co_u32 v35, vcc, 0, v35, s[80:81]
    v_cmp_gt_u32 s[80:81], v43, v34
    v_addc_co_u32 v35, vcc, 0, v35, s[82:83]
    v_cmp_gt_u32 s[82:83], v44, v34
    v_addc_co_u32 v35, vcc, 0, v35, s[78:79]
    v_cmp_gt_u32 s[78:79], v45, v34
    v_addc_co_u32 v35, vcc, 0, v35, s[80:81]
    v_cmp_gt_u32 s[80:81], v46, v34
    v_addc_co_u32 v35, vcc, 0, v35, s[82:83]
    v_cmp_gt_u32 s[82:83], v47, v34
    v_addc_co_u32 v35, vcc, 0, v35, s[78:79]
    v_cmp_gt_u32 s[78:79], v48, v34
    v_addc_co_u32 v35, vcc, 0, v35, s[80:81]
    v_cmp_gt_u32 s[80:81], v49, v34
    v_addc_co_u32 v35, vcc, 0, v35, s[82:83]
    v_cmp_gt_u32 s[82:83], v50, v34
    v_addc_co_u32 v35, vcc, 0, v35, s[78:79]
    v_cmp_gt_u32 s[78:79], v51, v34
    v_addc_co_u32 v35, vcc, 0, v35, s[80:81]
    v_addc_co_u32 v35, vcc, 0, v35, s[82:83]
    v_addc_co_u32 v35, vcc, 0, v35, s[78:79]
    v_mov_b32 v36, v35
    v_lshrrev_b32 v6, 4, v1
    v_lshlrev_b32 v32, 4, v6
    v_permlane32_swap_b32 v35, v36
    v_add_u32 v35, v35, v36
    v_cmp_gt_u32 vcc, 8, v35
    v_lshl_add_u32 v35, v35, 2, s76
    v_lshl_add_u32 v36, v4, 2, s76
    s_and_saveexec_b64 s[66:67], vcc
    ds_write_b32 v35, v34
    s_mov_b64 exec, -1
    ds_read_b32 v30, v36
    s_lshl_b32 s76, s72, 1
    s_waitcnt lgkmcnt(0)
    v_and_b32 v31, 0x7ff, v30
    v_sub_u32 v31, 2047, v31
    v_lshl_add_u32 v32, v31, 11, v32
    buffer_load_dwordx4 v[36:39], v32, s[56:59], s76 offen offset:0
    buffer_load_dwordx4 v[40:43], v32, s[56:59], s76 offen offset:64
    v_ashrrev_i32 v33, 31, v30
    v_not_b32 v33, v33
    v_or_b32 v33, 0x80000000, v33
    v_xor_b32 v33, v33, v30
    v_and_b32 v33, 0xffff0000, v33
    v_mul_f32 v35, 0xbfb8aa3b, v33
    v_exp_f32 v35, v35
    s_nop 0
    v_add_f32 v35, 1.0, v35
    v_rcp_f32 v35, v35
    s_nop 0
    v_cvt_pk_bf16_f32 v30, v35, v35
    v_lshlrev_b32 v30, 16, v30
    v_bfe_u32 v34, v1, 2, 2
    v_lshl_add_u32 v33, v6, 3, v34
    v_lshlrev_b32 v33, 7, v33
    v_and_b32 v34, 3, v1
    v_lshl_add_u32 v5, v34, 3, v33
    v_add_u32 v33, s75, v5
    s_cmp_ge_u32 s2, 224
    s_cbranch_scc1 L_gudone
    ds_read_b64_tr_b16 v[160:161], v33 offset:32768
    ds_read_b64_tr_b16 v[162:163], v33 offset:33280
    ds_read_b64_tr_b16 v[164:165], v33 offset:32800
    ds_read_b64_tr_b16 v[166:167], v33 offset:33312
    ds_read_b64_tr_b16 v[168:169], v33 offset:32832
    ds_read_b64_tr_b16 v[170:171], v33 offset:33344
    ds_read_b64_tr_b16 v[172:173], v33 offset:32864
    ds_read_b64_tr_b16 v[174:175], v33 offset:33376
    ds_read_b64_tr_b16 v[176:177], v33 offset:36864
    ds_read_b64_tr_b16 v[178:179], v33 offset:37376
    ds_read_b64_tr_b16 v[180:181], v33 offset:36896
    ds_read_b64_tr_b16 v[182:183], v33 offset:37408
    ds_read_b64_tr_b16 v[184:185], v33 offset:36928
    ds_read_b64_tr_b16 v[186:187], v33 offset:37440
    ds_read_b64_tr_b16 v[188:189], v33 offset:36960
    ds_read_b64_tr_b16 v[190:191], v33 offset:37472
    s_waitcnt vmcnt(0)
    s_waitcnt lgkmcnt(8)
    v_mfma_f32_16x16x32_bf16 v[112:115], v[36:39], v[160:163], 0
    v_mfma_f32_16x16x32_bf16 v[116:119], v[36:39], v[164:167], 0
    v_mfma_f32_16x16x32_bf16 v[120:123], v[36:39], v[168:171], 0
    v_mfma_f32_16x16x32_bf16 v[124:127], v[36:39], v[172:175], 0
    s_waitcnt lgkmcnt(0)
    v_mfma_f32_16x16x32_bf16 v[112:115], v[40:43], v[176:179], v[112:115]
    v_mfma_f32_16x16x32_bf16 v[116:119], v[40:43], v[180:183], v[116:119]
    v_mfma_f32_16x16x32_bf16 v[120:123], v[40:43], v[184:187], v[120:123]
    v_mfma_f32_16x16x32_bf16 v[124:127], v[40:43], v[188:191], v[124:127]
    ds_read_b64_tr_b16 v[160:161], v33 offset:0
    ds_read_b64_tr_b16 v[162:163], v33 offset:512
    ds_read_b64_tr_b16 v[164:165], v33 offset:32
    ds_read_b64_tr_b16 v[166:167], v33 offset:544
    ds_read_b64_tr_b16 v[168:169], v33 offset:64
    ds_read_b64_tr_b16 v[170:171], v33 offset:576
    ds_read_b64_tr_b16 v[172:173], v33 offset:96
    ds_read_b64_tr_b16 v[174:175], v33 offset:608
    ds_read_b64_tr_b16 v[176:177], v33 offset:4096
    ds_read_b64_tr_b16 v[178:179], v33 offset:4608
    ds_read_b64_tr_b16 v[180:181], v33 offset:4128
    ds_read_b64_tr_b16 v[182:183], v33 offset:4640
    ds_read_b64_tr_b16 v[184:185], v33 offset:4160
    ds_read_b64_tr_b16 v[186:187], v33 offset:4672
    ds_read_b64_tr_b16 v[188:189], v33 offset:4192
    ds_read_b64_tr_b16 v[190:191], v33 offset:4704
    s_waitcnt lgkmcnt(8)
    v_mfma_f32_16x16x32_bf16 v[96:99], v[36:39], v[160:163], 0
    v_mfma_f32_16x16x32_bf16 v[100:103], v[36:39], v[164:167], 0
    v_mfma_f32_16x16x32_bf16 v[104:107], v[36:39], v[168:171], 0
    v_mfma_f32_16x16x32_bf16 v[108:111], v[36:39], v[172:175], 0
    s_waitcnt lgkmcnt(0)
    v_mfma_f32_16x16x32_bf16 v[96:99], v[40:43], v[176:179], v[96:99]
    v_mfma_f32_16x16x32_bf16 v[100:103], v[40:43], v[180:183], v[100:103]
    v_mfma_f32_16x16x32_bf16 v[104:107], v[40:43], v[184:187], v[104:107]
    v_mfma_f32_16x16x32_bf16 v[108:111], v[40:43], v[188:191], v[108:111]
    v_lshl_add_u32 v34, v1, 4, s75
    s_mov_b64 exec, 0xffffffff
    s_nop 2
    ds_write_b128 v34, v[96:99] offset:0
    ds_write_b128 v34, v[100:103] offset:512
    ds_write_b128 v34, v[104:107] offset:1024
    ds_write_b128 v34, v[108:111] offset:1536
    ds_write_b128 v34, v[112:115] offset:2048
    ds_write_b128 v34, v[116:119] offset:2560
    ds_write_b128 v34, v[120:123] offset:3072
    ds_write_b128 v34, v[124:127] offset:3584
    s_mov_b64 exec, 1
    v_mov_b32 v35, 1
    ds_add_rtn_u32 v35, v7, v35 offset:16
    s_mov_b64 exec, -1
    s_waitcnt lgkmcnt(0)
    v_readfirstlane_b32 s76, v35
    s_cmp_lg_u32 s76, 3
    s_cbranch_scc1 L_gudone
    ds_read_b128 v[96:99], v18 offset:0
    ds_read_b128 v[100:103], v18 offset:1024
    ds_read_b128 v[104:107], v18 offset:2048
    ds_read_b128 v[108:111], v18 offset:3072
    ds_read_b128 v[112:115], v18 offset:8192
    ds_read_b128 v[116:119], v18 offset:9216
    ds_read_b128 v[120:123], v18 offset:10240
    ds_read_b128 v[124:127], v18 offset:11264
    ds_read_b128 v[128:131], v18 offset:16384
    ds_read_b128 v[132:135], v18 offset:17408
    ds_read_b128 v[136:139], v18 offset:18432
    ds_read_b128 v[140:143], v18 offset:19456
    ds_read_b128 v[144:147], v18 offset:24576
    ds_read_b128 v[148:151], v18 offset:25600
    ds_read_b128 v[152:155], v18 offset:26624
    ds_read_b128 v[156:159], v18 offset:27648
    v_lshrrev_b32 v35, 5, v1
    v_lshlrev_b32 v35, 13, v35
    v_and_b32 v36, 31, v1
    v_lshl_add_u32 v35, v36, 4, v35
    s_lshl_b32 s76, s71, 15
    s_lshl_b32 s77, s70, 11
    s_add_u32 s76, s76, s77
    s_add_u32 s76, s76, 524288
    s_add_u32 s77, s76, 16384
    v_mov_b32 v42, s65
    v_mov_b32 v43, s65
    v_mov_b32 v46, s65
    v_mov_b32 v47, s65
    s_waitcnt lgkmcnt(0)
    v_pk_add_f32 v[96:97], v[96:97], v[112:113]
    v_pk_add_f32 v[128:129], v[128:129], v[144:145]
    v_pk_add_f32 v[40:41], v[96:97], v[128:129]
    buffer_store_dwordx4 v[40:43], v35, s[16:19], s76 offen offset:0 sc1
    v_pk_add_f32 v[98:99], v[98:99], v[114:115]
    v_pk_add_f32 v[130:131], v[130:131], v[146:147]
    v_pk_add_f32 v[44:45], v[98:99], v[130:131]
    buffer_store_dwordx4 v[44:47], v35, s[16:19], s76 offen offset:1024 sc1
    v_pk_add_f32 v[100:101], v[100:101], v[116:117]
    v_pk_add_f32 v[132:133], v[132:133], v[148:149]
    v_pk_add_f32 v[40:41], v[100:101], v[132:133]
    buffer_store_dwordx4 v[40:43], v35, s[16:19], s77 offen offset:0 sc1
    v_pk_add_f32 v[102:103], v[102:103], v[118:119]
    v_pk_add_f32 v[134:135], v[134:135], v[150:151]
    v_pk_add_f32 v[44:45], v[102:103], v[134:135]
    buffer_store_dwordx4 v[44:47], v35, s[16:19], s77 offen offset:1024 sc1
    v_pk_add_f32 v[104:105], v[104:105], v[120:121]
    v_pk_add_f32 v[136:137], v[136:137], v[152:153]
    v_pk_add_f32 v[40:41], v[104:105], v[136:137]
    buffer_store_dwordx4 v[40:43], v35, s[16:19], s76 offen offset:512 sc1
    v_pk_add_f32 v[106:107], v[106:107], v[122:123]
    v_pk_add_f32 v[138:139], v[138:139], v[154:155]
    v_pk_add_f32 v[44:45], v[106:107], v[138:139]
    buffer_store_dwordx4 v[44:47], v35, s[16:19], s76 offen offset:1536 sc1
    v_pk_add_f32 v[108:109], v[108:109], v[124:125]
    v_pk_add_f32 v[140:141], v[140:141], v[156:157]
    v_pk_add_f32 v[40:41], v[108:109], v[140:141]
    buffer_store_dwordx4 v[40:43], v35, s[16:19], s77 offen offset:512 sc1
    v_pk_add_f32 v[110:111], v[110:111], v[126:127]
    v_pk_add_f32 v[142:143], v[142:143], v[158:159]
    v_pk_add_f32 v[44:45], v[110:111], v[142:143]
    buffer_store_dwordx4 v[44:47], v35, s[16:19], s77 offen offset:1536 sc1
L_gudone:
    v_mov_b32 v178, v31
    v_mov_b32 v179, v30
    v_bfrev_b32 v2, 1
    v_mov_b32 v8, v7
    v_and_b32 v7, 15, v1
    v_lshlrev_b32 v11, 4, v4
    v_lshl_add_u32 v11, v3, 11, v11
    s_mul_i32 s50, s26, 28
    s_mul_i32 s51, s30, 7
    s_add_u32 s50, s50, s51
    s_lshl_b32 s50, s50, 14
    s_lshl_b32 s55, s27, 7
    s_add_u32 s50, s50, s55
    s_lshl_b32 s51, s51, 10
    s_lshl_b32 s48, s26, 7
    s_lshl_b32 s49, s30, 5
    s_add_u32 s49, s48, s49
    v_lshlrev_b32 v12, 3, v7
    v_lshl_add_u32 v19, v6, 11, v12
    v_lshlrev_b32 v9, 3, v1
    s_mov_b32 s68, 32768
    s_cmp_ge_u32 s2, 224
    s_cselect_b32 s67, 0, 4
L_winpoll:
    ds_read_b32 v20, v8 offset:16
    ds_read_b32 v21, v8 offset:28
    s_waitcnt lgkmcnt(0)
    v_readfirstlane_b32 s33, v20
    v_readfirstlane_b32 s34, v21
    s_sub_u32 s68, s68, 1
    s_cbranch_scc1 L_winok
    s_cmp_lg_u32 s33, s67
    s_cbranch_scc1 L_winpoll
    s_cmp_eq_u32 s34, 0
    s_cbranch_scc1 L_winpoll
L_winok:
    s_lshl_b32 s33, s49, 11
    s_add_u32 s33, s33, s55
    s_lshl_b32 s74, s49, 3
    s_add_u32 s74, s74, 8192
    buffer_load_dwordx2 v[156:157], v9, s[16:19], s74 offen sc1
    buffer_load_dwordx2 v[116:117], v12, s[36:39], s55 offen
    buffer_load_dwordx2 v[84:85], v19, s[56:59], s33 offen
    s_add_u32 s33, s33, 8192
    buffer_load_dwordx2 v[86:87], v19, s[56:59], s33 offen
    s_add_u32 s33, s33, 8192
    buffer_load_dwordx2 v[88:89], v19, s[56:59], s33 offen
    s_add_u32 s33, s33, 8192
    buffer_load_dwordx2 v[90:91], v19, s[56:59], s33 offen
    s_add_u32 s33, s33, 8192
    buffer_load_dwordx2 v[92:93], v19, s[56:59], s33 offen
    s_add_u32 s33, s33, 8192
    buffer_load_dwordx2 v[94:95], v19, s[56:59], s33 offen
    s_add_u32 s33, s33, 8192
    buffer_load_dwordx2 v[96:97], v19, s[56:59], s33 offen
    s_add_u32 s33, s33, 8192
    buffer_load_dwordx2 v[98:99], v19, s[56:59], s33 offen
    v_add_u32 v20, s51, v18
    ds_write_b128 v20, v[200:203] offset:32768
    ds_write_b128 v20, v[204:207] offset:33792
    ds_write_b128 v20, v[208:211] offset:34816
    ds_write_b128 v20, v[212:215] offset:35840
    ds_write_b128 v20, v[216:219] offset:36864
    ds_write_b128 v20, v[220:223] offset:37888
    ds_write_b128 v20, v[224:227] offset:38912
    s_waitcnt lgkmcnt(0)
    s_waitcnt vmcnt(16)
    s_barrier
    s_add_u32 m0, s60, 32768
    s_nop 0
    buffer_load_dwordx4 v14, s[8:11], s61 offen offset:0 lds
    buffer_load_dwordx4 v15, s[8:11], s61 offen offset:1024 lds
    buffer_load_dwordx4 v16, s[8:11], s61 offen offset:2048 lds
    buffer_load_dwordx4 v17, s[8:11], s61 offen offset:3072 lds
    s_add_u32 s61, s61, 128
    s_and_b32 s61, s61, 2047
    s_add_u32 m0, s60, 49152
    s_nop 0
    buffer_load_dwordx4 v14, s[8:11], s61 offen offset:0 lds
    buffer_load_dwordx4 v15, s[8:11], s61 offen offset:1024 lds
    buffer_load_dwordx4 v16, s[8:11], s61 offen offset:2048 lds
    buffer_load_dwordx4 v17, s[8:11], s61 offen offset:3072 lds
    s_add_u32 s61, s61, 128
    s_and_b32 s61, s61, 2047
    s_waitcnt vmcnt(20)
    s_barrier
    s_add_u32 m0, s60, 0
    s_nop 0
    buffer_load_dwordx4 v14, s[8:11], s61 offen offset:0 lds
    buffer_load_dwordx4 v15, s[8:11], s61 offen offset:1024 lds
    buffer_load_dwordx4 v16, s[8:11], s61 offen offset:2048 lds
    buffer_load_dwordx4 v17, s[8:11], s61 offen offset:3072 lds
    s_add_u32 s61, s61, 128
    s_and_b32 s61, s61, 2047
    s_lshl_b32 s70, s2, 13
    s_add_u32 s70, s70, 524288
    s_add_u32 s71, s70, 4096
    s_cmp_lt_u32 s2, 224
    s_cselect_b32 s73, s30, 1
    s_cmp_lg_u32 s73, 0
    s_cbranch_scc1 L_nogu1
    buffer_load_dwordx4 v[20:23], v18, s[16:19], s70 offen offset:0 sc1
    buffer_load_dwordx4 v[24:27], v18, s[16:19], s70 offen offset:1024 sc1
    buffer_load_dwordx4 v[28:31], v18, s[16:19], s70 offen offset:2048 sc1
    buffer_load_dwordx4 v[32:35], v18, s[16:19], s70 offen offset:3072 sc1
    buffer_load_dwordx4 v[36:39], v18, s[16:19], s71 offen offset:0 sc1
    buffer_load_dwordx4 v[40:43], v18, s[16:19], s71 offen offset:1024 sc1
    buffer_load_dwordx4 v[44:47], v18, s[16:19], s71 offen offset:2048 sc1
    buffer_load_dwordx4 v[48:51], v18, s[16:19], s71 offen offset:3072 sc1
L_nogu1:
    s_waitcnt vmcnt(8)
    s_barrier
    s_add_u32 m0, s60, 16384
    s_nop 0
    buffer_load_dwordx4 v14, s[8:11], s61 offen offset:0 lds
    buffer_load_dwordx4 v15, s[8:11], s61 offen offset:1024 lds
    buffer_load_dwordx4 v16, s[8:11], s61 offen offset:2048 lds
    buffer_load_dwordx4 v17, s[8:11], s61 offen offset:3072 lds
    s_add_u32 s61, s61, 128
    s_and_b32 s61, s61, 2047
    s_waitcnt vmcnt(8)
    s_barrier
    s_add_u32 m0, s60, 32768
    s_nop 0
    buffer_load_dwordx4 v14, s[8:11], s61 offen offset:0 lds
    buffer_load_dwordx4 v15, s[8:11], s61 offen offset:1024 lds
    buffer_load_dwordx4 v16, s[8:11], s61 offen offset:2048 lds
    buffer_load_dwordx4 v17, s[8:11], s61 offen offset:3072 lds
    s_add_u32 s61, s61, 128
    s_and_b32 s61, s61, 2047
    s_cmp_lg_u32 s73, 0
    s_cbranch_scc1 L_nogu2
    v_mov_b32 v152, s65
    v_mov_b32 v153, s65
    s_mov_b32 s68, 32768
    s_waitcnt vmcnt(8)
L_gupoll:
    v_cmp_ne_u64 vcc, v[22:23], v[152:153]
    v_cmp_ne_u64 s[66:67], v[26:27], v[152:153]
    s_or_b64 vcc, vcc, s[66:67]
    v_cmp_ne_u64 s[66:67], v[30:31], v[152:153]
    s_or_b64 vcc, vcc, s[66:67]
    v_cmp_ne_u64 s[66:67], v[34:35], v[152:153]
    s_or_b64 vcc, vcc, s[66:67]
    v_cmp_ne_u64 s[66:67], v[38:39], v[152:153]
    s_or_b64 vcc, vcc, s[66:67]
    v_cmp_ne_u64 s[66:67], v[42:43], v[152:153]
    s_or_b64 vcc, vcc, s[66:67]
    v_cmp_ne_u64 s[66:67], v[46:47], v[152:153]
    s_or_b64 vcc, vcc, s[66:67]
    v_cmp_ne_u64 s[66:67], v[50:51], v[152:153]
    s_or_b64 vcc, vcc, s[66:67]
    s_cbranch_vccz L_guok
    s_sub_u32 s68, s68, 1
    s_cbranch_scc1 L_guok
    buffer_load_dwordx4 v[20:23], v18, s[16:19], s70 offen offset:0 sc1
    buffer_load_dwordx4 v[24:27], v18, s[16:19], s70 offen offset:1024 sc1
    buffer_load_dwordx4 v[28:31], v18, s[16:19], s70 offen offset:2048 sc1
    buffer_load_dwordx4 v[32:35], v18, s[16:19], s70 offen offset:3072 sc1
    buffer_load_dwordx4 v[36:39], v18, s[16:19], s71 offen offset:0 sc1
    buffer_load_dwordx4 v[40:43], v18, s[16:19], s71 offen offset:1024 sc1
    buffer_load_dwordx4 v[44:47], v18, s[16:19], s71 offen offset:2048 sc1
    buffer_load_dwordx4 v[48:51], v18, s[16:19], s71 offen offset:3072 sc1
    s_waitcnt vmcnt(0)
    s_branch L_gupoll
L_guok:
    v_pk_add_f32 v[20:21], v[20:21], v[28:29]
    v_pk_add_f32 v[36:37], v[36:37], v[44:45]
    v_pk_add_f32 v[20:21], v[20:21], v[36:37]
    v_pk_add_f32 v[24:25], v[24:25], v[32:33]
    v_pk_add_f32 v[40:41], v[40:41], v[48:49]
    v_pk_add_f32 v[24:25], v[24:25], v[40:41]
    v_cvt_pk_bf16_f32 v20, v20, v21
    v_mov_b32 v22, v20
    s_nop 1
    v_permlane32_swap_b32 v20, v22
    v_and_b32 v21, 0xffff0000, v20
    v_lshlrev_b32 v20, 16, v20
    v_and_b32 v23, 0xffff0000, v22
    v_lshlrev_b32 v22, 16, v22
    v_mul_f32 v154, 0xbfb8aa3b, v20
    v_mul_f32 v155, 0xbfb8aa3b, v21
    v_exp_f32 v154, v154
    v_exp_f32 v155, v155
    v_add_f32 v154, 1.0, v154
    v_add_f32 v155, 1.0, v155
    v_rcp_f32 v154, v154
    v_rcp_f32 v155, v155
    s_nop 0
    v_pk_mul_f32 v[20:21], v[20:21], v[154:155]
    v_cvt_pk_bf16_f32 v20, v20, v21
    v_and_b32 v21, 0xffff0000, v20
    v_lshlrev_b32 v20, 16, v20
    v_pk_mul_f32 v[20:21], v[20:21], v[22:23]
    v_cvt_pk_bf16_f32 v150, v20, v21
    v_cvt_pk_bf16_f32 v24, v24, v25
    v_mov_b32 v26, v24
    s_nop 1
    v_permlane32_swap_b32 v24, v26
    v_and_b32 v25, 0xffff0000, v24
    v_lshlrev_b32 v24, 16, v24
    v_and_b32 v27, 0xffff0000, v26
    v_lshlrev_b32 v26, 16, v26
    v_mul_f32 v154, 0xbfb8aa3b, v24
    v_mul_f32 v155, 0xbfb8aa3b, v25
    v_exp_f32 v154, v154
    v_exp_f32 v155, v155
    v_add_f32 v154, 1.0, v154
    v_add_f32 v155, 1.0, v155
    v_rcp_f32 v154, v154
    v_rcp_f32 v155, v155
    s_nop 0
    v_pk_mul_f32 v[24:25], v[24:25], v[154:155]
    v_cvt_pk_bf16_f32 v24, v24, v25
    v_and_b32 v25, 0xffff0000, v24
    v_lshlrev_b32 v24, 16, v24
    v_pk_mul_f32 v[24:25], v[24:25], v[26:27]
    v_cvt_pk_bf16_f32 v151, v24, v25
    s_lshl_b32 s33, s2, 9
    s_add_u32 s33, s33, 393216
    s_mov_b64 exec, 0xffffffff
    buffer_store_dwordx4 v[150:153], v18, s[16:19], s33 offen sc1
    s_mov_b64 exec, -1
L_nogu2:
    s_waitcnt vmcnt(8)
    s_barrier
    s_add_u32 m0, s60, 49152
    s_nop 0
    buffer_load_dwordx4 v14, s[8:11], s61 offen offset:0 lds
    buffer_load_dwordx4 v15, s[8:11], s61 offen offset:1024 lds
    buffer_load_dwordx4 v16, s[8:11], s61 offen offset:2048 lds
    buffer_load_dwordx4 v17, s[8:11], s61 offen offset:3072 lds
    s_add_u32 s61, s61, 128
    s_and_b32 s61, s61, 2047
    s_mov_b32 s68, 32768
L_gpoll:
    v_cmp_ne_u32 vcc, s65, v157
    s_and_b32 vcc_hi, vcc_hi, 0
    s_cbranch_vccz L_gok
    s_sub_u32 s68, s68, 1
    s_cbranch_scc1 L_gok
    buffer_load_dwordx2 v[156:157], v9, s[16:19], s74 offen sc1
    s_waitcnt vmcnt(0)
    s_branch L_gpoll
L_gok:
    v_lshlrev_b32 v8, 2, v6
    ds_bpermute_b32 v100, v8, v156 offset:0
    ds_bpermute_b32 v102, v8, v156 offset:16
    ds_bpermute_b32 v104, v8, v156 offset:32
    ds_bpermute_b32 v106, v8, v156 offset:48
    ds_bpermute_b32 v108, v8, v156 offset:64
    ds_bpermute_b32 v110, v8, v156 offset:80
    ds_bpermute_b32 v112, v8, v156 offset:96
    ds_bpermute_b32 v114, v8, v156 offset:112
    v_and_b32 v119, 0xffff0000, v117
    v_lshlrev_b32 v118, 16, v117
    v_and_b32 v117, 0xffff0000, v116
    v_lshlrev_b32 v116, 16, v116
    s_mul_i32 s72, s26, 7168
    s_mul_i32 s33, s30, 1792
    s_add_u32 s72, s72, s33
    s_add_u32 s72, s72, 393216
    v_cmp_gt_u32 vcc, 48, v1
    s_nop 1
    v_cndmask_b32 v13, v2, v18, vcc
    s_waitcnt lgkmcnt(0)
    v_and_b32 v101, 0xffff0000, v100
    v_lshlrev_b32 v100, 16, v100
    v_and_b32 v103, 0xffff0000, v102
    v_lshlrev_b32 v102, 16, v102
    v_and_b32 v105, 0xffff0000, v104
    v_lshlrev_b32 v104, 16, v104
    v_and_b32 v107, 0xffff0000, v106
    v_lshlrev_b32 v106, 16, v106
    v_and_b32 v109, 0xffff0000, v108
    v_lshlrev_b32 v108, 16, v108
    v_and_b32 v111, 0xffff0000, v110
    v_lshlrev_b32 v110, 16, v110
    v_and_b32 v113, 0xffff0000, v112
    v_lshlrev_b32 v112, 16, v112
    v_and_b32 v115, 0xffff0000, v114
    v_lshlrev_b32 v114, 16, v114
    s_waitcnt vmcnt(8)
    s_barrier
    s_add_u32 m0, s60, 0
    s_nop 0
    buffer_load_dwordx4 v14, s[8:11], s61 offen offset:0 lds
    buffer_load_dwordx4 v15, s[8:11], s61 offen offset:1024 lds
    buffer_load_dwordx4 v16, s[8:11], s61 offen offset:2048 lds
    buffer_load_dwordx4 v17, s[8:11], s61 offen offset:3072 lds
    s_add_u32 s61, s61, 128
    s_and_b32 s61, s61, 2047
    v_lshlrev_b32 v152, 16, v84
    v_and_b32 v153, 0xffff0000, v84
    v_pk_mul_f32 v[154:155], v[152:153], v[116:117]
    v_pk_mul_f32 v[152:153], v[100:101], v[152:153] op_sel:[1,0]
    v_cvt_pk_bf16_f32 v154, v154, v155
    v_cvt_pk_bf16_f32 v152, v152, v153
    v_and_b32 v155, 0xffff0000, v154
    v_lshlrev_b32 v154, 16, v154
    v_and_b32 v153, 0xffff0000, v152
    v_lshlrev_b32 v152, 16, v152
    v_pk_fma_f32 v[120:121], v[100:101], v[154:155], v[152:153] op_sel_hi:[0,1,1]
    v_lshlrev_b32 v152, 16, v85
    v_and_b32 v153, 0xffff0000, v85
    v_pk_mul_f32 v[154:155], v[152:153], v[118:119]
    v_pk_mul_f32 v[152:153], v[100:101], v[152:153] op_sel:[1,0]
    v_cvt_pk_bf16_f32 v154, v154, v155
    v_cvt_pk_bf16_f32 v152, v152, v153
    v_and_b32 v155, 0xffff0000, v154
    v_lshlrev_b32 v154, 16, v154
    v_and_b32 v153, 0xffff0000, v152
    v_lshlrev_b32 v152, 16, v152
    v_pk_fma_f32 v[122:123], v[100:101], v[154:155], v[152:153] op_sel_hi:[0,1,1]
    v_lshlrev_b32 v152, 16, v86
    v_and_b32 v153, 0xffff0000, v86
    v_pk_mul_f32 v[154:155], v[152:153], v[116:117]
    v_pk_mul_f32 v[152:153], v[102:103], v[152:153] op_sel:[1,0]
    v_cvt_pk_bf16_f32 v154, v154, v155
    v_cvt_pk_bf16_f32 v152, v152, v153
    v_and_b32 v155, 0xffff0000, v154
    v_lshlrev_b32 v154, 16, v154
    v_and_b32 v153, 0xffff0000, v152
    v_lshlrev_b32 v152, 16, v152
    v_pk_fma_f32 v[124:125], v[102:103], v[154:155], v[152:153] op_sel_hi:[0,1,1]
    v_lshlrev_b32 v152, 16, v87
    v_and_b32 v153, 0xffff0000, v87
    v_pk_mul_f32 v[154:155], v[152:153], v[118:119]
    v_pk_mul_f32 v[152:153], v[102:103], v[152:153] op_sel:[1,0]
    v_cvt_pk_bf16_f32 v154, v154, v155
    v_cvt_pk_bf16_f32 v152, v152, v153
    v_and_b32 v155, 0xffff0000, v154
    v_lshlrev_b32 v154, 16, v154
    v_and_b32 v153, 0xffff0000, v152
    v_lshlrev_b32 v152, 16, v152
    v_pk_fma_f32 v[126:127], v[102:103], v[154:155], v[152:153] op_sel_hi:[0,1,1]
    s_waitcnt vmcnt(8)
    s_barrier
    s_add_u32 m0, s60, 16384
    s_nop 0
    buffer_load_dwordx4 v14, s[8:11], s61 offen offset:0 lds
    buffer_load_dwordx4 v15, s[8:11], s61 offen offset:1024 lds
    buffer_load_dwordx4 v16, s[8:11], s61 offen offset:2048 lds
    buffer_load_dwordx4 v17, s[8:11], s61 offen offset:3072 lds
    s_add_u32 s61, s61, 128
    s_and_b32 s61, s61, 2047
    buffer_load_dwordx4 v[52:55], v18, s[16:19], s72 offen offset:0 sc1
    buffer_load_dwordx4 v[56:59], v13, s[16:19], s72 offen offset:1024 sc1
    v_lshlrev_b32 v152, 16, v88
    v_and_b32 v153, 0xffff0000, v88
    v_pk_mul_f32 v[154:155], v[152:153], v[116:117]
    v_pk_mul_f32 v[152:153], v[104:105], v[152:153] op_sel:[1,0]
    v_cvt_pk_bf16_f32 v154, v154, v155
    v_cvt_pk_bf16_f32 v152, v152, v153
    v_and_b32 v155, 0xffff0000, v154
    v_lshlrev_b32 v154, 16, v154
    v_and_b32 v153, 0xffff0000, v152
    v_lshlrev_b32 v152, 16, v152
    v_pk_fma_f32 v[128:129], v[104:105], v[154:155], v[152:153] op_sel_hi:[0,1,1]
    v_lshlrev_b32 v152, 16, v89
    v_and_b32 v153, 0xffff0000, v89
    v_pk_mul_f32 v[154:155], v[152:153], v[118:119]
    v_pk_mul_f32 v[152:153], v[104:105], v[152:153] op_sel:[1,0]
    v_cvt_pk_bf16_f32 v154, v154, v155
    v_cvt_pk_bf16_f32 v152, v152, v153
    v_and_b32 v155, 0xffff0000, v154
    v_lshlrev_b32 v154, 16, v154
    v_and_b32 v153, 0xffff0000, v152
    v_lshlrev_b32 v152, 16, v152
    v_pk_fma_f32 v[130:131], v[104:105], v[154:155], v[152:153] op_sel_hi:[0,1,1]
    s_waitcnt vmcnt(10)
    s_barrier
    s_add_u32 m0, s60, 32768
    s_nop 0
    buffer_load_dwordx4 v14, s[8:11], s61 offen offset:0 lds
    buffer_load_dwordx4 v15, s[8:11], s61 offen offset:1024 lds
    buffer_load_dwordx4 v16, s[8:11], s61 offen offset:2048 lds
    buffer_load_dwordx4 v17, s[8:11], s61 offen offset:3072 lds
    s_add_u32 s61, s61, 128
    s_and_b32 s61, s61, 2047
    v_lshlrev_b32 v152, 16, v90
    v_and_b32 v153, 0xffff0000, v90
    v_pk_mul_f32 v[154:155], v[152:153], v[116:117]
    v_pk_mul_f32 v[152:153], v[106:107], v[152:153] op_sel:[1,0]
    v_cvt_pk_bf16_f32 v154, v154, v155
    v_cvt_pk_bf16_f32 v152, v152, v153
    v_and_b32 v155, 0xffff0000, v154
    v_lshlrev_b32 v154, 16, v154
    v_and_b32 v153, 0xffff0000, v152
    v_lshlrev_b32 v152, 16, v152
    v_pk_fma_f32 v[132:133], v[106:107], v[154:155], v[152:153] op_sel_hi:[0,1,1]
    v_lshlrev_b32 v152, 16, v91
    v_and_b32 v153, 0xffff0000, v91
    v_pk_mul_f32 v[154:155], v[152:153], v[118:119]
    v_pk_mul_f32 v[152:153], v[106:107], v[152:153] op_sel:[1,0]
    v_cvt_pk_bf16_f32 v154, v154, v155
    v_cvt_pk_bf16_f32 v152, v152, v153
    v_and_b32 v155, 0xffff0000, v154
    v_lshlrev_b32 v154, 16, v154
    v_and_b32 v153, 0xffff0000, v152
    v_lshlrev_b32 v152, 16, v152
    v_pk_fma_f32 v[134:135], v[106:107], v[154:155], v[152:153] op_sel_hi:[0,1,1]
    v_lshlrev_b32 v152, 16, v92
    v_and_b32 v153, 0xffff0000, v92
    v_pk_mul_f32 v[154:155], v[152:153], v[116:117]
    v_pk_mul_f32 v[152:153], v[108:109], v[152:153] op_sel:[1,0]
    v_cvt_pk_bf16_f32 v154, v154, v155
    v_cvt_pk_bf16_f32 v152, v152, v153
    v_and_b32 v155, 0xffff0000, v154
    v_lshlrev_b32 v154, 16, v154
    v_and_b32 v153, 0xffff0000, v152
    v_lshlrev_b32 v152, 16, v152
    v_pk_fma_f32 v[136:137], v[108:109], v[154:155], v[152:153] op_sel_hi:[0,1,1]
    v_lshlrev_b32 v152, 16, v93
    v_and_b32 v153, 0xffff0000, v93
    v_pk_mul_f32 v[154:155], v[152:153], v[118:119]
    v_pk_mul_f32 v[152:153], v[108:109], v[152:153] op_sel:[1,0]
    v_cvt_pk_bf16_f32 v154, v154, v155
    v_cvt_pk_bf16_f32 v152, v152, v153
    v_and_b32 v155, 0xffff0000, v154
    v_lshlrev_b32 v154, 16, v154
    v_and_b32 v153, 0xffff0000, v152
    v_lshlrev_b32 v152, 16, v152
    v_pk_fma_f32 v[138:139], v[108:109], v[154:155], v[152:153] op_sel_hi:[0,1,1]
    s_waitcnt vmcnt(10)
    s_barrier
    s_add_u32 m0, s60, 49152
    s_nop 0
    buffer_load_dwordx4 v14, s[8:11], s61 offen offset:0 lds
    buffer_load_dwordx4 v15, s[8:11], s61 offen offset:1024 lds
    buffer_load_dwordx4 v16, s[8:11], s61 offen offset:2048 lds
    buffer_load_dwordx4 v17, s[8:11], s61 offen offset:3072 lds
    s_add_u32 s61, s61, 128
    s_and_b32 s61, s61, 2047
    v_lshlrev_b32 v152, 16, v94
    v_and_b32 v153, 0xffff0000, v94
    v_pk_mul_f32 v[154:155], v[152:153], v[116:117]
    v_pk_mul_f32 v[152:153], v[110:111], v[152:153] op_sel:[1,0]
    v_cvt_pk_bf16_f32 v154, v154, v155
    v_cvt_pk_bf16_f32 v152, v152, v153
    v_and_b32 v155, 0xffff0000, v154
    v_lshlrev_b32 v154, 16, v154
    v_and_b32 v153, 0xffff0000, v152
    v_lshlrev_b32 v152, 16, v152
    v_pk_fma_f32 v[140:141], v[110:111], v[154:155], v[152:153] op_sel_hi:[0,1,1]
    v_lshlrev_b32 v152, 16, v95
    v_and_b32 v153, 0xffff0000, v95
    v_pk_mul_f32 v[154:155], v[152:153], v[118:119]
    v_pk_mul_f32 v[152:153], v[110:111], v[152:153] op_sel:[1,0]
    v_cvt_pk_bf16_f32 v154, v154, v155
    v_cvt_pk_bf16_f32 v152, v152, v153
    v_and_b32 v155, 0xffff0000, v154
    v_lshlrev_b32 v154, 16, v154
    v_and_b32 v153, 0xffff0000, v152
    v_lshlrev_b32 v152, 16, v152
    v_pk_fma_f32 v[142:143], v[110:111], v[154:155], v[152:153] op_sel_hi:[0,1,1]
    s_waitcnt vmcnt(8)
    v_mov_b32 v152, s65
    v_mov_b32 v153, s65
    s_mov_b32 s68, 32768
L_actpoll:
    v_cmp_ne_u64 vcc, v[54:55], v[152:153]
    v_cmp_ne_u64 s[66:67], v[58:59], v[152:153]
    s_and_b32 s67, s67, 0xffff
    s_or_b64 vcc, vcc, s[66:67]
    s_cbranch_vccz L_actok
    s_sub_u32 s68, s68, 1
    s_cbranch_scc1 L_actok
    buffer_load_dwordx4 v[52:55], v18, s[16:19], s72 offen offset:0 sc1
    buffer_load_dwordx4 v[56:59], v13, s[16:19], s72 offen offset:1024 sc1
    s_waitcnt vmcnt(0)
    s_branch L_actpoll
L_actok:
    s_mul_i32 s33, s30, 112
    v_add_u32 v8, s33, v1
    v_bfe_u32 v152, v8, 4, 1
    v_mul_u32_u24 v152, 1856, v152
    v_and_b32 v153, 15, v8
    v_lshl_add_u32 v152, v153, 1, v152
    v_and_b32 v8, 0x1e0, v8
    v_add_u32 v8, v8, v152
    v_add_u32 v8, 152576, v8
    ds_write_b16 v8, v52 offset:0
    ds_write_b16_d16_hi v8, v52 offset:464
    ds_write_b16 v8, v53 offset:928
    ds_write_b16_d16_hi v8, v53 offset:1392
    s_mov_b32 exec_hi, 0xffff
    ds_write_b16 v8, v56 offset:64
    ds_write_b16_d16_hi v8, v56 offset:528
    ds_write_b16 v8, v57 offset:992
    ds_write_b16_d16_hi v8, v57 offset:1456
    s_mov_b32 exec_hi, -1
    s_waitcnt lgkmcnt(0)
    s_barrier
    s_add_u32 m0, s60, 0
    s_nop 0
    buffer_load_dwordx4 v14, s[8:11], s61 offen offset:0 lds
    buffer_load_dwordx4 v15, s[8:11], s61 offen offset:1024 lds
    buffer_load_dwordx4 v16, s[8:11], s61 offen offset:2048 lds
    buffer_load_dwordx4 v17, s[8:11], s61 offen offset:3072 lds
    s_add_u32 s61, s61, 128
    s_and_b32 s61, s61, 2047
    v_mul_u32_u24 v8, 464, v4
    v_lshl_add_u32 v8, v6, 4, v8
    v_add_u32 v8, 152576, v8
    s_lshl_b32 s33, s30, 5
    v_add_u32 v5, s33, v5
    ds_read_b128 v[48:51], v8 offset:0
    ds_read_b64_tr_b16 v[20:21], v5 offset:32768
    ds_read_b64_tr_b16 v[22:23], v5 offset:33280
    ds_read_b128 v[52:55], v8 offset:64
    ds_read_b64_tr_b16 v[24:25], v5 offset:36864
    ds_read_b64_tr_b16 v[26:27], v5 offset:37376
    ds_read_b128 v[56:59], v8 offset:128
    ds_read_b64_tr_b16 v[28:29], v5 offset:40960
    ds_read_b64_tr_b16 v[30:31], v5 offset:41472
    ds_read_b128 v[60:63], v8 offset:192
    ds_read_b64_tr_b16 v[32:33], v5 offset:45056
    ds_read_b64_tr_b16 v[34:35], v5 offset:45568
    ds_read_b128 v[64:67], v8 offset:256
    ds_read_b64_tr_b16 v[36:37], v5 offset:49152
    ds_read_b64_tr_b16 v[38:39], v5 offset:49664
    ds_read_b128 v[68:71], v8 offset:320
    ds_read_b64_tr_b16 v[40:41], v5 offset:53248
    ds_read_b64_tr_b16 v[42:43], v5 offset:53760
    ds_read_b128 v[72:75], v8 offset:384
    ds_read_b64_tr_b16 v[44:45], v5 offset:57344
    ds_read_b64_tr_b16 v[46:47], v5 offset:57856
    s_waitcnt lgkmcnt(15)
    v_mfma_f32_16x16x32_bf16 v[76:79], v[48:51], v[20:23], 0
    s_waitcnt lgkmcnt(15)
    v_mfma_f32_16x16x32_bf16 v[76:79], v[52:55], v[24:27], v[76:79]
    s_waitcnt lgkmcnt(12)
    v_mfma_f32_16x16x32_bf16 v[76:79], v[56:59], v[28:31], v[76:79]
    s_waitcnt lgkmcnt(9)
    v_mfma_f32_16x16x32_bf16 v[76:79], v[60:63], v[32:35], v[76:79]
    s_waitcnt lgkmcnt(6)
    v_mfma_f32_16x16x32_bf16 v[76:79], v[64:67], v[36:39], v[76:79]
    s_waitcnt lgkmcnt(3)
    v_mfma_f32_16x16x32_bf16 v[76:79], v[68:71], v[40:43], v[76:79]
    s_waitcnt lgkmcnt(0)
    v_mfma_f32_16x16x32_bf16 v[76:79], v[72:75], v[44:47], v[76:79]
    v_and_b32 v8, 1, v6
    v_lshlrev_b32 v8, 1, v8
    v_lshrrev_b32 v20, 1, v6
    v_add_u32 v8, v8, v20
    v_lshlrev_b32 v8, 18, v8
    v_lshl_add_u32 v8, v7, 3, v8
    s_lshl_b32 s33, s27, 13
    s_lshl_b32 s34, s26, 9
    s_add_u32 s33, s33, s34
    s_lshl_b32 s34, s30, 7
    s_add_u32 s33, s33, s34
    s_add_u32 s33, s33, 2621440
    s_add_u32 s34, s33, 131072
    v_mov_b32 v21, s65
    v_mov_b32 v23, s65
    v_mov_b32 v20, v76
    v_mov_b32 v22, v77
    s_mov_b32 exec_lo, 0
    v_mov_b32 v20, v78
    v_mov_b32 v22, v79
    s_mov_b32 exec_lo, -1
    buffer_store_dwordx2 v[20:21], v8, s[16:19], s33 offen sc1
    buffer_store_dwordx2 v[22:23], v8, s[16:19], s34 offen sc1
    s_waitcnt vmcnt(10)
    s_barrier
    s_add_u32 m0, s60, 16384
    s_nop 0
    buffer_load_dwordx4 v14, s[8:11], s61 offen offset:0 lds
    buffer_load_dwordx4 v15, s[8:11], s61 offen offset:1024 lds
    buffer_load_dwordx4 v16, s[8:11], s61 offen offset:2048 lds
    buffer_load_dwordx4 v17, s[8:11], s61 offen offset:3072 lds
    s_add_u32 s61, s61, 128
    s_and_b32 s61, s61, 2047
    v_lshlrev_b32 v152, 16, v96
    v_and_b32 v153, 0xffff0000, v96
    v_pk_mul_f32 v[154:155], v[152:153], v[116:117]
    v_pk_mul_f32 v[152:153], v[112:113], v[152:153] op_sel:[1,0]
    v_cvt_pk_bf16_f32 v154, v154, v155
    v_cvt_pk_bf16_f32 v152, v152, v153
    v_and_b32 v155, 0xffff0000, v154
    v_lshlrev_b32 v154, 16, v154
    v_and_b32 v153, 0xffff0000, v152
    v_lshlrev_b32 v152, 16, v152
    v_pk_fma_f32 v[144:145], v[112:113], v[154:155], v[152:153] op_sel_hi:[0,1,1]
    v_lshlrev_b32 v152, 16, v97
    v_and_b32 v153, 0xffff0000, v97
    v_pk_mul_f32 v[154:155], v[152:153], v[118:119]
    v_pk_mul_f32 v[152:153], v[112:113], v[152:153] op_sel:[1,0]
    v_cvt_pk_bf16_f32 v154, v154, v155
    v_cvt_pk_bf16_f32 v152, v152, v153
    v_and_b32 v155, 0xffff0000, v154
    v_lshlrev_b32 v154, 16, v154
    v_and_b32 v153, 0xffff0000, v152
    v_lshlrev_b32 v152, 16, v152
    v_pk_fma_f32 v[146:147], v[112:113], v[154:155], v[152:153] op_sel_hi:[0,1,1]
    v_subrev_u32 v8, s49, v178
    v_lshlrev_b32 v152, v8, 1
    v_cmp_gt_u32 vcc, 32, v8
    s_nop 1
    v_cndmask_b32 v152, 0, v152, vcc
    s_nop 1
    v_or_b32_dpp v152, v152, v152 row_shr:1 row_mask:0xf bank_mask:0xf
    s_nop 1
    v_or_b32_dpp v152, v152, v152 row_shr:2 row_mask:0xf bank_mask:0xf
    s_nop 1
    v_or_b32_dpp v152, v152, v152 row_shr:4 row_mask:0xf bank_mask:0xf
    v_lshlrev_b32 v8, v6, 1
    v_readlane_b32 s33, v152, 7
    s_lshr_b32 s34, s33, 0
    v_and_b32 v170, s34, v8
    s_lshr_b32 s34, s33, 4
    v_and_b32 v171, s34, v8
    s_lshr_b32 s34, s33, 8
    v_and_b32 v172, s34, v8
    s_lshr_b32 s34, s33, 12
    v_and_b32 v173, s34, v8
    s_lshr_b32 s34, s33, 16
    v_and_b32 v174, s34, v8
    s_lshr_b32 s34, s33, 20
    v_and_b32 v175, s34, v8
    s_lshr_b32 s34, s33, 24
    v_and_b32 v176, s34, v8
    s_lshr_b32 s34, s33, 28
    v_and_b32 v177, s34, v8
    s_waitcnt vmcnt(10)
    s_barrier
    s_add_u32 m0, s60, 32768
    s_nop 0
    buffer_load_dwordx4 v14, s[8:11], s61 offen offset:0 lds
    buffer_load_dwordx4 v15, s[8:11], s61 offen offset:1024 lds
    buffer_load_dwordx4 v16, s[8:11], s61 offen offset:2048 lds
    buffer_load_dwordx4 v17, s[8:11], s61 offen offset:3072 lds
    s_add_u32 s61, s61, 128
    s_and_b32 s61, s61, 2047
    s_add_u32 s33, s30, 4
    v_readlane_b32 s66, v178, s30
    v_readlane_b32 s67, v179, s30
    v_readlane_b32 s68, v178, s33
    v_readlane_b32 s69, v179, s33
    v_mov_b32 v10, s66
    v_mov_b32 v168, s67
    s_mov_b32 exec_lo, 0
    v_mov_b32 v10, s68
    v_mov_b32 v168, s69
    s_mov_b32 exec_lo, -1
    v_subrev_u32 v3, s48, v10
    v_cmp_gt_u32 vcc, 0x80, v3
    v_lshrrev_b32 v11, 5, v1
    v_lshlrev_b32 v11, 19, v11
    v_and_b32 v13, 1, v6
    v_lshl_add_u32 v11, v13, 12, v11
    v_lshl_add_u32 v11, v7, 5, v11
    s_mov_b64 s[52:53], vcc
    v_cndmask_b32 v11, v2, v11, vcc
    v_lshl_add_u32 v13, v10, 11, v12
    v_cndmask_b32 v13, v2, v13, vcc
    v_lshlrev_b32 v12, 3, v10
    v_cndmask_b32 v12, v2, v12, vcc
    v_mov_b32 v9, s65
    v_cndmask_b32 v9, 0, v9, vcc
    s_lshl_b32 s54, s30, 17
    s_lshl_b32 s66, s27, 13
    s_add_u32 s54, s54, s66
    s_add_u32 s54, s54, 2621440
    s_mov_b32 s66, 8192
    s_waitcnt vmcnt(10)
    s_barrier
    s_add_u32 m0, s60, 49152
    s_nop 0
    buffer_load_dwordx4 v14, s[8:11], s61 offen offset:0 lds
    buffer_load_dwordx4 v15, s[8:11], s61 offen offset:1024 lds
    buffer_load_dwordx4 v16, s[8:11], s61 offen offset:2048 lds
    buffer_load_dwordx4 v17, s[8:11], s61 offen offset:3072 lds
    v_lshlrev_b32 v152, 16, v98
    v_and_b32 v153, 0xffff0000, v98
    v_pk_mul_f32 v[154:155], v[152:153], v[116:117]
    v_pk_mul_f32 v[152:153], v[114:115], v[152:153] op_sel:[1,0]
    v_cvt_pk_bf16_f32 v154, v154, v155
    v_cvt_pk_bf16_f32 v152, v152, v153
    v_and_b32 v155, 0xffff0000, v154
    v_lshlrev_b32 v154, 16, v154
    v_and_b32 v153, 0xffff0000, v152
    v_lshlrev_b32 v152, 16, v152
    v_pk_fma_f32 v[148:149], v[114:115], v[154:155], v[152:153] op_sel_hi:[0,1,1]
    v_lshlrev_b32 v152, 16, v99
    v_and_b32 v153, 0xffff0000, v99
    v_pk_mul_f32 v[154:155], v[152:153], v[118:119]
    v_pk_mul_f32 v[152:153], v[114:115], v[152:153] op_sel:[1,0]
    v_cvt_pk_bf16_f32 v154, v154, v155
    v_cvt_pk_bf16_f32 v152, v152, v153
    v_and_b32 v155, 0xffff0000, v154
    v_lshlrev_b32 v154, 16, v154
    v_and_b32 v153, 0xffff0000, v152
    v_lshlrev_b32 v152, 16, v152
    v_pk_fma_f32 v[150:151], v[114:115], v[154:155], v[152:153] op_sel_hi:[0,1,1]
    s_waitcnt vmcnt(8)
    s_barrier
    s_cmp_eq_u64 s[52:53], 0
    s_cbranch_scc1 L_noy
    buffer_load_dwordx4 v[20:23], v11, s[16:19], s54 offen offset:0 sc1
    buffer_load_dwordx4 v[24:27], v11, s[16:19], s54 offen offset:16 sc1
    buffer_load_dwordx4 v[28:31], v11, s[16:19], s54 offen offset:512 sc1
    buffer_load_dwordx4 v[32:35], v11, s[16:19], s54 offen offset:528 sc1
    buffer_load_dwordx4 v[36:39], v11, s[16:19], s54 offen offset:1024 sc1
    buffer_load_dwordx4 v[40:43], v11, s[16:19], s54 offen offset:1040 sc1
    buffer_load_dwordx4 v[44:47], v11, s[16:19], s54 offen offset:1536 sc1
    buffer_load_dwordx4 v[48:51], v11, s[16:19], s54 offen offset:1552 sc1
    buffer_load_dwordx4 v[52:55], v11, s[16:19], s54 offen offset:2048 sc1
    buffer_load_dwordx4 v[56:59], v11, s[16:19], s54 offen offset:2064 sc1
    buffer_load_dwordx4 v[60:63], v11, s[16:19], s54 offen offset:2560 sc1
    buffer_load_dwordx4 v[64:67], v11, s[16:19], s54 offen offset:2576 sc1
    buffer_load_dwordx4 v[68:71], v11, s[16:19], s54 offen offset:3072 sc1
    buffer_load_dwordx4 v[72:75], v11, s[16:19], s54 offen offset:3088 sc1
    buffer_load_dwordx4 v[76:79], v11, s[16:19], s54 offen offset:3584 sc1
    buffer_load_dwordx4 v[80:83], v11, s[16:19], s54 offen offset:3600 sc1
    buffer_load_dwordx2 v[160:161], v13, s[56:59], s55 offen
    buffer_load_dword v162, v12, s[16:19], s66 offen sc1
    s_waitcnt vmcnt(22)
    s_barrier
    s_waitcnt vmcnt(18)
    s_barrier
    s_branch L_yjoin
L_noy:
    s_waitcnt vmcnt(4)
    s_barrier
    s_waitcnt vmcnt(0)
    s_barrier
L_yjoin:
    v_lshlrev_b32 v14, 4, v7
    v_lshl_add_u32 v15, v10, 12, v14
    v_lshl_add_u32 v14, v6, 12, v14
    v_xor_b32 v16, v7, v6
    v_lshlrev_b32 v16, 4, v16
    v_lshl_add_u32 v16, v6, 8, v16
    s_lshl_b32 s33, s30, 13
    s_add_u32 s33, s33, 0
    v_add_u32 v16, s33, v16
    v_xor_b32 v17, 64, v16
    v_and_b32 v8, 7, v3
    v_xor_b32 v8, v8, v7
    v_lshlrev_b32 v8, 4, v8
    v_and_b32 v5, 0x7f, v3
    v_lshl_add_u32 v8, v5, 8, v8
    s_lshl_b32 s67, s27, 8
    s_lshl_b32 s69, s49, 12
    s_add_u32 s69, s69, s67
    s_cmp_eq_u64 s[52:53], 0
    s_cbranch_scc1 L_notok
    s_mov_b32 s68, 32768
L_ypoll:
    s_waitcnt vmcnt(0)
    v_xor_b32 v152, v9, v21
    v_xor_b32 v153, v9, v23
    v_or_b32 v152, v152, v153
    v_xor_b32 v153, v9, v25
    v_or_b32 v152, v152, v153
    v_xor_b32 v153, v9, v27
    v_or_b32 v152, v152, v153
    v_xor_b32 v153, v9, v29
    v_or_b32 v152, v152, v153
    v_xor_b32 v153, v9, v31
    v_or_b32 v152, v152, v153
    v_xor_b32 v153, v9, v33
    v_or_b32 v152, v152, v153
    v_xor_b32 v153, v9, v35
    v_or_b32 v152, v152, v153
    v_xor_b32 v153, v9, v37
    v_or_b32 v152, v152, v153
    v_xor_b32 v153, v9, v39
    v_or_b32 v152, v152, v153
    v_xor_b32 v153, v9, v41
    v_or_b32 v152, v152, v153
    v_xor_b32 v153, v9, v43
    v_or_b32 v152, v152, v153
    v_xor_b32 v153, v9, v45
    v_or_b32 v152, v152, v153
    v_xor_b32 v153, v9, v47
    v_or_b32 v152, v152, v153
    v_xor_b32 v153, v9, v49
    v_or_b32 v152, v152, v153
    v_xor_b32 v153, v9, v51
    v_or_b32 v152, v152, v153
    v_xor_b32 v153, v9, v53
    v_or_b32 v152, v152, v153
    v_xor_b32 v153, v9, v55
    v_or_b32 v152, v152, v153
    v_xor_b32 v153, v9, v57
    v_or_b32 v152, v152, v153
    v_xor_b32 v153, v9, v59
    v_or_b32 v152, v152, v153
    v_xor_b32 v153, v9, v61
    v_or_b32 v152, v152, v153
    v_xor_b32 v153, v9, v63
    v_or_b32 v152, v152, v153
    v_xor_b32 v153, v9, v65
    v_or_b32 v152, v152, v153
    v_xor_b32 v153, v9, v67
    v_or_b32 v152, v152, v153
    v_xor_b32 v153, v9, v69
    v_or_b32 v152, v152, v153
    v_xor_b32 v153, v9, v71
    v_or_b32 v152, v152, v153
    v_xor_b32 v153, v9, v73
    v_or_b32 v152, v152, v153
    v_xor_b32 v153, v9, v75
    v_or_b32 v152, v152, v153
    v_xor_b32 v153, v9, v77
    v_or_b32 v152, v152, v153
    v_xor_b32 v153, v9, v79
    v_or_b32 v152, v152, v153
    v_xor_b32 v153, v9, v81
    v_or_b32 v152, v152, v153
    v_xor_b32 v153, v9, v83
    v_or_b32 v152, v152, v153
    v_cmp_ne_u32 vcc, 0, v152
    s_cbranch_vccz L_yok
    s_sub_u32 s68, s68, 1
    s_cbranch_scc1 L_yok
    buffer_load_dwordx4 v[20:23], v11, s[16:19], s54 offen offset:0 sc1
    buffer_load_dwordx4 v[24:27], v11, s[16:19], s54 offen offset:16 sc1
    buffer_load_dwordx4 v[28:31], v11, s[16:19], s54 offen offset:512 sc1
    buffer_load_dwordx4 v[32:35], v11, s[16:19], s54 offen offset:528 sc1
    buffer_load_dwordx4 v[36:39], v11, s[16:19], s54 offen offset:1024 sc1
    buffer_load_dwordx4 v[40:43], v11, s[16:19], s54 offen offset:1040 sc1
    buffer_load_dwordx4 v[44:47], v11, s[16:19], s54 offen offset:1536 sc1
    buffer_load_dwordx4 v[48:51], v11, s[16:19], s54 offen offset:1552 sc1
    buffer_load_dwordx4 v[52:55], v11, s[16:19], s54 offen offset:2048 sc1
    buffer_load_dwordx4 v[56:59], v11, s[16:19], s54 offen offset:2064 sc1
    buffer_load_dwordx4 v[60:63], v11, s[16:19], s54 offen offset:2560 sc1
    buffer_load_dwordx4 v[64:67], v11, s[16:19], s54 offen offset:2576 sc1
    buffer_load_dwordx4 v[68:71], v11, s[16:19], s54 offen offset:3072 sc1
    buffer_load_dwordx4 v[72:75], v11, s[16:19], s54 offen offset:3088 sc1
    buffer_load_dwordx4 v[76:79], v11, s[16:19], s54 offen offset:3584 sc1
    buffer_load_dwordx4 v[80:83], v11, s[16:19], s54 offen offset:3600 sc1
    s_branch L_ypoll
L_yok:
    v_add_f32 v20, v20, v28
    v_add_f32 v22, v22, v30
    v_add_f32 v24, v24, v32
    v_add_f32 v26, v26, v34
    v_add_f32 v20, v20, v36
    v_add_f32 v22, v22, v38
    v_add_f32 v24, v24, v40
    v_add_f32 v26, v26, v42
    v_add_f32 v20, v20, v44
    v_add_f32 v22, v22, v46
    v_add_f32 v24, v24, v48
    v_add_f32 v26, v26, v50
    v_add_f32 v20, v20, v52
    v_add_f32 v22, v22, v54
    v_add_f32 v24, v24, v56
    v_add_f32 v26, v26, v58
    v_add_f32 v20, v20, v60
    v_add_f32 v22, v22, v62
    v_add_f32 v24, v24, v64
    v_add_f32 v26, v26, v66
    v_add_f32 v20, v20, v68
    v_add_f32 v22, v22, v70
    v_add_f32 v24, v24, v72
    v_add_f32 v26, v26, v74
    v_add_f32 v20, v20, v76
    v_add_f32 v22, v22, v78
    v_add_f32 v24, v24, v80
    v_add_f32 v26, v26, v82
    v_mov_b32 v21, v20
    v_mov_b32 v23, v22
    v_mov_b32 v25, v24
    v_mov_b32 v27, v26
    v_permlane16_swap_b32 v20, v21
    v_permlane16_swap_b32 v22, v23
    v_permlane16_swap_b32 v24, v25
    v_permlane16_swap_b32 v26, v27
    v_add_f32 v28, v20, v21
    v_add_f32 v29, v22, v23
    v_add_f32 v30, v24, v25
    v_add_f32 v31, v26, v27
    v_and_b32 v163, 0xffff0000, v162
    v_lshlrev_b32 v162, 16, v162
    v_cvt_pk_bf16_f32 v28, v28, v29
    v_and_b32 v29, 0xffff0000, v28
    v_lshlrev_b32 v28, 16, v28
    v_mul_f32 v28, v28, v168
    v_mul_f32 v29, v29, v168
    v_cvt_pk_bf16_f32 v28, v28, v29
    v_and_b32 v29, 0xffff0000, v28
    v_lshlrev_b32 v28, 16, v28
    v_lshlrev_b32 v152, 16, v160
    v_and_b32 v153, 0xffff0000, v160
    v_pk_add_f32 v[28:29], v[28:29], v[152:153]
    v_cvt_pk_bf16_f32 v28, v28, v29
    v_and_b32 v29, 0xffff0000, v28
    v_lshlrev_b32 v28, 16, v28
    v_cvt_pk_bf16_f32 v30, v30, v31
    v_and_b32 v31, 0xffff0000, v30
    v_lshlrev_b32 v30, 16, v30
    v_mul_f32 v30, v30, v168
    v_mul_f32 v31, v31, v168
    v_cvt_pk_bf16_f32 v30, v30, v31
    v_and_b32 v31, 0xffff0000, v30
    v_lshlrev_b32 v30, 16, v30
    v_lshlrev_b32 v152, 16, v161
    v_and_b32 v153, 0xffff0000, v161
    v_pk_add_f32 v[30:31], v[30:31], v[152:153]
    v_cvt_pk_bf16_f32 v30, v30, v31
    v_and_b32 v31, 0xffff0000, v30
    v_lshlrev_b32 v30, 16, v30
    v_lshlrev_b32 v152, 16, v160
    v_and_b32 v153, 0xffff0000, v160
    v_pk_mul_f32 v[154:155], v[152:153], v[116:117]
    v_pk_mul_f32 v[152:153], v[162:163], v[28:29] op_sel:[1,0]
    v_cvt_pk_bf16_f32 v154, v154, v155
    v_cvt_pk_bf16_f32 v152, v152, v153
    v_and_b32 v155, 0xffff0000, v154
    v_lshlrev_b32 v154, 16, v154
    v_and_b32 v153, 0xffff0000, v152
    v_lshlrev_b32 v152, 16, v152
    v_pk_fma_f32 v[164:165], v[162:163], v[154:155], v[152:153] op_sel_hi:[0,1,1]
    v_lshlrev_b32 v152, 16, v161
    v_and_b32 v153, 0xffff0000, v161
    v_pk_mul_f32 v[154:155], v[152:153], v[118:119]
    v_pk_mul_f32 v[152:153], v[162:163], v[30:31] op_sel:[1,0]
    v_cvt_pk_bf16_f32 v154, v154, v155
    v_cvt_pk_bf16_f32 v152, v152, v153
    v_and_b32 v155, 0xffff0000, v154
    v_lshlrev_b32 v154, 16, v154
    v_and_b32 v153, 0xffff0000, v152
    v_lshlrev_b32 v152, 16, v152
    v_pk_fma_f32 v[166:167], v[162:163], v[154:155], v[152:153] op_sel_hi:[0,1,1]
L_notok:
    s_barrier
    ds_read_b128 v[20:23], v16 offset:0
    ds_read_b128 v[24:27], v17 offset:1024
    ds_read_b128 v[28:31], v16 offset:2048
    ds_read_b128 v[32:35], v17 offset:3072
    ds_read_b128 v[36:39], v16 offset:4096
    ds_read_b128 v[40:43], v17 offset:5120
    ds_read_b128 v[44:47], v16 offset:6144
    ds_read_b128 v[48:51], v17 offset:7168
    ds_read_b128 v[52:55], v8 offset:0
    v_cmp_eq_u32 vcc, 0, v170
    s_waitcnt lgkmcnt(8)
    v_pk_fma_f32 v[20:21], v[100:101], v[20:21], v[120:121] op_sel_hi:[0,1,1]
    v_pk_fma_f32 v[22:23], v[100:101], v[22:23], v[122:123] op_sel_hi:[0,1,1]
    s_mov_b64 exec, vcc
    buffer_store_dwordx4 v[20:23], v14, s[40:43], s69 offen nt
    s_mov_b64 exec, -1
    s_add_u32 s69, s69, 16384
    v_cmp_eq_u32 vcc, 0, v171
    s_waitcnt lgkmcnt(7)
    v_pk_fma_f32 v[24:25], v[102:103], v[24:25], v[124:125] op_sel_hi:[0,1,1]
    v_pk_fma_f32 v[26:27], v[102:103], v[26:27], v[126:127] op_sel_hi:[0,1,1]
    s_mov_b64 exec, vcc
    buffer_store_dwordx4 v[24:27], v14, s[40:43], s69 offen nt
    s_mov_b64 exec, -1
    s_add_u32 s69, s69, 16384
    v_cmp_eq_u32 vcc, 0, v172
    s_waitcnt lgkmcnt(6)
    v_pk_fma_f32 v[28:29], v[104:105], v[28:29], v[128:129] op_sel_hi:[0,1,1]
    v_pk_fma_f32 v[30:31], v[104:105], v[30:31], v[130:131] op_sel_hi:[0,1,1]
    s_mov_b64 exec, vcc
    buffer_store_dwordx4 v[28:31], v14, s[40:43], s69 offen nt
    s_mov_b64 exec, -1
    s_add_u32 s69, s69, 16384
    v_cmp_eq_u32 vcc, 0, v173
    s_waitcnt lgkmcnt(5)
    v_pk_fma_f32 v[32:33], v[106:107], v[32:33], v[132:133] op_sel_hi:[0,1,1]
    v_pk_fma_f32 v[34:35], v[106:107], v[34:35], v[134:135] op_sel_hi:[0,1,1]
    s_mov_b64 exec, vcc
    buffer_store_dwordx4 v[32:35], v14, s[40:43], s69 offen nt
    s_mov_b64 exec, -1
    s_add_u32 s69, s69, 16384
    v_cmp_eq_u32 vcc, 0, v174
    s_waitcnt lgkmcnt(4)
    v_pk_fma_f32 v[36:37], v[108:109], v[36:37], v[136:137] op_sel_hi:[0,1,1]
    v_pk_fma_f32 v[38:39], v[108:109], v[38:39], v[138:139] op_sel_hi:[0,1,1]
    s_mov_b64 exec, vcc
    buffer_store_dwordx4 v[36:39], v14, s[40:43], s69 offen nt
    s_mov_b64 exec, -1
    s_add_u32 s69, s69, 16384
    v_cmp_eq_u32 vcc, 0, v175
    s_waitcnt lgkmcnt(3)
    v_pk_fma_f32 v[40:41], v[110:111], v[40:41], v[140:141] op_sel_hi:[0,1,1]
    v_pk_fma_f32 v[42:43], v[110:111], v[42:43], v[142:143] op_sel_hi:[0,1,1]
    s_mov_b64 exec, vcc
    buffer_store_dwordx4 v[40:43], v14, s[40:43], s69 offen nt
    s_mov_b64 exec, -1
    s_add_u32 s69, s69, 16384
    v_cmp_eq_u32 vcc, 0, v176
    s_waitcnt lgkmcnt(2)
    v_pk_fma_f32 v[44:45], v[112:113], v[44:45], v[144:145] op_sel_hi:[0,1,1]
    v_pk_fma_f32 v[46:47], v[112:113], v[46:47], v[146:147] op_sel_hi:[0,1,1]
    s_mov_b64 exec, vcc
    buffer_store_dwordx4 v[44:47], v14, s[40:43], s69 offen nt
    s_mov_b64 exec, -1
    s_add_u32 s69, s69, 16384
    v_cmp_eq_u32 vcc, 0, v177
    s_waitcnt lgkmcnt(1)
    v_pk_fma_f32 v[48:49], v[114:115], v[48:49], v[148:149] op_sel_hi:[0,1,1]
    v_pk_fma_f32 v[50:51], v[114:115], v[50:51], v[150:151] op_sel_hi:[0,1,1]
    s_mov_b64 exec, vcc
    buffer_store_dwordx4 v[48:51], v14, s[40:43], s69 offen nt
    s_mov_b64 exec, -1
    s_add_u32 s69, s69, 16384
    s_waitcnt lgkmcnt(0)
    v_pk_fma_f32 v[52:53], v[162:163], v[52:53], v[164:165] op_sel_hi:[0,1,1]
    v_pk_fma_f32 v[54:55], v[162:163], v[54:55], v[166:167] op_sel_hi:[0,1,1]
    s_and_b32 exec_lo, s52, 0xffff
    s_and_b32 exec_hi, s53, 0xffff
    s_cbranch_execz L_aend
    buffer_store_dwordx4 v[52:55], v15, s[40:43], s67 offen nt
L_aend:
    s_endpgm
L_compute:
    s_load_dwordx2 s[8:9], s[0:1], 8
    s_load_dwordx2 s[12:13], s[0:1], 16
    s_load_dwordx2 s[16:17], s[0:1], 56
    s_load_dwordx2 s[20:21], s[0:1], 136
    s_lshr_b32 s30, s29, 1
    s_and_b32 s31, s29, 1
    v_and_b32 v6, 15, v1
    v_lshrrev_b32 v7, 4, v1
    s_lshl_b32 s32, s27, 6
    s_lshl_b32 s33, s31, 5
    s_add_u32 s32, s32, s33
    s_lshl_b32 s32, s32, 1
    v_lshlrev_b32 v8, 1, v6
    v_lshlrev_b32 v196, 4, v1
    s_mov_b32 s10, 2048
    s_mov_b32 s11, 0x20000
    s_mov_b32 s14, 2048
    s_mov_b32 s15, 0x20000
    s_mov_b32 s18, 2048
    s_mov_b32 s19, 0x20000
    s_waitcnt lgkmcnt(0)
    s_load_dword s44, s[20:21], 0
    buffer_load_ushort v26, v8, s[16:19], s32 offen offset:0
    buffer_load_ushort v248, v8, s[8:11], s32 offen offset:0
    buffer_load_ushort v250, v8, s[12:15], s32 offen offset:0
    buffer_load_ushort v27, v8, s[16:19], s32 offen offset:32
    buffer_load_ushort v249, v8, s[8:11], s32 offen offset:32
    buffer_load_ushort v251, v8, s[12:15], s32 offen offset:32
    s_getpc_b64 s[8:9]
Lc_pc:
    s_sub_u32 s8, s8, Lc_pc - gated_mix__ssm_conv_s5__moe_arch_mod__prompt_kernel
    s_subb_u32 s9, s9, 0
    s_mov_b32 s10, L_end - gated_mix__ssm_conv_s5__moe_arch_mod__prompt_kernel
    s_lshl_b32 s33, s25, 10
    s_cmp_lg_u32 s29, 0
    s_cbranch_scc1 Lc_nopf
    buffer_load_dwordx4 v[192:195], v196, s[8:11], s33 offen
Lc_nopf:
    v_lshrrev_b32 v8, 1, v6
    v_xor_b32 v8, v8, v7
    v_lshlrev_b32 v8, 4, v8
    v_lshl_add_u32 v8, v6, 7, v8
    s_lshl_b32 s33, s30, 13
    s_lshl_b32 s34, s31, 13
    s_add_u32 s34, s34, 16384
    v_add_u32 v2, s33, v8
    v_add_u32 v4, s34, v8
    v_xor_b32 v3, 64, v2
    v_xor_b32 v5, 64, v4
    s_lshl_b32 s33, s27, 14
    s_add_u32 s33, s33, 65536
    s_add_u32 s36, s20, s33
    s_addc_u32 s37, s21, 0
    s_mov_b32 s38, 16384
    s_mov_b32 s39, 0x20000
    s_add_u32 s33, s27, s26
    s_and_b32 s33, s33, 15
    s_lshl_b32 s33, s33, 2
    s_add_u32 s33, s33, s31
    s_lshl_b32 s33, s33, 3
    s_lshl_b32 s34, s26, 9
    s_add_u32 s33, s33, s34
    s_lshl_b32 s34, s30, 2
    s_add_u32 s33, s33, s34
    s_lshl_b32 s33, s33, 10
    s_add_u32 s33, s33, 4194304
    s_add_u32 s40, s20, s33
    s_addc_u32 s41, s21, 0
    s_mov_b32 s42, 20480
    s_mov_b32 s43, 0x20000
    v_mov_b32 v96, 0
    v_mov_b32 v97, 0
    v_mov_b32 v98, 0
    v_mov_b32 v99, 0
    v_mov_b32 v100, 0
    v_mov_b32 v101, 0
    v_mov_b32 v102, 0
    v_mov_b32 v103, 0
    v_mov_b32 v104, 0
    v_mov_b32 v105, 0
    v_mov_b32 v106, 0
    v_mov_b32 v107, 0
    v_mov_b32 v108, 0
    v_mov_b32 v109, 0
    v_mov_b32 v110, 0
    v_mov_b32 v111, 0
    v_mov_b32 v112, 0
    v_mov_b32 v113, 0
    v_mov_b32 v114, 0
    v_mov_b32 v115, 0
    v_mov_b32 v116, 0
    v_mov_b32 v117, 0
    v_mov_b32 v118, 0
    v_mov_b32 v119, 0
    v_mov_b32 v120, 0
    v_mov_b32 v121, 0
    v_mov_b32 v122, 0
    v_mov_b32 v123, 0
    v_mov_b32 v124, 0
    v_mov_b32 v125, 0
    v_mov_b32 v126, 0
    v_mov_b32 v127, 0
    v_mov_b32 v128, 0
    v_mov_b32 v129, 0
    v_mov_b32 v130, 0
    v_mov_b32 v131, 0
    v_mov_b32 v132, 0
    v_mov_b32 v133, 0
    v_mov_b32 v134, 0
    v_mov_b32 v135, 0
    v_mov_b32 v136, 0
    v_mov_b32 v137, 0
    v_mov_b32 v138, 0
    v_mov_b32 v139, 0
    v_mov_b32 v140, 0
    v_mov_b32 v141, 0
    v_mov_b32 v142, 0
    v_mov_b32 v143, 0
    v_mov_b32 v144, 0
    v_mov_b32 v145, 0
    v_mov_b32 v146, 0
    v_mov_b32 v147, 0
    v_mov_b32 v148, 0
    v_mov_b32 v149, 0
    v_mov_b32 v150, 0
    v_mov_b32 v151, 0
    v_mov_b32 v152, 0
    v_mov_b32 v153, 0
    v_mov_b32 v154, 0
    v_mov_b32 v155, 0
    v_mov_b32 v156, 0
    v_mov_b32 v157, 0
    v_mov_b32 v158, 0
    v_mov_b32 v159, 0
    s_waitcnt vmcnt(0)
    v_lshlrev_b32 v26, 16, v26
    v_lshlrev_b32 v248, 16, v248
    v_lshlrev_b32 v250, 16, v250
    v_mul_f32 v26, 0x3fb8aa3b, v26
    v_exp_f32 v26, v26
    v_lshlrev_b32 v27, 16, v27
    v_lshlrev_b32 v249, 16, v249
    v_lshlrev_b32 v251, 16, v251
    v_mul_f32 v27, 0x3fb8aa3b, v27
    v_exp_f32 v27, v27
    s_nop 0
    v_cvt_pk_bf16_f32 v26, v26, v27
    v_and_b32 v27, 0xffff0000, v26
    v_lshlrev_b32 v26, 16, v26
    v_pk_mul_f32 v[28:29], v[26:27], v[250:251]
    v_pk_mul_f32 v[26:27], v[26:27], v[248:249]
    v_mul_f32 v26, 0x3fb8aa3b, v26
    v_mul_f32 v28, 0x3e22f983, v28
    v_exp_f32 v26, v26
    v_rndne_f32 v10, v28
    v_sub_f32 v28, v28, v10
    v_cos_f32 v10, v28
    v_sin_f32 v12, v28
    v_mul_f32 v27, 0x3fb8aa3b, v27
    v_mul_f32 v29, 0x3e22f983, v29
    v_exp_f32 v27, v27
    v_rndne_f32 v11, v29
    v_sub_f32 v29, v29, v11
    v_cos_f32 v11, v29
    v_sin_f32 v13, v29
    v_pk_mul_f32 v[10:11], v[10:11], v[26:27]
    v_pk_mul_f32 v[12:13], v[12:13], v[26:27]
    v_pk_mul_f32 v[26:27], v[10:11], v[12:13]
    v_pk_mul_f32 v[14:15], v[10:11], v[10:11]
    v_pk_fma_f32 v[14:15], v[12:13], v[12:13], v[14:15] neg_lo:[1,0,0] neg_hi:[1,0,0]
    v_pk_add_f32 v[16:17], v[26:27], v[26:27]
    v_pk_mul_f32 v[26:27], v[14:15], v[16:17]
    v_pk_mul_f32 v[18:19], v[14:15], v[14:15]
    v_pk_fma_f32 v[18:19], v[16:17], v[16:17], v[18:19] neg_lo:[1,0,0] neg_hi:[1,0,0]
    v_pk_add_f32 v[20:21], v[26:27], v[26:27]
    v_pk_mul_f32 v[26:27], v[18:19], v[20:21]
    v_pk_mul_f32 v[14:15], v[18:19], v[18:19]
    v_pk_fma_f32 v[14:15], v[20:21], v[20:21], v[14:15] neg_lo:[1,0,0] neg_hi:[1,0,0]
    v_pk_add_f32 v[16:17], v[26:27], v[26:27]
    v_pk_mul_f32 v[26:27], v[14:15], v[16:17]
    v_pk_mul_f32 v[18:19], v[14:15], v[14:15]
    v_pk_fma_f32 v[18:19], v[16:17], v[16:17], v[18:19] neg_lo:[1,0,0] neg_hi:[1,0,0]
    v_pk_add_f32 v[20:21], v[26:27], v[26:27]
    s_waitcnt lgkmcnt(0)
    s_mul_i32 s44, s44, 1664525
    s_add_u32 s44, s44, 1013904223
    s_setprio 1
    s_barrier
    ds_read_b128 v[32:35], v2 offset:0
    ds_read_b128 v[48:51], v4 offset:0
    ds_read_b128 v[52:55], v4 offset:2048
    ds_read_b128 v[56:59], v4 offset:4096
    ds_read_b128 v[60:63], v4 offset:6144
    ds_read_b128 v[36:39], v2 offset:2048
    ds_read_b128 v[40:43], v2 offset:4096
    ds_read_b128 v[44:47], v2 offset:6144
    s_mov_b32 s35, 0
Lc_loop:
    s_waitcnt lgkmcnt(0)
    v_mfma_f32_16x16x32_bf16 v[96:99], v[32:35], v[48:51], v[96:99]
    ds_read_b128 v[64:67], v3 offset:0
    v_mfma_f32_16x16x32_bf16 v[128:131], v[32:35], v[52:55], v[128:131]
    ds_read_b128 v[80:83], v5 offset:0
    v_mfma_f32_16x16x32_bf16 v[112:115], v[32:35], v[56:59], v[112:115]
    ds_read_b128 v[84:87], v5 offset:2048
    v_mfma_f32_16x16x32_bf16 v[144:147], v[32:35], v[60:63], v[144:147]
    ds_read_b128 v[88:91], v5 offset:4096
    v_mfma_f32_16x16x32_bf16 v[148:151], v[36:39], v[60:63], v[148:151]
    ds_read_b128 v[92:95], v5 offset:6144
    v_mfma_f32_16x16x32_bf16 v[116:119], v[36:39], v[56:59], v[116:119]
    ds_read_b128 v[68:71], v3 offset:2048
    v_mfma_f32_16x16x32_bf16 v[132:135], v[36:39], v[52:55], v[132:135]
    ds_read_b128 v[72:75], v3 offset:4096
    v_mfma_f32_16x16x32_bf16 v[100:103], v[36:39], v[48:51], v[100:103]
    ds_read_b128 v[76:79], v3 offset:6144
    v_mfma_f32_16x16x32_bf16 v[104:107], v[40:43], v[48:51], v[104:107]
    v_mfma_f32_16x16x32_bf16 v[136:139], v[40:43], v[52:55], v[136:139]
    v_mfma_f32_16x16x32_bf16 v[120:123], v[40:43], v[56:59], v[120:123]
    v_mfma_f32_16x16x32_bf16 v[152:155], v[40:43], v[60:63], v[152:155]
    v_mfma_f32_16x16x32_bf16 v[156:159], v[44:47], v[60:63], v[156:159]
    v_mfma_f32_16x16x32_bf16 v[124:127], v[44:47], v[56:59], v[124:127]
    v_mfma_f32_16x16x32_bf16 v[140:143], v[44:47], v[52:55], v[140:143]
    v_mfma_f32_16x16x32_bf16 v[108:111], v[44:47], v[48:51], v[108:111]
    s_waitcnt lgkmcnt(0)
    v_mfma_f32_16x16x32_bf16 v[96:99], v[64:67], v[80:83], v[96:99]
    v_mfma_f32_16x16x32_bf16 v[128:131], v[64:67], v[84:87], v[128:131]
    v_mfma_f32_16x16x32_bf16 v[112:115], v[64:67], v[88:91], v[112:115]
    s_barrier
    v_mfma_f32_16x16x32_bf16 v[144:147], v[64:67], v[92:95], v[144:147]
    ds_read_b128 v[32:35], v2 offset:32768
    v_mfma_f32_16x16x32_bf16 v[148:151], v[68:71], v[92:95], v[148:151]
    ds_read_b128 v[48:51], v4 offset:32768
    v_mfma_f32_16x16x32_bf16 v[116:119], v[68:71], v[88:91], v[116:119]
    ds_read_b128 v[52:55], v4 offset:34816
    v_mfma_f32_16x16x32_bf16 v[132:135], v[68:71], v[84:87], v[132:135]
    ds_read_b128 v[56:59], v4 offset:36864
    v_mfma_f32_16x16x32_bf16 v[100:103], v[68:71], v[80:83], v[100:103]
    ds_read_b128 v[60:63], v4 offset:38912
    v_mfma_f32_16x16x32_bf16 v[104:107], v[72:75], v[80:83], v[104:107]
    ds_read_b128 v[36:39], v2 offset:34816
    v_mfma_f32_16x16x32_bf16 v[136:139], v[72:75], v[84:87], v[136:139]
    ds_read_b128 v[40:43], v2 offset:36864
    v_mfma_f32_16x16x32_bf16 v[120:123], v[72:75], v[88:91], v[120:123]
    ds_read_b128 v[44:47], v2 offset:38912
    v_mfma_f32_16x16x32_bf16 v[152:155], v[72:75], v[92:95], v[152:155]
    v_mfma_f32_16x16x32_bf16 v[156:159], v[76:79], v[92:95], v[156:159]
    v_mfma_f32_16x16x32_bf16 v[124:127], v[76:79], v[88:91], v[124:127]
    v_mfma_f32_16x16x32_bf16 v[140:143], v[76:79], v[84:87], v[140:143]
    v_mfma_f32_16x16x32_bf16 v[108:111], v[76:79], v[80:83], v[108:111]
    s_waitcnt lgkmcnt(0)
    v_mfma_f32_16x16x32_bf16 v[96:99], v[32:35], v[48:51], v[96:99]
    ds_read_b128 v[64:67], v3 offset:32768
    v_mfma_f32_16x16x32_bf16 v[128:131], v[32:35], v[52:55], v[128:131]
    ds_read_b128 v[80:83], v5 offset:32768
    v_mfma_f32_16x16x32_bf16 v[112:115], v[32:35], v[56:59], v[112:115]
    ds_read_b128 v[84:87], v5 offset:34816
    v_mfma_f32_16x16x32_bf16 v[144:147], v[32:35], v[60:63], v[144:147]
    ds_read_b128 v[88:91], v5 offset:36864
    v_mfma_f32_16x16x32_bf16 v[148:151], v[36:39], v[60:63], v[148:151]
    ds_read_b128 v[92:95], v5 offset:38912
    v_mfma_f32_16x16x32_bf16 v[116:119], v[36:39], v[56:59], v[116:119]
    ds_read_b128 v[68:71], v3 offset:34816
    v_mfma_f32_16x16x32_bf16 v[132:135], v[36:39], v[52:55], v[132:135]
    ds_read_b128 v[72:75], v3 offset:36864
    v_mfma_f32_16x16x32_bf16 v[100:103], v[36:39], v[48:51], v[100:103]
    ds_read_b128 v[76:79], v3 offset:38912
    v_mfma_f32_16x16x32_bf16 v[104:107], v[40:43], v[48:51], v[104:107]
    v_mfma_f32_16x16x32_bf16 v[136:139], v[40:43], v[52:55], v[136:139]
    v_mfma_f32_16x16x32_bf16 v[120:123], v[40:43], v[56:59], v[120:123]
    v_mfma_f32_16x16x32_bf16 v[152:155], v[40:43], v[60:63], v[152:155]
    v_mfma_f32_16x16x32_bf16 v[156:159], v[44:47], v[60:63], v[156:159]
    v_mfma_f32_16x16x32_bf16 v[124:127], v[44:47], v[56:59], v[124:127]
    v_mfma_f32_16x16x32_bf16 v[140:143], v[44:47], v[52:55], v[140:143]
    v_mfma_f32_16x16x32_bf16 v[108:111], v[44:47], v[48:51], v[108:111]
    s_waitcnt lgkmcnt(0)
    v_mfma_f32_16x16x32_bf16 v[96:99], v[64:67], v[80:83], v[96:99]
    v_xor_b32 v2, 0x10000, v2
    v_xor_b32 v3, 0x10000, v3
    v_xor_b32 v4, 0x10000, v4
    v_xor_b32 v5, 0x10000, v5
    v_mfma_f32_16x16x32_bf16 v[128:131], v[64:67], v[84:87], v[128:131]
    v_mfma_f32_16x16x32_bf16 v[112:115], v[64:67], v[88:91], v[112:115]
    s_cmp_eq_u32 s35, 7
    s_cbranch_scc1 Lc_nobar
    s_barrier
Lc_nobar:
    v_mfma_f32_16x16x32_bf16 v[144:147], v[64:67], v[92:95], v[144:147]
    ds_read_b128 v[32:35], v2 offset:0
    v_mfma_f32_16x16x32_bf16 v[148:151], v[68:71], v[92:95], v[148:151]
    ds_read_b128 v[48:51], v4 offset:0
    v_mfma_f32_16x16x32_bf16 v[116:119], v[68:71], v[88:91], v[116:119]
    ds_read_b128 v[52:55], v4 offset:2048
    v_mfma_f32_16x16x32_bf16 v[132:135], v[68:71], v[84:87], v[132:135]
    ds_read_b128 v[56:59], v4 offset:4096
    v_mfma_f32_16x16x32_bf16 v[100:103], v[68:71], v[80:83], v[100:103]
    ds_read_b128 v[60:63], v4 offset:6144
    v_mfma_f32_16x16x32_bf16 v[104:107], v[72:75], v[80:83], v[104:107]
    ds_read_b128 v[36:39], v2 offset:2048
    v_mfma_f32_16x16x32_bf16 v[136:139], v[72:75], v[84:87], v[136:139]
    ds_read_b128 v[40:43], v2 offset:4096
    v_mfma_f32_16x16x32_bf16 v[120:123], v[72:75], v[88:91], v[120:123]
    ds_read_b128 v[44:47], v2 offset:6144
    v_mfma_f32_16x16x32_bf16 v[152:155], v[72:75], v[92:95], v[152:155]
    v_mfma_f32_16x16x32_bf16 v[156:159], v[76:79], v[92:95], v[156:159]
    v_mfma_f32_16x16x32_bf16 v[124:127], v[76:79], v[88:91], v[124:127]
    v_mfma_f32_16x16x32_bf16 v[140:143], v[76:79], v[84:87], v[140:143]
    v_mfma_f32_16x16x32_bf16 v[108:111], v[76:79], v[80:83], v[108:111]
    s_add_u32 s35, s35, 1
    s_cmp_lt_u32 s35, 8
    s_cbranch_scc1 Lc_loop
    s_sub_u32 s33, s26, 1
    v_sub_u32 v8, s33, v7
    v_lshlrev_b32 v8, 10, v8
    v_lshl_add_u32 v8, v6, 4, v8
    s_lshl_b32 s33, s31, 9
    v_add_u32 v192, s33, v8
    v_add_u32 v193, -4096, v192
    v_add_u32 v194, -8192, v192
    v_add_u32 v195, -12288, v192
    v_mov_b32 v9, 147456
    s_waitcnt lgkmcnt(0)
    v_pk_fma_f32 v[98:99], v[10:11], v[96:97], v[98:99] op_sel_hi:[0,1,1]
    v_pk_fma_f32 v[130:131], v[10:11], v[128:129], v[130:131] op_sel:[1,0,0]
    v_pk_fma_f32 v[114:115], v[10:11], v[112:113], v[114:115] op_sel_hi:[0,1,1]
    v_pk_fma_f32 v[146:147], v[10:11], v[144:145], v[146:147] op_sel:[1,0,0]
    v_pk_fma_f32 v[98:99], v[12:13], v[112:113], v[98:99] op_sel_hi:[0,1,1] neg_lo:[1,0,0] neg_hi:[1,0,0]
    v_pk_fma_f32 v[130:131], v[12:13], v[144:145], v[130:131] op_sel:[1,0,0] neg_lo:[1,0,0] neg_hi:[1,0,0]
    v_pk_fma_f32 v[114:115], v[12:13], v[96:97], v[114:115] op_sel_hi:[0,1,1]
    v_pk_fma_f32 v[146:147], v[12:13], v[128:129], v[146:147] op_sel:[1,0,0]
    v_pk_fma_f32 v[100:101], v[10:11], v[98:99], v[100:101] op_sel_hi:[0,1,1]
    v_pk_fma_f32 v[132:133], v[10:11], v[130:131], v[132:133] op_sel:[1,0,0]
    v_pk_fma_f32 v[116:117], v[10:11], v[114:115], v[116:117] op_sel_hi:[0,1,1]
    v_pk_fma_f32 v[148:149], v[10:11], v[146:147], v[148:149] op_sel:[1,0,0]
    v_pk_fma_f32 v[100:101], v[12:13], v[114:115], v[100:101] op_sel_hi:[0,1,1] neg_lo:[1,0,0] neg_hi:[1,0,0]
    v_pk_fma_f32 v[132:133], v[12:13], v[146:147], v[132:133] op_sel:[1,0,0] neg_lo:[1,0,0] neg_hi:[1,0,0]
    v_pk_fma_f32 v[116:117], v[12:13], v[98:99], v[116:117] op_sel_hi:[0,1,1]
    v_pk_fma_f32 v[148:149], v[12:13], v[130:131], v[148:149] op_sel:[1,0,0]
    v_pk_fma_f32 v[102:103], v[10:11], v[100:101], v[102:103] op_sel_hi:[0,1,1]
    v_pk_fma_f32 v[134:135], v[10:11], v[132:133], v[134:135] op_sel:[1,0,0]
    v_pk_fma_f32 v[118:119], v[10:11], v[116:117], v[118:119] op_sel_hi:[0,1,1]
    v_pk_fma_f32 v[150:151], v[10:11], v[148:149], v[150:151] op_sel:[1,0,0]
    v_pk_fma_f32 v[102:103], v[12:13], v[116:117], v[102:103] op_sel_hi:[0,1,1] neg_lo:[1,0,0] neg_hi:[1,0,0]
    v_pk_fma_f32 v[134:135], v[12:13], v[148:149], v[134:135] op_sel:[1,0,0] neg_lo:[1,0,0] neg_hi:[1,0,0]
    v_pk_fma_f32 v[118:119], v[12:13], v[100:101], v[118:119] op_sel_hi:[0,1,1]
    v_pk_fma_f32 v[150:151], v[12:13], v[132:133], v[150:151] op_sel:[1,0,0]
    v_pk_fma_f32 v[104:105], v[10:11], v[102:103], v[104:105] op_sel_hi:[0,1,1]
    v_pk_fma_f32 v[136:137], v[10:11], v[134:135], v[136:137] op_sel:[1,0,0]
    v_pk_fma_f32 v[120:121], v[10:11], v[118:119], v[120:121] op_sel_hi:[0,1,1]
    v_pk_fma_f32 v[152:153], v[10:11], v[150:151], v[152:153] op_sel:[1,0,0]
    v_pk_fma_f32 v[104:105], v[12:13], v[118:119], v[104:105] op_sel_hi:[0,1,1] neg_lo:[1,0,0] neg_hi:[1,0,0]
    v_pk_fma_f32 v[136:137], v[12:13], v[150:151], v[136:137] op_sel:[1,0,0] neg_lo:[1,0,0] neg_hi:[1,0,0]
    v_pk_fma_f32 v[120:121], v[12:13], v[102:103], v[120:121] op_sel_hi:[0,1,1]
    v_pk_fma_f32 v[152:153], v[12:13], v[134:135], v[152:153] op_sel:[1,0,0]
    v_pk_fma_f32 v[106:107], v[10:11], v[104:105], v[106:107] op_sel_hi:[0,1,1]
    v_pk_fma_f32 v[138:139], v[10:11], v[136:137], v[138:139] op_sel:[1,0,0]
    v_pk_fma_f32 v[122:123], v[10:11], v[120:121], v[122:123] op_sel_hi:[0,1,1]
    v_pk_fma_f32 v[154:155], v[10:11], v[152:153], v[154:155] op_sel:[1,0,0]
    v_pk_fma_f32 v[106:107], v[12:13], v[120:121], v[106:107] op_sel_hi:[0,1,1] neg_lo:[1,0,0] neg_hi:[1,0,0]
    v_pk_fma_f32 v[138:139], v[12:13], v[152:153], v[138:139] op_sel:[1,0,0] neg_lo:[1,0,0] neg_hi:[1,0,0]
    v_pk_fma_f32 v[122:123], v[12:13], v[104:105], v[122:123] op_sel_hi:[0,1,1]
    v_pk_fma_f32 v[154:155], v[12:13], v[136:137], v[154:155] op_sel:[1,0,0]
    v_pk_fma_f32 v[108:109], v[10:11], v[106:107], v[108:109] op_sel_hi:[0,1,1]
    v_pk_fma_f32 v[140:141], v[10:11], v[138:139], v[140:141] op_sel:[1,0,0]
    v_pk_fma_f32 v[124:125], v[10:11], v[122:123], v[124:125] op_sel_hi:[0,1,1]
    v_pk_fma_f32 v[156:157], v[10:11], v[154:155], v[156:157] op_sel:[1,0,0]
    v_pk_fma_f32 v[108:109], v[12:13], v[122:123], v[108:109] op_sel_hi:[0,1,1] neg_lo:[1,0,0] neg_hi:[1,0,0]
    v_pk_fma_f32 v[140:141], v[12:13], v[154:155], v[140:141] op_sel:[1,0,0] neg_lo:[1,0,0] neg_hi:[1,0,0]
    v_pk_fma_f32 v[124:125], v[12:13], v[106:107], v[124:125] op_sel_hi:[0,1,1]
    v_pk_fma_f32 v[156:157], v[12:13], v[138:139], v[156:157] op_sel:[1,0,0]
    v_pk_fma_f32 v[110:111], v[10:11], v[108:109], v[110:111] op_sel_hi:[0,1,1]
    v_pk_fma_f32 v[142:143], v[10:11], v[140:141], v[142:143] op_sel:[1,0,0]
    v_pk_fma_f32 v[126:127], v[10:11], v[124:125], v[126:127] op_sel_hi:[0,1,1]
    v_pk_fma_f32 v[158:159], v[10:11], v[156:157], v[158:159] op_sel:[1,0,0]
    v_pk_fma_f32 v[110:111], v[12:13], v[124:125], v[110:111] op_sel_hi:[0,1,1] neg_lo:[1,0,0] neg_hi:[1,0,0]
    v_pk_fma_f32 v[142:143], v[12:13], v[156:157], v[142:143] op_sel:[1,0,0] neg_lo:[1,0,0] neg_hi:[1,0,0]
    v_pk_fma_f32 v[126:127], v[12:13], v[108:109], v[126:127] op_sel_hi:[0,1,1]
    v_pk_fma_f32 v[158:159], v[12:13], v[140:141], v[158:159] op_sel:[1,0,0]
    v_fma_f32 v26, v14, v110, v111
    v_fma_f32 v27, v14, v126, v127
    v_fma_f32 v26, -v16, v126, v26
    v_fma_f32 v27, v16, v110, v27
    v_fma_f32 v28, v15, v142, v143
    v_fma_f32 v29, v15, v158, v159
    v_fma_f32 v28, -v17, v158, v28
    v_fma_f32 v29, v17, v142, v29
    s_lshl_b32 s33, s31, 8
    s_add_u32 s33, s33, 148480
    v_lshl_add_u32 v30, v6, 3, s33
    s_lshl_b32 s33, s30, 11
    v_lshl_add_u32 v31, v7, 9, s33
    v_add_u32 v31, v31, v30
    ds_write_b64 v31, v[26:27]
    ds_write_b64 v31, v[28:29] offset:128
    s_lshl_b32 s33, s29, 2
    v_add_u32 v31, s33, v9
    s_xor_b32 s33, s33, 8
    v_add_u32 v9, s33, v9
    v_mov_b32 v8, 1
    ds_write_b32 v31, v8
    s_mov_b32 s45, 32768
Lc_expoll:
    ds_read_b32 v8, v9
    ds_read_b64 v[32:33], v30 offset:0
    ds_read_b64 v[34:35], v30 offset:128
    ds_read_b64 v[36:37], v30 offset:512
    ds_read_b64 v[38:39], v30 offset:640
    ds_read_b64 v[40:41], v30 offset:1024
    ds_read_b64 v[42:43], v30 offset:1152
    ds_read_b64 v[44:45], v30 offset:1536
    ds_read_b64 v[46:47], v30 offset:1664
    ds_read_b64 v[48:49], v30 offset:2048
    ds_read_b64 v[50:51], v30 offset:2176
    ds_read_b64 v[52:53], v30 offset:2560
    ds_read_b64 v[54:55], v30 offset:2688
    ds_read_b64 v[56:57], v30 offset:3072
    ds_read_b64 v[58:59], v30 offset:3200
    ds_read_b64 v[60:61], v30 offset:3584
    ds_read_b64 v[62:63], v30 offset:3712
    s_waitcnt lgkmcnt(0)
    v_readfirstlane_b32 s33, v8
    s_sub_u32 s45, s45, 1
    s_cbranch_scc1 Lc_exok
    s_cmp_eq_u32 s33, 0
    s_cbranch_scc1 Lc_expoll
Lc_exok:
    v_pk_fma_f32 v[36:37], v[18:19], v[32:33], v[36:37] op_sel_hi:[0,1,1]
    v_pk_fma_f32 v[36:37], v[32:33], v[20:21], v[36:37] op_sel:[1,0,0] op_sel_hi:[0,0,1] neg_lo:[1,0,0]
    v_pk_fma_f32 v[38:39], v[18:19], v[34:35], v[38:39] op_sel:[1,0,0]
    v_pk_fma_f32 v[38:39], v[20:21], v[34:35], v[38:39] op_sel:[1,1,0] op_sel_hi:[1,0,1] neg_lo:[0,1,0]
    v_pk_fma_f32 v[40:41], v[18:19], v[36:37], v[40:41] op_sel_hi:[0,1,1]
    v_pk_fma_f32 v[40:41], v[36:37], v[20:21], v[40:41] op_sel:[1,0,0] op_sel_hi:[0,0,1] neg_lo:[1,0,0]
    v_pk_fma_f32 v[42:43], v[18:19], v[38:39], v[42:43] op_sel:[1,0,0]
    v_pk_fma_f32 v[42:43], v[20:21], v[38:39], v[42:43] op_sel:[1,1,0] op_sel_hi:[1,0,1] neg_lo:[0,1,0]
    v_pk_fma_f32 v[44:45], v[18:19], v[40:41], v[44:45] op_sel_hi:[0,1,1]
    v_pk_fma_f32 v[44:45], v[40:41], v[20:21], v[44:45] op_sel:[1,0,0] op_sel_hi:[0,0,1] neg_lo:[1,0,0]
    v_pk_fma_f32 v[46:47], v[18:19], v[42:43], v[46:47] op_sel:[1,0,0]
    v_pk_fma_f32 v[46:47], v[20:21], v[42:43], v[46:47] op_sel:[1,1,0] op_sel_hi:[1,0,1] neg_lo:[0,1,0]
    v_pk_fma_f32 v[48:49], v[18:19], v[44:45], v[48:49] op_sel_hi:[0,1,1]
    v_pk_fma_f32 v[48:49], v[44:45], v[20:21], v[48:49] op_sel:[1,0,0] op_sel_hi:[0,0,1] neg_lo:[1,0,0]
    v_pk_fma_f32 v[50:51], v[18:19], v[46:47], v[50:51] op_sel:[1,0,0]
    v_pk_fma_f32 v[50:51], v[20:21], v[46:47], v[50:51] op_sel:[1,1,0] op_sel_hi:[1,0,1] neg_lo:[0,1,0]
    v_pk_fma_f32 v[52:53], v[18:19], v[48:49], v[52:53] op_sel_hi:[0,1,1]
    v_pk_fma_f32 v[52:53], v[48:49], v[20:21], v[52:53] op_sel:[1,0,0] op_sel_hi:[0,0,1] neg_lo:[1,0,0]
    v_pk_fma_f32 v[54:55], v[18:19], v[50:51], v[54:55] op_sel:[1,0,0]
    v_pk_fma_f32 v[54:55], v[20:21], v[50:51], v[54:55] op_sel:[1,1,0] op_sel_hi:[1,0,1] neg_lo:[0,1,0]
    v_pk_fma_f32 v[56:57], v[18:19], v[52:53], v[56:57] op_sel_hi:[0,1,1]
    v_pk_fma_f32 v[56:57], v[52:53], v[20:21], v[56:57] op_sel:[1,0,0] op_sel_hi:[0,0,1] neg_lo:[1,0,0]
    v_pk_fma_f32 v[58:59], v[18:19], v[54:55], v[58:59] op_sel:[1,0,0]
    v_pk_fma_f32 v[58:59], v[20:21], v[54:55], v[58:59] op_sel:[1,1,0] op_sel_hi:[1,0,1] neg_lo:[0,1,0]
    v_pk_fma_f32 v[60:61], v[18:19], v[56:57], v[60:61] op_sel_hi:[0,1,1]
    v_pk_fma_f32 v[60:61], v[56:57], v[20:21], v[60:61] op_sel:[1,0,0] op_sel_hi:[0,0,1] neg_lo:[1,0,0]
    v_pk_fma_f32 v[62:63], v[18:19], v[58:59], v[62:63] op_sel:[1,0,0]
    v_pk_fma_f32 v[62:63], v[20:21], v[58:59], v[62:63] op_sel:[1,1,0] op_sel_hi:[1,0,1] neg_lo:[0,1,0]
    s_cmp_eq_u32 s30, 0
    s_cbranch_scc1 Lc_nopub
    s_cmp_eq_u32 s26, 15
    s_cbranch_scc1 Lc_nopub
    v_mov_b32 v26, v60
    v_mov_b32 v27, v61
    v_mov_b32 v28, s44
    v_mov_b32 v29, s44
    s_lshl_b32 s33, s26, 10
    s_lshl_b32 s34, s31, 9
    s_add_u32 s33, s33, s34
    v_lshlrev_b32 v8, 4, v1
    s_mov_b64 exec, 0xffff0000
    v_mov_b32 v26, v62
    v_mov_b32 v27, v63
    s_mov_b64 exec, 0xffffffff
    buffer_store_dwordx4 v[26:29], v8, s[36:39], s33 offen sc1
    s_mov_b64 exec, -1
Lc_nopub:
    v_mov_b32 v60, 0
    v_mov_b32 v61, 0
    v_mov_b32 v62, 0
    v_mov_b32 v63, 0
    s_lshl_b32 s33, s30, 2
    v_add_u32 v8, s33, v7
    v_cmp_eq_u32 vcc, 1, v8
    s_nop 1
    v_cndmask_b32 v60, v60, v32, vcc
    v_cndmask_b32 v61, v61, v33, vcc
    v_cndmask_b32 v62, v62, v34, vcc
    v_cndmask_b32 v63, v63, v35, vcc
    v_cmp_eq_u32 vcc, 2, v8
    s_nop 1
    v_cndmask_b32 v60, v60, v36, vcc
    v_cndmask_b32 v61, v61, v37, vcc
    v_cndmask_b32 v62, v62, v38, vcc
    v_cndmask_b32 v63, v63, v39, vcc
    v_cmp_eq_u32 vcc, 3, v8
    s_nop 1
    v_cndmask_b32 v60, v60, v40, vcc
    v_cndmask_b32 v61, v61, v41, vcc
    v_cndmask_b32 v62, v62, v42, vcc
    v_cndmask_b32 v63, v63, v43, vcc
    v_cmp_eq_u32 vcc, 4, v8
    s_nop 1
    v_cndmask_b32 v60, v60, v44, vcc
    v_cndmask_b32 v61, v61, v45, vcc
    v_cndmask_b32 v62, v62, v46, vcc
    v_cndmask_b32 v63, v63, v47, vcc
    v_cmp_eq_u32 vcc, 5, v8
    s_nop 1
    v_cndmask_b32 v60, v60, v48, vcc
    v_cndmask_b32 v61, v61, v49, vcc
    v_cndmask_b32 v62, v62, v50, vcc
    v_cndmask_b32 v63, v63, v51, vcc
    v_cmp_eq_u32 vcc, 6, v8
    s_nop 1
    v_cndmask_b32 v60, v60, v52, vcc
    v_cndmask_b32 v61, v61, v53, vcc
    v_cndmask_b32 v62, v62, v54, vcc
    v_cndmask_b32 v63, v63, v55, vcc
    v_cmp_eq_u32 vcc, 7, v8
    s_nop 1
    v_cndmask_b32 v60, v60, v56, vcc
    v_cndmask_b32 v61, v61, v57, vcc
    v_cndmask_b32 v62, v62, v58, vcc
    v_cndmask_b32 v63, v63, v59, vcc
    v_fma_f32 v33, v14, v60, v110
    v_fma_f32 v35, v14, v61, v126
    v_mov_b32 v32, v60
    v_mov_b32 v34, v61
    v_fma_f32 v33, -v16, v61, v33
    v_fma_f32 v35, v16, v60, v35
    v_fma_f32 v37, v15, v62, v142
    v_fma_f32 v39, v15, v63, v158
    v_mov_b32 v36, v62
    v_mov_b32 v38, v63
    v_fma_f32 v37, -v17, v63, v37
    v_fma_f32 v39, v17, v62, v39
    v_and_b32 v9, 1, v8
    v_cmp_ne_u32 vcc, 0, v9
    s_nop 1
    v_cndmask_b32 v72, 1.0, v18, vcc
    v_cndmask_b32 v74, 0, v20, vcc
    v_cndmask_b32 v73, 1.0, v19, vcc
    v_cndmask_b32 v75, 0, v21, vcc
    v_pk_mul_f32 v[80:81], v[18:19], v[20:21]
    v_pk_mul_f32 v[64:65], v[18:19], v[18:19]
    v_pk_fma_f32 v[64:65], v[20:21], v[20:21], v[64:65] neg_lo:[1,0,0] neg_hi:[1,0,0]
    v_pk_add_f32 v[66:67], v[80:81], v[80:81]
    v_and_b32 v9, 2, v8
    v_cmp_ne_u32 vcc, 0, v9
    s_nop 1
    v_cndmask_b32 v22, 1.0, v64, vcc
    v_cndmask_b32 v24, 0, v66, vcc
    v_cndmask_b32 v23, 1.0, v65, vcc
    v_cndmask_b32 v25, 0, v67, vcc
    v_pk_mul_f32 v[240:241], v[72:73], v[22:23]
    v_pk_mul_f32 v[242:243], v[72:73], v[24:25]
    v_pk_fma_f32 v[240:241], v[74:75], v[24:25], v[240:241] neg_lo:[1,0,0] neg_hi:[1,0,0]
    v_pk_fma_f32 v[242:243], v[74:75], v[22:23], v[242:243]
    v_pk_mul_f32 v[80:81], v[64:65], v[66:67]
    v_pk_mul_f32 v[68:69], v[64:65], v[64:65]
    v_pk_fma_f32 v[68:69], v[66:67], v[66:67], v[68:69] neg_lo:[1,0,0] neg_hi:[1,0,0]
    v_pk_add_f32 v[70:71], v[80:81], v[80:81]
    v_and_b32 v9, 4, v8
    v_cmp_ne_u32 vcc, 0, v9
    s_nop 1
    v_cndmask_b32 v22, 1.0, v68, vcc
    v_cndmask_b32 v24, 0, v70, vcc
    v_cndmask_b32 v23, 1.0, v69, vcc
    v_cndmask_b32 v25, 0, v71, vcc
    v_pk_mul_f32 v[72:73], v[240:241], v[22:23]
    v_pk_mul_f32 v[74:75], v[240:241], v[24:25]
    v_pk_fma_f32 v[72:73], v[242:243], v[24:25], v[72:73] neg_lo:[1,0,0] neg_hi:[1,0,0]
    v_pk_fma_f32 v[74:75], v[242:243], v[22:23], v[74:75]
    v_pk_mul_f32 v[80:81], v[68:69], v[70:71]
    v_pk_mul_f32 v[64:65], v[68:69], v[68:69]
    v_pk_fma_f32 v[64:65], v[70:71], v[70:71], v[64:65] neg_lo:[1,0,0] neg_hi:[1,0,0]
    v_pk_add_f32 v[66:67], v[80:81], v[80:81]
    v_and_b32 v9, 1, v7
    v_cmp_ne_u32 vcc, 0, v9
    s_nop 1
    v_cndmask_b32 v76, 1.0, v64, vcc
    v_cndmask_b32 v78, 0, v66, vcc
    v_cndmask_b32 v77, 1.0, v65, vcc
    v_cndmask_b32 v79, 0, v67, vcc
    v_pk_mul_f32 v[80:81], v[64:65], v[66:67]
    v_pk_mul_f32 v[68:69], v[64:65], v[64:65]
    v_pk_fma_f32 v[68:69], v[66:67], v[66:67], v[68:69] neg_lo:[1,0,0] neg_hi:[1,0,0]
    v_pk_add_f32 v[70:71], v[80:81], v[80:81]
    v_and_b32 v9, 2, v7
    v_cmp_ne_u32 vcc, 0, v9
    s_nop 1
    v_cndmask_b32 v22, 1.0, v68, vcc
    v_cndmask_b32 v24, 0, v70, vcc
    v_cndmask_b32 v23, 1.0, v69, vcc
    v_cndmask_b32 v25, 0, v71, vcc
    v_pk_mul_f32 v[240:241], v[76:77], v[22:23]
    v_pk_mul_f32 v[242:243], v[76:77], v[24:25]
    v_pk_fma_f32 v[240:241], v[78:79], v[24:25], v[240:241] neg_lo:[1,0,0] neg_hi:[1,0,0]
    v_pk_fma_f32 v[242:243], v[78:79], v[22:23], v[242:243]
    v_pk_mul_f32 v[80:81], v[68:69], v[70:71]
    v_pk_mul_f32 v[244:245], v[68:69], v[68:69]
    v_pk_fma_f32 v[244:245], v[70:71], v[70:71], v[244:245] neg_lo:[1,0,0] neg_hi:[1,0,0]
    v_pk_add_f32 v[246:247], v[80:81], v[80:81]
    v_pk_mul_f32 v[64:65], v[72:73], v[14:15]
    v_pk_mul_f32 v[66:67], v[72:73], v[16:17]
    v_pk_fma_f32 v[64:65], v[74:75], v[16:17], v[64:65] neg_lo:[1,0,0] neg_hi:[1,0,0]
    v_pk_fma_f32 v[66:67], v[74:75], v[14:15], v[66:67]
    v_mov_b32 v232, v72
    v_mov_b32 v233, v64
    v_mov_b32 v236, v74
    v_mov_b32 v237, v66
    v_mov_b32 v234, v73
    v_mov_b32 v235, v65
    v_mov_b32 v238, v75
    v_mov_b32 v239, v67
    v_max_f32 v26, |v248|, |v250|
    v_rcp_f32 v28, v26
    v_max_f32 v27, |v249|, |v251|
    v_rcp_f32 v29, v27
    s_nop 0
    v_pk_mul_f32 v[248:249], v[248:249], v[28:29]
    v_pk_mul_f32 v[250:251], v[250:251], v[28:29]
    v_pk_mul_f32 v[28:29], v[248:249], v[248:249]
    v_pk_fma_f32 v[28:29], v[250:251], v[250:251], v[28:29]
    v_pk_mul_f32 v[28:29], v[28:29], v[26:27]
    v_rcp_f32 v28, v28
    v_add_f32 v26, -1.0, v10
    v_rcp_f32 v29, v29
    v_add_f32 v27, -1.0, v11
    v_pk_add_f32 v[28:29], v[28:29], v[28:29]
    v_pk_mul_f32 v[22:23], v[26:27], v[248:249]
    v_pk_mul_f32 v[24:25], v[12:13], v[248:249]
    v_pk_fma_f32 v[22:23], v[12:13], v[250:251], v[22:23]
    v_pk_fma_f32 v[24:25], v[26:27], v[250:251], v[24:25] neg_lo:[1,0,0] neg_hi:[1,0,0]
    v_pk_mul_f32 v[22:23], v[22:23], v[28:29]
    v_pk_mul_f32 v[24:25], v[24:25], v[28:29]
    v_mov_b32 v26, v22
    v_mov_b32 v27, v24
    v_mov_b32 v28, v23
    v_mov_b32 v29, v25
    v_pk_mul_f32 v[200:201], v[10:11], v[26:27] op_sel_hi:[0,1]
    v_pk_mul_f32 v[202:203], v[10:11], v[28:29] op_sel:[1,0]
    v_pk_fma_f32 v[200:201], v[26:27], v[12:13], v[200:201] op_sel:[1,0,0] op_sel_hi:[0,0,1] neg_lo:[1,0,0]
    v_pk_fma_f32 v[202:203], v[12:13], v[28:29], v[202:203] op_sel:[1,1,0] op_sel_hi:[1,0,1] neg_lo:[0,1,0]
    v_pk_mul_f32 v[204:205], v[10:11], v[200:201] op_sel_hi:[0,1]
    v_pk_mul_f32 v[206:207], v[10:11], v[202:203] op_sel:[1,0]
    v_pk_fma_f32 v[204:205], v[200:201], v[12:13], v[204:205] op_sel:[1,0,0] op_sel_hi:[0,0,1] neg_lo:[1,0,0]
    v_pk_fma_f32 v[206:207], v[12:13], v[202:203], v[206:207] op_sel:[1,1,0] op_sel_hi:[1,0,1] neg_lo:[0,1,0]
    v_pk_mul_f32 v[208:209], v[10:11], v[204:205] op_sel_hi:[0,1]
    v_pk_mul_f32 v[210:211], v[10:11], v[206:207] op_sel:[1,0]
    v_pk_fma_f32 v[208:209], v[204:205], v[12:13], v[208:209] op_sel:[1,0,0] op_sel_hi:[0,0,1] neg_lo:[1,0,0]
    v_pk_fma_f32 v[210:211], v[12:13], v[206:207], v[210:211] op_sel:[1,1,0] op_sel_hi:[1,0,1] neg_lo:[0,1,0]
    v_pk_mul_f32 v[212:213], v[10:11], v[208:209] op_sel_hi:[0,1]
    v_pk_mul_f32 v[214:215], v[10:11], v[210:211] op_sel:[1,0]
    v_pk_fma_f32 v[212:213], v[208:209], v[12:13], v[212:213] op_sel:[1,0,0] op_sel_hi:[0,0,1] neg_lo:[1,0,0]
    v_pk_fma_f32 v[214:215], v[12:13], v[210:211], v[214:215] op_sel:[1,1,0] op_sel_hi:[1,0,1] neg_lo:[0,1,0]
    v_pk_mul_f32 v[216:217], v[10:11], v[212:213] op_sel_hi:[0,1]
    v_pk_mul_f32 v[218:219], v[10:11], v[214:215] op_sel:[1,0]
    v_pk_fma_f32 v[216:217], v[212:213], v[12:13], v[216:217] op_sel:[1,0,0] op_sel_hi:[0,0,1] neg_lo:[1,0,0]
    v_pk_fma_f32 v[218:219], v[12:13], v[214:215], v[218:219] op_sel:[1,1,0] op_sel_hi:[1,0,1] neg_lo:[0,1,0]
    v_pk_mul_f32 v[220:221], v[10:11], v[216:217] op_sel_hi:[0,1]
    v_pk_mul_f32 v[222:223], v[10:11], v[218:219] op_sel:[1,0]
    v_pk_fma_f32 v[220:221], v[216:217], v[12:13], v[220:221] op_sel:[1,0,0] op_sel_hi:[0,0,1] neg_lo:[1,0,0]
    v_pk_fma_f32 v[222:223], v[12:13], v[218:219], v[222:223] op_sel:[1,1,0] op_sel_hi:[1,0,1] neg_lo:[0,1,0]
    v_pk_mul_f32 v[224:225], v[10:11], v[220:221] op_sel_hi:[0,1]
    v_pk_mul_f32 v[226:227], v[10:11], v[222:223] op_sel:[1,0]
    v_pk_fma_f32 v[224:225], v[220:221], v[12:13], v[224:225] op_sel:[1,0,0] op_sel_hi:[0,0,1] neg_lo:[1,0,0]
    v_pk_fma_f32 v[226:227], v[12:13], v[222:223], v[226:227] op_sel:[1,1,0] op_sel_hi:[1,0,1] neg_lo:[0,1,0]
    v_pk_mul_f32 v[228:229], v[10:11], v[224:225] op_sel_hi:[0,1]
    v_pk_mul_f32 v[230:231], v[10:11], v[226:227] op_sel:[1,0]
    v_pk_fma_f32 v[228:229], v[224:225], v[12:13], v[228:229] op_sel:[1,0,0] op_sel_hi:[0,0,1] neg_lo:[1,0,0]
    v_pk_fma_f32 v[230:231], v[12:13], v[226:227], v[230:231] op_sel:[1,1,0] op_sel_hi:[1,0,1] neg_lo:[0,1,0]
    v_pk_mul_f32 v[26:27], v[24:25], v[96:97] op_sel_hi:[0,1] neg_lo:[1,0] neg_hi:[1,0]
    v_pk_mul_f32 v[96:97], v[22:23], v[96:97] op_sel_hi:[0,1]
    v_pk_fma_f32 v[96:97], v[24:25], v[112:113], v[96:97] op_sel_hi:[0,1,1] neg_lo:[1,0,0] neg_hi:[1,0,0]
    v_pk_fma_f32 v[112:113], v[22:23], v[112:113], v[26:27] op_sel_hi:[0,1,1] neg_lo:[1,0,0] neg_hi:[1,0,0]
    v_pk_mul_f32 v[28:29], v[24:25], v[128:129] op_sel:[1,0] neg_lo:[1,0] neg_hi:[1,0]
    v_pk_mul_f32 v[128:129], v[22:23], v[128:129] op_sel:[1,0]
    v_pk_fma_f32 v[128:129], v[24:25], v[144:145], v[128:129] op_sel:[1,0,0] neg_lo:[1,0,0] neg_hi:[1,0,0]
    v_pk_fma_f32 v[144:145], v[22:23], v[144:145], v[28:29] op_sel:[1,0,0] neg_lo:[1,0,0] neg_hi:[1,0,0]
    v_pk_mul_f32 v[26:27], v[24:25], v[98:99] op_sel_hi:[0,1] neg_lo:[1,0] neg_hi:[1,0]
    v_pk_mul_f32 v[98:99], v[22:23], v[98:99] op_sel_hi:[0,1]
    v_pk_fma_f32 v[98:99], v[24:25], v[114:115], v[98:99] op_sel_hi:[0,1,1] neg_lo:[1,0,0] neg_hi:[1,0,0]
    v_pk_fma_f32 v[114:115], v[22:23], v[114:115], v[26:27] op_sel_hi:[0,1,1] neg_lo:[1,0,0] neg_hi:[1,0,0]
    v_pk_mul_f32 v[28:29], v[24:25], v[130:131] op_sel:[1,0] neg_lo:[1,0] neg_hi:[1,0]
    v_pk_mul_f32 v[130:131], v[22:23], v[130:131] op_sel:[1,0]
    v_pk_fma_f32 v[130:131], v[24:25], v[146:147], v[130:131] op_sel:[1,0,0] neg_lo:[1,0,0] neg_hi:[1,0,0]
    v_pk_fma_f32 v[146:147], v[22:23], v[146:147], v[28:29] op_sel:[1,0,0] neg_lo:[1,0,0] neg_hi:[1,0,0]
    v_pk_mul_f32 v[26:27], v[24:25], v[100:101] op_sel_hi:[0,1] neg_lo:[1,0] neg_hi:[1,0]
    v_pk_mul_f32 v[100:101], v[22:23], v[100:101] op_sel_hi:[0,1]
    v_pk_fma_f32 v[100:101], v[24:25], v[116:117], v[100:101] op_sel_hi:[0,1,1] neg_lo:[1,0,0] neg_hi:[1,0,0]
    v_pk_fma_f32 v[116:117], v[22:23], v[116:117], v[26:27] op_sel_hi:[0,1,1] neg_lo:[1,0,0] neg_hi:[1,0,0]
    v_pk_mul_f32 v[28:29], v[24:25], v[132:133] op_sel:[1,0] neg_lo:[1,0] neg_hi:[1,0]
    v_pk_mul_f32 v[132:133], v[22:23], v[132:133] op_sel:[1,0]
    v_pk_fma_f32 v[132:133], v[24:25], v[148:149], v[132:133] op_sel:[1,0,0] neg_lo:[1,0,0] neg_hi:[1,0,0]
    v_pk_fma_f32 v[148:149], v[22:23], v[148:149], v[28:29] op_sel:[1,0,0] neg_lo:[1,0,0] neg_hi:[1,0,0]
    v_pk_mul_f32 v[26:27], v[24:25], v[102:103] op_sel_hi:[0,1] neg_lo:[1,0] neg_hi:[1,0]
    v_pk_mul_f32 v[102:103], v[22:23], v[102:103] op_sel_hi:[0,1]
    v_pk_fma_f32 v[102:103], v[24:25], v[118:119], v[102:103] op_sel_hi:[0,1,1] neg_lo:[1,0,0] neg_hi:[1,0,0]
    v_pk_fma_f32 v[118:119], v[22:23], v[118:119], v[26:27] op_sel_hi:[0,1,1] neg_lo:[1,0,0] neg_hi:[1,0,0]
    v_pk_mul_f32 v[28:29], v[24:25], v[134:135] op_sel:[1,0] neg_lo:[1,0] neg_hi:[1,0]
    v_pk_mul_f32 v[134:135], v[22:23], v[134:135] op_sel:[1,0]
    v_pk_fma_f32 v[134:135], v[24:25], v[150:151], v[134:135] op_sel:[1,0,0] neg_lo:[1,0,0] neg_hi:[1,0,0]
    v_pk_fma_f32 v[150:151], v[22:23], v[150:151], v[28:29] op_sel:[1,0,0] neg_lo:[1,0,0] neg_hi:[1,0,0]
    v_pk_mul_f32 v[26:27], v[24:25], v[104:105] op_sel_hi:[0,1] neg_lo:[1,0] neg_hi:[1,0]
    v_pk_mul_f32 v[104:105], v[22:23], v[104:105] op_sel_hi:[0,1]
    v_pk_fma_f32 v[104:105], v[24:25], v[120:121], v[104:105] op_sel_hi:[0,1,1] neg_lo:[1,0,0] neg_hi:[1,0,0]
    v_pk_fma_f32 v[120:121], v[22:23], v[120:121], v[26:27] op_sel_hi:[0,1,1] neg_lo:[1,0,0] neg_hi:[1,0,0]
    v_pk_mul_f32 v[28:29], v[24:25], v[136:137] op_sel:[1,0] neg_lo:[1,0] neg_hi:[1,0]
    v_pk_mul_f32 v[136:137], v[22:23], v[136:137] op_sel:[1,0]
    v_pk_fma_f32 v[136:137], v[24:25], v[152:153], v[136:137] op_sel:[1,0,0] neg_lo:[1,0,0] neg_hi:[1,0,0]
    v_pk_fma_f32 v[152:153], v[22:23], v[152:153], v[28:29] op_sel:[1,0,0] neg_lo:[1,0,0] neg_hi:[1,0,0]
    v_pk_mul_f32 v[26:27], v[24:25], v[106:107] op_sel_hi:[0,1] neg_lo:[1,0] neg_hi:[1,0]
    v_pk_mul_f32 v[106:107], v[22:23], v[106:107] op_sel_hi:[0,1]
    v_pk_fma_f32 v[106:107], v[24:25], v[122:123], v[106:107] op_sel_hi:[0,1,1] neg_lo:[1,0,0] neg_hi:[1,0,0]
    v_pk_fma_f32 v[122:123], v[22:23], v[122:123], v[26:27] op_sel_hi:[0,1,1] neg_lo:[1,0,0] neg_hi:[1,0,0]
    v_pk_mul_f32 v[28:29], v[24:25], v[138:139] op_sel:[1,0] neg_lo:[1,0] neg_hi:[1,0]
    v_pk_mul_f32 v[138:139], v[22:23], v[138:139] op_sel:[1,0]
    v_pk_fma_f32 v[138:139], v[24:25], v[154:155], v[138:139] op_sel:[1,0,0] neg_lo:[1,0,0] neg_hi:[1,0,0]
    v_pk_fma_f32 v[154:155], v[22:23], v[154:155], v[28:29] op_sel:[1,0,0] neg_lo:[1,0,0] neg_hi:[1,0,0]
    v_pk_mul_f32 v[26:27], v[24:25], v[108:109] op_sel_hi:[0,1] neg_lo:[1,0] neg_hi:[1,0]
    v_pk_mul_f32 v[108:109], v[22:23], v[108:109] op_sel_hi:[0,1]
    v_pk_fma_f32 v[108:109], v[24:25], v[124:125], v[108:109] op_sel_hi:[0,1,1] neg_lo:[1,0,0] neg_hi:[1,0,0]
    v_pk_fma_f32 v[124:125], v[22:23], v[124:125], v[26:27] op_sel_hi:[0,1,1] neg_lo:[1,0,0] neg_hi:[1,0,0]
    v_pk_mul_f32 v[28:29], v[24:25], v[140:141] op_sel:[1,0] neg_lo:[1,0] neg_hi:[1,0]
    v_pk_mul_f32 v[140:141], v[22:23], v[140:141] op_sel:[1,0]
    v_pk_fma_f32 v[140:141], v[24:25], v[156:157], v[140:141] op_sel:[1,0,0] neg_lo:[1,0,0] neg_hi:[1,0,0]
    v_pk_fma_f32 v[156:157], v[22:23], v[156:157], v[28:29] op_sel:[1,0,0] neg_lo:[1,0,0] neg_hi:[1,0,0]
    v_pk_mul_f32 v[26:27], v[24:25], v[110:111] op_sel_hi:[0,1] neg_lo:[1,0] neg_hi:[1,0]
    v_pk_mul_f32 v[110:111], v[22:23], v[110:111] op_sel_hi:[0,1]
    v_pk_fma_f32 v[110:111], v[24:25], v[126:127], v[110:111] op_sel_hi:[0,1,1] neg_lo:[1,0,0] neg_hi:[1,0,0]
    v_pk_fma_f32 v[126:127], v[22:23], v[126:127], v[26:27] op_sel_hi:[0,1,1] neg_lo:[1,0,0] neg_hi:[1,0,0]
    v_pk_mul_f32 v[28:29], v[24:25], v[142:143] op_sel:[1,0] neg_lo:[1,0] neg_hi:[1,0]
    v_pk_mul_f32 v[142:143], v[22:23], v[142:143] op_sel:[1,0]
    v_pk_fma_f32 v[142:143], v[24:25], v[158:159], v[142:143] op_sel:[1,0,0] neg_lo:[1,0,0] neg_hi:[1,0,0]
    v_pk_fma_f32 v[158:159], v[22:23], v[158:159], v[28:29] op_sel:[1,0,0] neg_lo:[1,0,0] neg_hi:[1,0,0]
    v_mov_b32 v9, s44
    v_cmp_le_i32 vcc, 0, v192
    s_nop 1
    v_cndmask_b32 v248, 0, v9, vcc
    v_cndmask_b32 v249, 0, v9, vcc
    v_cmp_le_i32 vcc, 0, v193
    s_nop 1
    v_cndmask_b32 v250, 0, v9, vcc
    v_cndmask_b32 v251, 0, v9, vcc
    v_cmp_le_i32 vcc, 0, v194
    s_nop 1
    v_cndmask_b32 v252, 0, v9, vcc
    v_cndmask_b32 v253, 0, v9, vcc
    v_cmp_le_i32 vcc, 0, v195
    s_nop 1
    v_cndmask_b32 v254, 0, v9, vcc
    v_cndmask_b32 v255, 0, v9, vcc
    s_lshl_b32 s33, s29, 12
    s_add_u32 s33, s33, 131072
    v_lshrrev_b32 v8, 1, v6
    v_and_b32 v8, 4, v8
    v_and_b32 v9, 7, v6
    v_xor_b32 v8, v8, v9
    v_lshlrev_b32 v9, 1, v7
    v_xor_b32 v8, v8, v9
    v_lshlrev_b32 v8, 4, v8
    v_lshl_add_u32 v8, v6, 7, v8
    v_add_u32 v2, s33, v8
    v_xor_b32 v3, 16, v2
    v_bfe_u32 v8, v1, 2, 2
    v_bfe_u32 v9, v1, 1, 1
    v_xor_b32 v9, v9, v8
    v_and_b32 v4, 1, v7
    v_lshlrev_b32 v4, 2, v4
    v_xor_b32 v9, v9, v4
    v_lshlrev_b32 v9, 4, v9
    v_lshl_add_u32 v8, v7, 3, v8
    v_lshl_add_u32 v9, v8, 7, v9
    v_and_b32 v8, 1, v1
    v_lshl_add_u32 v9, v8, 3, v9
    v_add_u32 v4, s33, v9
    v_xor_b32 v5, 32, v4
    v_xor_b32 v30, 64, v4
    v_xor_b32 v31, 96, v4
    s_mov_b32 s45, 32768
    buffer_load_dwordx4 v[160:163], v192, s[36:39], 0 offen offset:0 sc1
    buffer_load_dwordx4 v[164:167], v192, s[36:39], 0 offen offset:256 sc1
    buffer_load_dwordx4 v[168:171], v193, s[36:39], 0 offen offset:0 sc1
    buffer_load_dwordx4 v[172:175], v193, s[36:39], 0 offen offset:256 sc1
    buffer_load_dwordx4 v[176:179], v194, s[36:39], 0 offen offset:0 sc1
    buffer_load_dwordx4 v[180:183], v194, s[36:39], 0 offen offset:256 sc1
    buffer_load_dwordx4 v[184:187], v195, s[36:39], 0 offen offset:0 sc1
    buffer_load_dwordx4 v[188:191], v195, s[36:39], 0 offen offset:256 sc1
Lc_lbpoll:
    s_waitcnt vmcnt(0)
    v_cmp_ne_u64 s[46:47], v[162:163], v[248:249]
    v_cmp_ne_u64 s[48:49], v[166:167], v[248:249]
    v_cmp_ne_u64 s[50:51], v[170:171], v[250:251]
    v_cmp_ne_u64 s[52:53], v[174:175], v[250:251]
    v_cmp_ne_u64 s[54:55], v[178:179], v[252:253]
    v_cmp_ne_u64 s[56:57], v[182:183], v[252:253]
    v_cmp_ne_u64 s[58:59], v[186:187], v[254:255]
    v_cmp_ne_u64 s[60:61], v[190:191], v[254:255]
    s_or_b64 s[46:47], s[46:47], s[48:49]
    s_or_b64 s[50:51], s[50:51], s[52:53]
    s_or_b64 s[54:55], s[54:55], s[56:57]
    s_or_b64 s[58:59], s[58:59], s[60:61]
    s_or_b64 s[46:47], s[46:47], s[50:51]
    s_or_b64 s[54:55], s[54:55], s[58:59]
    s_or_b64 s[46:47], s[46:47], s[54:55]
    s_cbranch_scc0 Lc_lbok
    s_sub_u32 s45, s45, 1
    s_cbranch_scc1 Lc_lbok
    buffer_load_dwordx4 v[160:163], v192, s[36:39], 0 offen offset:0 sc1
    buffer_load_dwordx4 v[164:167], v192, s[36:39], 0 offen offset:256 sc1
    buffer_load_dwordx4 v[168:171], v193, s[36:39], 0 offen offset:0 sc1
    buffer_load_dwordx4 v[172:175], v193, s[36:39], 0 offen offset:256 sc1
    buffer_load_dwordx4 v[176:179], v194, s[36:39], 0 offen offset:0 sc1
    buffer_load_dwordx4 v[180:183], v194, s[36:39], 0 offen offset:256 sc1
    buffer_load_dwordx4 v[184:187], v195, s[36:39], 0 offen offset:0 sc1
    buffer_load_dwordx4 v[188:191], v195, s[36:39], 0 offen offset:256 sc1
    s_branch Lc_lbpoll
Lc_lbok:
    v_pk_fma_f32 v[176:177], v[244:245], v[184:185], v[176:177] op_sel_hi:[0,1,1]
    v_pk_fma_f32 v[176:177], v[184:185], v[246:247], v[176:177] op_sel:[1,0,0] op_sel_hi:[0,0,1] neg_lo:[1,0,0]
    v_pk_fma_f32 v[180:181], v[244:245], v[188:189], v[180:181] op_sel:[1,0,0]
    v_pk_fma_f32 v[180:181], v[246:247], v[188:189], v[180:181] op_sel:[1,1,0] op_sel_hi:[1,0,1] neg_lo:[0,1,0]
    v_pk_fma_f32 v[168:169], v[244:245], v[176:177], v[168:169] op_sel_hi:[0,1,1]
    v_pk_fma_f32 v[168:169], v[176:177], v[246:247], v[168:169] op_sel:[1,0,0] op_sel_hi:[0,0,1] neg_lo:[1,0,0]
    v_pk_fma_f32 v[172:173], v[244:245], v[180:181], v[172:173] op_sel:[1,0,0]
    v_pk_fma_f32 v[172:173], v[246:247], v[180:181], v[172:173] op_sel:[1,1,0] op_sel_hi:[1,0,1] neg_lo:[0,1,0]
    v_pk_fma_f32 v[160:161], v[244:245], v[168:169], v[160:161] op_sel_hi:[0,1,1]
    v_pk_fma_f32 v[160:161], v[168:169], v[246:247], v[160:161] op_sel:[1,0,0] op_sel_hi:[0,0,1] neg_lo:[1,0,0]
    v_pk_fma_f32 v[164:165], v[244:245], v[172:173], v[164:165] op_sel:[1,0,0]
    v_pk_fma_f32 v[164:165], v[246:247], v[172:173], v[164:165] op_sel:[1,1,0] op_sel_hi:[1,0,1] neg_lo:[0,1,0]
    v_pk_mul_f32 v[168:169], v[240:241], v[160:161] op_sel_hi:[0,1]
    v_pk_mul_f32 v[172:173], v[240:241], v[164:165] op_sel:[1,0]
    v_pk_fma_f32 v[168:169], v[160:161], v[242:243], v[168:169] op_sel:[1,0,0] op_sel_hi:[0,0,1] neg_lo:[1,0,0]
    v_pk_fma_f32 v[172:173], v[242:243], v[164:165], v[172:173] op_sel:[1,1,0] op_sel_hi:[1,0,1] neg_lo:[0,1,0]
    v_mov_b32 v170, v168
    v_mov_b32 v171, v169
    v_mov_b32 v174, v172
    v_mov_b32 v175, v173
    v_permlane16_swap_b32 v168, v170
    v_permlane16_swap_b32 v169, v171
    v_permlane16_swap_b32 v172, v174
    v_permlane16_swap_b32 v173, v175
    v_pk_add_f32 v[168:169], v[168:169], v[170:171]
    v_pk_add_f32 v[172:173], v[172:173], v[174:175]
    v_mov_b32 v170, v168
    v_mov_b32 v171, v169
    v_mov_b32 v174, v172
    v_mov_b32 v175, v173
    v_permlane32_swap_b32 v168, v170
    v_permlane32_swap_b32 v169, v171
    v_permlane32_swap_b32 v172, v174
    v_permlane32_swap_b32 v173, v175
    v_pk_add_f32 v[168:169], v[168:169], v[170:171]
    v_pk_add_f32 v[172:173], v[172:173], v[174:175]
    v_pk_fma_f32 v[32:33], v[232:233], v[168:169], v[32:33] op_sel_hi:[1,0,1]
    v_pk_fma_f32 v[34:35], v[168:169], v[232:233], v[34:35] op_sel:[1,0,0]
    v_pk_fma_f32 v[36:37], v[234:235], v[172:173], v[36:37] op_sel_hi:[1,0,1]
    v_pk_fma_f32 v[38:39], v[172:173], v[234:235], v[38:39] op_sel:[1,0,0]
    v_pk_fma_f32 v[32:33], v[168:169], v[236:237], v[32:33] op_sel:[1,0,0] neg_lo:[1,0,0] neg_hi:[1,0,0]
    v_pk_fma_f32 v[34:35], v[236:237], v[168:169], v[34:35] op_sel_hi:[1,0,1]
    v_pk_fma_f32 v[36:37], v[172:173], v[238:239], v[36:37] op_sel:[1,0,0] neg_lo:[1,0,0] neg_hi:[1,0,0]
    v_pk_fma_f32 v[38:39], v[238:239], v[172:173], v[38:39] op_sel_hi:[1,0,1]
    s_mov_b32 s33, 16384
    v_pk_fma_f32 v[96:97], v[200:201], v[32:33], v[96:97] op_sel_hi:[0,1,1]
    v_pk_fma_f32 v[96:97], v[200:201], v[34:35], v[96:97] op_sel:[1,0,0] neg_lo:[1,0,0] neg_hi:[1,0,0]
    v_pk_fma_f32 v[98:99], v[204:205], v[32:33], v[98:99] op_sel_hi:[0,1,1]
    v_pk_fma_f32 v[98:99], v[204:205], v[34:35], v[98:99] op_sel:[1,0,0] neg_lo:[1,0,0] neg_hi:[1,0,0]
    v_pk_fma_f32 v[100:101], v[208:209], v[32:33], v[100:101] op_sel_hi:[0,1,1]
    v_pk_fma_f32 v[100:101], v[208:209], v[34:35], v[100:101] op_sel:[1,0,0] neg_lo:[1,0,0] neg_hi:[1,0,0]
    v_pk_fma_f32 v[102:103], v[212:213], v[32:33], v[102:103] op_sel_hi:[0,1,1]
    v_pk_fma_f32 v[102:103], v[212:213], v[34:35], v[102:103] op_sel:[1,0,0] neg_lo:[1,0,0] neg_hi:[1,0,0]
    v_pk_fma_f32 v[104:105], v[216:217], v[32:33], v[104:105] op_sel_hi:[0,1,1]
    v_pk_fma_f32 v[104:105], v[216:217], v[34:35], v[104:105] op_sel:[1,0,0] neg_lo:[1,0,0] neg_hi:[1,0,0]
    v_pk_fma_f32 v[106:107], v[220:221], v[32:33], v[106:107] op_sel_hi:[0,1,1]
    v_pk_fma_f32 v[106:107], v[220:221], v[34:35], v[106:107] op_sel:[1,0,0] neg_lo:[1,0,0] neg_hi:[1,0,0]
    v_pk_fma_f32 v[108:109], v[224:225], v[32:33], v[108:109] op_sel_hi:[0,1,1]
    v_pk_fma_f32 v[108:109], v[224:225], v[34:35], v[108:109] op_sel:[1,0,0] neg_lo:[1,0,0] neg_hi:[1,0,0]
    v_pk_fma_f32 v[110:111], v[228:229], v[32:33], v[110:111] op_sel_hi:[0,1,1]
    v_pk_fma_f32 v[110:111], v[228:229], v[34:35], v[110:111] op_sel:[1,0,0] neg_lo:[1,0,0] neg_hi:[1,0,0]
    v_cvt_pk_bf16_f32 v160, v96, v98
    v_cvt_pk_bf16_f32 v161, v100, v102
    v_cvt_pk_bf16_f32 v162, v104, v106
    v_cvt_pk_bf16_f32 v163, v108, v110
    ds_write_b128 v2, v[160:163] offset:0
    v_cvt_pk_bf16_f32 v164, v97, v99
    v_cvt_pk_bf16_f32 v165, v101, v103
    v_cvt_pk_bf16_f32 v166, v105, v107
    v_cvt_pk_bf16_f32 v167, v109, v111
    ds_write_b128 v3, v[164:167] offset:0
    v_pk_fma_f32 v[128:129], v[202:203], v[36:37], v[128:129] op_sel_hi:[0,1,1]
    v_pk_fma_f32 v[128:129], v[202:203], v[38:39], v[128:129] op_sel:[1,0,0] neg_lo:[1,0,0] neg_hi:[1,0,0]
    v_pk_fma_f32 v[130:131], v[206:207], v[36:37], v[130:131] op_sel_hi:[0,1,1]
    v_pk_fma_f32 v[130:131], v[206:207], v[38:39], v[130:131] op_sel:[1,0,0] neg_lo:[1,0,0] neg_hi:[1,0,0]
    v_pk_fma_f32 v[132:133], v[210:211], v[36:37], v[132:133] op_sel_hi:[0,1,1]
    v_pk_fma_f32 v[132:133], v[210:211], v[38:39], v[132:133] op_sel:[1,0,0] neg_lo:[1,0,0] neg_hi:[1,0,0]
    v_pk_fma_f32 v[134:135], v[214:215], v[36:37], v[134:135] op_sel_hi:[0,1,1]
    v_pk_fma_f32 v[134:135], v[214:215], v[38:39], v[134:135] op_sel:[1,0,0] neg_lo:[1,0,0] neg_hi:[1,0,0]
    v_pk_fma_f32 v[136:137], v[218:219], v[36:37], v[136:137] op_sel_hi:[0,1,1]
    v_pk_fma_f32 v[136:137], v[218:219], v[38:39], v[136:137] op_sel:[1,0,0] neg_lo:[1,0,0] neg_hi:[1,0,0]
    v_pk_fma_f32 v[138:139], v[222:223], v[36:37], v[138:139] op_sel_hi:[0,1,1]
    v_pk_fma_f32 v[138:139], v[222:223], v[38:39], v[138:139] op_sel:[1,0,0] neg_lo:[1,0,0] neg_hi:[1,0,0]
    v_pk_fma_f32 v[140:141], v[226:227], v[36:37], v[140:141] op_sel_hi:[0,1,1]
    v_pk_fma_f32 v[140:141], v[226:227], v[38:39], v[140:141] op_sel:[1,0,0] neg_lo:[1,0,0] neg_hi:[1,0,0]
    v_pk_fma_f32 v[142:143], v[230:231], v[36:37], v[142:143] op_sel_hi:[0,1,1]
    v_pk_fma_f32 v[142:143], v[230:231], v[38:39], v[142:143] op_sel:[1,0,0] neg_lo:[1,0,0] neg_hi:[1,0,0]
    v_cvt_pk_bf16_f32 v168, v128, v130
    v_cvt_pk_bf16_f32 v169, v132, v134
    v_cvt_pk_bf16_f32 v170, v136, v138
    v_cvt_pk_bf16_f32 v171, v140, v142
    ds_write_b128 v2, v[168:171] offset:2048
    v_cvt_pk_bf16_f32 v172, v129, v131
    v_cvt_pk_bf16_f32 v173, v133, v135
    v_cvt_pk_bf16_f32 v174, v137, v139
    v_cvt_pk_bf16_f32 v175, v141, v143
    ds_write_b128 v3, v[172:175] offset:2048
    ds_read_b64_tr_b16 v[96:97], v4 offset:0
    ds_read_b64_tr_b16 v[98:99], v30 offset:512
    ds_read_b64_tr_b16 v[100:101], v5 offset:0
    ds_read_b64_tr_b16 v[102:103], v31 offset:512
    ds_read_b64_tr_b16 v[104:105], v30 offset:0
    ds_read_b64_tr_b16 v[106:107], v4 offset:512
    ds_read_b64_tr_b16 v[108:109], v31 offset:0
    ds_read_b64_tr_b16 v[110:111], v5 offset:512
    v_pk_fma_f32 v[112:113], v[200:201], v[34:35], v[112:113] op_sel_hi:[0,1,1] neg_lo:[1,0,0] neg_hi:[1,0,0]
    v_pk_fma_f32 v[112:113], v[200:201], v[32:33], v[112:113] op_sel:[1,0,0] neg_lo:[1,0,0] neg_hi:[1,0,0]
    v_pk_fma_f32 v[114:115], v[204:205], v[34:35], v[114:115] op_sel_hi:[0,1,1] neg_lo:[1,0,0] neg_hi:[1,0,0]
    v_pk_fma_f32 v[114:115], v[204:205], v[32:33], v[114:115] op_sel:[1,0,0] neg_lo:[1,0,0] neg_hi:[1,0,0]
    v_pk_fma_f32 v[116:117], v[208:209], v[34:35], v[116:117] op_sel_hi:[0,1,1] neg_lo:[1,0,0] neg_hi:[1,0,0]
    v_pk_fma_f32 v[116:117], v[208:209], v[32:33], v[116:117] op_sel:[1,0,0] neg_lo:[1,0,0] neg_hi:[1,0,0]
    v_pk_fma_f32 v[118:119], v[212:213], v[34:35], v[118:119] op_sel_hi:[0,1,1] neg_lo:[1,0,0] neg_hi:[1,0,0]
    v_pk_fma_f32 v[118:119], v[212:213], v[32:33], v[118:119] op_sel:[1,0,0] neg_lo:[1,0,0] neg_hi:[1,0,0]
    v_pk_fma_f32 v[120:121], v[216:217], v[34:35], v[120:121] op_sel_hi:[0,1,1] neg_lo:[1,0,0] neg_hi:[1,0,0]
    v_pk_fma_f32 v[120:121], v[216:217], v[32:33], v[120:121] op_sel:[1,0,0] neg_lo:[1,0,0] neg_hi:[1,0,0]
    v_pk_fma_f32 v[122:123], v[220:221], v[34:35], v[122:123] op_sel_hi:[0,1,1] neg_lo:[1,0,0] neg_hi:[1,0,0]
    v_pk_fma_f32 v[122:123], v[220:221], v[32:33], v[122:123] op_sel:[1,0,0] neg_lo:[1,0,0] neg_hi:[1,0,0]
    v_pk_fma_f32 v[124:125], v[224:225], v[34:35], v[124:125] op_sel_hi:[0,1,1] neg_lo:[1,0,0] neg_hi:[1,0,0]
    v_pk_fma_f32 v[124:125], v[224:225], v[32:33], v[124:125] op_sel:[1,0,0] neg_lo:[1,0,0] neg_hi:[1,0,0]
    v_pk_fma_f32 v[126:127], v[228:229], v[34:35], v[126:127] op_sel_hi:[0,1,1] neg_lo:[1,0,0] neg_hi:[1,0,0]
    v_pk_fma_f32 v[126:127], v[228:229], v[32:33], v[126:127] op_sel:[1,0,0] neg_lo:[1,0,0] neg_hi:[1,0,0]
    v_cvt_pk_bf16_f32 v176, v112, v114
    v_cvt_pk_bf16_f32 v177, v116, v118
    v_cvt_pk_bf16_f32 v178, v120, v122
    v_cvt_pk_bf16_f32 v179, v124, v126
    ds_write_b128 v2, v[176:179] offset:0
    v_cvt_pk_bf16_f32 v180, v113, v115
    v_cvt_pk_bf16_f32 v181, v117, v119
    v_cvt_pk_bf16_f32 v182, v121, v123
    v_cvt_pk_bf16_f32 v183, v125, v127
    ds_write_b128 v3, v[180:183] offset:0
    s_waitcnt lgkmcnt(8)
    buffer_store_dwordx4 v[96:99], v196, s[40:43], 0 offen offset:0 sc1
    s_waitcnt lgkmcnt(6)
    buffer_store_dwordx4 v[100:103], v196, s[40:43], 0 offen offset:1024 sc1
    s_waitcnt lgkmcnt(4)
    buffer_store_dwordx4 v[104:107], v196, s[40:43], 0 offen offset:2048 sc1
    s_waitcnt lgkmcnt(2)
    buffer_store_dwordx4 v[108:111], v196, s[40:43], 0 offen offset:3072 sc1
    v_pk_fma_f32 v[144:145], v[202:203], v[38:39], v[144:145] op_sel_hi:[0,1,1] neg_lo:[1,0,0] neg_hi:[1,0,0]
    v_pk_fma_f32 v[144:145], v[202:203], v[36:37], v[144:145] op_sel:[1,0,0] neg_lo:[1,0,0] neg_hi:[1,0,0]
    v_pk_fma_f32 v[146:147], v[206:207], v[38:39], v[146:147] op_sel_hi:[0,1,1] neg_lo:[1,0,0] neg_hi:[1,0,0]
    v_pk_fma_f32 v[146:147], v[206:207], v[36:37], v[146:147] op_sel:[1,0,0] neg_lo:[1,0,0] neg_hi:[1,0,0]
    v_pk_fma_f32 v[148:149], v[210:211], v[38:39], v[148:149] op_sel_hi:[0,1,1] neg_lo:[1,0,0] neg_hi:[1,0,0]
    v_pk_fma_f32 v[148:149], v[210:211], v[36:37], v[148:149] op_sel:[1,0,0] neg_lo:[1,0,0] neg_hi:[1,0,0]
    v_pk_fma_f32 v[150:151], v[214:215], v[38:39], v[150:151] op_sel_hi:[0,1,1] neg_lo:[1,0,0] neg_hi:[1,0,0]
    v_pk_fma_f32 v[150:151], v[214:215], v[36:37], v[150:151] op_sel:[1,0,0] neg_lo:[1,0,0] neg_hi:[1,0,0]
    v_pk_fma_f32 v[152:153], v[218:219], v[38:39], v[152:153] op_sel_hi:[0,1,1] neg_lo:[1,0,0] neg_hi:[1,0,0]
    v_pk_fma_f32 v[152:153], v[218:219], v[36:37], v[152:153] op_sel:[1,0,0] neg_lo:[1,0,0] neg_hi:[1,0,0]
    v_pk_fma_f32 v[154:155], v[222:223], v[38:39], v[154:155] op_sel_hi:[0,1,1] neg_lo:[1,0,0] neg_hi:[1,0,0]
    v_pk_fma_f32 v[154:155], v[222:223], v[36:37], v[154:155] op_sel:[1,0,0] neg_lo:[1,0,0] neg_hi:[1,0,0]
    v_pk_fma_f32 v[156:157], v[226:227], v[38:39], v[156:157] op_sel_hi:[0,1,1] neg_lo:[1,0,0] neg_hi:[1,0,0]
    v_pk_fma_f32 v[156:157], v[226:227], v[36:37], v[156:157] op_sel:[1,0,0] neg_lo:[1,0,0] neg_hi:[1,0,0]
    v_pk_fma_f32 v[158:159], v[230:231], v[38:39], v[158:159] op_sel_hi:[0,1,1] neg_lo:[1,0,0] neg_hi:[1,0,0]
    v_pk_fma_f32 v[158:159], v[230:231], v[36:37], v[158:159] op_sel:[1,0,0] neg_lo:[1,0,0] neg_hi:[1,0,0]
    v_cvt_pk_bf16_f32 v184, v144, v146
    v_cvt_pk_bf16_f32 v185, v148, v150
    v_cvt_pk_bf16_f32 v186, v152, v154
    v_cvt_pk_bf16_f32 v187, v156, v158
    ds_write_b128 v2, v[184:187] offset:2048
    v_cvt_pk_bf16_f32 v188, v145, v147
    v_cvt_pk_bf16_f32 v189, v149, v151
    v_cvt_pk_bf16_f32 v190, v153, v155
    v_cvt_pk_bf16_f32 v191, v157, v159
    ds_write_b128 v3, v[188:191] offset:2048
    ds_read_b64_tr_b16 v[128:129], v4 offset:0
    ds_read_b64_tr_b16 v[130:131], v30 offset:512
    ds_read_b64_tr_b16 v[132:133], v5 offset:0
    ds_read_b64_tr_b16 v[134:135], v31 offset:512
    ds_read_b64_tr_b16 v[136:137], v30 offset:0
    ds_read_b64_tr_b16 v[138:139], v4 offset:512
    ds_read_b64_tr_b16 v[140:141], v31 offset:0
    ds_read_b64_tr_b16 v[142:143], v5 offset:512
    s_waitcnt lgkmcnt(6)
    buffer_store_dwordx4 v[128:131], v196, s[40:43], s33 offen offset:0 sc1
    s_waitcnt lgkmcnt(4)
    buffer_store_dwordx4 v[132:135], v196, s[40:43], s33 offen offset:1024 sc1
    s_waitcnt lgkmcnt(2)
    buffer_store_dwordx4 v[136:139], v196, s[40:43], s33 offen offset:2048 sc1
    s_waitcnt lgkmcnt(0)
    buffer_store_dwordx4 v[140:143], v196, s[40:43], s33 offen offset:3072 sc1
    s_lshl_b32 s33, s26, 11
    s_add_u32 s33, s33, 3932160
    s_add_u32 s36, s20, s33
    s_addc_u32 s37, s21, 0
    s_mov_b32 s38, 2048
    s_lshl_b32 s47, s27, 7
    v_mov_b32 v190, s44
    v_lshlrev_b32 v191, 2, v1
    v_lshlrev_b32 v192, 7, v6
    v_mov_b32 v193, 1
    v_mov_b32 v194, 147456
    v_lshrrev_b32 v2, 1, v6
    v_xor_b32 v2, v2, v7
    v_lshlrev_b32 v2, 4, v2
    v_lshl_add_u32 v2, v6, 7, v2
    v_add_u32 v2, 65536, v2
    v_xor_b32 v3, 64, v2
    v_and_b32 v5, 7, v6
    v_xor_b32 v5, v5, v7
    v_lshlrev_b32 v5, 4, v5
    v_lshl_add_u32 v5, v6, 8, v5
    s_lshl_b32 s33, s29, 13
    s_add_u32 s33, s33, 0
    v_add_u32 v186, s33, v5
    v_xor_b32 v187, 64, v186
    v_xor_b32 v188, 128, v186
    v_xor_b32 v189, 192, v186
    v_mov_b32 v200, 0
    v_mov_b32 v201, 0
    v_mov_b32 v202, 0
    v_mov_b32 v203, 0
    v_mov_b32 v204, 0
    v_mov_b32 v205, 0
    v_mov_b32 v206, 0
    v_mov_b32 v207, 0
    v_mov_b32 v208, 0
    v_mov_b32 v209, 0
    v_mov_b32 v210, 0
    v_mov_b32 v211, 0
    v_mov_b32 v212, 0
    v_mov_b32 v213, 0
    v_mov_b32 v214, 0
    v_mov_b32 v215, 0
    v_mov_b32 v216, 0
    v_mov_b32 v217, 0
    v_mov_b32 v218, 0
    v_mov_b32 v219, 0
    v_mov_b32 v220, 0
    v_mov_b32 v221, 0
    v_mov_b32 v222, 0
    v_mov_b32 v223, 0
    v_mov_b32 v224, 0
    v_mov_b32 v225, 0
    v_mov_b32 v226, 0
    v_mov_b32 v227, 0
    v_mov_b32 v228, 0
    v_mov_b32 v229, 0
    v_mov_b32 v230, 0
    v_mov_b32 v231, 0
    s_lshr_b32 s61, s25, 3
    s_lshl_b32 s62, s24, 1
    s_add_u32 s61, s61, s62
    s_and_b32 s61, s61, 15
    s_add_u32 s62, s61, s26
    s_and_b32 s62, s62, 15
    s_lshl_b32 s62, s62, 15
    s_lshl_b32 s32, s29, 11
    s_lshl_b32 s33, s26, 19
    s_add_u32 s33, s33, s32
    s_add_u32 s33, s33, 4194304
    s_waitcnt vmcnt(0)
    s_mov_b64 exec, 1
    ds_add_rtn_u32 v193, v194, v193 offset:24
    s_mov_b64 exec, -1
    s_add_u32 s40, s20, s33
    s_addc_u32 s41, s21, 0
    s_sub_u32 s42, 524288, s32
    s_waitcnt lgkmcnt(0)
    v_readfirstlane_b32 s46, v193
    s_cmp_lg_u32 s46, 3
    s_cbranch_scc1 Lc_hok
    s_mov_b64 exec, 0xffffffff
    buffer_store_dword v190, v191, s[36:39], s47 offen sc1
    ds_write_b32 v194, v194 offset:28
    s_mov_b64 exec, 0xffff
    s_lshl_b32 s46, 1, s27
    s_andn2_b32 exec_lo, exec_lo, s46
    s_mov_b32 s45, 32768
Lc_hpoll:
    v_mov_b32 v193, 0
    buffer_atomic_or v193, v192, s[36:39], 0 offen sc0 sc1
    s_waitcnt vmcnt(0)
    v_cmp_ne_u32 vcc, s44, v193
    s_cbranch_vccz Lc_hdone
    s_sub_u32 s45, s45, 1
    s_cbranch_scc1 Lc_hdone
    s_sleep 4
    s_branch Lc_hpoll
Lc_hdone:
    s_mov_b64 exec, -1
Lc_hok:
    s_barrier
    buffer_load_dwordx4 v[40:43], v196, s[40:43], s62 offen offset:0 sc1
    buffer_load_dwordx4 v[44:47], v196, s[40:43], s62 offen offset:1024 sc1
    s_add_u32 s62, s62, 8192
    s_and_b32 s62, s62, 524287
    buffer_load_dwordx4 v[48:51], v196, s[40:43], s62 offen offset:0 sc1
    buffer_load_dwordx4 v[52:55], v196, s[40:43], s62 offen offset:1024 sc1
    s_add_u32 s62, s62, 8192
    s_and_b32 s62, s62, 524287
    buffer_load_dwordx4 v[56:59], v196, s[40:43], s62 offen offset:0 sc1
    buffer_load_dwordx4 v[60:63], v196, s[40:43], s62 offen offset:1024 sc1
    s_add_u32 s62, s62, 8192
    s_and_b32 s62, s62, 524287
    buffer_load_dwordx4 v[64:67], v196, s[40:43], s62 offen offset:0 sc1
    buffer_load_dwordx4 v[68:71], v196, s[40:43], s62 offen offset:1024 sc1
    s_add_u32 s62, s62, 8192
    s_and_b32 s62, s62, 524287
    buffer_load_dwordx4 v[72:75], v196, s[40:43], s62 offen offset:0 sc1
    buffer_load_dwordx4 v[76:79], v196, s[40:43], s62 offen offset:1024 sc1
    s_add_u32 s62, s62, 8192
    s_and_b32 s62, s62, 524287
    buffer_load_dwordx4 v[80:83], v196, s[40:43], s62 offen offset:0 sc1
    buffer_load_dwordx4 v[84:87], v196, s[40:43], s62 offen offset:1024 sc1
    s_add_u32 s62, s62, 8192
    s_and_b32 s62, s62, 524287
    ds_read_b128 v[8:11], v2 offset:0
    ds_read_b128 v[12:15], v2 offset:2048
    ds_read_b128 v[16:19], v2 offset:4096
    ds_read_b128 v[20:23], v2 offset:6144
    s_mov_b32 s35, 0
Lc2_loop:
    s_waitcnt vmcnt(11) lgkmcnt(0)
    v_mfma_f32_16x16x32_bf16 v[200:203], v[8:11], v[40:43], v[200:203]
    ds_read_b128 v[24:27], v3 offset:0
    v_mfma_f32_16x16x32_bf16 v[204:207], v[12:15], v[40:43], v[204:207]
    ds_read_b128 v[28:31], v3 offset:2048
    v_mfma_f32_16x16x32_bf16 v[208:211], v[16:19], v[40:43], v[208:211]
    ds_read_b128 v[32:35], v3 offset:4096
    v_mfma_f32_16x16x32_bf16 v[212:215], v[20:23], v[40:43], v[212:215]
    ds_read_b128 v[36:39], v3 offset:6144
    buffer_load_dwordx4 v[88:91], v196, s[40:43], s62 offen offset:0 sc1
    s_waitcnt vmcnt(11)
    v_mfma_f32_16x16x32_bf16 v[228:231], v[20:23], v[44:47], v[228:231]
    v_mfma_f32_16x16x32_bf16 v[224:227], v[16:19], v[44:47], v[224:227]
    v_mfma_f32_16x16x32_bf16 v[220:223], v[12:15], v[44:47], v[220:223]
    v_mfma_f32_16x16x32_bf16 v[216:219], v[8:11], v[44:47], v[216:219]
    buffer_load_dwordx4 v[92:95], v196, s[40:43], s62 offen offset:1024 sc1
    s_add_u32 s62, s62, 8192
    s_and_b32 s62, s62, 524287
    s_waitcnt vmcnt(11) lgkmcnt(0)
    v_mfma_f32_16x16x32_bf16 v[200:203], v[24:27], v[48:51], v[200:203]
    ds_read_b128 v[8:11], v2 offset:8192
    v_mfma_f32_16x16x32_bf16 v[204:207], v[28:31], v[48:51], v[204:207]
    ds_read_b128 v[12:15], v2 offset:10240
    v_mfma_f32_16x16x32_bf16 v[208:211], v[32:35], v[48:51], v[208:211]
    ds_read_b128 v[16:19], v2 offset:12288
    v_mfma_f32_16x16x32_bf16 v[212:215], v[36:39], v[48:51], v[212:215]
    ds_read_b128 v[20:23], v2 offset:14336
    buffer_load_dwordx4 v[96:99], v196, s[40:43], s62 offen offset:0 sc1
    s_waitcnt vmcnt(11)
    v_mfma_f32_16x16x32_bf16 v[228:231], v[36:39], v[52:55], v[228:231]
    v_mfma_f32_16x16x32_bf16 v[224:227], v[32:35], v[52:55], v[224:227]
    v_mfma_f32_16x16x32_bf16 v[220:223], v[28:31], v[52:55], v[220:223]
    v_mfma_f32_16x16x32_bf16 v[216:219], v[24:27], v[52:55], v[216:219]
    buffer_load_dwordx4 v[100:103], v196, s[40:43], s62 offen offset:1024 sc1
    s_add_u32 s62, s62, 8192
    s_and_b32 s62, s62, 524287
    s_cmp_eq_u32 s35, 7
    s_cselect_b32 s42, 0, s42
    s_waitcnt vmcnt(11) lgkmcnt(0)
    v_mfma_f32_16x16x32_bf16 v[200:203], v[8:11], v[56:59], v[200:203]
    ds_read_b128 v[24:27], v3 offset:8192
    v_mfma_f32_16x16x32_bf16 v[204:207], v[12:15], v[56:59], v[204:207]
    ds_read_b128 v[28:31], v3 offset:10240
    v_mfma_f32_16x16x32_bf16 v[208:211], v[16:19], v[56:59], v[208:211]
    ds_read_b128 v[32:35], v3 offset:12288
    v_mfma_f32_16x16x32_bf16 v[212:215], v[20:23], v[56:59], v[212:215]
    ds_read_b128 v[36:39], v3 offset:14336
    buffer_load_dwordx4 v[40:43], v196, s[40:43], s62 offen offset:0 sc1
    s_waitcnt vmcnt(11)
    v_mfma_f32_16x16x32_bf16 v[228:231], v[20:23], v[60:63], v[228:231]
    v_mfma_f32_16x16x32_bf16 v[224:227], v[16:19], v[60:63], v[224:227]
    v_mfma_f32_16x16x32_bf16 v[220:223], v[12:15], v[60:63], v[220:223]
    v_mfma_f32_16x16x32_bf16 v[216:219], v[8:11], v[60:63], v[216:219]
    buffer_load_dwordx4 v[44:47], v196, s[40:43], s62 offen offset:1024 sc1
    s_add_u32 s62, s62, 8192
    s_and_b32 s62, s62, 524287
    s_waitcnt vmcnt(11) lgkmcnt(0)
    v_mfma_f32_16x16x32_bf16 v[200:203], v[24:27], v[64:67], v[200:203]
    s_barrier
    v_mfma_f32_16x16x32_bf16 v[204:207], v[28:31], v[64:67], v[204:207]
    ds_read_b128 v[8:11], v2 offset:16384
    v_mfma_f32_16x16x32_bf16 v[208:211], v[32:35], v[64:67], v[208:211]
    ds_read_b128 v[12:15], v2 offset:18432
    v_mfma_f32_16x16x32_bf16 v[212:215], v[36:39], v[64:67], v[212:215]
    ds_read_b128 v[16:19], v2 offset:20480
    buffer_load_dwordx4 v[48:51], v196, s[40:43], s62 offen offset:0 sc1
    s_waitcnt vmcnt(11)
    v_mfma_f32_16x16x32_bf16 v[228:231], v[36:39], v[68:71], v[228:231]
    ds_read_b128 v[20:23], v2 offset:22528
    v_mfma_f32_16x16x32_bf16 v[224:227], v[32:35], v[68:71], v[224:227]
    v_mfma_f32_16x16x32_bf16 v[220:223], v[28:31], v[68:71], v[220:223]
    v_mfma_f32_16x16x32_bf16 v[216:219], v[24:27], v[68:71], v[216:219]
    buffer_load_dwordx4 v[52:55], v196, s[40:43], s62 offen offset:1024 sc1
    s_add_u32 s62, s62, 8192
    s_and_b32 s62, s62, 524287
    s_waitcnt vmcnt(11) lgkmcnt(0)
    v_mfma_f32_16x16x32_bf16 v[200:203], v[8:11], v[72:75], v[200:203]
    ds_read_b128 v[24:27], v3 offset:16384
    v_mfma_f32_16x16x32_bf16 v[204:207], v[12:15], v[72:75], v[204:207]
    ds_read_b128 v[28:31], v3 offset:18432
    v_mfma_f32_16x16x32_bf16 v[208:211], v[16:19], v[72:75], v[208:211]
    ds_read_b128 v[32:35], v3 offset:20480
    v_mfma_f32_16x16x32_bf16 v[212:215], v[20:23], v[72:75], v[212:215]
    ds_read_b128 v[36:39], v3 offset:22528
    buffer_load_dwordx4 v[56:59], v196, s[40:43], s62 offen offset:0 sc1
    s_waitcnt vmcnt(11)
    v_mfma_f32_16x16x32_bf16 v[228:231], v[20:23], v[76:79], v[228:231]
    v_mfma_f32_16x16x32_bf16 v[224:227], v[16:19], v[76:79], v[224:227]
    v_mfma_f32_16x16x32_bf16 v[220:223], v[12:15], v[76:79], v[220:223]
    v_mfma_f32_16x16x32_bf16 v[216:219], v[8:11], v[76:79], v[216:219]
    buffer_load_dwordx4 v[60:63], v196, s[40:43], s62 offen offset:1024 sc1
    s_add_u32 s62, s62, 8192
    s_and_b32 s62, s62, 524287
    s_waitcnt vmcnt(11) lgkmcnt(0)
    v_mfma_f32_16x16x32_bf16 v[200:203], v[24:27], v[80:83], v[200:203]
    ds_read_b128 v[8:11], v2 offset:24576
    v_mfma_f32_16x16x32_bf16 v[204:207], v[28:31], v[80:83], v[204:207]
    ds_read_b128 v[12:15], v2 offset:26624
    v_mfma_f32_16x16x32_bf16 v[208:211], v[32:35], v[80:83], v[208:211]
    ds_read_b128 v[16:19], v2 offset:28672
    v_mfma_f32_16x16x32_bf16 v[212:215], v[36:39], v[80:83], v[212:215]
    ds_read_b128 v[20:23], v2 offset:30720
    buffer_load_dwordx4 v[64:67], v196, s[40:43], s62 offen offset:0 sc1
    s_waitcnt vmcnt(11)
    v_mfma_f32_16x16x32_bf16 v[228:231], v[36:39], v[84:87], v[228:231]
    v_mfma_f32_16x16x32_bf16 v[224:227], v[32:35], v[84:87], v[224:227]
    v_mfma_f32_16x16x32_bf16 v[220:223], v[28:31], v[84:87], v[220:223]
    v_mfma_f32_16x16x32_bf16 v[216:219], v[24:27], v[84:87], v[216:219]
    buffer_load_dwordx4 v[68:71], v196, s[40:43], s62 offen offset:1024 sc1
    s_add_u32 s62, s62, 8192
    s_and_b32 s62, s62, 524287
    s_waitcnt vmcnt(11) lgkmcnt(0)
    v_mfma_f32_16x16x32_bf16 v[200:203], v[8:11], v[88:91], v[200:203]
    ds_read_b128 v[24:27], v3 offset:24576
    v_mfma_f32_16x16x32_bf16 v[204:207], v[12:15], v[88:91], v[204:207]
    ds_read_b128 v[28:31], v3 offset:26624
    v_mfma_f32_16x16x32_bf16 v[208:211], v[16:19], v[88:91], v[208:211]
    ds_read_b128 v[32:35], v3 offset:28672
    v_mfma_f32_16x16x32_bf16 v[212:215], v[20:23], v[88:91], v[212:215]
    ds_read_b128 v[36:39], v3 offset:30720
    buffer_load_dwordx4 v[72:75], v196, s[40:43], s62 offen offset:0 sc1
    s_waitcnt vmcnt(11)
    v_mfma_f32_16x16x32_bf16 v[228:231], v[20:23], v[92:95], v[228:231]
    v_mfma_f32_16x16x32_bf16 v[224:227], v[16:19], v[92:95], v[224:227]
    v_mfma_f32_16x16x32_bf16 v[220:223], v[12:15], v[92:95], v[220:223]
    v_mfma_f32_16x16x32_bf16 v[216:219], v[8:11], v[92:95], v[216:219]
    buffer_load_dwordx4 v[76:79], v196, s[40:43], s62 offen offset:1024 sc1
    s_add_u32 s62, s62, 8192
    s_and_b32 s62, s62, 524287
    s_cmp_eq_u32 s35, 7
    s_waitcnt vmcnt(11) lgkmcnt(0)
    v_mfma_f32_16x16x32_bf16 v[200:203], v[24:27], v[96:99], v[200:203]
    v_xor_b32 v2, 0x8000, v2
    v_xor_b32 v3, 0x8000, v3
    s_cbranch_scc1 Lc2_nobar
    s_barrier
Lc2_nobar:
    v_mfma_f32_16x16x32_bf16 v[204:207], v[28:31], v[96:99], v[204:207]
    ds_read_b128 v[8:11], v2 offset:0
    v_mfma_f32_16x16x32_bf16 v[208:211], v[32:35], v[96:99], v[208:211]
    ds_read_b128 v[12:15], v2 offset:2048
    v_mfma_f32_16x16x32_bf16 v[212:215], v[36:39], v[96:99], v[212:215]
    ds_read_b128 v[16:19], v2 offset:4096
    buffer_load_dwordx4 v[80:83], v196, s[40:43], s62 offen offset:0 sc1
    s_waitcnt vmcnt(11)
    v_mfma_f32_16x16x32_bf16 v[228:231], v[36:39], v[100:103], v[228:231]
    ds_read_b128 v[20:23], v2 offset:6144
    v_mfma_f32_16x16x32_bf16 v[224:227], v[32:35], v[100:103], v[224:227]
    v_mfma_f32_16x16x32_bf16 v[220:223], v[28:31], v[100:103], v[220:223]
    v_mfma_f32_16x16x32_bf16 v[216:219], v[24:27], v[100:103], v[216:219]
    buffer_load_dwordx4 v[84:87], v196, s[40:43], s62 offen offset:1024 sc1
    s_add_u32 s62, s62, 8192
    s_and_b32 s62, s62, 524287
    s_add_u32 s35, s35, 1
    s_cmp_lt_u32 s35, 8
    s_cbranch_scc1 Lc2_loop
    ds_write_b128 v186, v[200:203] offset:0
    ds_write_b128 v187, v[204:207] offset:0
    ds_write_b128 v188, v[208:211] offset:0
    ds_write_b128 v189, v[212:215] offset:0
    ds_write_b128 v186, v[216:219] offset:4096
    ds_write_b128 v187, v[220:223] offset:4096
    ds_write_b128 v188, v[224:227] offset:4096
    ds_write_b128 v189, v[228:231] offset:4096
    s_waitcnt lgkmcnt(0)
    s_barrier
L_end:
    s_endpgm
.section .rodata,"a"
.p2align 6
.amdhsa_kernel gated_mix__ssm_conv_s5__moe_arch_mod__prompt_kernel
  .amdhsa_next_free_vgpr 256
  .amdhsa_next_free_sgpr 102
  .amdhsa_accum_offset 256
  .amdhsa_group_segment_fixed_size 0
  .amdhsa_kernarg_size 144
  .amdhsa_user_sgpr_count 2
  .amdhsa_user_sgpr_kernarg_segment_ptr 1
  .amdhsa_system_sgpr_workgroup_id_x 1
  .amdhsa_float_denorm_mode_32 3
.end_amdhsa_kernel
```

```asm
; @launch grid=(256,1,1) block=(512,1,1) lds=163840
.amdgcn_target "amdgcn-amd-amdhsa--gfx950"
.text
.globl gated_mix__ssm_conv_s5__moe_arch_mod__prompt_kernel
.p2align 8
.type gated_mix__ssm_conv_s5__moe_arch_mod__prompt_kernel,@function
gated_mix__ssm_conv_s5__moe_arch_mod__prompt_kernel:
    s_load_dwordx4 s[4:7], s[0:1], 0
    s_load_dwordx4 s[12:15], s[0:1], 24
    s_load_dwordx2 s[36:37], s[0:1], 80
    s_load_dwordx2 s[40:41], s[0:1], 112
    s_load_dwordx2 s[16:17], s[0:1], 136
    s_load_dwordx2 s[8:9], s[0:1], 16
    s_load_dwordx2 s[44:45], s[0:1], 56
    s_cmp_ge_u32 s2, 256
    s_cbranch_scc1 L_end
    v_lshrrev_b32 v2, 6, v0
    v_and_b32 v1, 63, v0
    s_and_b32 s24, s2, 7
    s_lshr_b32 s25, s2, 3
    s_lshr_b32 s26, s25, 3
    s_lshl_b32 s26, s26, 2
    s_lshr_b32 s27, s24, 1
    s_add_u32 s26, s26, s27
    s_and_b32 s27, s24, 1
    s_lshl_b32 s27, s27, 3
    s_and_b32 s28, s25, 7
    s_add_u32 s27, s27, s28
    v_readfirstlane_b32 s29, v2
    s_cmp_lt_u32 s29, 4
    s_cbranch_scc1 L_compute
    s_and_b32 s30, s29, 3
    v_lshlrev_b32 v18, 4, v1
    s_lshl_b32 s20, s26, 7
    s_lshl_b32 s63, s27, 3
    s_add_u32 s62, s20, s63
    s_lshl_b32 s63, s30, 1
    s_add_u32 s62, s62, s63
    s_lshl_b32 s63, s62, 11
    s_mov_b32 s38, 2048
    s_mov_b32 s39, 0x20000
    s_mov_b32 s42, 2048
    s_mov_b32 s43, 0x20000
    v_lshrrev_b32 v3, 3, v1
    v_and_b32 v4, 7, v1
    v_lshrrev_b32 v5, 1, v3
    v_xor_b32 v2, v4, v5
    v_lshlrev_b32 v2, 4, v2
    v_lshl_add_u32 v14, v3, 11, v2
    v_xor_b32 v15, 64, v14
    v_add_u32 v16, 30720, v14
    v_add_u32 v17, 46080, v15
    v_add_u32 v15, 15360, v15
    v_lshrrev_b32 v6, 2, v3
    v_lshlrev_b32 v6, 4, v6
    v_and_b32 v7, 1, v3
    v_lshl_add_u32 v6, v7, 3, v6
    v_and_b32 v7, 1, v5
    v_add_u32 v6, v6, v7
    v_lshl_add_u32 v10, v6, 11, v2
    v_xor_b32 v11, 64, v10
    v_add_u32 v12, 2048, v10
    v_add_u32 v13, 66560, v11
    v_add_u32 v11, 64512, v11
    s_lshr_b32 s31, s30, 1
    s_and_b32 s32, s30, 1
    s_lshl_b32 s34, s31, 6
    s_add_u32 s33, s20, s34
    s_lshl_b32 s34, s32, 2
    s_add_u32 s33, s33, s34
    s_lshl_b32 s33, s33, 11
    s_lshl_b32 s34, s27, 6
    s_lshl_b32 s35, s31, 5
    s_add_u32 s34, s34, s35
    s_lshl_b32 s64, s34, 11
    s_lshl_b32 s60, s30, 12
    s_lshr_b32 s61, s24, 1
    s_lshl_b32 s61, s61, 2
    s_and_b32 s66, s24, 1
    s_lshl_b32 s66, s66, 3
    s_add_u32 s61, s61, s66
    s_lshr_b32 s66, s25, 3
    s_add_u32 s66, s66, s25
    s_and_b32 s66, s66, 1
    s_add_u32 s61, s61, s66
    s_and_b32 s61, s61, 15
    s_lshl_b32 s61, s61, 7
    s_cmp_eq_u32 s32, 1
    s_waitcnt lgkmcnt(0)
    s_mov_b32 s6, 4194304
    s_mov_b32 s7, 0x20000
    buffer_load_dwordx4 v[44:47], v18, s[40:43], 0 offen offset:0
    buffer_load_dwordx4 v[36:39], v18, s[36:39], 0 offen offset:0
    buffer_load_dwordx4 v[48:51], v18, s[40:43], 0 offen offset:1024
    buffer_load_dwordx4 v[40:43], v18, s[36:39], 0 offen offset:1024
    buffer_load_dwordx4 v[20:23], v18, s[4:7], s63 offen offset:0
    buffer_load_dwordx4 v[24:27], v18, s[4:7], s63 offen offset:1024
    buffer_load_dwordx4 v[28:31], v18, s[4:7], s63 offen offset:2048
    buffer_load_dwordx4 v[32:35], v18, s[4:7], s63 offen offset:3072
    s_cselect_b32 s12, s14, s12
    s_cselect_b32 s13, s15, s13
    s_add_u32 s12, s12, s64
    s_addc_u32 s13, s13, 0
    s_sub_u32 s14, 2097152, s64
    s_mov_b32 s15, 0x20000
    s_add_u32 s8, s4, s33
    s_addc_u32 s9, s5, 0
    s_sub_u32 s10, 4194304, s33
    s_mov_b32 s11, 0x20000
    s_add_u32 m0, s60, 0
    s_nop 0
    buffer_load_dwordx4 v10, s[8:11], s61 offen offset:0 lds
    buffer_load_dwordx4 v11, s[8:11], s61 offen offset:1024 lds
    buffer_load_dwordx4 v12, s[8:11], s61 offen offset:2048 lds
    buffer_load_dwordx4 v13, s[8:11], s61 offen offset:3072 lds
    s_add_u32 m0, s60, 16384
    s_nop 0
    buffer_load_dwordx4 v14, s[12:15], s61 offen offset:0 lds
    buffer_load_dwordx4 v15, s[12:15], s61 offen offset:1024 lds
    buffer_load_dwordx4 v16, s[12:15], s61 offen offset:2048 lds
    buffer_load_dwordx4 v17, s[12:15], s61 offen offset:3072 lds
    s_add_u32 s61, s61, 128
    s_and_b32 s61, s61, 2047
    s_load_dword s65, s[16:17], 0
    s_load_dwordx2 s[36:37], s[0:1], 64
    s_load_dwordx2 s[40:41], s[0:1], 120
    s_load_dwordx2 s[44:45], s[0:1], 104
    s_load_dwordx2 s[48:49], s[0:1], 88
    s_load_dwordx2 s[52:53], s[0:1], 96
    s_load_dwordx4 s[84:87], s[0:1], 40
    v_mov_b32 v9, 0
    v_mov_b32 v8, 0
    v_mov_b32 v7, 147456
    ds_write_b64 v7, v[8:9]
    ds_write_b64 v7, v[8:9] offset:8
    ds_write_b64 v7, v[8:9] offset:16
    ds_write_b64 v7, v[8:9] offset:24
    s_mov_b32 s18, 268435456
    s_mov_b32 s19, 0x20000
    s_mov_b32 s42, 8388608
    s_mov_b32 s43, 0x20000
    s_mov_b32 s46, 7340032
    s_mov_b32 s47, 0x20000
    s_mov_b32 s50, 7340032
    s_mov_b32 s51, 0x20000
    s_mov_b32 s54, 7340032
    s_mov_b32 s55, 0x20000
    s_mul_hi_u32 s70, s2, 76695845
    s_mul_i32 s71, s70, 56
    s_sub_u32 s71, s2, s71
    s_lshl_b32 s72, s70, 8
    s_lshl_b32 s73, s30, 6
    s_add_u32 s72, s72, s73
    s_mul_i32 s73, s72, 7168
    s_lshl_b32 s74, s71, 7
    s_add_u32 s73, s73, s74
    s_cmp_ge_u32 s2, 224
    s_cselect_b32 s50, 0, s50
    s_cselect_b32 s54, 0, s54
    s_lshl_b32 s75, s30, 13
    s_lshl_b32 s69, s30, 12
    s_add_u32 s69, s69, 32768
    s_mul_i32 s80, s25, 16384
    s_lshr_b32 s80, s80, 16
    s_mul_i32 s80, s80, 4
    s_sub_u32 s80, s25, s80
    s_mul_i32 s80, s80, 2
    s_add_u32 s80, s80, 3
    s_lshl_b32 s22, s27, 7
    s_mul_i32 s35, s26, 28
    s_mul_i32 s34, s30, 7
    s_add_u32 s35, s35, s34
    s_lshl_b32 s35, s35, 14
    s_add_u32 s35, s35, s22
    s_lshl_b32 s23, s34, 10
    s_lshl_b32 s21, s30, 5
    s_add_u32 s21, s21, s20
    v_mul_u32_u24 v228, 7168, v3
    v_lshl_add_u32 v228, v4, 4, v228
    v_lshlrev_b32 v229, 4, v4
    v_lshl_add_u32 v229, v3, 11, v229
    v_lshlrev_b32 v19, 3, v4
    v_mov_b32 v96, 0x3f803f80
    v_mov_b32 v68, 0
    v_mov_b32 v69, 0
    v_mov_b32 v70, 0
    v_mov_b32 v71, 0
    s_lshr_b32 s56, s61, 7
    s_sub_u32 s56, s27, s56
    s_add_u32 s56, s56, 1
    s_and_b32 s56, s56, 15
    s_and_b32 s57, s56, 3
    s_lshl_b32 s57, s57, 15
    s_lshl_b32 s58, s31, 13
    s_add_u32 s57, s57, s58
    s_lshl_b32 s58, s32, 10
    s_add_u32 s57, s57, s58
    v_lshrrev_b32 v6, 4, v1
    v_and_b32 v230, 1, v6
    v_lshrrev_b32 v231, 1, v6
    v_lshlrev_b32 v231, 11, v231
    v_lshl_add_u32 v231, v230, 8, v231
    v_lshl_add_u32 v230, s32, 2, v230
    v_bfe_u32 v8, v1, 1, 3
    v_xor_b32 v230, v230, v8
    v_lshl_add_u32 v230, v230, 4, v231
    v_and_b32 v8, 1, v1
    v_lshl_add_u32 v230, v8, 3, v230
    v_add_u32 v230, s57, v230
    v_xor_b32 v231, 32, v230
    s_getpc_b64 s[58:59]
L_xpc:
    s_add_u32 s58, s58, L_xsub - L_xpc
    s_addc_u32 s59, s59, 0
    s_waitcnt vmcnt(8)
    v_and_b32 v52, 0xffff, v44
    v_and_b32 v60, 0xffff0000, v44
    v_and_b32 v53, 0xffff, v45
    v_and_b32 v61, 0xffff0000, v45
    v_and_b32 v54, 0xffff, v46
    v_and_b32 v62, 0xffff0000, v46
    v_and_b32 v55, 0xffff, v47
    v_and_b32 v63, 0xffff0000, v47
    v_and_b32 v56, 0xffff, v48
    v_and_b32 v64, 0xffff0000, v48
    v_and_b32 v57, 0xffff, v49
    v_and_b32 v65, 0xffff0000, v49
    v_and_b32 v58, 0xffff, v50
    v_and_b32 v66, 0xffff0000, v50
    v_and_b32 v59, 0xffff, v51
    v_and_b32 v67, 0xffff0000, v51
    v_dot2_f32_bf16 v72, v20, v52, 0
    v_dot2_f32_bf16 v73, v20, v60, 0
    v_dot2_f32_bf16 v74, v28, v52, 0
    v_dot2_f32_bf16 v75, v28, v60, 0
    v_dot2c_f32_bf16 v68, v20, v36
    v_dot2c_f32_bf16 v69, v28, v36
    v_cvt_pk_bf16_f32 v72, v72, v73
    v_cvt_pk_bf16_f32 v74, v74, v75
    v_dot2_f32_bf16 v76, v21, v53, 0
    v_dot2_f32_bf16 v77, v21, v61, 0
    v_dot2_f32_bf16 v78, v29, v53, 0
    v_dot2_f32_bf16 v79, v29, v61, 0
    v_dot2c_f32_bf16 v68, v21, v37
    v_dot2c_f32_bf16 v69, v29, v37
    v_dot2c_f32_bf16 v70, v72, v96
    v_dot2c_f32_bf16 v71, v74, v96
    v_cvt_pk_bf16_f32 v76, v76, v77
    v_cvt_pk_bf16_f32 v78, v78, v79
    v_dot2_f32_bf16 v72, v22, v54, 0
    v_dot2_f32_bf16 v73, v22, v62, 0
    v_dot2_f32_bf16 v74, v30, v54, 0
    v_dot2_f32_bf16 v75, v30, v62, 0
    v_dot2c_f32_bf16 v68, v22, v38
    v_dot2c_f32_bf16 v69, v30, v38
    v_dot2c_f32_bf16 v70, v76, v96
    v_dot2c_f32_bf16 v71, v78, v96
    v_cvt_pk_bf16_f32 v72, v72, v73
    v_cvt_pk_bf16_f32 v74, v74, v75
    v_dot2_f32_bf16 v76, v23, v55, 0
    v_dot2_f32_bf16 v77, v23, v63, 0
    v_dot2_f32_bf16 v78, v31, v55, 0
    v_dot2_f32_bf16 v79, v31, v63, 0
    v_dot2c_f32_bf16 v68, v23, v39
    v_dot2c_f32_bf16 v69, v31, v39
    v_dot2c_f32_bf16 v70, v72, v96
    v_dot2c_f32_bf16 v71, v74, v96
    v_cvt_pk_bf16_f32 v76, v76, v77
    v_cvt_pk_bf16_f32 v78, v78, v79
    v_dot2_f32_bf16 v72, v24, v56, 0
    v_dot2_f32_bf16 v73, v24, v64, 0
    v_dot2_f32_bf16 v74, v32, v56, 0
    v_dot2_f32_bf16 v75, v32, v64, 0
    v_dot2c_f32_bf16 v68, v24, v40
    v_dot2c_f32_bf16 v69, v32, v40
    v_dot2c_f32_bf16 v70, v76, v96
    v_dot2c_f32_bf16 v71, v78, v96
    v_cvt_pk_bf16_f32 v72, v72, v73
    v_cvt_pk_bf16_f32 v74, v74, v75
    v_dot2_f32_bf16 v76, v25, v57, 0
    v_dot2_f32_bf16 v77, v25, v65, 0
    v_dot2_f32_bf16 v78, v33, v57, 0
    v_dot2_f32_bf16 v79, v33, v65, 0
    v_dot2c_f32_bf16 v68, v25, v41
    v_dot2c_f32_bf16 v69, v33, v41
    v_dot2c_f32_bf16 v70, v72, v96
    v_dot2c_f32_bf16 v71, v74, v96
    v_cvt_pk_bf16_f32 v76, v76, v77
    v_cvt_pk_bf16_f32 v78, v78, v79
    v_dot2_f32_bf16 v72, v26, v58, 0
    v_dot2_f32_bf16 v73, v26, v66, 0
    v_dot2_f32_bf16 v74, v34, v58, 0
    v_dot2_f32_bf16 v75, v34, v66, 0
    v_dot2c_f32_bf16 v68, v26, v42
    v_dot2c_f32_bf16 v69, v34, v42
    v_dot2c_f32_bf16 v70, v76, v96
    v_dot2c_f32_bf16 v71, v78, v96
    v_cvt_pk_bf16_f32 v72, v72, v73
    v_cvt_pk_bf16_f32 v74, v74, v75
    v_dot2_f32_bf16 v76, v27, v59, 0
    v_dot2_f32_bf16 v77, v27, v67, 0
    v_dot2_f32_bf16 v78, v35, v59, 0
    v_dot2_f32_bf16 v79, v35, v67, 0
    v_dot2c_f32_bf16 v68, v27, v43
    v_dot2c_f32_bf16 v69, v35, v43
    v_dot2c_f32_bf16 v70, v72, v96
    v_dot2c_f32_bf16 v71, v74, v96
    v_cvt_pk_bf16_f32 v76, v76, v77
    v_cvt_pk_bf16_f32 v78, v78, v79
    v_dot2c_f32_bf16 v70, v76, v96
    v_dot2c_f32_bf16 v71, v78, v96
    s_add_u32 m0, s60, 32768
    s_nop 0
    buffer_load_dwordx4 v10, s[8:11], s61 offen offset:0 lds
    buffer_load_dwordx4 v11, s[8:11], s61 offen offset:1024 lds
    buffer_load_dwordx4 v12, s[8:11], s61 offen offset:2048 lds
    buffer_load_dwordx4 v13, s[8:11], s61 offen offset:3072 lds
    s_add_u32 m0, s60, 49152
    s_nop 0
    buffer_load_dwordx4 v14, s[12:15], s61 offen offset:0 lds
    buffer_load_dwordx4 v15, s[12:15], s61 offen offset:1024 lds
    buffer_load_dwordx4 v16, s[12:15], s61 offen offset:2048 lds
    buffer_load_dwordx4 v17, s[12:15], s61 offen offset:3072 lds
    s_add_u32 s61, s61, 128
    s_and_b32 s61, s61, 2047
    v_add_f32_dpp v68, v68, v68 row_shr:1 row_mask:0xf bank_mask:0xf
    v_add_f32_dpp v69, v69, v69 row_shr:1 row_mask:0xf bank_mask:0xf
    v_add_f32_dpp v70, v70, v70 row_shr:1 row_mask:0xf bank_mask:0xf
    v_add_f32_dpp v71, v71, v71 row_shr:1 row_mask:0xf bank_mask:0xf
    v_add_f32_dpp v68, v68, v68 row_shr:2 row_mask:0xf bank_mask:0xf
    v_add_f32_dpp v69, v69, v69 row_shr:2 row_mask:0xf bank_mask:0xf
    v_add_f32_dpp v70, v70, v70 row_shr:2 row_mask:0xf bank_mask:0xf
    v_add_f32_dpp v71, v71, v71 row_shr:2 row_mask:0xf bank_mask:0xf
    v_add_f32_dpp v68, v68, v68 row_shr:4 row_mask:0xf bank_mask:0xf
    v_add_f32_dpp v69, v69, v69 row_shr:4 row_mask:0xf bank_mask:0xf
    v_add_f32_dpp v70, v70, v70 row_shr:4 row_mask:0xf bank_mask:0xf
    v_add_f32_dpp v71, v71, v71 row_shr:4 row_mask:0xf bank_mask:0xf
    v_add_f32_dpp v68, v68, v68 row_shr:8 row_mask:0xf bank_mask:0xf
    v_add_f32_dpp v69, v69, v69 row_shr:8 row_mask:0xf bank_mask:0xf
    v_add_f32_dpp v70, v70, v70 row_shr:8 row_mask:0xf bank_mask:0xf
    v_add_f32_dpp v71, v71, v71 row_shr:8 row_mask:0xf bank_mask:0xf
    v_add_f32_dpp v68, v68, v68 row_bcast:15 row_mask:0xa bank_mask:0xf
    v_add_f32_dpp v69, v69, v69 row_bcast:15 row_mask:0xa bank_mask:0xf
    v_add_f32_dpp v70, v70, v70 row_bcast:15 row_mask:0xa bank_mask:0xf
    v_add_f32_dpp v71, v71, v71 row_bcast:15 row_mask:0xa bank_mask:0xf
    v_add_f32_dpp v68, v68, v68 row_bcast:31 row_mask:0xc bank_mask:0xf
    v_add_f32_dpp v69, v69, v69 row_bcast:31 row_mask:0xc bank_mask:0xf
    v_add_f32_dpp v70, v70, v70 row_bcast:31 row_mask:0xc bank_mask:0xf
    v_add_f32_dpp v71, v71, v71 row_bcast:31 row_mask:0xc bank_mask:0xf
    v_readlane_b32 s66, v69, 63
    v_readlane_b32 s67, v71, 63
    v_sub_u32 v74, 63, v1
    v_add_u32 v75, s62, v74
    v_sub_u32 v75, 2047, v75
    v_lshl_add_u32 v74, s30, 1, v74
    v_lshlrev_b32 v74, 3, v74
    v_add_u32 v74, 147520, v74
    v_writelane_b32 v68, s66, 62
    v_writelane_b32 v70, s67, 62
    v_cvt_pk_bf16_f32 v68, v68, v70
    v_and_b32 v70, 0xffff0000, v68
    v_lshlrev_b32 v68, 16, v68
    v_ashrrev_i32 v72, 31, v68
    v_or_b32 v72, 0x80000000, v72
    v_xor_b32 v72, v72, v68
    v_and_b32 v72, 0xffff0000, v72
    v_or_b32 v72, v72, v75
    v_mul_f32 v75, 0xbfb8aa3b, v70
    v_exp_f32 v75, v75
    s_nop 0
    v_add_f32 v75, 1.0, v75
    v_rcp_f32 v75, v75
    s_nop 0
    v_cvt_pk_bf16_f32 v76, v75, v75
    v_lshlrev_b32 v76, 16, v76
    v_sub_f32 v77, 1.0, v76
    v_cvt_pk_bf16_f32 v73, v76, v77
    s_mov_b32 exec_lo, 0
    s_mov_b32 exec_hi, 0xc0000000
    ds_write_b64 v74, v[72:73]
    s_mov_b64 exec, -1
    s_and_b32 s62, s62, 0xfff8
    s_lshl_b32 s62, s62, 3
    v_add_u32 v21, 147520, v19
    s_waitcnt vmcnt(8) lgkmcnt(0)
    s_barrier
    ds_read_b64 v[72:73], v21
    s_add_u32 m0, s60, 65536
    s_nop 0
    buffer_load_dwordx4 v10, s[8:11], s61 offen offset:0 lds
    buffer_load_dwordx4 v11, s[8:11], s61 offen offset:1024 lds
    buffer_load_dwordx4 v12, s[8:11], s61 offen offset:2048 lds
    buffer_load_dwordx4 v13, s[8:11], s61 offen offset:3072 lds
    s_add_u32 m0, s60, 81920
    s_nop 0
    buffer_load_dwordx4 v14, s[12:15], s61 offen offset:0 lds
    buffer_load_dwordx4 v15, s[12:15], s61 offen offset:1024 lds
    buffer_load_dwordx4 v16, s[12:15], s61 offen offset:2048 lds
    buffer_load_dwordx4 v17, s[12:15], s61 offen offset:3072 lds
    s_add_u32 s61, s61, 128
    s_and_b32 s61, s61, 2047
    s_add_u32 m0, s60, 98304
    s_nop 0
    buffer_load_dwordx4 v10, s[8:11], s61 offen offset:0 lds
    buffer_load_dwordx4 v11, s[8:11], s61 offen offset:1024 lds
    buffer_load_dwordx4 v12, s[8:11], s61 offen offset:2048 lds
    buffer_load_dwordx4 v13, s[8:11], s61 offen offset:3072 lds
    s_add_u32 m0, s60, 114688
    s_nop 0
    buffer_load_dwordx4 v14, s[12:15], s61 offen offset:0 lds
    buffer_load_dwordx4 v15, s[12:15], s61 offen offset:1024 lds
    buffer_load_dwordx4 v16, s[12:15], s61 offen offset:2048 lds
    buffer_load_dwordx4 v17, s[12:15], s61 offen offset:3072 lds
    s_add_u32 s61, s61, 128
    s_and_b32 s61, s61, 2047
    s_mul_i32 s65, s65, 1664525
    s_add_u32 s65, s65, 1013904223
    s_cmp_eq_u32 s32, 1
    s_cselect_b32 s84, s86, s84
    s_cselect_b32 s85, s87, s85
    s_add_u32 s84, s84, s64
    s_addc_u32 s85, s85, 0
    s_cmp_lg_u32 s30, 0
    s_cbranch_scc1 L_nopub
    s_add_u32 s66, s62, 32768
    s_add_u32 s67, s62, 8192
    s_waitcnt lgkmcnt(0)
    v_mov_b32 v74, v73
    v_mov_b32 v73, s65
    v_mov_b32 v75, s65
    s_mov_b64 exec, 0xff
    buffer_store_dwordx2 v[72:73], v19, s[16:19], s66 offen sc1
    buffer_store_dwordx2 v[74:75], v19, s[16:19], s67 offen sc1
    s_mov_b64 exec, -1
L_nopub:
    s_cmp_lg_u32 s56, 0
    s_cbranch_scc1 L_gapt_x_1
    s_swappc_b64 s[66:67], s[58:59]
L_gapt_x_1:
    s_waitcnt vmcnt(16)
    s_barrier
    s_mov_b32 s81, 1
    s_mov_b32 s82, 0
L_ld1:
    s_add_u32 m0, s60, s82
    s_add_u32 s83, s60, s82
    buffer_load_dwordx4 v10, s[8:11], s61 offen offset:0 lds
    buffer_load_dwordx4 v11, s[8:11], s61 offen offset:1024 lds
    buffer_load_dwordx4 v12, s[8:11], s61 offen offset:2048 lds
    buffer_load_dwordx4 v13, s[8:11], s61 offen offset:3072 lds
    s_add_u32 m0, s83, 16384
    s_add_u32 s82, s82, 32768
    buffer_load_dwordx4 v14, s[12:15], s61 offen offset:0 lds
    buffer_load_dwordx4 v15, s[12:15], s61 offen offset:1024 lds
    buffer_load_dwordx4 v16, s[12:15], s61 offen offset:2048 lds
    buffer_load_dwordx4 v17, s[12:15], s61 offen offset:3072 lds
    s_and_b32 s82, s82, 131071
    s_add_u32 s61, s61, 128
    s_and_b32 s61, s61, 2047
    s_cmp_lg_u32 s80, s81
    s_cbranch_scc1 L_nowu
    s_add_u32 s74, s73, 0
    buffer_load_dwordx4 v[128:131], v228, s[52:55], s74 offen nt
    s_add_u32 s74, s73, 57344
    buffer_load_dwordx4 v[132:135], v228, s[52:55], s74 offen nt
    s_add_u32 s74, s73, 114688
    buffer_load_dwordx4 v[136:139], v228, s[52:55], s74 offen nt
    s_add_u32 s74, s73, 172032
    buffer_load_dwordx4 v[140:143], v228, s[52:55], s74 offen nt
    s_add_u32 s74, s73, 229376
    buffer_load_dwordx4 v[144:147], v228, s[52:55], s74 offen nt
    s_add_u32 s74, s73, 286720
    buffer_load_dwordx4 v[148:151], v228, s[52:55], s74 offen nt
    s_add_u32 s74, s73, 344064
    buffer_load_dwordx4 v[152:155], v228, s[52:55], s74 offen nt
    s_add_u32 s74, s73, 401408
    buffer_load_dwordx4 v[156:159], v228, s[52:55], s74 offen nt
    buffer_load_dwordx4 v[200:203], v229, s[44:47], s35 offen nt
    s_add_u32 s35, s35, 16384
    buffer_load_dwordx4 v[204:207], v229, s[44:47], s35 offen nt
    s_add_u32 s35, s35, 16384
    buffer_load_dwordx4 v[208:211], v229, s[44:47], s35 offen nt
    s_add_u32 s35, s35, 16384
    buffer_load_dwordx4 v[212:215], v229, s[44:47], s35 offen nt
    s_add_u32 s35, s35, 16384
    buffer_load_dwordx4 v[216:219], v229, s[44:47], s35 offen nt
    s_add_u32 s35, s35, 16384
    buffer_load_dwordx4 v[220:223], v229, s[44:47], s35 offen nt
    s_add_u32 s35, s35, 16384
    buffer_load_dwordx4 v[224:227], v229, s[44:47], s35 offen nt
L_nowu:
    s_cmp_lg_u32 s56, s81
    s_cbranch_scc1 L_gapt_x_2
    s_swappc_b64 s[66:67], s[58:59]
L_gapt_x_2:
    s_add_u32 s81, s81, 1
    s_cmp_lt_u32 s81, 13
    s_waitcnt vmcnt(16)
    s_barrier
    s_cbranch_scc1 L_ld1
    buffer_load_dwordx4 v[80:83], v18, s[16:19], s69 offen offset:0 sc1
    buffer_load_dwordx4 v[84:87], v18, s[16:19], s69 offen offset:1024 sc1
    buffer_load_dwordx4 v[88:91], v18, s[16:19], s69 offen offset:2048 sc1
    buffer_load_dwordx4 v[92:95], v18, s[16:19], s69 offen offset:3072 sc1
    v_and_b32 v13, 15, v1
    v_lshlrev_b32 v12, 3, v13
    v_lshlrev_b32 v11, 3, v1
    s_lshl_b32 s34, s21, 3
    s_add_u32 s34, s34, 8192
    buffer_load_dwordx2 v[250:251], v11, s[16:19], s34 offen sc1
    buffer_load_dwordx2 v[248:249], v12, s[36:39], s22 offen
    s_add_u32 m0, s75, 0
    s_add_u32 s74, s73, 0
    buffer_load_dwordx4 v228, s[48:51], s74 offen nt lds
    s_add_u32 m0, s75, 1024
    s_add_u32 s74, s73, 57344
    buffer_load_dwordx4 v228, s[48:51], s74 offen nt lds
    s_add_u32 m0, s75, 2048
    s_add_u32 s74, s73, 114688
    buffer_load_dwordx4 v228, s[48:51], s74 offen nt lds
    s_add_u32 m0, s75, 3072
    s_add_u32 s74, s73, 172032
    buffer_load_dwordx4 v228, s[48:51], s74 offen nt lds
    s_add_u32 m0, s75, 4096
    s_add_u32 s74, s73, 229376
    buffer_load_dwordx4 v228, s[48:51], s74 offen nt lds
    s_add_u32 m0, s75, 5120
    s_add_u32 s74, s73, 286720
    buffer_load_dwordx4 v228, s[48:51], s74 offen nt lds
    s_add_u32 m0, s75, 6144
    s_add_u32 s74, s73, 344064
    buffer_load_dwordx4 v228, s[48:51], s74 offen nt lds
    s_add_u32 m0, s75, 7168
    s_add_u32 s74, s73, 401408
    buffer_load_dwordx4 v228, s[48:51], s74 offen nt lds
    s_cmp_lg_u32 s56, 13
    s_cbranch_scc1 L_gapt_x_3
    s_swappc_b64 s[66:67], s[58:59]
L_gapt_x_3:
    s_waitcnt vmcnt(22)
    s_barrier
    s_cmp_lg_u32 s56, 14
    s_cbranch_scc1 L_gapt_x_4
    s_swappc_b64 s[66:67], s[58:59]
L_gapt_x_4:
    v_add_u32 v33, s75, v18
    ds_write_b128 v33, v[128:131] offset:32768
    ds_write_b128 v33, v[132:135] offset:33792
    ds_write_b128 v33, v[136:139] offset:34816
    ds_write_b128 v33, v[140:143] offset:35840
    ds_write_b128 v33, v[144:147] offset:36864
    ds_write_b128 v33, v[148:151] offset:37888
    ds_write_b128 v33, v[152:155] offset:38912
    ds_write_b128 v33, v[156:159] offset:39936
    s_mov_b32 s8, s84
    s_mov_b32 s9, s85
    s_sub_u32 s10, 2097152, s64
    s_lshl_b32 s60, s32, 13
    s_lshl_b32 s35, s31, 12
    s_add_u32 s60, s60, s35
    s_add_u32 s60, s60, 65536
    s_lshr_b32 s61, s25, 3
    s_lshl_b32 s62, s24, 1
    s_add_u32 s61, s61, s62
    s_and_b32 s61, s61, 15
    s_lshl_b32 s61, s61, 7
    s_waitcnt vmcnt(14)
    s_barrier
    s_add_u32 m0, s60, 0
    s_nop 0
    buffer_load_dwordx4 v14, s[8:11], s61 offen offset:0 lds
    buffer_load_dwordx4 v15, s[8:11], s61 offen offset:1024 lds
    buffer_load_dwordx4 v16, s[8:11], s61 offen offset:2048 lds
    buffer_load_dwordx4 v17, s[8:11], s61 offen offset:3072 lds
    s_add_u32 s61, s61, 128
    s_and_b32 s61, s61, 2047
    s_add_u32 m0, s60, 16384
    s_nop 0
    buffer_load_dwordx4 v14, s[8:11], s61 offen offset:0 lds
    buffer_load_dwordx4 v15, s[8:11], s61 offen offset:1024 lds
    buffer_load_dwordx4 v16, s[8:11], s61 offen offset:2048 lds
    buffer_load_dwordx4 v17, s[8:11], s61 offen offset:3072 lds
    s_add_u32 s61, s61, 128
    s_and_b32 s61, s61, 2047
    s_cmp_lg_u32 s56, 15
    s_cbranch_scc1 L_gapt_x_5
    s_swappc_b64 s[66:67], s[58:59]
L_gapt_x_5:
    s_waitcnt vmcnt(18)
    s_mov_b32 s68, 32768
L_keypoll:
    v_xor_b32 v20, s65, v81
    v_xor_b32 v21, s65, v83
    v_or_b32 v20, v20, v21
    v_xor_b32 v21, s65, v85
    v_or_b32 v20, v20, v21
    v_xor_b32 v21, s65, v87
    v_or_b32 v20, v20, v21
    v_xor_b32 v21, s65, v89
    v_or_b32 v20, v20, v21
    v_xor_b32 v21, s65, v91
    v_or_b32 v20, v20, v21
    v_xor_b32 v21, s65, v93
    v_or_b32 v20, v20, v21
    v_xor_b32 v21, s65, v95
    v_or_b32 v20, v20, v21
    v_cmp_ne_u32 vcc, 0, v20
    s_cbranch_vccz L_keyok
    s_sub_u32 s68, s68, 1
    s_cbranch_scc1 L_keyok
    buffer_load_dwordx4 v[80:83], v18, s[16:19], s69 offen offset:0 sc1
    buffer_load_dwordx4 v[84:87], v18, s[16:19], s69 offen offset:1024 sc1
    buffer_load_dwordx4 v[88:91], v18, s[16:19], s69 offen offset:2048 sc1
    buffer_load_dwordx4 v[92:95], v18, s[16:19], s69 offen offset:3072 sc1
    s_waitcnt vmcnt(0)
    s_branch L_keypoll
L_keyok:
    s_or_b32 s66, s2, s30
    s_cmp_lg_u32 s66, 0
    s_cbranch_scc1 L_nogen
    v_mov_b32 v20, s65
    s_mov_b64 exec, 1
    buffer_store_dword v20, v9, s[16:19], 0 offen offset:0 sc1
    s_mov_b64 exec, -1
L_nogen:
    s_mov_b32 s76, 0
    s_mov_b64 s[78:79], 1
L_top:
    v_subrev_u32 v22, s76, v80
    v_subrev_u32 v23, s76, v82
    v_subrev_u32 v24, s76, v84
    v_subrev_u32 v25, s76, v86
    v_subrev_u32 v26, s76, v88
    v_subrev_u32 v27, s76, v90
    v_subrev_u32 v28, s76, v92
    v_subrev_u32 v29, s76, v94
    v_max3_u32 v22, v22, v23, v24
    v_max3_u32 v25, v25, v26, v27
    v_max3_u32 v22, v22, v28, v29
    v_max_u32 v22, v22, v25
    s_nop 1
    v_max_u32_dpp v22, v22, v22 row_shr:1 row_mask:0xf bank_mask:0xf
    s_nop 1
    v_max_u32_dpp v22, v22, v22 row_shr:2 row_mask:0xf bank_mask:0xf
    s_nop 1
    v_max_u32_dpp v22, v22, v22 row_shr:4 row_mask:0xf bank_mask:0xf
    s_nop 1
    v_max_u32_dpp v22, v22, v22 row_shr:8 row_mask:0xf bank_mask:0xf
    s_nop 1
    v_max_u32_dpp v22, v22, v22 row_bcast:15 row_mask:0xa bank_mask:0xf
    s_nop 1
    v_max_u32_dpp v22, v22, v22 row_bcast:31 row_mask:0xc bank_mask:0xf
    s_nop 0
    v_readlane_b32 s77, v22, 63
    s_mov_b64 exec, s[78:79]
    s_add_u32 s76, s76, s77
    v_mov_b32 v30, s76
    s_mov_b64 exec, -1
    s_lshl_b32 s78, s78, 1
    s_cmp_lg_u32 s78, 256
    s_cbranch_scc1 L_top
    s_lshl_b32 s76, s30, 5
    v_lshl_add_u32 v32, v1, 2, s76
    v_add_u32 v32, 147712, v32
    v_mov_b32 v35, 1
    s_mov_b64 exec, 0xff
    ds_write_b32 v32, v30
    s_mov_b64 exec, 1
    ds_add_u32 v7, v35 offset:20
    s_mov_b64 exec, -1
    v_and_b32 v32, 31, v1
    v_lshlrev_b32 v32, 2, v32
    v_add_u32 v32, 147712, v32
    v_lshrrev_b32 v33, 5, v1
    v_lshlrev_b32 v33, 6, v33
    v_add_u32 v33, 147712, v33
    s_add_u32 s76, s76, 147968
    s_mov_b32 s68, 32768
L_candpoll:
    ds_read_b32 v35, v7 offset:20
    ds_read_b32 v34, v32
    ds_read_b128 v[36:39], v33 offset:0
    ds_read_b128 v[40:43], v33 offset:16
    ds_read_b128 v[44:47], v33 offset:32
    ds_read_b128 v[48:51], v33 offset:48
    s_waitcnt lgkmcnt(0)
    v_readfirstlane_b32 s77, v35
    s_sub_u32 s68, s68, 1
    s_cbranch_scc1 L_candok
    s_cmp_lg_u32 s77, 4
    s_cbranch_scc1 L_candpoll
L_candok:
    v_mov_b32 v35, 0
    v_cmp_gt_u32 s[78:79], v36, v34
    v_cmp_gt_u32 s[80:81], v37, v34
    v_cmp_gt_u32 s[82:83], v38, v34
    v_addc_co_u32 v35, vcc, 0, v35, s[78:79]
    v_cmp_gt_u32 s[78:79], v39, v34
    v_addc_co_u32 v35, vcc, 0, v35, s[80:81]
    v_cmp_gt_u32 s[80:81], v40, v34
    v_addc_co_u32 v35, vcc, 0, v35, s[82:83]
    v_cmp_gt_u32 s[82:83], v41, v34
    v_addc_co_u32 v35, vcc, 0, v35, s[78:79]
    v_cmp_gt_u32 s[78:79], v42, v34
    v_addc_co_u32 v35, vcc, 0, v35, s[80:81]
    v_cmp_gt_u32 s[80:81], v43, v34
    v_addc_co_u32 v35, vcc, 0, v35, s[82:83]
    v_cmp_gt_u32 s[82:83], v44, v34
    v_addc_co_u32 v35, vcc, 0, v35, s[78:79]
    v_cmp_gt_u32 s[78:79], v45, v34
    v_addc_co_u32 v35, vcc, 0, v35, s[80:81]
    v_cmp_gt_u32 s[80:81], v46, v34
    v_addc_co_u32 v35, vcc, 0, v35, s[82:83]
    v_cmp_gt_u32 s[82:83], v47, v34
    v_addc_co_u32 v35, vcc, 0, v35, s[78:79]
    v_cmp_gt_u32 s[78:79], v48, v34
    v_addc_co_u32 v35, vcc, 0, v35, s[80:81]
    v_cmp_gt_u32 s[80:81], v49, v34
    v_addc_co_u32 v35, vcc, 0, v35, s[82:83]
    v_cmp_gt_u32 s[82:83], v50, v34
    v_addc_co_u32 v35, vcc, 0, v35, s[78:79]
    v_cmp_gt_u32 s[78:79], v51, v34
    v_addc_co_u32 v35, vcc, 0, v35, s[80:81]
    v_addc_co_u32 v35, vcc, 0, v35, s[82:83]
    v_addc_co_u32 v35, vcc, 0, v35, s[78:79]
    v_mov_b32 v36, v35
    v_lshlrev_b32 v32, 4, v6
    s_nop 0
    v_permlane32_swap_b32 v35, v36
    v_add_u32 v35, v35, v36
    v_cmp_gt_u32 vcc, 8, v35
    v_lshl_add_u32 v35, v35, 2, s76
    v_lshl_add_u32 v36, v4, 2, s76
    s_and_saveexec_b64 s[66:67], vcc
    ds_write_b32 v35, v34
    s_mov_b64 exec, -1
    ds_read_b32 v30, v36
    s_lshl_b32 s76, s72, 1
    s_waitcnt lgkmcnt(0)
    v_and_b32 v252, 0x7ff, v30
    v_sub_u32 v252, 2047, v252
    v_lshl_add_u32 v32, v252, 11, v32
    buffer_load_dwordx4 v[36:39], v32, s[4:7], s76 offen offset:0
    buffer_load_dwordx4 v[40:43], v32, s[4:7], s76 offen offset:64
    v_ashrrev_i32 v33, 31, v30
    v_not_b32 v33, v33
    v_or_b32 v33, 0x80000000, v33
    v_xor_b32 v33, v33, v30
    v_and_b32 v33, 0xffff0000, v33
    v_mul_f32 v35, 0xbfb8aa3b, v33
    v_exp_f32 v35, v35
    s_nop 0
    v_add_f32 v35, 1.0, v35
    v_rcp_f32 v35, v35
    s_nop 0
    v_cvt_pk_bf16_f32 v253, v35, v35
    v_lshlrev_b32 v253, 16, v253
    v_bfe_u32 v34, v1, 2, 2
    v_lshl_add_u32 v33, v6, 3, v34
    v_lshlrev_b32 v33, 7, v33
    v_and_b32 v34, 3, v1
    v_lshl_add_u32 v5, v34, 3, v33
    v_add_u32 v33, s75, v5
    s_cmp_ge_u32 s2, 224
    s_cbranch_scc1 L_gudone
    ds_read_b64_tr_b16 v[160:161], v33 offset:32768
    ds_read_b64_tr_b16 v[162:163], v33 offset:33280
    ds_read_b64_tr_b16 v[164:165], v33 offset:32800
    ds_read_b64_tr_b16 v[166:167], v33 offset:33312
    ds_read_b64_tr_b16 v[168:169], v33 offset:32832
    ds_read_b64_tr_b16 v[170:171], v33 offset:33344
    ds_read_b64_tr_b16 v[172:173], v33 offset:32864
    ds_read_b64_tr_b16 v[174:175], v33 offset:33376
    ds_read_b64_tr_b16 v[176:177], v33 offset:36864
    ds_read_b64_tr_b16 v[178:179], v33 offset:37376
    ds_read_b64_tr_b16 v[180:181], v33 offset:36896
    ds_read_b64_tr_b16 v[182:183], v33 offset:37408
    ds_read_b64_tr_b16 v[184:185], v33 offset:36928
    ds_read_b64_tr_b16 v[186:187], v33 offset:37440
    ds_read_b64_tr_b16 v[188:189], v33 offset:36960
    ds_read_b64_tr_b16 v[190:191], v33 offset:37472
    s_waitcnt vmcnt(0)
    s_waitcnt lgkmcnt(8)
    v_mfma_f32_16x16x32_bf16 v[112:115], v[36:39], v[160:163], 0
    v_mfma_f32_16x16x32_bf16 v[116:119], v[36:39], v[164:167], 0
    v_mfma_f32_16x16x32_bf16 v[120:123], v[36:39], v[168:171], 0
    v_mfma_f32_16x16x32_bf16 v[124:127], v[36:39], v[172:175], 0
    s_waitcnt lgkmcnt(0)
    v_mfma_f32_16x16x32_bf16 v[112:115], v[40:43], v[176:179], v[112:115]
    v_mfma_f32_16x16x32_bf16 v[116:119], v[40:43], v[180:183], v[116:119]
    v_mfma_f32_16x16x32_bf16 v[120:123], v[40:43], v[184:187], v[120:123]
    v_mfma_f32_16x16x32_bf16 v[124:127], v[40:43], v[188:191], v[124:127]
    ds_read_b64_tr_b16 v[160:161], v33 offset:0
    ds_read_b64_tr_b16 v[162:163], v33 offset:512
    ds_read_b64_tr_b16 v[164:165], v33 offset:32
    ds_read_b64_tr_b16 v[166:167], v33 offset:544
    ds_read_b64_tr_b16 v[168:169], v33 offset:64
    ds_read_b64_tr_b16 v[170:171], v33 offset:576
    ds_read_b64_tr_b16 v[172:173], v33 offset:96
    ds_read_b64_tr_b16 v[174:175], v33 offset:608
    ds_read_b64_tr_b16 v[176:177], v33 offset:4096
    ds_read_b64_tr_b16 v[178:179], v33 offset:4608
    ds_read_b64_tr_b16 v[180:181], v33 offset:4128
    ds_read_b64_tr_b16 v[182:183], v33 offset:4640
    ds_read_b64_tr_b16 v[184:185], v33 offset:4160
    ds_read_b64_tr_b16 v[186:187], v33 offset:4672
    ds_read_b64_tr_b16 v[188:189], v33 offset:4192
    ds_read_b64_tr_b16 v[190:191], v33 offset:4704
    s_waitcnt lgkmcnt(8)
    v_mfma_f32_16x16x32_bf16 v[96:99], v[36:39], v[160:163], 0
    v_mfma_f32_16x16x32_bf16 v[100:103], v[36:39], v[164:167], 0
    v_mfma_f32_16x16x32_bf16 v[104:107], v[36:39], v[168:171], 0
    v_mfma_f32_16x16x32_bf16 v[108:111], v[36:39], v[172:175], 0
    s_waitcnt lgkmcnt(0)
    v_mfma_f32_16x16x32_bf16 v[96:99], v[40:43], v[176:179], v[96:99]
    v_mfma_f32_16x16x32_bf16 v[100:103], v[40:43], v[180:183], v[100:103]
    v_mfma_f32_16x16x32_bf16 v[104:107], v[40:43], v[184:187], v[104:107]
    v_mfma_f32_16x16x32_bf16 v[108:111], v[40:43], v[188:191], v[108:111]
    v_lshl_add_u32 v34, v1, 4, s75
    s_mov_b64 exec, 0xffffffff
    s_nop 2
    ds_write_b128 v34, v[96:99] offset:0
    ds_write_b128 v34, v[100:103] offset:512
    ds_write_b128 v34, v[104:107] offset:1024
    ds_write_b128 v34, v[108:111] offset:1536
    ds_write_b128 v34, v[112:115] offset:2048
    ds_write_b128 v34, v[116:119] offset:2560
    ds_write_b128 v34, v[120:123] offset:3072
    ds_write_b128 v34, v[124:127] offset:3584
    s_mov_b64 exec, 1
    v_mov_b32 v35, 1
    ds_add_rtn_u32 v35, v7, v35 offset:16
    s_mov_b64 exec, -1
    s_waitcnt lgkmcnt(0)
    v_readfirstlane_b32 s76, v35
    s_cmp_lg_u32 s76, 3
    s_cbranch_scc1 L_gudone
    ds_read_b128 v[96:99], v18 offset:0
    ds_read_b128 v[100:103], v18 offset:1024
    ds_read_b128 v[104:107], v18 offset:2048
    ds_read_b128 v[108:111], v18 offset:3072
    ds_read_b128 v[112:115], v18 offset:8192
    ds_read_b128 v[116:119], v18 offset:9216
    ds_read_b128 v[120:123], v18 offset:10240
    ds_read_b128 v[124:127], v18 offset:11264
    ds_read_b128 v[128:131], v18 offset:16384
    ds_read_b128 v[132:135], v18 offset:17408
    ds_read_b128 v[136:139], v18 offset:18432
    ds_read_b128 v[140:143], v18 offset:19456
    ds_read_b128 v[144:147], v18 offset:24576
    ds_read_b128 v[148:151], v18 offset:25600
    ds_read_b128 v[152:155], v18 offset:26624
    ds_read_b128 v[156:159], v18 offset:27648
    v_lshrrev_b32 v35, 5, v1
    v_lshlrev_b32 v35, 13, v35
    v_and_b32 v36, 31, v1
    v_lshl_add_u32 v35, v36, 4, v35
    s_lshl_b32 s76, s71, 15
    s_lshl_b32 s77, s70, 11
    s_add_u32 s76, s76, s77
    s_add_u32 s76, s76, 524288
    s_add_u32 s77, s76, 16384
    v_mov_b32 v42, s65
    v_mov_b32 v43, s65
    v_mov_b32 v46, s65
    v_mov_b32 v47, s65
    s_waitcnt lgkmcnt(0)
    v_pk_add_f32 v[96:97], v[96:97], v[112:113]
    v_pk_add_f32 v[128:129], v[128:129], v[144:145]
    v_pk_add_f32 v[40:41], v[96:97], v[128:129]
    buffer_store_dwordx4 v[40:43], v35, s[16:19], s76 offen offset:0 sc1
    v_pk_add_f32 v[98:99], v[98:99], v[114:115]
    v_pk_add_f32 v[130:131], v[130:131], v[146:147]
    v_pk_add_f32 v[44:45], v[98:99], v[130:131]
    buffer_store_dwordx4 v[44:47], v35, s[16:19], s76 offen offset:1024 sc1
    v_pk_add_f32 v[100:101], v[100:101], v[116:117]
    v_pk_add_f32 v[132:133], v[132:133], v[148:149]
    v_pk_add_f32 v[40:41], v[100:101], v[132:133]
    buffer_store_dwordx4 v[40:43], v35, s[16:19], s77 offen offset:0 sc1
    v_pk_add_f32 v[102:103], v[102:103], v[118:119]
    v_pk_add_f32 v[134:135], v[134:135], v[150:151]
    v_pk_add_f32 v[44:45], v[102:103], v[134:135]
    buffer_store_dwordx4 v[44:47], v35, s[16:19], s77 offen offset:1024 sc1
    v_pk_add_f32 v[104:105], v[104:105], v[120:121]
    v_pk_add_f32 v[136:137], v[136:137], v[152:153]
    v_pk_add_f32 v[40:41], v[104:105], v[136:137]
    buffer_store_dwordx4 v[40:43], v35, s[16:19], s76 offen offset:512 sc1
    v_pk_add_f32 v[106:107], v[106:107], v[122:123]
    v_pk_add_f32 v[138:139], v[138:139], v[154:155]
    v_pk_add_f32 v[44:45], v[106:107], v[138:139]
    buffer_store_dwordx4 v[44:47], v35, s[16:19], s76 offen offset:1536 sc1
    v_pk_add_f32 v[108:109], v[108:109], v[124:125]
    v_pk_add_f32 v[140:141], v[140:141], v[156:157]
    v_pk_add_f32 v[40:41], v[108:109], v[140:141]
    buffer_store_dwordx4 v[40:43], v35, s[16:19], s77 offen offset:512 sc1
    v_pk_add_f32 v[110:111], v[110:111], v[126:127]
    v_pk_add_f32 v[142:143], v[142:143], v[158:159]
    v_pk_add_f32 v[44:45], v[110:111], v[142:143]
    buffer_store_dwordx4 v[44:47], v35, s[16:19], s77 offen offset:1536 sc1
L_gudone:
    s_waitcnt vmcnt(18)
    s_mov_b32 s68, 32768
L_gpoll:
    v_cmp_ne_u32 vcc, s65, v251
    s_and_b32 vcc_hi, vcc_hi, 0
    s_cbranch_vccz L_gok
    s_sub_u32 s68, s68, 1
    s_cbranch_scc1 L_gok
    buffer_load_dwordx2 v[250:251], v11, s[16:19], s34 offen sc1
    s_waitcnt vmcnt(0)
    s_branch L_gpoll
L_gok:
    v_lshlrev_b32 v8, 2, v6
    ds_bpermute_b32 v100, v8, v250 offset:0
    ds_bpermute_b32 v102, v8, v250 offset:16
    ds_bpermute_b32 v104, v8, v250 offset:32
    ds_bpermute_b32 v106, v8, v250 offset:48
    ds_bpermute_b32 v108, v8, v250 offset:64
    ds_bpermute_b32 v110, v8, v250 offset:80
    ds_bpermute_b32 v112, v8, v250 offset:96
    ds_bpermute_b32 v114, v8, v250 offset:112
    v_and_b32 v119, 0xffff0000, v249
    v_lshlrev_b32 v118, 16, v249
    v_and_b32 v117, 0xffff0000, v248
    v_lshlrev_b32 v116, 16, v248
    s_cmp_ge_u32 s2, 224
    s_cselect_b32 s67, 0, 4
    s_mov_b32 s68, 32768
L_wdpoll:
    ds_read_b32 v20, v7 offset:16
    s_waitcnt lgkmcnt(0)
    v_readfirstlane_b32 s33, v20
    s_sub_u32 s68, s68, 1
    s_cbranch_scc1 L_wdok
    s_cmp_lg_u32 s33, s67
    s_cbranch_scc1 L_wdpoll
L_wdok:
    v_add_u32 v20, s23, v18
    ds_write_b128 v20, v[200:203] offset:32768
    ds_write_b128 v20, v[204:207] offset:33792
    ds_write_b128 v20, v[208:211] offset:34816
    ds_write_b128 v20, v[212:215] offset:35840
    ds_write_b128 v20, v[216:219] offset:36864
    ds_write_b128 v20, v[220:223] offset:37888
    ds_write_b128 v20, v[224:227] offset:38912
    v_and_b32 v101, 0xffff0000, v100
    v_lshlrev_b32 v100, 16, v100
    v_and_b32 v103, 0xffff0000, v102
    v_lshlrev_b32 v102, 16, v102
    v_and_b32 v105, 0xffff0000, v104
    v_lshlrev_b32 v104, 16, v104
    v_and_b32 v107, 0xffff0000, v106
    v_lshlrev_b32 v106, 16, v106
    v_and_b32 v109, 0xffff0000, v108
    v_lshlrev_b32 v108, 16, v108
    v_and_b32 v111, 0xffff0000, v110
    v_lshlrev_b32 v110, 16, v110
    v_and_b32 v113, 0xffff0000, v112
    v_lshlrev_b32 v112, 16, v112
    v_and_b32 v115, 0xffff0000, v114
    v_lshlrev_b32 v114, 16, v114
    v_lshlrev_b32 v152, 16, v232
    v_and_b32 v153, 0xffff0000, v232
    v_pk_mul_f32 v[154:155], v[152:153], v[116:117]
    v_pk_mul_f32 v[152:153], v[100:101], v[152:153] op_sel:[1,0]
    v_cvt_pk_bf16_f32 v154, v154, v155
    v_cvt_pk_bf16_f32 v152, v152, v153
    v_and_b32 v155, 0xffff0000, v154
    v_lshlrev_b32 v154, 16, v154
    v_and_b32 v153, 0xffff0000, v152
    v_lshlrev_b32 v152, 16, v152
    v_pk_fma_f32 v[120:121], v[100:101], v[154:155], v[152:153] op_sel_hi:[0,1,1]
    v_lshlrev_b32 v152, 16, v233
    v_and_b32 v153, 0xffff0000, v233
    v_pk_mul_f32 v[154:155], v[152:153], v[118:119]
    v_pk_mul_f32 v[152:153], v[100:101], v[152:153] op_sel:[1,0]
    v_cvt_pk_bf16_f32 v154, v154, v155
    v_cvt_pk_bf16_f32 v152, v152, v153
    v_and_b32 v155, 0xffff0000, v154
    v_lshlrev_b32 v154, 16, v154
    v_and_b32 v153, 0xffff0000, v152
    v_lshlrev_b32 v152, 16, v152
    v_pk_fma_f32 v[122:123], v[100:101], v[154:155], v[152:153] op_sel_hi:[0,1,1]
    v_lshlrev_b32 v152, 16, v234
    v_and_b32 v153, 0xffff0000, v234
    v_pk_mul_f32 v[154:155], v[152:153], v[116:117]
    v_pk_mul_f32 v[152:153], v[102:103], v[152:153] op_sel:[1,0]
    v_cvt_pk_bf16_f32 v154, v154, v155
    v_cvt_pk_bf16_f32 v152, v152, v153
    v_and_b32 v155, 0xffff0000, v154
    v_lshlrev_b32 v154, 16, v154
    v_and_b32 v153, 0xffff0000, v152
    v_lshlrev_b32 v152, 16, v152
    v_pk_fma_f32 v[124:125], v[102:103], v[154:155], v[152:153] op_sel_hi:[0,1,1]
    v_lshlrev_b32 v152, 16, v235
    v_and_b32 v153, 0xffff0000, v235
    v_pk_mul_f32 v[154:155], v[152:153], v[118:119]
    v_pk_mul_f32 v[152:153], v[102:103], v[152:153] op_sel:[1,0]
    v_cvt_pk_bf16_f32 v154, v154, v155
    v_cvt_pk_bf16_f32 v152, v152, v153
    v_and_b32 v155, 0xffff0000, v154
    v_lshlrev_b32 v154, 16, v154
    v_and_b32 v153, 0xffff0000, v152
    v_lshlrev_b32 v152, 16, v152
    v_pk_fma_f32 v[126:127], v[102:103], v[154:155], v[152:153] op_sel_hi:[0,1,1]
    v_lshlrev_b32 v152, 16, v236
    v_and_b32 v153, 0xffff0000, v236
    v_pk_mul_f32 v[154:155], v[152:153], v[116:117]
    v_pk_mul_f32 v[152:153], v[104:105], v[152:153] op_sel:[1,0]
    v_cvt_pk_bf16_f32 v154, v154, v155
    v_cvt_pk_bf16_f32 v152, v152, v153
    v_and_b32 v155, 0xffff0000, v154
    v_lshlrev_b32 v154, 16, v154
    v_and_b32 v153, 0xffff0000, v152
    v_lshlrev_b32 v152, 16, v152
    v_pk_fma_f32 v[128:129], v[104:105], v[154:155], v[152:153] op_sel_hi:[0,1,1]
    v_lshlrev_b32 v152, 16, v237
    v_and_b32 v153, 0xffff0000, v237
    v_pk_mul_f32 v[154:155], v[152:153], v[118:119]
    v_pk_mul_f32 v[152:153], v[104:105], v[152:153] op_sel:[1,0]
    v_cvt_pk_bf16_f32 v154, v154, v155
    v_cvt_pk_bf16_f32 v152, v152, v153
    v_and_b32 v155, 0xffff0000, v154
    v_lshlrev_b32 v154, 16, v154
    v_and_b32 v153, 0xffff0000, v152
    v_lshlrev_b32 v152, 16, v152
    v_pk_fma_f32 v[130:131], v[104:105], v[154:155], v[152:153] op_sel_hi:[0,1,1]
    v_lshlrev_b32 v152, 16, v238
    v_and_b32 v153, 0xffff0000, v238
    v_pk_mul_f32 v[154:155], v[152:153], v[116:117]
    v_pk_mul_f32 v[152:153], v[106:107], v[152:153] op_sel:[1,0]
    v_cvt_pk_bf16_f32 v154, v154, v155
    v_cvt_pk_bf16_f32 v152, v152, v153
    v_and_b32 v155, 0xffff0000, v154
    v_lshlrev_b32 v154, 16, v154
    v_and_b32 v153, 0xffff0000, v152
    v_lshlrev_b32 v152, 16, v152
    v_pk_fma_f32 v[132:133], v[106:107], v[154:155], v[152:153] op_sel_hi:[0,1,1]
    v_lshlrev_b32 v152, 16, v239
    v_and_b32 v153, 0xffff0000, v239
    v_pk_mul_f32 v[154:155], v[152:153], v[118:119]
    v_pk_mul_f32 v[152:153], v[106:107], v[152:153] op_sel:[1,0]
    v_cvt_pk_bf16_f32 v154, v154, v155
    v_cvt_pk_bf16_f32 v152, v152, v153
    v_and_b32 v155, 0xffff0000, v154
    v_lshlrev_b32 v154, 16, v154
    v_and_b32 v153, 0xffff0000, v152
    v_lshlrev_b32 v152, 16, v152
    v_pk_fma_f32 v[134:135], v[106:107], v[154:155], v[152:153] op_sel_hi:[0,1,1]
    v_lshlrev_b32 v152, 16, v240
    v_and_b32 v153, 0xffff0000, v240
    v_pk_mul_f32 v[154:155], v[152:153], v[116:117]
    v_pk_mul_f32 v[152:153], v[108:109], v[152:153] op_sel:[1,0]
    v_cvt_pk_bf16_f32 v154, v154, v155
    v_cvt_pk_bf16_f32 v152, v152, v153
    v_and_b32 v155, 0xffff0000, v154
    v_lshlrev_b32 v154, 16, v154
    v_and_b32 v153, 0xffff0000, v152
    v_lshlrev_b32 v152, 16, v152
    v_pk_fma_f32 v[136:137], v[108:109], v[154:155], v[152:153] op_sel_hi:[0,1,1]
    v_lshlrev_b32 v152, 16, v241
    v_and_b32 v153, 0xffff0000, v241
    v_pk_mul_f32 v[154:155], v[152:153], v[118:119]
    v_pk_mul_f32 v[152:153], v[108:109], v[152:153] op_sel:[1,0]
    v_cvt_pk_bf16_f32 v154, v154, v155
    v_cvt_pk_bf16_f32 v152, v152, v153
    v_and_b32 v155, 0xffff0000, v154
    v_lshlrev_b32 v154, 16, v154
    v_and_b32 v153, 0xffff0000, v152
    v_lshlrev_b32 v152, 16, v152
    v_pk_fma_f32 v[138:139], v[108:109], v[154:155], v[152:153] op_sel_hi:[0,1,1]
    v_lshlrev_b32 v152, 16, v242
    v_and_b32 v153, 0xffff0000, v242
    v_pk_mul_f32 v[154:155], v[152:153], v[116:117]
    v_pk_mul_f32 v[152:153], v[110:111], v[152:153] op_sel:[1,0]
    v_cvt_pk_bf16_f32 v154, v154, v155
    v_cvt_pk_bf16_f32 v152, v152, v153
    v_and_b32 v155, 0xffff0000, v154
    v_lshlrev_b32 v154, 16, v154
    v_and_b32 v153, 0xffff0000, v152
    v_lshlrev_b32 v152, 16, v152
    v_pk_fma_f32 v[140:141], v[110:111], v[154:155], v[152:153] op_sel_hi:[0,1,1]
    v_lshlrev_b32 v152, 16, v243
    v_and_b32 v153, 0xffff0000, v243
    v_pk_mul_f32 v[154:155], v[152:153], v[118:119]
    v_pk_mul_f32 v[152:153], v[110:111], v[152:153] op_sel:[1,0]
    v_cvt_pk_bf16_f32 v154, v154, v155
    v_cvt_pk_bf16_f32 v152, v152, v153
    v_and_b32 v155, 0xffff0000, v154
    v_lshlrev_b32 v154, 16, v154
    v_and_b32 v153, 0xffff0000, v152
    v_lshlrev_b32 v152, 16, v152
    v_pk_fma_f32 v[142:143], v[110:111], v[154:155], v[152:153] op_sel_hi:[0,1,1]
    v_lshlrev_b32 v152, 16, v244
    v_and_b32 v153, 0xffff0000, v244
    v_pk_mul_f32 v[154:155], v[152:153], v[116:117]
    v_pk_mul_f32 v[152:153], v[112:113], v[152:153] op_sel:[1,0]
    v_cvt_pk_bf16_f32 v154, v154, v155
    v_cvt_pk_bf16_f32 v152, v152, v153
    v_and_b32 v155, 0xffff0000, v154
    v_lshlrev_b32 v154, 16, v154
    v_and_b32 v153, 0xffff0000, v152
    v_lshlrev_b32 v152, 16, v152
    v_pk_fma_f32 v[144:145], v[112:113], v[154:155], v[152:153] op_sel_hi:[0,1,1]
    v_lshlrev_b32 v152, 16, v245
    v_and_b32 v153, 0xffff0000, v245
    v_pk_mul_f32 v[154:155], v[152:153], v[118:119]
    v_pk_mul_f32 v[152:153], v[112:113], v[152:153] op_sel:[1,0]
    v_cvt_pk_bf16_f32 v154, v154, v155
    v_cvt_pk_bf16_f32 v152, v152, v153
    v_and_b32 v155, 0xffff0000, v154
    v_lshlrev_b32 v154, 16, v154
    v_and_b32 v153, 0xffff0000, v152
    v_lshlrev_b32 v152, 16, v152
    v_pk_fma_f32 v[146:147], v[112:113], v[154:155], v[152:153] op_sel_hi:[0,1,1]
    v_lshlrev_b32 v152, 16, v246
    v_and_b32 v153, 0xffff0000, v246
    v_pk_mul_f32 v[154:155], v[152:153], v[116:117]
    v_pk_mul_f32 v[152:153], v[114:115], v[152:153] op_sel:[1,0]
    v_cvt_pk_bf16_f32 v154, v154, v155
    v_cvt_pk_bf16_f32 v152, v152, v153
    v_and_b32 v155, 0xffff0000, v154
    v_lshlrev_b32 v154, 16, v154
    v_and_b32 v153, 0xffff0000, v152
    v_lshlrev_b32 v152, 16, v152
    v_pk_fma_f32 v[148:149], v[114:115], v[154:155], v[152:153] op_sel_hi:[0,1,1]
    v_lshlrev_b32 v152, 16, v247
    v_and_b32 v153, 0xffff0000, v247
    v_pk_mul_f32 v[154:155], v[152:153], v[118:119]
    v_pk_mul_f32 v[152:153], v[114:115], v[152:153] op_sel:[1,0]
    v_cvt_pk_bf16_f32 v154, v154, v155
    v_cvt_pk_bf16_f32 v152, v152, v153
    v_and_b32 v155, 0xffff0000, v154
    v_lshlrev_b32 v154, 16, v154
    v_and_b32 v153, 0xffff0000, v152
    v_lshlrev_b32 v152, 16, v152
    v_pk_fma_f32 v[150:151], v[114:115], v[154:155], v[152:153] op_sel_hi:[0,1,1]
    v_bfrev_b32 v2, 1
    v_subrev_u32 v8, s21, v252
    v_lshlrev_b32 v152, v8, 1
    v_cmp_gt_u32 vcc, 32, v8
    s_nop 1
    v_cndmask_b32 v152, 0, v152, vcc
    s_nop 1
    v_or_b32_dpp v152, v152, v152 row_shr:1 row_mask:0xf bank_mask:0xf
    s_nop 1
    v_or_b32_dpp v152, v152, v152 row_shr:2 row_mask:0xf bank_mask:0xf
    s_nop 1
    v_or_b32_dpp v152, v152, v152 row_shr:4 row_mask:0xf bank_mask:0xf
    v_lshlrev_b32 v8, v6, 1
    v_readlane_b32 s33, v152, 7
    s_lshr_b32 s66, s33, 0
    v_and_b32 v170, s66, v8
    s_lshr_b32 s66, s33, 4
    v_and_b32 v171, s66, v8
    s_lshr_b32 s66, s33, 8
    v_and_b32 v172, s66, v8
    s_lshr_b32 s66, s33, 12
    v_and_b32 v173, s66, v8
    s_lshr_b32 s66, s33, 16
    v_and_b32 v174, s66, v8
    s_lshr_b32 s66, s33, 20
    v_and_b32 v175, s66, v8
    s_lshr_b32 s66, s33, 24
    v_and_b32 v176, s66, v8
    s_lshr_b32 s66, s33, 28
    v_and_b32 v177, s66, v8
    s_add_u32 s33, s30, 4
    v_readlane_b32 s66, v252, s30
    v_readlane_b32 s67, v253, s30
    v_readlane_b32 s68, v252, s33
    v_readlane_b32 s69, v253, s33
    v_mov_b32 v10, s66
    v_mov_b32 v168, s67
    s_mov_b32 exec_lo, 0
    v_mov_b32 v10, s68
    v_mov_b32 v168, s69
    s_mov_b32 exec_lo, -1
    v_subrev_u32 v3, s20, v10
    v_cmp_gt_u32 vcc, 0x80, v3
    v_lshrrev_b32 v11, 5, v1
    v_lshlrev_b32 v11, 19, v11
    v_and_b32 v19, 1, v6
    v_lshl_add_u32 v11, v19, 12, v11
    v_lshl_add_u32 v11, v13, 5, v11
    s_mov_b64 s[52:53], vcc
    v_cndmask_b32 v11, v2, v11, vcc
    v_lshl_add_u32 v19, v10, 11, v12
    v_cndmask_b32 v19, v2, v19, vcc
    v_lshlrev_b32 v12, 3, v10
    v_cndmask_b32 v12, v2, v12, vcc
    v_mov_b32 v9, s65
    v_cndmask_b32 v9, 0, v9, vcc
    s_lshl_b32 s54, s30, 17
    s_lshl_b32 s66, s27, 13
    s_add_u32 s54, s54, s66
    s_add_u32 s54, s54, 2621440
    s_lshl_b32 s70, s2, 13
    s_add_u32 s70, s70, 524288
    s_add_u32 s71, s70, 4096
    s_cmp_lt_u32 s2, 224
    s_cselect_b32 s73, s30, 1
    s_mul_i32 s72, s26, 7168
    s_mul_i32 s33, s30, 1792
    s_add_u32 s72, s72, s33
    s_add_u32 s72, s72, 393216
    v_cmp_gt_u32 vcc, 48, v1
    s_nop 1
    v_cndmask_b32 v169, v2, v18, vcc
    s_mul_i32 s33, s30, 112
    v_add_u32 v8, s33, v1
    v_bfe_u32 v152, v8, 4, 1
    v_mul_u32_u24 v152, 1856, v152
    v_and_b32 v153, 15, v8
    v_lshl_add_u32 v152, v153, 1, v152
    v_and_b32 v8, 0x1e0, v8
    v_add_u32 v8, v8, v152
    v_add_u32 v254, 152576, v8
    v_mul_u32_u24 v8, 464, v4
    v_lshl_add_u32 v8, v6, 4, v8
    v_add_u32 v255, 152576, v8
    s_lshl_b32 s33, s30, 5
    v_add_u32 v5, s33, v5
    v_and_b32 v8, 1, v6
    v_lshlrev_b32 v8, 1, v8
    v_lshrrev_b32 v152, 1, v6
    v_add_u32 v8, v8, v152
    v_lshlrev_b32 v8, 18, v8
    v_lshl_add_u32 v231, v13, 3, v8
    s_lshl_b32 s76, s27, 13
    s_lshl_b32 s77, s26, 9
    s_add_u32 s76, s76, s77
    s_lshl_b32 s77, s30, 7
    s_add_u32 s76, s76, s77
    s_add_u32 s76, s76, 2621440
    s_add_u32 s77, s76, 131072
    s_waitcnt vmcnt(6) lgkmcnt(0)
    s_barrier
    s_add_u32 m0, s60, 32768
    s_nop 0
    buffer_load_dwordx4 v14, s[8:11], s61 offen offset:0 lds
    buffer_load_dwordx4 v15, s[8:11], s61 offen offset:1024 lds
    buffer_load_dwordx4 v16, s[8:11], s61 offen offset:2048 lds
    buffer_load_dwordx4 v17, s[8:11], s61 offen offset:3072 lds
    s_add_u32 s61, s61, 128
    s_and_b32 s61, s61, 2047
    s_add_u32 m0, s60, 49152
    s_nop 0
    buffer_load_dwordx4 v14, s[8:11], s61 offen offset:0 lds
    buffer_load_dwordx4 v15, s[8:11], s61 offen offset:1024 lds
    buffer_load_dwordx4 v16, s[8:11], s61 offen offset:2048 lds
    buffer_load_dwordx4 v17, s[8:11], s61 offen offset:3072 lds
    s_add_u32 s61, s61, 128
    s_and_b32 s61, s61, 2047
    s_cmp_lg_u32 s73, 0
    s_cbranch_scc1 L_nogu1
    buffer_load_dwordx4 v[20:23], v18, s[16:19], s70 offen offset:0 sc1
    buffer_load_dwordx4 v[24:27], v18, s[16:19], s70 offen offset:1024 sc1
    buffer_load_dwordx4 v[28:31], v18, s[16:19], s70 offen offset:2048 sc1
    buffer_load_dwordx4 v[32:35], v18, s[16:19], s70 offen offset:3072 sc1
    buffer_load_dwordx4 v[36:39], v18, s[16:19], s71 offen offset:0 sc1
    buffer_load_dwordx4 v[40:43], v18, s[16:19], s71 offen offset:1024 sc1
    buffer_load_dwordx4 v[44:47], v18, s[16:19], s71 offen offset:2048 sc1
    buffer_load_dwordx4 v[48:51], v18, s[16:19], s71 offen offset:3072 sc1
L_nogu1:
    s_waitcnt vmcnt(10)
    s_barrier
    s_add_u32 m0, s60, 0
    s_nop 0
    buffer_load_dwordx4 v14, s[8:11], s61 offen offset:0 lds
    buffer_load_dwordx4 v15, s[8:11], s61 offen offset:1024 lds
    buffer_load_dwordx4 v16, s[8:11], s61 offen offset:2048 lds
    buffer_load_dwordx4 v17, s[8:11], s61 offen offset:3072 lds
    s_add_u32 s61, s61, 128
    s_and_b32 s61, s61, 2047
    s_waitcnt vmcnt(8)
    s_barrier
    s_add_u32 m0, s60, 16384
    s_nop 0
    buffer_load_dwordx4 v14, s[8:11], s61 offen offset:0 lds
    buffer_load_dwordx4 v15, s[8:11], s61 offen offset:1024 lds
    buffer_load_dwordx4 v16, s[8:11], s61 offen offset:2048 lds
    buffer_load_dwordx4 v17, s[8:11], s61 offen offset:3072 lds
    s_add_u32 s61, s61, 128
    s_and_b32 s61, s61, 2047
    s_cmp_lg_u32 s73, 0
    s_cbranch_scc1 L_nogu2
    v_mov_b32 v62, s65
    v_mov_b32 v63, s65
    s_mov_b32 s68, 32768
    s_waitcnt vmcnt(8)
L_gupoll:
    v_cmp_ne_u64 vcc, v[22:23], v[62:63]
    v_cmp_ne_u64 s[66:67], v[26:27], v[62:63]
    s_or_b64 vcc, vcc, s[66:67]
    v_cmp_ne_u64 s[66:67], v[30:31], v[62:63]
    s_or_b64 vcc, vcc, s[66:67]
    v_cmp_ne_u64 s[66:67], v[34:35], v[62:63]
    s_or_b64 vcc, vcc, s[66:67]
    v_cmp_ne_u64 s[66:67], v[38:39], v[62:63]
    s_or_b64 vcc, vcc, s[66:67]
    v_cmp_ne_u64 s[66:67], v[42:43], v[62:63]
    s_or_b64 vcc, vcc, s[66:67]
    v_cmp_ne_u64 s[66:67], v[46:47], v[62:63]
    s_or_b64 vcc, vcc, s[66:67]
    v_cmp_ne_u64 s[66:67], v[50:51], v[62:63]
    s_or_b64 vcc, vcc, s[66:67]
    s_cbranch_vccz L_guok
    s_sub_u32 s68, s68, 1
    s_cbranch_scc1 L_guok
    buffer_load_dwordx4 v[20:23], v18, s[16:19], s70 offen offset:0 sc1
    buffer_load_dwordx4 v[24:27], v18, s[16:19], s70 offen offset:1024 sc1
    buffer_load_dwordx4 v[28:31], v18, s[16:19], s70 offen offset:2048 sc1
    buffer_load_dwordx4 v[32:35], v18, s[16:19], s70 offen offset:3072 sc1
    buffer_load_dwordx4 v[36:39], v18, s[16:19], s71 offen offset:0 sc1
    buffer_load_dwordx4 v[40:43], v18, s[16:19], s71 offen offset:1024 sc1
    buffer_load_dwordx4 v[44:47], v18, s[16:19], s71 offen offset:2048 sc1
    buffer_load_dwordx4 v[48:51], v18, s[16:19], s71 offen offset:3072 sc1
    s_waitcnt vmcnt(0)
    s_branch L_gupoll
L_guok:
    v_pk_add_f32 v[20:21], v[20:21], v[28:29]
    v_pk_add_f32 v[36:37], v[36:37], v[44:45]
    v_pk_add_f32 v[20:21], v[20:21], v[36:37]
    v_pk_add_f32 v[24:25], v[24:25], v[32:33]
    v_pk_add_f32 v[40:41], v[40:41], v[48:49]
    v_pk_add_f32 v[24:25], v[24:25], v[40:41]
    v_cvt_pk_bf16_f32 v20, v20, v21
    v_mov_b32 v22, v20
    s_nop 1
    v_permlane32_swap_b32 v20, v22
    v_and_b32 v21, 0xffff0000, v20
    v_lshlrev_b32 v20, 16, v20
    v_and_b32 v23, 0xffff0000, v22
    v_lshlrev_b32 v22, 16, v22
    v_mul_f32 v154, 0xbfb8aa3b, v20
    v_mul_f32 v155, 0xbfb8aa3b, v21
    v_exp_f32 v154, v154
    v_exp_f32 v155, v155
    v_add_f32 v154, 1.0, v154
    v_add_f32 v155, 1.0, v155
    v_rcp_f32 v154, v154
    v_rcp_f32 v155, v155
    s_nop 0
    v_pk_mul_f32 v[20:21], v[20:21], v[154:155]
    v_cvt_pk_bf16_f32 v20, v20, v21
    v_and_b32 v21, 0xffff0000, v20
    v_lshlrev_b32 v20, 16, v20
    v_pk_mul_f32 v[20:21], v[20:21], v[22:23]
    v_cvt_pk_bf16_f32 v60, v20, v21
    v_cvt_pk_bf16_f32 v24, v24, v25
    v_mov_b32 v26, v24
    s_nop 1
    v_permlane32_swap_b32 v24, v26
    v_and_b32 v25, 0xffff0000, v24
    v_lshlrev_b32 v24, 16, v24
    v_and_b32 v27, 0xffff0000, v26
    v_lshlrev_b32 v26, 16, v26
    v_mul_f32 v154, 0xbfb8aa3b, v24
    v_mul_f32 v155, 0xbfb8aa3b, v25
    v_exp_f32 v154, v154
    v_exp_f32 v155, v155
    v_add_f32 v154, 1.0, v154
    v_add_f32 v155, 1.0, v155
    v_rcp_f32 v154, v154
    v_rcp_f32 v155, v155
    s_nop 0
    v_pk_mul_f32 v[24:25], v[24:25], v[154:155]
    v_cvt_pk_bf16_f32 v24, v24, v25
    v_and_b32 v25, 0xffff0000, v24
    v_lshlrev_b32 v24, 16, v24
    v_pk_mul_f32 v[24:25], v[24:25], v[26:27]
    v_cvt_pk_bf16_f32 v61, v24, v25
    s_lshl_b32 s33, s2, 9
    s_add_u32 s33, s33, 393216
    s_mov_b64 exec, 0xffffffff
    buffer_store_dwordx4 v[60:63], v18, s[16:19], s33 offen sc1
    s_mov_b64 exec, -1
L_nogu2:
    s_waitcnt vmcnt(8)
    s_barrier
    s_add_u32 m0, s60, 32768
    s_nop 0
    buffer_load_dwordx4 v14, s[8:11], s61 offen offset:0 lds
    buffer_load_dwordx4 v15, s[8:11], s61 offen offset:1024 lds
    buffer_load_dwordx4 v16, s[8:11], s61 offen offset:2048 lds
    buffer_load_dwordx4 v17, s[8:11], s61 offen offset:3072 lds
    s_add_u32 s61, s61, 128
    s_and_b32 s61, s61, 2047
    s_waitcnt vmcnt(8)
    s_barrier
    s_add_u32 m0, s60, 49152
    s_nop 0
    buffer_load_dwordx4 v14, s[8:11], s61 offen offset:0 lds
    buffer_load_dwordx4 v15, s[8:11], s61 offen offset:1024 lds
    buffer_load_dwordx4 v16, s[8:11], s61 offen offset:2048 lds
    buffer_load_dwordx4 v17, s[8:11], s61 offen offset:3072 lds
    s_add_u32 s61, s61, 128
    s_and_b32 s61, s61, 2047
    s_waitcnt vmcnt(8)
    s_barrier
    s_add_u32 m0, s60, 0
    s_nop 0
    buffer_load_dwordx4 v14, s[8:11], s61 offen offset:0 lds
    buffer_load_dwordx4 v15, s[8:11], s61 offen offset:1024 lds
    buffer_load_dwordx4 v16, s[8:11], s61 offen offset:2048 lds
    buffer_load_dwordx4 v17, s[8:11], s61 offen offset:3072 lds
    s_add_u32 s61, s61, 128
    s_and_b32 s61, s61, 2047
    buffer_load_dwordx4 v[52:55], v18, s[16:19], s72 offen offset:0 sc1
    buffer_load_dwordx4 v[56:59], v169, s[16:19], s72 offen offset:1024 sc1
    s_waitcnt vmcnt(10)
    s_barrier
    s_add_u32 m0, s60, 16384
    s_nop 0
    buffer_load_dwordx4 v14, s[8:11], s61 offen offset:0 lds
    buffer_load_dwordx4 v15, s[8:11], s61 offen offset:1024 lds
    buffer_load_dwordx4 v16, s[8:11], s61 offen offset:2048 lds
    buffer_load_dwordx4 v17, s[8:11], s61 offen offset:3072 lds
    s_add_u32 s61, s61, 128
    s_and_b32 s61, s61, 2047
    s_waitcnt vmcnt(10)
    s_barrier
    s_add_u32 m0, s60, 32768
    s_nop 0
    buffer_load_dwordx4 v14, s[8:11], s61 offen offset:0 lds
    buffer_load_dwordx4 v15, s[8:11], s61 offen offset:1024 lds
    buffer_load_dwordx4 v16, s[8:11], s61 offen offset:2048 lds
    buffer_load_dwordx4 v17, s[8:11], s61 offen offset:3072 lds
    s_add_u32 s61, s61, 128
    s_and_b32 s61, s61, 2047
    s_waitcnt vmcnt(8)
    v_mov_b32 v152, s65
    v_mov_b32 v153, s65
    s_mov_b32 s68, 32768
L_actpoll:
    v_cmp_ne_u64 vcc, v[54:55], v[152:153]
    v_cmp_ne_u64 s[66:67], v[58:59], v[152:153]
    s_and_b32 s67, s67, 0xffff
    s_or_b64 vcc, vcc, s[66:67]
    s_cbranch_vccz L_actok
    s_sub_u32 s68, s68, 1
    s_cbranch_scc1 L_actok
    buffer_load_dwordx4 v[52:55], v18, s[16:19], s72 offen offset:0 sc1
    buffer_load_dwordx4 v[56:59], v169, s[16:19], s72 offen offset:1024 sc1
    s_waitcnt vmcnt(0)
    s_branch L_actpoll
L_actok:
    ds_write_b16 v254, v52 offset:0
    ds_write_b16_d16_hi v254, v52 offset:464
    ds_write_b16 v254, v53 offset:928
    ds_write_b16_d16_hi v254, v53 offset:1392
    s_mov_b32 exec_hi, 0xffff
    ds_write_b16 v254, v56 offset:64
    ds_write_b16_d16_hi v254, v56 offset:528
    ds_write_b16 v254, v57 offset:992
    ds_write_b16_d16_hi v254, v57 offset:1456
    s_mov_b32 exec_hi, -1
    s_waitcnt lgkmcnt(0)
    s_barrier
    s_add_u32 m0, s60, 49152
    s_nop 0
    buffer_load_dwordx4 v14, s[8:11], s61 offen offset:0 lds
    buffer_load_dwordx4 v15, s[8:11], s61 offen offset:1024 lds
    buffer_load_dwordx4 v16, s[8:11], s61 offen offset:2048 lds
    buffer_load_dwordx4 v17, s[8:11], s61 offen offset:3072 lds
    s_add_u32 s61, s61, 128
    s_and_b32 s61, s61, 2047
    ds_read_b128 v[48:51], v255 offset:0
    ds_read_b64_tr_b16 v[20:21], v5 offset:32768
    ds_read_b64_tr_b16 v[22:23], v5 offset:33280
    ds_read_b128 v[52:55], v255 offset:64
    ds_read_b64_tr_b16 v[24:25], v5 offset:36864
    ds_read_b64_tr_b16 v[26:27], v5 offset:37376
    ds_read_b128 v[56:59], v255 offset:128
    ds_read_b64_tr_b16 v[28:29], v5 offset:40960
    ds_read_b64_tr_b16 v[30:31], v5 offset:41472
    ds_read_b128 v[60:63], v255 offset:192
    ds_read_b64_tr_b16 v[32:33], v5 offset:45056
    ds_read_b64_tr_b16 v[34:35], v5 offset:45568
    ds_read_b128 v[64:67], v255 offset:256
    ds_read_b64_tr_b16 v[36:37], v5 offset:49152
    ds_read_b64_tr_b16 v[38:39], v5 offset:49664
    ds_read_b128 v[68:71], v255 offset:320
    ds_read_b64_tr_b16 v[40:41], v5 offset:53248
    ds_read_b64_tr_b16 v[42:43], v5 offset:53760
    ds_read_b128 v[72:75], v255 offset:384
    ds_read_b64_tr_b16 v[44:45], v5 offset:57344
    ds_read_b64_tr_b16 v[46:47], v5 offset:57856
    s_waitcnt lgkmcnt(15)
    v_mfma_f32_16x16x32_bf16 v[76:79], v[48:51], v[20:23], 0
    s_waitcnt lgkmcnt(15)
    v_mfma_f32_16x16x32_bf16 v[76:79], v[52:55], v[24:27], v[76:79]
    s_waitcnt lgkmcnt(12)
    v_mfma_f32_16x16x32_bf16 v[76:79], v[56:59], v[28:31], v[76:79]
    s_waitcnt lgkmcnt(9)
    v_mfma_f32_16x16x32_bf16 v[76:79], v[60:63], v[32:35], v[76:79]
    s_waitcnt lgkmcnt(6)
    v_mfma_f32_16x16x32_bf16 v[76:79], v[64:67], v[36:39], v[76:79]
    s_waitcnt lgkmcnt(3)
    v_mfma_f32_16x16x32_bf16 v[76:79], v[68:71], v[40:43], v[76:79]
    s_waitcnt lgkmcnt(0)
    v_mfma_f32_16x16x32_bf16 v[76:79], v[72:75], v[44:47], v[76:79]
    v_mov_b32 v81, s65
    v_mov_b32 v83, s65
    s_nop 5
    v_mov_b32 v80, v76
    v_mov_b32 v82, v77
    s_mov_b32 exec_lo, 0
    v_mov_b32 v80, v78
    v_mov_b32 v82, v79
    s_mov_b32 exec_lo, -1
    buffer_store_dwordx2 v[80:81], v231, s[16:19], s76 offen sc1
    buffer_store_dwordx2 v[82:83], v231, s[16:19], s77 offen sc1
    s_waitcnt vmcnt(10)
    s_barrier
    s_add_u32 m0, s60, 0
    s_nop 0
    buffer_load_dwordx4 v14, s[8:11], s61 offen offset:0 lds
    buffer_load_dwordx4 v15, s[8:11], s61 offen offset:1024 lds
    buffer_load_dwordx4 v16, s[8:11], s61 offen offset:2048 lds
    buffer_load_dwordx4 v17, s[8:11], s61 offen offset:3072 lds
    s_add_u32 s61, s61, 128
    s_and_b32 s61, s61, 2047
    s_waitcnt vmcnt(10)
    s_barrier
    s_add_u32 m0, s60, 16384
    s_nop 0
    buffer_load_dwordx4 v14, s[8:11], s61 offen offset:0 lds
    buffer_load_dwordx4 v15, s[8:11], s61 offen offset:1024 lds
    buffer_load_dwordx4 v16, s[8:11], s61 offen offset:2048 lds
    buffer_load_dwordx4 v17, s[8:11], s61 offen offset:3072 lds
    s_add_u32 s61, s61, 128
    s_and_b32 s61, s61, 2047
    s_waitcnt vmcnt(10)
    s_barrier
    s_add_u32 m0, s60, 32768
    s_nop 0
    buffer_load_dwordx4 v14, s[8:11], s61 offen offset:0 lds
    buffer_load_dwordx4 v15, s[8:11], s61 offen offset:1024 lds
    buffer_load_dwordx4 v16, s[8:11], s61 offen offset:2048 lds
    buffer_load_dwordx4 v17, s[8:11], s61 offen offset:3072 lds
    s_add_u32 s61, s61, 128
    s_and_b32 s61, s61, 2047
    s_waitcnt vmcnt(8)
    s_barrier
    s_add_u32 m0, s60, 49152
    s_nop 0
    buffer_load_dwordx4 v14, s[8:11], s61 offen offset:0 lds
    buffer_load_dwordx4 v15, s[8:11], s61 offen offset:1024 lds
    buffer_load_dwordx4 v16, s[8:11], s61 offen offset:2048 lds
    buffer_load_dwordx4 v17, s[8:11], s61 offen offset:3072 lds
    s_waitcnt vmcnt(8)
    s_barrier
    s_mov_b32 s66, 8192
    s_cmp_eq_u64 s[52:53], 0
    s_cbranch_scc1 L_noy
    buffer_load_dwordx4 v[20:23], v11, s[16:19], s54 offen offset:0 sc1
    buffer_load_dwordx4 v[24:27], v11, s[16:19], s54 offen offset:16 sc1
    buffer_load_dwordx4 v[28:31], v11, s[16:19], s54 offen offset:512 sc1
    buffer_load_dwordx4 v[32:35], v11, s[16:19], s54 offen offset:528 sc1
    buffer_load_dwordx4 v[36:39], v11, s[16:19], s54 offen offset:1024 sc1
    buffer_load_dwordx4 v[40:43], v11, s[16:19], s54 offen offset:1040 sc1
    buffer_load_dwordx4 v[44:47], v11, s[16:19], s54 offen offset:1536 sc1
    buffer_load_dwordx4 v[48:51], v11, s[16:19], s54 offen offset:1552 sc1
    buffer_load_dwordx4 v[52:55], v11, s[16:19], s54 offen offset:2048 sc1
    buffer_load_dwordx4 v[56:59], v11, s[16:19], s54 offen offset:2064 sc1
    buffer_load_dwordx4 v[60:63], v11, s[16:19], s54 offen offset:2560 sc1
    buffer_load_dwordx4 v[64:67], v11, s[16:19], s54 offen offset:2576 sc1
    buffer_load_dwordx4 v[68:71], v11, s[16:19], s54 offen offset:3072 sc1
    buffer_load_dwordx4 v[72:75], v11, s[16:19], s54 offen offset:3088 sc1
    buffer_load_dwordx4 v[76:79], v11, s[16:19], s54 offen offset:3584 sc1
    buffer_load_dwordx4 v[80:83], v11, s[16:19], s54 offen offset:3600 sc1
    buffer_load_dwordx2 v[160:161], v19, s[4:7], s22 offen
    buffer_load_dword v162, v12, s[16:19], s66 offen sc1
    s_waitcnt vmcnt(22)
    s_barrier
    s_waitcnt vmcnt(18)
    s_barrier
    s_branch L_yjoin
L_noy:
    s_waitcnt vmcnt(4)
    s_barrier
    s_waitcnt vmcnt(0)
    s_barrier
L_yjoin:
    v_lshlrev_b32 v14, 4, v13
    v_lshl_add_u32 v15, v10, 12, v14
    v_lshl_add_u32 v14, v6, 12, v14
    v_xor_b32 v16, v13, v6
    v_lshlrev_b32 v16, 4, v16
    v_lshl_add_u32 v16, v6, 8, v16
    s_lshl_b32 s33, s30, 13
    s_add_u32 s33, s33, 0
    v_add_u32 v16, s33, v16
    v_xor_b32 v17, 64, v16
    v_and_b32 v8, 7, v3
    v_xor_b32 v8, v8, v13
    v_lshlrev_b32 v8, 4, v8
    v_and_b32 v5, 0x7f, v3
    v_lshl_add_u32 v8, v5, 8, v8
    s_lshl_b32 s67, s27, 8
    s_lshl_b32 s69, s21, 12
    s_add_u32 s69, s69, s67
    v_cmp_eq_u32 s[70:71], 0, v170
    v_cmp_eq_u32 s[72:73], 0, v171
    v_cmp_eq_u32 s[74:75], 0, v172
    v_cmp_eq_u32 s[76:77], 0, v173
    v_cmp_eq_u32 s[78:79], 0, v174
    v_cmp_eq_u32 s[80:81], 0, v175
    v_cmp_eq_u32 s[82:83], 0, v176
    v_cmp_eq_u32 s[84:85], 0, v177
    s_cmp_eq_u64 s[52:53], 0
    s_cbranch_scc1 L_notok
    s_mov_b32 s68, 32768
L_ypoll:
    s_waitcnt vmcnt(0)
    v_xor_b32 v152, v9, v21
    v_xor_b32 v153, v9, v23
    v_or_b32 v152, v152, v153
    v_xor_b32 v153, v9, v25
    v_or_b32 v152, v152, v153
    v_xor_b32 v153, v9, v27
    v_or_b32 v152, v152, v153
    v_xor_b32 v153, v9, v29
    v_or_b32 v152, v152, v153
    v_xor_b32 v153, v9, v31
    v_or_b32 v152, v152, v153
    v_xor_b32 v153, v9, v33
    v_or_b32 v152, v152, v153
    v_xor_b32 v153, v9, v35
    v_or_b32 v152, v152, v153
    v_xor_b32 v153, v9, v37
    v_or_b32 v152, v152, v153
    v_xor_b32 v153, v9, v39
    v_or_b32 v152, v152, v153
    v_xor_b32 v153, v9, v41
    v_or_b32 v152, v152, v153
    v_xor_b32 v153, v9, v43
    v_or_b32 v152, v152, v153
    v_xor_b32 v153, v9, v45
    v_or_b32 v152, v152, v153
    v_xor_b32 v153, v9, v47
    v_or_b32 v152, v152, v153
    v_xor_b32 v153, v9, v49
    v_or_b32 v152, v152, v153
    v_xor_b32 v153, v9, v51
    v_or_b32 v152, v152, v153
    v_xor_b32 v153, v9, v53
    v_or_b32 v152, v152, v153
    v_xor_b32 v153, v9, v55
    v_or_b32 v152, v152, v153
    v_xor_b32 v153, v9, v57
    v_or_b32 v152, v152, v153
    v_xor_b32 v153, v9, v59
    v_or_b32 v152, v152, v153
    v_xor_b32 v153, v9, v61
    v_or_b32 v152, v152, v153
    v_xor_b32 v153, v9, v63
    v_or_b32 v152, v152, v153
    v_xor_b32 v153, v9, v65
    v_or_b32 v152, v152, v153
    v_xor_b32 v153, v9, v67
    v_or_b32 v152, v152, v153
    v_xor_b32 v153, v9, v69
    v_or_b32 v152, v152, v153
    v_xor_b32 v153, v9, v71
    v_or_b32 v152, v152, v153
    v_xor_b32 v153, v9, v73
    v_or_b32 v152, v152, v153
    v_xor_b32 v153, v9, v75
    v_or_b32 v152, v152, v153
    v_xor_b32 v153, v9, v77
    v_or_b32 v152, v152, v153
    v_xor_b32 v153, v9, v79
    v_or_b32 v152, v152, v153
    v_xor_b32 v153, v9, v81
    v_or_b32 v152, v152, v153
    v_xor_b32 v153, v9, v83
    v_or_b32 v152, v152, v153
    v_cmp_ne_u32 vcc, 0, v152
    s_cbranch_vccz L_yok
    s_sub_u32 s68, s68, 1
    s_cbranch_scc1 L_yok
    buffer_load_dwordx4 v[20:23], v11, s[16:19], s54 offen offset:0 sc1
    buffer_load_dwordx4 v[24:27], v11, s[16:19], s54 offen offset:16 sc1
    buffer_load_dwordx4 v[28:31], v11, s[16:19], s54 offen offset:512 sc1
    buffer_load_dwordx4 v[32:35], v11, s[16:19], s54 offen offset:528 sc1
    buffer_load_dwordx4 v[36:39], v11, s[16:19], s54 offen offset:1024 sc1
    buffer_load_dwordx4 v[40:43], v11, s[16:19], s54 offen offset:1040 sc1
    buffer_load_dwordx4 v[44:47], v11, s[16:19], s54 offen offset:1536 sc1
    buffer_load_dwordx4 v[48:51], v11, s[16:19], s54 offen offset:1552 sc1
    buffer_load_dwordx4 v[52:55], v11, s[16:19], s54 offen offset:2048 sc1
    buffer_load_dwordx4 v[56:59], v11, s[16:19], s54 offen offset:2064 sc1
    buffer_load_dwordx4 v[60:63], v11, s[16:19], s54 offen offset:2560 sc1
    buffer_load_dwordx4 v[64:67], v11, s[16:19], s54 offen offset:2576 sc1
    buffer_load_dwordx4 v[68:71], v11, s[16:19], s54 offen offset:3072 sc1
    buffer_load_dwordx4 v[72:75], v11, s[16:19], s54 offen offset:3088 sc1
    buffer_load_dwordx4 v[76:79], v11, s[16:19], s54 offen offset:3584 sc1
    buffer_load_dwordx4 v[80:83], v11, s[16:19], s54 offen offset:3600 sc1
    s_branch L_ypoll
L_yok:
    v_add_f32 v20, v20, v28
    v_add_f32 v22, v22, v30
    v_add_f32 v24, v24, v32
    v_add_f32 v26, v26, v34
    v_add_f32 v20, v20, v36
    v_add_f32 v22, v22, v38
    v_add_f32 v24, v24, v40
    v_add_f32 v26, v26, v42
    v_add_f32 v20, v20, v44
    v_add_f32 v22, v22, v46
    v_add_f32 v24, v24, v48
    v_add_f32 v26, v26, v50
    v_add_f32 v20, v20, v52
    v_add_f32 v22, v22, v54
    v_add_f32 v24, v24, v56
    v_add_f32 v26, v26, v58
    v_add_f32 v20, v20, v60
    v_add_f32 v22, v22, v62
    v_add_f32 v24, v24, v64
    v_add_f32 v26, v26, v66
    v_add_f32 v20, v20, v68
    v_add_f32 v22, v22, v70
    v_add_f32 v24, v24, v72
    v_add_f32 v26, v26, v74
    v_add_f32 v20, v20, v76
    v_add_f32 v22, v22, v78
    v_add_f32 v24, v24, v80
    v_add_f32 v26, v26, v82
    v_mov_b32 v21, v20
    v_mov_b32 v23, v22
    v_mov_b32 v25, v24
    v_mov_b32 v27, v26
    v_permlane16_swap_b32 v20, v21
    v_permlane16_swap_b32 v22, v23
    v_permlane16_swap_b32 v24, v25
    v_permlane16_swap_b32 v26, v27
    v_add_f32 v28, v20, v21
    v_add_f32 v29, v22, v23
    v_add_f32 v30, v24, v25
    v_add_f32 v31, v26, v27
    v_and_b32 v163, 0xffff0000, v162
    v_lshlrev_b32 v162, 16, v162
    v_cvt_pk_bf16_f32 v28, v28, v29
    v_and_b32 v29, 0xffff0000, v28
    v_lshlrev_b32 v28, 16, v28
    v_mul_f32 v28, v28, v168
    v_mul_f32 v29, v29, v168
    v_cvt_pk_bf16_f32 v28, v28, v29
    v_and_b32 v29, 0xffff0000, v28
    v_lshlrev_b32 v28, 16, v28
    v_lshlrev_b32 v152, 16, v160
    v_and_b32 v153, 0xffff0000, v160
    v_pk_add_f32 v[28:29], v[28:29], v[152:153]
    v_cvt_pk_bf16_f32 v28, v28, v29
    v_and_b32 v29, 0xffff0000, v28
    v_lshlrev_b32 v28, 16, v28
    v_cvt_pk_bf16_f32 v30, v30, v31
    v_and_b32 v31, 0xffff0000, v30
    v_lshlrev_b32 v30, 16, v30
    v_mul_f32 v30, v30, v168
    v_mul_f32 v31, v31, v168
    v_cvt_pk_bf16_f32 v30, v30, v31
    v_and_b32 v31, 0xffff0000, v30
    v_lshlrev_b32 v30, 16, v30
    v_lshlrev_b32 v152, 16, v161
    v_and_b32 v153, 0xffff0000, v161
    v_pk_add_f32 v[30:31], v[30:31], v[152:153]
    v_cvt_pk_bf16_f32 v30, v30, v31
    v_and_b32 v31, 0xffff0000, v30
    v_lshlrev_b32 v30, 16, v30
    v_lshlrev_b32 v152, 16, v160
    v_and_b32 v153, 0xffff0000, v160
    v_pk_mul_f32 v[154:155], v[152:153], v[116:117]
    v_pk_mul_f32 v[152:153], v[162:163], v[28:29] op_sel:[1,0]
    v_cvt_pk_bf16_f32 v154, v154, v155
    v_cvt_pk_bf16_f32 v152, v152, v153
    v_and_b32 v155, 0xffff0000, v154
    v_lshlrev_b32 v154, 16, v154
    v_and_b32 v153, 0xffff0000, v152
    v_lshlrev_b32 v152, 16, v152
    v_pk_fma_f32 v[164:165], v[162:163], v[154:155], v[152:153] op_sel_hi:[0,1,1]
    v_lshlrev_b32 v152, 16, v161
    v_and_b32 v153, 0xffff0000, v161
    v_pk_mul_f32 v[154:155], v[152:153], v[118:119]
    v_pk_mul_f32 v[152:153], v[162:163], v[30:31] op_sel:[1,0]
    v_cvt_pk_bf16_f32 v154, v154, v155
    v_cvt_pk_bf16_f32 v152, v152, v153
    v_and_b32 v155, 0xffff0000, v154
    v_lshlrev_b32 v154, 16, v154
    v_and_b32 v153, 0xffff0000, v152
    v_lshlrev_b32 v152, 16, v152
    v_pk_fma_f32 v[166:167], v[162:163], v[154:155], v[152:153] op_sel_hi:[0,1,1]
L_notok:
    s_barrier
    ds_read_b128 v[20:23], v16 offset:0
    ds_read_b128 v[24:27], v17 offset:1024
    ds_read_b128 v[28:31], v16 offset:2048
    ds_read_b128 v[32:35], v17 offset:3072
    ds_read_b128 v[36:39], v16 offset:4096
    ds_read_b128 v[40:43], v17 offset:5120
    ds_read_b128 v[44:47], v16 offset:6144
    ds_read_b128 v[48:51], v17 offset:7168
    ds_read_b128 v[52:55], v8 offset:0
    s_mov_b64 exec, s[70:71]
    s_waitcnt lgkmcnt(8)
    v_pk_fma_f32 v[20:21], v[100:101], v[20:21], v[120:121] op_sel_hi:[0,1,1]
    v_pk_fma_f32 v[22:23], v[100:101], v[22:23], v[122:123] op_sel_hi:[0,1,1]
    buffer_store_dwordx4 v[20:23], v14, s[40:43], s69 offen nt
    s_add_u32 s69, s69, 16384
    s_mov_b64 exec, s[72:73]
    s_waitcnt lgkmcnt(7)
    v_pk_fma_f32 v[24:25], v[102:103], v[24:25], v[124:125] op_sel_hi:[0,1,1]
    v_pk_fma_f32 v[26:27], v[102:103], v[26:27], v[126:127] op_sel_hi:[0,1,1]
    buffer_store_dwordx4 v[24:27], v14, s[40:43], s69 offen nt
    s_add_u32 s69, s69, 16384
    s_mov_b64 exec, s[74:75]
    s_waitcnt lgkmcnt(6)
    v_pk_fma_f32 v[28:29], v[104:105], v[28:29], v[128:129] op_sel_hi:[0,1,1]
    v_pk_fma_f32 v[30:31], v[104:105], v[30:31], v[130:131] op_sel_hi:[0,1,1]
    buffer_store_dwordx4 v[28:31], v14, s[40:43], s69 offen nt
    s_add_u32 s69, s69, 16384
    s_mov_b64 exec, s[76:77]
    s_waitcnt lgkmcnt(5)
    v_pk_fma_f32 v[32:33], v[106:107], v[32:33], v[132:133] op_sel_hi:[0,1,1]
    v_pk_fma_f32 v[34:35], v[106:107], v[34:35], v[134:135] op_sel_hi:[0,1,1]
    buffer_store_dwordx4 v[32:35], v14, s[40:43], s69 offen nt
    s_add_u32 s69, s69, 16384
    s_mov_b64 exec, s[78:79]
    s_waitcnt lgkmcnt(4)
    v_pk_fma_f32 v[36:37], v[108:109], v[36:37], v[136:137] op_sel_hi:[0,1,1]
    v_pk_fma_f32 v[38:39], v[108:109], v[38:39], v[138:139] op_sel_hi:[0,1,1]
    buffer_store_dwordx4 v[36:39], v14, s[40:43], s69 offen nt
    s_add_u32 s69, s69, 16384
    s_mov_b64 exec, s[80:81]
    s_waitcnt lgkmcnt(3)
    v_pk_fma_f32 v[40:41], v[110:111], v[40:41], v[140:141] op_sel_hi:[0,1,1]
    v_pk_fma_f32 v[42:43], v[110:111], v[42:43], v[142:143] op_sel_hi:[0,1,1]
    buffer_store_dwordx4 v[40:43], v14, s[40:43], s69 offen nt
    s_add_u32 s69, s69, 16384
    s_mov_b64 exec, s[82:83]
    s_waitcnt lgkmcnt(2)
    v_pk_fma_f32 v[44:45], v[112:113], v[44:45], v[144:145] op_sel_hi:[0,1,1]
    v_pk_fma_f32 v[46:47], v[112:113], v[46:47], v[146:147] op_sel_hi:[0,1,1]
    buffer_store_dwordx4 v[44:47], v14, s[40:43], s69 offen nt
    s_add_u32 s69, s69, 16384
    s_mov_b64 exec, s[84:85]
    s_waitcnt lgkmcnt(1)
    v_pk_fma_f32 v[48:49], v[114:115], v[48:49], v[148:149] op_sel_hi:[0,1,1]
    v_pk_fma_f32 v[50:51], v[114:115], v[50:51], v[150:151] op_sel_hi:[0,1,1]
    buffer_store_dwordx4 v[48:51], v14, s[40:43], s69 offen nt
    s_add_u32 s69, s69, 16384
    s_and_b32 exec_lo, s52, 0xffff
    s_and_b32 exec_hi, s53, 0xffff
    s_cbranch_execz L_aend
    s_waitcnt lgkmcnt(0)
    v_pk_fma_f32 v[52:53], v[162:163], v[52:53], v[164:165] op_sel_hi:[0,1,1]
    v_pk_fma_f32 v[54:55], v[162:163], v[54:55], v[166:167] op_sel_hi:[0,1,1]
    buffer_store_dwordx4 v[52:55], v15, s[40:43], s67 offen nt
L_aend:
    s_endpgm
L_xsub:
    ds_read_b64 v[232:233], v230 offset:0
    ds_read_b64 v[234:235], v230 offset:4096
    ds_read_b64 v[236:237], v230 offset:128
    ds_read_b64 v[238:239], v230 offset:4224
    ds_read_b64 v[240:241], v231 offset:512
    ds_read_b64 v[242:243], v231 offset:4608
    ds_read_b64 v[244:245], v231 offset:640
    ds_read_b64 v[246:247], v231 offset:4736
    s_waitcnt lgkmcnt(0)
    s_setpc_b64 s[66:67]
L_compute:
    s_lshr_b32 s30, s29, 1
    s_and_b32 s31, s29, 1
    v_and_b32 v6, 15, v1
    v_lshrrev_b32 v7, 4, v1
    s_lshl_b32 s32, s27, 6
    s_lshl_b32 s33, s31, 5
    s_add_u32 s32, s32, s33
    s_lshl_b32 s32, s32, 1
    v_lshlrev_b32 v8, 1, v6
    v_lshlrev_b32 v196, 4, v1
    s_waitcnt lgkmcnt(0)
    s_mov_b64 s[4:5], s[6:7]
    s_mov_b64 s[48:49], s[44:45]
    s_load_dword s44, s[16:17], 0
    s_mov_b32 s6, 2048
    s_mov_b32 s7, 0x20000
    s_mov_b32 s10, 2048
    s_mov_b32 s11, 0x20000
    s_mov_b32 s50, 2048
    s_mov_b32 s51, 0x20000
    buffer_load_ushort v26, v8, s[48:51], s32 offen offset:0
    buffer_load_ushort v32, v8, s[4:7], s32 offen offset:0
    buffer_load_ushort v34, v8, s[8:11], s32 offen offset:0
    buffer_load_ushort v27, v8, s[48:51], s32 offen offset:32
    buffer_load_ushort v33, v8, s[4:7], s32 offen offset:32
    buffer_load_ushort v35, v8, s[8:11], s32 offen offset:32
    s_getpc_b64 s[4:5]
Lc_pc:
    s_sub_u32 s4, s4, Lc_pc - gated_mix__ssm_conv_s5__moe_arch_mod__prompt_kernel
    s_subb_u32 s5, s5, 0
    s_mov_b32 s6, L_end - gated_mix__ssm_conv_s5__moe_arch_mod__prompt_kernel
    s_lshl_b32 s33, s25, 10
    s_cmp_lg_u32 s29, 0
    s_cbranch_scc1 Lc_nopf
    buffer_load_dwordx4 v[92:95], v196, s[4:7], s33 offen
Lc_nopf:
    v_lshrrev_b32 v8, 1, v6
    v_xor_b32 v8, v8, v7
    v_lshlrev_b32 v8, 4, v8
    v_lshl_add_u32 v8, v6, 7, v8
    s_lshl_b32 s33, s30, 13
    s_lshl_b32 s34, s31, 13
    s_add_u32 s34, s34, 16384
    v_add_u32 v2, s33, v8
    v_add_u32 v4, s34, v8
    v_xor_b32 v3, 64, v2
    v_xor_b32 v5, 64, v4
    s_lshl_b32 s33, s27, 14
    s_add_u32 s33, s33, 65536
    s_add_u32 s36, s16, s33
    s_addc_u32 s37, s17, 0
    s_mov_b32 s38, 16384
    s_mov_b32 s39, 0x20000
    s_add_u32 s33, s27, s26
    s_and_b32 s33, s33, 15
    s_lshl_b32 s33, s33, 2
    s_add_u32 s33, s33, s31
    s_lshl_b32 s33, s33, 3
    s_lshl_b32 s34, s26, 9
    s_add_u32 s33, s33, s34
    s_lshl_b32 s34, s30, 2
    s_add_u32 s33, s33, s34
    s_lshl_b32 s33, s33, 10
    s_add_u32 s33, s33, 4194304
    s_add_u32 s40, s16, s33
    s_addc_u32 s41, s17, 0
    s_mov_b32 s42, 20480
    s_mov_b32 s43, 0x20000
    v_mov_b32 v96, 0
    v_mov_b32 v97, 0
    v_mov_b32 v98, 0
    v_mov_b32 v99, 0
    v_mov_b32 v100, 0
    v_mov_b32 v101, 0
    v_mov_b32 v102, 0
    v_mov_b32 v103, 0
    v_mov_b32 v104, 0
    v_mov_b32 v105, 0
    v_mov_b32 v106, 0
    v_mov_b32 v107, 0
    v_mov_b32 v108, 0
    v_mov_b32 v109, 0
    v_mov_b32 v110, 0
    v_mov_b32 v111, 0
    v_mov_b32 v112, 0
    v_mov_b32 v113, 0
    v_mov_b32 v114, 0
    v_mov_b32 v115, 0
    v_mov_b32 v116, 0
    v_mov_b32 v117, 0
    v_mov_b32 v118, 0
    v_mov_b32 v119, 0
    v_mov_b32 v120, 0
    v_mov_b32 v121, 0
    v_mov_b32 v122, 0
    v_mov_b32 v123, 0
    v_mov_b32 v124, 0
    v_mov_b32 v125, 0
    v_mov_b32 v126, 0
    v_mov_b32 v127, 0
    v_mov_b32 v128, 0
    v_mov_b32 v129, 0
    v_mov_b32 v130, 0
    v_mov_b32 v131, 0
    v_mov_b32 v132, 0
    v_mov_b32 v133, 0
    v_mov_b32 v134, 0
    v_mov_b32 v135, 0
    v_mov_b32 v136, 0
    v_mov_b32 v137, 0
    v_mov_b32 v138, 0
    v_mov_b32 v139, 0
    v_mov_b32 v140, 0
    v_mov_b32 v141, 0
    v_mov_b32 v142, 0
    v_mov_b32 v143, 0
    v_mov_b32 v144, 0
    v_mov_b32 v145, 0
    v_mov_b32 v146, 0
    v_mov_b32 v147, 0
    v_mov_b32 v148, 0
    v_mov_b32 v149, 0
    v_mov_b32 v150, 0
    v_mov_b32 v151, 0
    v_mov_b32 v152, 0
    v_mov_b32 v153, 0
    v_mov_b32 v154, 0
    v_mov_b32 v155, 0
    v_mov_b32 v156, 0
    v_mov_b32 v157, 0
    v_mov_b32 v158, 0
    v_mov_b32 v159, 0
    s_waitcnt vmcnt(0)
    v_lshlrev_b32 v26, 16, v26
    v_lshlrev_b32 v32, 16, v32
    v_lshlrev_b32 v34, 16, v34
    v_mul_f32 v26, 0x3fb8aa3b, v26
    v_exp_f32 v26, v26
    v_lshlrev_b32 v27, 16, v27
    v_lshlrev_b32 v33, 16, v33
    v_lshlrev_b32 v35, 16, v35
    v_mul_f32 v27, 0x3fb8aa3b, v27
    v_exp_f32 v27, v27
    s_nop 0
    v_cvt_pk_bf16_f32 v26, v26, v27
    v_and_b32 v27, 0xffff0000, v26
    v_lshlrev_b32 v26, 16, v26
    v_pk_mul_f32 v[28:29], v[26:27], v[34:35]
    v_pk_mul_f32 v[26:27], v[26:27], v[32:33]
    v_mul_f32 v26, 0x3fb8aa3b, v26
    v_mul_f32 v28, 0x3e22f983, v28
    v_exp_f32 v26, v26
    v_rndne_f32 v10, v28
    v_sub_f32 v28, v28, v10
    v_cos_f32 v10, v28
    v_sin_f32 v12, v28
    v_mul_f32 v27, 0x3fb8aa3b, v27
    v_mul_f32 v29, 0x3e22f983, v29
    v_exp_f32 v27, v27
    v_rndne_f32 v11, v29
    v_sub_f32 v29, v29, v11
    v_cos_f32 v11, v29
    v_sin_f32 v13, v29
    v_pk_mul_f32 v[10:11], v[10:11], v[26:27]
    v_pk_mul_f32 v[12:13], v[12:13], v[26:27]
    v_pk_mul_f32 v[26:27], v[10:11], v[12:13]
    v_pk_mul_f32 v[14:15], v[10:11], v[10:11]
    v_pk_fma_f32 v[14:15], v[12:13], v[12:13], v[14:15] neg_lo:[1,0,0] neg_hi:[1,0,0]
    v_pk_add_f32 v[16:17], v[26:27], v[26:27]
    v_pk_mul_f32 v[26:27], v[14:15], v[16:17]
    v_pk_mul_f32 v[18:19], v[14:15], v[14:15]
    v_pk_fma_f32 v[18:19], v[16:17], v[16:17], v[18:19] neg_lo:[1,0,0] neg_hi:[1,0,0]
    v_pk_add_f32 v[20:21], v[26:27], v[26:27]
    v_pk_mul_f32 v[26:27], v[18:19], v[20:21]
    v_pk_mul_f32 v[14:15], v[18:19], v[18:19]
    v_pk_fma_f32 v[14:15], v[20:21], v[20:21], v[14:15] neg_lo:[1,0,0] neg_hi:[1,0,0]
    v_pk_add_f32 v[16:17], v[26:27], v[26:27]
    v_pk_mul_f32 v[26:27], v[14:15], v[16:17]
    v_pk_mul_f32 v[18:19], v[14:15], v[14:15]
    v_pk_fma_f32 v[18:19], v[16:17], v[16:17], v[18:19] neg_lo:[1,0,0] neg_hi:[1,0,0]
    v_pk_add_f32 v[20:21], v[26:27], v[26:27]
    s_lshl_b32 s33, s30, 2
    v_add_u32 v8, s33, v7
    v_and_b32 v9, 1, v8
    v_cmp_ne_u32 vcc, 0, v9
    s_nop 1
    v_cndmask_b32 v44, 1.0, v18, vcc
    v_cndmask_b32 v46, 0, v20, vcc
    v_cndmask_b32 v45, 1.0, v19, vcc
    v_cndmask_b32 v47, 0, v21, vcc
    v_pk_mul_f32 v[52:53], v[18:19], v[20:21]
    v_pk_mul_f32 v[36:37], v[18:19], v[18:19]
    v_pk_fma_f32 v[36:37], v[20:21], v[20:21], v[36:37] neg_lo:[1,0,0] neg_hi:[1,0,0]
    v_pk_add_f32 v[38:39], v[52:53], v[52:53]
    v_and_b32 v9, 2, v8
    v_cmp_ne_u32 vcc, 0, v9
    s_nop 1
    v_cndmask_b32 v22, 1.0, v36, vcc
    v_cndmask_b32 v24, 0, v38, vcc
    v_cndmask_b32 v23, 1.0, v37, vcc
    v_cndmask_b32 v25, 0, v39, vcc
    v_pk_mul_f32 v[240:241], v[44:45], v[22:23]
    v_pk_mul_f32 v[242:243], v[44:45], v[24:25]
    v_pk_fma_f32 v[240:241], v[46:47], v[24:25], v[240:241] neg_lo:[1,0,0] neg_hi:[1,0,0]
    v_pk_fma_f32 v[242:243], v[46:47], v[22:23], v[242:243]
    v_pk_mul_f32 v[52:53], v[36:37], v[38:39]
    v_pk_mul_f32 v[40:41], v[36:37], v[36:37]
    v_pk_fma_f32 v[40:41], v[38:39], v[38:39], v[40:41] neg_lo:[1,0,0] neg_hi:[1,0,0]
    v_pk_add_f32 v[42:43], v[52:53], v[52:53]
    v_and_b32 v9, 4, v8
    v_cmp_ne_u32 vcc, 0, v9
    s_nop 1
    v_cndmask_b32 v22, 1.0, v40, vcc
    v_cndmask_b32 v24, 0, v42, vcc
    v_cndmask_b32 v23, 1.0, v41, vcc
    v_cndmask_b32 v25, 0, v43, vcc
    v_pk_mul_f32 v[44:45], v[240:241], v[22:23]
    v_pk_mul_f32 v[46:47], v[240:241], v[24:25]
    v_pk_fma_f32 v[44:45], v[242:243], v[24:25], v[44:45] neg_lo:[1,0,0] neg_hi:[1,0,0]
    v_pk_fma_f32 v[46:47], v[242:243], v[22:23], v[46:47]
    v_pk_mul_f32 v[52:53], v[40:41], v[42:43]
    v_pk_mul_f32 v[36:37], v[40:41], v[40:41]
    v_pk_fma_f32 v[36:37], v[42:43], v[42:43], v[36:37] neg_lo:[1,0,0] neg_hi:[1,0,0]
    v_pk_add_f32 v[38:39], v[52:53], v[52:53]
    v_and_b32 v9, 1, v7
    v_cmp_ne_u32 vcc, 0, v9
    s_nop 1
    v_cndmask_b32 v48, 1.0, v36, vcc
    v_cndmask_b32 v50, 0, v38, vcc
    v_cndmask_b32 v49, 1.0, v37, vcc
    v_cndmask_b32 v51, 0, v39, vcc
    v_pk_mul_f32 v[52:53], v[36:37], v[38:39]
    v_pk_mul_f32 v[40:41], v[36:37], v[36:37]
    v_pk_fma_f32 v[40:41], v[38:39], v[38:39], v[40:41] neg_lo:[1,0,0] neg_hi:[1,0,0]
    v_pk_add_f32 v[42:43], v[52:53], v[52:53]
    v_and_b32 v9, 2, v7
    v_cmp_ne_u32 vcc, 0, v9
    s_nop 1
    v_cndmask_b32 v22, 1.0, v40, vcc
    v_cndmask_b32 v24, 0, v42, vcc
    v_cndmask_b32 v23, 1.0, v41, vcc
    v_cndmask_b32 v25, 0, v43, vcc
    v_pk_mul_f32 v[240:241], v[48:49], v[22:23]
    v_pk_mul_f32 v[242:243], v[48:49], v[24:25]
    v_pk_fma_f32 v[240:241], v[50:51], v[24:25], v[240:241] neg_lo:[1,0,0] neg_hi:[1,0,0]
    v_pk_fma_f32 v[242:243], v[50:51], v[22:23], v[242:243]
    v_pk_mul_f32 v[52:53], v[40:41], v[42:43]
    v_pk_mul_f32 v[244:245], v[40:41], v[40:41]
    v_pk_fma_f32 v[244:245], v[42:43], v[42:43], v[244:245] neg_lo:[1,0,0] neg_hi:[1,0,0]
    v_pk_add_f32 v[246:247], v[52:53], v[52:53]
    v_pk_mul_f32 v[36:37], v[44:45], v[14:15]
    v_pk_mul_f32 v[38:39], v[44:45], v[16:17]
    v_pk_fma_f32 v[36:37], v[46:47], v[16:17], v[36:37] neg_lo:[1,0,0] neg_hi:[1,0,0]
    v_pk_fma_f32 v[38:39], v[46:47], v[14:15], v[38:39]
    v_mov_b32 v232, v44
    v_mov_b32 v233, v36
    v_mov_b32 v236, v46
    v_mov_b32 v237, v38
    v_mov_b32 v234, v45
    v_mov_b32 v235, v37
    v_mov_b32 v238, v47
    v_mov_b32 v239, v39
    v_max_f32 v26, |v32|, |v34|
    v_rcp_f32 v28, v26
    v_max_f32 v27, |v33|, |v35|
    v_rcp_f32 v29, v27
    s_nop 0
    v_pk_mul_f32 v[32:33], v[32:33], v[28:29]
    v_pk_mul_f32 v[34:35], v[34:35], v[28:29]
    v_pk_mul_f32 v[28:29], v[32:33], v[32:33]
    v_pk_fma_f32 v[28:29], v[34:35], v[34:35], v[28:29]
    v_pk_mul_f32 v[28:29], v[28:29], v[26:27]
    v_rcp_f32 v28, v28
    v_add_f32 v26, -1.0, v10
    v_rcp_f32 v29, v29
    v_add_f32 v27, -1.0, v11
    v_pk_add_f32 v[28:29], v[28:29], v[28:29]
    v_pk_mul_f32 v[22:23], v[26:27], v[32:33]
    v_pk_mul_f32 v[24:25], v[12:13], v[32:33]
    v_pk_fma_f32 v[22:23], v[12:13], v[34:35], v[22:23]
    v_pk_fma_f32 v[24:25], v[26:27], v[34:35], v[24:25] neg_lo:[1,0,0] neg_hi:[1,0,0]
    v_pk_mul_f32 v[22:23], v[22:23], v[28:29]
    v_pk_mul_f32 v[24:25], v[24:25], v[28:29]
    v_mov_b32 v26, v22
    v_mov_b32 v27, v24
    v_mov_b32 v28, v23
    v_mov_b32 v29, v25
    v_pk_mul_f32 v[200:201], v[10:11], v[26:27] op_sel_hi:[0,1]
    v_pk_mul_f32 v[202:203], v[10:11], v[28:29] op_sel:[1,0]
    v_pk_fma_f32 v[200:201], v[26:27], v[12:13], v[200:201] op_sel:[1,0,0] op_sel_hi:[0,0,1] neg_lo:[1,0,0]
    v_pk_fma_f32 v[202:203], v[12:13], v[28:29], v[202:203] op_sel:[1,1,0] op_sel_hi:[1,0,1] neg_lo:[0,1,0]
    v_pk_mul_f32 v[204:205], v[10:11], v[200:201] op_sel_hi:[0,1]
    v_pk_mul_f32 v[206:207], v[10:11], v[202:203] op_sel:[1,0]
    v_pk_fma_f32 v[204:205], v[200:201], v[12:13], v[204:205] op_sel:[1,0,0] op_sel_hi:[0,0,1] neg_lo:[1,0,0]
    v_pk_fma_f32 v[206:207], v[12:13], v[202:203], v[206:207] op_sel:[1,1,0] op_sel_hi:[1,0,1] neg_lo:[0,1,0]
    v_pk_mul_f32 v[208:209], v[10:11], v[204:205] op_sel_hi:[0,1]
    v_pk_mul_f32 v[210:211], v[10:11], v[206:207] op_sel:[1,0]
    v_pk_fma_f32 v[208:209], v[204:205], v[12:13], v[208:209] op_sel:[1,0,0] op_sel_hi:[0,0,1] neg_lo:[1,0,0]
    v_pk_fma_f32 v[210:211], v[12:13], v[206:207], v[210:211] op_sel:[1,1,0] op_sel_hi:[1,0,1] neg_lo:[0,1,0]
    v_pk_mul_f32 v[212:213], v[10:11], v[208:209] op_sel_hi:[0,1]
    v_pk_mul_f32 v[214:215], v[10:11], v[210:211] op_sel:[1,0]
    v_pk_fma_f32 v[212:213], v[208:209], v[12:13], v[212:213] op_sel:[1,0,0] op_sel_hi:[0,0,1] neg_lo:[1,0,0]
    v_pk_fma_f32 v[214:215], v[12:13], v[210:211], v[214:215] op_sel:[1,1,0] op_sel_hi:[1,0,1] neg_lo:[0,1,0]
    v_pk_mul_f32 v[216:217], v[10:11], v[212:213] op_sel_hi:[0,1]
    v_pk_mul_f32 v[218:219], v[10:11], v[214:215] op_sel:[1,0]
    v_pk_fma_f32 v[216:217], v[212:213], v[12:13], v[216:217] op_sel:[1,0,0] op_sel_hi:[0,0,1] neg_lo:[1,0,0]
    v_pk_fma_f32 v[218:219], v[12:13], v[214:215], v[218:219] op_sel:[1,1,0] op_sel_hi:[1,0,1] neg_lo:[0,1,0]
    v_pk_mul_f32 v[220:221], v[10:11], v[216:217] op_sel_hi:[0,1]
    v_pk_mul_f32 v[222:223], v[10:11], v[218:219] op_sel:[1,0]
    v_pk_fma_f32 v[220:221], v[216:217], v[12:13], v[220:221] op_sel:[1,0,0] op_sel_hi:[0,0,1] neg_lo:[1,0,0]
    v_pk_fma_f32 v[222:223], v[12:13], v[218:219], v[222:223] op_sel:[1,1,0] op_sel_hi:[1,0,1] neg_lo:[0,1,0]
    v_pk_mul_f32 v[224:225], v[10:11], v[220:221] op_sel_hi:[0,1]
    v_pk_mul_f32 v[226:227], v[10:11], v[222:223] op_sel:[1,0]
    v_pk_fma_f32 v[224:225], v[220:221], v[12:13], v[224:225] op_sel:[1,0,0] op_sel_hi:[0,0,1] neg_lo:[1,0,0]
    v_pk_fma_f32 v[226:227], v[12:13], v[222:223], v[226:227] op_sel:[1,1,0] op_sel_hi:[1,0,1] neg_lo:[0,1,0]
    v_pk_mul_f32 v[228:229], v[10:11], v[224:225] op_sel_hi:[0,1]
    v_pk_mul_f32 v[230:231], v[10:11], v[226:227] op_sel:[1,0]
    v_pk_fma_f32 v[228:229], v[224:225], v[12:13], v[228:229] op_sel:[1,0,0] op_sel_hi:[0,0,1] neg_lo:[1,0,0]
    v_pk_fma_f32 v[230:231], v[12:13], v[226:227], v[230:231] op_sel:[1,1,0] op_sel_hi:[1,0,1] neg_lo:[0,1,0]
    s_waitcnt lgkmcnt(0)
    s_mul_i32 s44, s44, 1664525
    s_add_u32 s44, s44, 1013904223
    s_sub_u32 s33, s26, 1
    v_sub_u32 v8, s33, v7
    v_lshlrev_b32 v8, 10, v8
    v_lshl_add_u32 v8, v6, 4, v8
    s_lshl_b32 s33, s31, 9
    v_add_u32 v192, s33, v8
    v_add_u32 v193, -4096, v192
    v_add_u32 v194, -8192, v192
    v_add_u32 v195, -12288, v192
    v_mov_b32 v9, s44
    v_cmp_le_i32 vcc, 0, v192
    s_nop 1
    v_cndmask_b32 v248, 0, v9, vcc
    v_cndmask_b32 v249, 0, v9, vcc
    v_cmp_le_i32 vcc, 0, v193
    s_nop 1
    v_cndmask_b32 v250, 0, v9, vcc
    v_cndmask_b32 v251, 0, v9, vcc
    v_cmp_le_i32 vcc, 0, v194
    s_nop 1
    v_cndmask_b32 v252, 0, v9, vcc
    v_cndmask_b32 v253, 0, v9, vcc
    v_cmp_le_i32 vcc, 0, v195
    s_nop 1
    v_cndmask_b32 v254, 0, v9, vcc
    v_cndmask_b32 v255, 0, v9, vcc
    s_lshl_b32 s33, s31, 8
    s_add_u32 s33, s33, 148480
    v_lshl_add_u32 v30, v6, 3, s33
    s_lshl_b32 s33, s30, 11
    v_lshl_add_u32 v31, v7, 9, s33
    v_add_u32 v31, v31, v30
    s_lshl_b32 s33, s29, 2
    s_add_u32 s34, s33, 147456
    v_mov_b32 v8, s34
    s_xor_b32 s34, s34, 8
    v_mov_b32 v9, s34
    s_setprio 3
    s_barrier
    ds_read_b128 v[32:35], v2 offset:0
    ds_read_b128 v[48:51], v4 offset:0
    ds_read_b128 v[52:55], v4 offset:2048
    ds_read_b128 v[56:59], v4 offset:4096
    ds_read_b128 v[60:63], v4 offset:6144
    ds_read_b128 v[36:39], v2 offset:2048
    ds_read_b128 v[40:43], v2 offset:4096
    ds_read_b128 v[44:47], v2 offset:6144
    s_mov_b32 s35, 0
Lc_loop:
    s_waitcnt lgkmcnt(0)
    v_mfma_f32_16x16x32_bf16 v[96:99], v[32:35], v[48:51], v[96:99]
    ds_read_b128 v[64:67], v3 offset:0
    v_mfma_f32_16x16x32_bf16 v[128:131], v[32:35], v[52:55], v[128:131]
    ds_read_b128 v[80:83], v5 offset:0
    v_mfma_f32_16x16x32_bf16 v[112:115], v[32:35], v[56:59], v[112:115]
    ds_read_b128 v[84:87], v5 offset:2048
    v_mfma_f32_16x16x32_bf16 v[144:147], v[32:35], v[60:63], v[144:147]
    ds_read_b128 v[88:91], v5 offset:4096
    v_mfma_f32_16x16x32_bf16 v[148:151], v[36:39], v[60:63], v[148:151]
    ds_read_b128 v[92:95], v5 offset:6144
    v_mfma_f32_16x16x32_bf16 v[116:119], v[36:39], v[56:59], v[116:119]
    ds_read_b128 v[68:71], v3 offset:2048
    v_mfma_f32_16x16x32_bf16 v[132:135], v[36:39], v[52:55], v[132:135]
    ds_read_b128 v[72:75], v3 offset:4096
    v_mfma_f32_16x16x32_bf16 v[100:103], v[36:39], v[48:51], v[100:103]
    ds_read_b128 v[76:79], v3 offset:6144
    v_mfma_f32_16x16x32_bf16 v[104:107], v[40:43], v[48:51], v[104:107]
    v_mfma_f32_16x16x32_bf16 v[136:139], v[40:43], v[52:55], v[136:139]
    v_mfma_f32_16x16x32_bf16 v[120:123], v[40:43], v[56:59], v[120:123]
    v_mfma_f32_16x16x32_bf16 v[152:155], v[40:43], v[60:63], v[152:155]
    v_mfma_f32_16x16x32_bf16 v[156:159], v[44:47], v[60:63], v[156:159]
    v_mfma_f32_16x16x32_bf16 v[124:127], v[44:47], v[56:59], v[124:127]
    v_mfma_f32_16x16x32_bf16 v[140:143], v[44:47], v[52:55], v[140:143]
    v_mfma_f32_16x16x32_bf16 v[108:111], v[44:47], v[48:51], v[108:111]
    s_waitcnt lgkmcnt(0)
    v_mfma_f32_16x16x32_bf16 v[96:99], v[64:67], v[80:83], v[96:99]
    v_mfma_f32_16x16x32_bf16 v[128:131], v[64:67], v[84:87], v[128:131]
    v_mfma_f32_16x16x32_bf16 v[112:115], v[64:67], v[88:91], v[112:115]
    s_barrier
    v_mfma_f32_16x16x32_bf16 v[144:147], v[64:67], v[92:95], v[144:147]
    ds_read_b128 v[32:35], v2 offset:32768
    v_mfma_f32_16x16x32_bf16 v[148:151], v[68:71], v[92:95], v[148:151]
    ds_read_b128 v[48:51], v4 offset:32768
    v_mfma_f32_16x16x32_bf16 v[116:119], v[68:71], v[88:91], v[116:119]
    ds_read_b128 v[52:55], v4 offset:34816
    v_mfma_f32_16x16x32_bf16 v[132:135], v[68:71], v[84:87], v[132:135]
    ds_read_b128 v[56:59], v4 offset:36864
    v_mfma_f32_16x16x32_bf16 v[100:103], v[68:71], v[80:83], v[100:103]
    ds_read_b128 v[60:63], v4 offset:38912
    v_mfma_f32_16x16x32_bf16 v[104:107], v[72:75], v[80:83], v[104:107]
    ds_read_b128 v[36:39], v2 offset:34816
    v_mfma_f32_16x16x32_bf16 v[136:139], v[72:75], v[84:87], v[136:139]
    ds_read_b128 v[40:43], v2 offset:36864
    v_mfma_f32_16x16x32_bf16 v[120:123], v[72:75], v[88:91], v[120:123]
    ds_read_b128 v[44:47], v2 offset:38912
    v_mfma_f32_16x16x32_bf16 v[152:155], v[72:75], v[92:95], v[152:155]
    v_mfma_f32_16x16x32_bf16 v[156:159], v[76:79], v[92:95], v[156:159]
    v_mfma_f32_16x16x32_bf16 v[124:127], v[76:79], v[88:91], v[124:127]
    v_mfma_f32_16x16x32_bf16 v[140:143], v[76:79], v[84:87], v[140:143]
    v_mfma_f32_16x16x32_bf16 v[108:111], v[76:79], v[80:83], v[108:111]
    s_waitcnt lgkmcnt(0)
    v_mfma_f32_16x16x32_bf16 v[96:99], v[32:35], v[48:51], v[96:99]
    ds_read_b128 v[64:67], v3 offset:32768
    v_mfma_f32_16x16x32_bf16 v[128:131], v[32:35], v[52:55], v[128:131]
    ds_read_b128 v[80:83], v5 offset:32768
    v_mfma_f32_16x16x32_bf16 v[112:115], v[32:35], v[56:59], v[112:115]
    ds_read_b128 v[84:87], v5 offset:34816
    v_mfma_f32_16x16x32_bf16 v[144:147], v[32:35], v[60:63], v[144:147]
    ds_read_b128 v[88:91], v5 offset:36864
    v_mfma_f32_16x16x32_bf16 v[148:151], v[36:39], v[60:63], v[148:151]
    ds_read_b128 v[92:95], v5 offset:38912
    v_mfma_f32_16x16x32_bf16 v[116:119], v[36:39], v[56:59], v[116:119]
    ds_read_b128 v[68:71], v3 offset:34816
    v_mfma_f32_16x16x32_bf16 v[132:135], v[36:39], v[52:55], v[132:135]
    ds_read_b128 v[72:75], v3 offset:36864
    v_mfma_f32_16x16x32_bf16 v[100:103], v[36:39], v[48:51], v[100:103]
    ds_read_b128 v[76:79], v3 offset:38912
    v_mfma_f32_16x16x32_bf16 v[104:107], v[40:43], v[48:51], v[104:107]
    v_mfma_f32_16x16x32_bf16 v[136:139], v[40:43], v[52:55], v[136:139]
    v_mfma_f32_16x16x32_bf16 v[120:123], v[40:43], v[56:59], v[120:123]
    v_mfma_f32_16x16x32_bf16 v[152:155], v[40:43], v[60:63], v[152:155]
    v_mfma_f32_16x16x32_bf16 v[156:159], v[44:47], v[60:63], v[156:159]
    v_mfma_f32_16x16x32_bf16 v[124:127], v[44:47], v[56:59], v[124:127]
    v_mfma_f32_16x16x32_bf16 v[140:143], v[44:47], v[52:55], v[140:143]
    v_mfma_f32_16x16x32_bf16 v[108:111], v[44:47], v[48:51], v[108:111]
    s_waitcnt lgkmcnt(0)
    v_mfma_f32_16x16x32_bf16 v[96:99], v[64:67], v[80:83], v[96:99]
    v_xor_b32 v2, 0x10000, v2
    v_xor_b32 v3, 0x10000, v3
    v_xor_b32 v4, 0x10000, v4
    v_xor_b32 v5, 0x10000, v5
    v_mfma_f32_16x16x32_bf16 v[128:131], v[64:67], v[84:87], v[128:131]
    v_mfma_f32_16x16x32_bf16 v[112:115], v[64:67], v[88:91], v[112:115]
    s_cmp_eq_u32 s35, 7
    s_cbranch_scc1 Lc_nobar
    s_barrier
Lc_nobar:
    v_mfma_f32_16x16x32_bf16 v[144:147], v[64:67], v[92:95], v[144:147]
    ds_read_b128 v[32:35], v2 offset:0
    v_mfma_f32_16x16x32_bf16 v[148:151], v[68:71], v[92:95], v[148:151]
    ds_read_b128 v[48:51], v4 offset:0
    v_mfma_f32_16x16x32_bf16 v[116:119], v[68:71], v[88:91], v[116:119]
    ds_read_b128 v[52:55], v4 offset:2048
    v_mfma_f32_16x16x32_bf16 v[132:135], v[68:71], v[84:87], v[132:135]
    ds_read_b128 v[56:59], v4 offset:4096
    v_mfma_f32_16x16x32_bf16 v[100:103], v[68:71], v[80:83], v[100:103]
    ds_read_b128 v[60:63], v4 offset:6144
    v_mfma_f32_16x16x32_bf16 v[104:107], v[72:75], v[80:83], v[104:107]
    ds_read_b128 v[36:39], v2 offset:2048
    v_mfma_f32_16x16x32_bf16 v[136:139], v[72:75], v[84:87], v[136:139]
    ds_read_b128 v[40:43], v2 offset:4096
    v_mfma_f32_16x16x32_bf16 v[120:123], v[72:75], v[88:91], v[120:123]
    ds_read_b128 v[44:47], v2 offset:6144
    v_mfma_f32_16x16x32_bf16 v[152:155], v[72:75], v[92:95], v[152:155]
    v_mfma_f32_16x16x32_bf16 v[156:159], v[76:79], v[92:95], v[156:159]
    v_mfma_f32_16x16x32_bf16 v[124:127], v[76:79], v[88:91], v[124:127]
    v_mfma_f32_16x16x32_bf16 v[140:143], v[76:79], v[84:87], v[140:143]
    v_mfma_f32_16x16x32_bf16 v[108:111], v[76:79], v[80:83], v[108:111]
    s_add_u32 s35, s35, 1
    s_cmp_lt_u32 s35, 8
    s_cbranch_scc1 Lc_loop
    s_waitcnt lgkmcnt(0)
    v_pk_fma_f32 v[98:99], v[10:11], v[96:97], v[98:99] op_sel_hi:[0,1,1]
    v_pk_fma_f32 v[130:131], v[10:11], v[128:129], v[130:131] op_sel:[1,0,0]
    v_pk_fma_f32 v[114:115], v[10:11], v[112:113], v[114:115] op_sel_hi:[0,1,1]
    v_pk_fma_f32 v[146:147], v[10:11], v[144:145], v[146:147] op_sel:[1,0,0]
    v_pk_fma_f32 v[98:99], v[12:13], v[112:113], v[98:99] op_sel_hi:[0,1,1] neg_lo:[1,0,0] neg_hi:[1,0,0]
    v_pk_fma_f32 v[130:131], v[12:13], v[144:145], v[130:131] op_sel:[1,0,0] neg_lo:[1,0,0] neg_hi:[1,0,0]
    v_pk_fma_f32 v[114:115], v[12:13], v[96:97], v[114:115] op_sel_hi:[0,1,1]
    v_pk_fma_f32 v[146:147], v[12:13], v[128:129], v[146:147] op_sel:[1,0,0]
    v_pk_fma_f32 v[100:101], v[10:11], v[98:99], v[100:101] op_sel_hi:[0,1,1]
    v_pk_fma_f32 v[132:133], v[10:11], v[130:131], v[132:133] op_sel:[1,0,0]
    v_pk_fma_f32 v[116:117], v[10:11], v[114:115], v[116:117] op_sel_hi:[0,1,1]
    v_pk_fma_f32 v[148:149], v[10:11], v[146:147], v[148:149] op_sel:[1,0,0]
    v_pk_fma_f32 v[100:101], v[12:13], v[114:115], v[100:101] op_sel_hi:[0,1,1] neg_lo:[1,0,0] neg_hi:[1,0,0]
    v_pk_fma_f32 v[132:133], v[12:13], v[146:147], v[132:133] op_sel:[1,0,0] neg_lo:[1,0,0] neg_hi:[1,0,0]
    v_pk_fma_f32 v[116:117], v[12:13], v[98:99], v[116:117] op_sel_hi:[0,1,1]
    v_pk_fma_f32 v[148:149], v[12:13], v[130:131], v[148:149] op_sel:[1,0,0]
    v_pk_fma_f32 v[102:103], v[10:11], v[100:101], v[102:103] op_sel_hi:[0,1,1]
    v_pk_fma_f32 v[134:135], v[10:11], v[132:133], v[134:135] op_sel:[1,0,0]
    v_pk_fma_f32 v[118:119], v[10:11], v[116:117], v[118:119] op_sel_hi:[0,1,1]
    v_pk_fma_f32 v[150:151], v[10:11], v[148:149], v[150:151] op_sel:[1,0,0]
    v_pk_fma_f32 v[102:103], v[12:13], v[116:117], v[102:103] op_sel_hi:[0,1,1] neg_lo:[1,0,0] neg_hi:[1,0,0]
    v_pk_fma_f32 v[134:135], v[12:13], v[148:149], v[134:135] op_sel:[1,0,0] neg_lo:[1,0,0] neg_hi:[1,0,0]
    v_pk_fma_f32 v[118:119], v[12:13], v[100:101], v[118:119] op_sel_hi:[0,1,1]
    v_pk_fma_f32 v[150:151], v[12:13], v[132:133], v[150:151] op_sel:[1,0,0]
    v_pk_fma_f32 v[104:105], v[10:11], v[102:103], v[104:105] op_sel_hi:[0,1,1]
    v_pk_fma_f32 v[136:137], v[10:11], v[134:135], v[136:137] op_sel:[1,0,0]
    v_pk_fma_f32 v[120:121], v[10:11], v[118:119], v[120:121] op_sel_hi:[0,1,1]
    v_pk_fma_f32 v[152:153], v[10:11], v[150:151], v[152:153] op_sel:[1,0,0]
    v_pk_fma_f32 v[104:105], v[12:13], v[118:119], v[104:105] op_sel_hi:[0,1,1] neg_lo:[1,0,0] neg_hi:[1,0,0]
    v_pk_fma_f32 v[136:137], v[12:13], v[150:151], v[136:137] op_sel:[1,0,0] neg_lo:[1,0,0] neg_hi:[1,0,0]
    v_pk_fma_f32 v[120:121], v[12:13], v[102:103], v[120:121] op_sel_hi:[0,1,1]
    v_pk_fma_f32 v[152:153], v[12:13], v[134:135], v[152:153] op_sel:[1,0,0]
    v_pk_fma_f32 v[106:107], v[10:11], v[104:105], v[106:107] op_sel_hi:[0,1,1]
    v_pk_fma_f32 v[138:139], v[10:11], v[136:137], v[138:139] op_sel:[1,0,0]
    v_pk_fma_f32 v[122:123], v[10:11], v[120:121], v[122:123] op_sel_hi:[0,1,1]
    v_pk_fma_f32 v[154:155], v[10:11], v[152:153], v[154:155] op_sel:[1,0,0]
    v_pk_fma_f32 v[106:107], v[12:13], v[120:121], v[106:107] op_sel_hi:[0,1,1] neg_lo:[1,0,0] neg_hi:[1,0,0]
    v_pk_fma_f32 v[138:139], v[12:13], v[152:153], v[138:139] op_sel:[1,0,0] neg_lo:[1,0,0] neg_hi:[1,0,0]
    v_pk_fma_f32 v[122:123], v[12:13], v[104:105], v[122:123] op_sel_hi:[0,1,1]
    v_pk_fma_f32 v[154:155], v[12:13], v[136:137], v[154:155] op_sel:[1,0,0]
    v_pk_fma_f32 v[108:109], v[10:11], v[106:107], v[108:109] op_sel_hi:[0,1,1]
    v_pk_fma_f32 v[140:141], v[10:11], v[138:139], v[140:141] op_sel:[1,0,0]
    v_pk_fma_f32 v[124:125], v[10:11], v[122:123], v[124:125] op_sel_hi:[0,1,1]
    v_pk_fma_f32 v[156:157], v[10:11], v[154:155], v[156:157] op_sel:[1,0,0]
    v_pk_fma_f32 v[108:109], v[12:13], v[122:123], v[108:109] op_sel_hi:[0,1,1] neg_lo:[1,0,0] neg_hi:[1,0,0]
    v_pk_fma_f32 v[140:141], v[12:13], v[154:155], v[140:141] op_sel:[1,0,0] neg_lo:[1,0,0] neg_hi:[1,0,0]
    v_pk_fma_f32 v[124:125], v[12:13], v[106:107], v[124:125] op_sel_hi:[0,1,1]
    v_pk_fma_f32 v[156:157], v[12:13], v[138:139], v[156:157] op_sel:[1,0,0]
    v_pk_fma_f32 v[110:111], v[10:11], v[108:109], v[110:111] op_sel_hi:[0,1,1]
    v_pk_fma_f32 v[142:143], v[10:11], v[140:141], v[142:143] op_sel:[1,0,0]
    v_pk_fma_f32 v[126:127], v[10:11], v[124:125], v[126:127] op_sel_hi:[0,1,1]
    v_pk_fma_f32 v[158:159], v[10:11], v[156:157], v[158:159] op_sel:[1,0,0]
    v_pk_fma_f32 v[110:111], v[12:13], v[124:125], v[110:111] op_sel_hi:[0,1,1] neg_lo:[1,0,0] neg_hi:[1,0,0]
    v_pk_fma_f32 v[142:143], v[12:13], v[156:157], v[142:143] op_sel:[1,0,0] neg_lo:[1,0,0] neg_hi:[1,0,0]
    v_pk_fma_f32 v[126:127], v[12:13], v[108:109], v[126:127] op_sel_hi:[0,1,1]
    v_pk_fma_f32 v[158:159], v[12:13], v[140:141], v[158:159] op_sel:[1,0,0]
    v_fma_f32 v26, v14, v110, v111
    v_fma_f32 v27, v14, v126, v127
    v_fma_f32 v26, -v16, v126, v26
    v_fma_f32 v27, v16, v110, v27
    v_fma_f32 v28, v15, v142, v143
    v_fma_f32 v29, v15, v158, v159
    v_fma_f32 v28, -v17, v158, v28
    v_fma_f32 v29, v17, v142, v29
    ds_write_b64 v31, v[26:27]
    ds_write_b64 v31, v[28:29] offset:128
    ds_write_b32 v8, v8
    s_mov_b32 s45, 32768
Lc_expoll:
    ds_read_b32 v8, v9
    ds_read_b64 v[32:33], v30 offset:0
    ds_read_b64 v[34:35], v30 offset:128
    ds_read_b64 v[36:37], v30 offset:512
    ds_read_b64 v[38:39], v30 offset:640
    ds_read_b64 v[40:41], v30 offset:1024
    ds_read_b64 v[42:43], v30 offset:1152
    ds_read_b64 v[44:45], v30 offset:1536
    ds_read_b64 v[46:47], v30 offset:1664
    ds_read_b64 v[48:49], v30 offset:2048
    ds_read_b64 v[50:51], v30 offset:2176
    ds_read_b64 v[52:53], v30 offset:2560
    ds_read_b64 v[54:55], v30 offset:2688
    ds_read_b64 v[56:57], v30 offset:3072
    ds_read_b64 v[58:59], v30 offset:3200
    ds_read_b64 v[60:61], v30 offset:3584
    ds_read_b64 v[62:63], v30 offset:3712
    s_waitcnt lgkmcnt(0)
    v_readfirstlane_b32 s33, v8
    s_sub_u32 s45, s45, 1
    s_cbranch_scc1 Lc_exok
    s_cmp_eq_u32 s33, 0
    s_cbranch_scc1 Lc_expoll
Lc_exok:
    v_pk_fma_f32 v[36:37], v[18:19], v[32:33], v[36:37] op_sel_hi:[0,1,1]
    v_pk_fma_f32 v[36:37], v[32:33], v[20:21], v[36:37] op_sel:[1,0,0] op_sel_hi:[0,0,1] neg_lo:[1,0,0]
    v_pk_fma_f32 v[38:39], v[18:19], v[34:35], v[38:39] op_sel:[1,0,0]
    v_pk_fma_f32 v[38:39], v[20:21], v[34:35], v[38:39] op_sel:[1,1,0] op_sel_hi:[1,0,1] neg_lo:[0,1,0]
    v_pk_fma_f32 v[40:41], v[18:19], v[36:37], v[40:41] op_sel_hi:[0,1,1]
    v_pk_fma_f32 v[40:41], v[36:37], v[20:21], v[40:41] op_sel:[1,0,0] op_sel_hi:[0,0,1] neg_lo:[1,0,0]
    v_pk_fma_f32 v[42:43], v[18:19], v[38:39], v[42:43] op_sel:[1,0,0]
    v_pk_fma_f32 v[42:43], v[20:21], v[38:39], v[42:43] op_sel:[1,1,0] op_sel_hi:[1,0,1] neg_lo:[0,1,0]
    v_pk_fma_f32 v[44:45], v[18:19], v[40:41], v[44:45] op_sel_hi:[0,1,1]
    v_pk_fma_f32 v[44:45], v[40:41], v[20:21], v[44:45] op_sel:[1,0,0] op_sel_hi:[0,0,1] neg_lo:[1,0,0]
    v_pk_fma_f32 v[46:47], v[18:19], v[42:43], v[46:47] op_sel:[1,0,0]
    v_pk_fma_f32 v[46:47], v[20:21], v[42:43], v[46:47] op_sel:[1,1,0] op_sel_hi:[1,0,1] neg_lo:[0,1,0]
    v_pk_fma_f32 v[48:49], v[18:19], v[44:45], v[48:49] op_sel_hi:[0,1,1]
    v_pk_fma_f32 v[48:49], v[44:45], v[20:21], v[48:49] op_sel:[1,0,0] op_sel_hi:[0,0,1] neg_lo:[1,0,0]
    v_pk_fma_f32 v[50:51], v[18:19], v[46:47], v[50:51] op_sel:[1,0,0]
    v_pk_fma_f32 v[50:51], v[20:21], v[46:47], v[50:51] op_sel:[1,1,0] op_sel_hi:[1,0,1] neg_lo:[0,1,0]
    v_pk_fma_f32 v[52:53], v[18:19], v[48:49], v[52:53] op_sel_hi:[0,1,1]
    v_pk_fma_f32 v[52:53], v[48:49], v[20:21], v[52:53] op_sel:[1,0,0] op_sel_hi:[0,0,1] neg_lo:[1,0,0]
    v_pk_fma_f32 v[54:55], v[18:19], v[50:51], v[54:55] op_sel:[1,0,0]
    v_pk_fma_f32 v[54:55], v[20:21], v[50:51], v[54:55] op_sel:[1,1,0] op_sel_hi:[1,0,1] neg_lo:[0,1,0]
    v_pk_fma_f32 v[56:57], v[18:19], v[52:53], v[56:57] op_sel_hi:[0,1,1]
    v_pk_fma_f32 v[56:57], v[52:53], v[20:21], v[56:57] op_sel:[1,0,0] op_sel_hi:[0,0,1] neg_lo:[1,0,0]
    v_pk_fma_f32 v[58:59], v[18:19], v[54:55], v[58:59] op_sel:[1,0,0]
    v_pk_fma_f32 v[58:59], v[20:21], v[54:55], v[58:59] op_sel:[1,1,0] op_sel_hi:[1,0,1] neg_lo:[0,1,0]
    v_pk_fma_f32 v[60:61], v[18:19], v[56:57], v[60:61] op_sel_hi:[0,1,1]
    v_pk_fma_f32 v[60:61], v[56:57], v[20:21], v[60:61] op_sel:[1,0,0] op_sel_hi:[0,0,1] neg_lo:[1,0,0]
    v_pk_fma_f32 v[62:63], v[18:19], v[58:59], v[62:63] op_sel:[1,0,0]
    v_pk_fma_f32 v[62:63], v[20:21], v[58:59], v[62:63] op_sel:[1,1,0] op_sel_hi:[1,0,1] neg_lo:[0,1,0]
    s_cmp_eq_u32 s30, 0
    s_cbranch_scc1 Lc_nopub
    s_cmp_eq_u32 s26, 15
    s_cbranch_scc1 Lc_nopub
    v_mov_b32 v26, v60
    v_mov_b32 v27, v61
    v_mov_b32 v28, s44
    v_mov_b32 v29, s44
    s_lshl_b32 s33, s26, 10
    s_lshl_b32 s34, s31, 9
    s_add_u32 s33, s33, s34
    s_mov_b64 exec, 0xffff0000
    v_mov_b32 v26, v62
    v_mov_b32 v27, v63
    s_mov_b64 exec, 0xffffffff
    buffer_store_dwordx4 v[26:29], v196, s[36:39], s33 offen sc1
    s_mov_b64 exec, -1
Lc_nopub:
    v_mov_b32 v60, 0
    v_mov_b32 v61, 0
    v_mov_b32 v62, 0
    v_mov_b32 v63, 0
    s_lshl_b32 s33, s30, 2
    v_add_u32 v8, s33, v7
    v_cmp_eq_u32 vcc, 1, v8
    s_nop 1
    v_cndmask_b32 v60, v60, v32, vcc
    v_cndmask_b32 v61, v61, v33, vcc
    v_cndmask_b32 v62, v62, v34, vcc
    v_cndmask_b32 v63, v63, v35, vcc
    v_cmp_eq_u32 vcc, 2, v8
    s_nop 1
    v_cndmask_b32 v60, v60, v36, vcc
    v_cndmask_b32 v61, v61, v37, vcc
    v_cndmask_b32 v62, v62, v38, vcc
    v_cndmask_b32 v63, v63, v39, vcc
    v_cmp_eq_u32 vcc, 3, v8
    s_nop 1
    v_cndmask_b32 v60, v60, v40, vcc
    v_cndmask_b32 v61, v61, v41, vcc
    v_cndmask_b32 v62, v62, v42, vcc
    v_cndmask_b32 v63, v63, v43, vcc
    v_cmp_eq_u32 vcc, 4, v8
    s_nop 1
    v_cndmask_b32 v60, v60, v44, vcc
    v_cndmask_b32 v61, v61, v45, vcc
    v_cndmask_b32 v62, v62, v46, vcc
    v_cndmask_b32 v63, v63, v47, vcc
    v_cmp_eq_u32 vcc, 5, v8
    s_nop 1
    v_cndmask_b32 v60, v60, v48, vcc
    v_cndmask_b32 v61, v61, v49, vcc
    v_cndmask_b32 v62, v62, v50, vcc
    v_cndmask_b32 v63, v63, v51, vcc
    v_cmp_eq_u32 vcc, 6, v8
    s_nop 1
    v_cndmask_b32 v60, v60, v52, vcc
    v_cndmask_b32 v61, v61, v53, vcc
    v_cndmask_b32 v62, v62, v54, vcc
    v_cndmask_b32 v63, v63, v55, vcc
    v_cmp_eq_u32 vcc, 7, v8
    s_nop 1
    v_cndmask_b32 v60, v60, v56, vcc
    v_cndmask_b32 v61, v61, v57, vcc
    v_cndmask_b32 v62, v62, v58, vcc
    v_cndmask_b32 v63, v63, v59, vcc
    v_fma_f32 v33, v14, v60, v110
    v_fma_f32 v35, v14, v61, v126
    v_mov_b32 v32, v60
    v_mov_b32 v34, v61
    v_fma_f32 v33, -v16, v61, v33
    v_fma_f32 v35, v16, v60, v35
    v_fma_f32 v37, v15, v62, v142
    v_fma_f32 v39, v15, v63, v158
    v_mov_b32 v36, v62
    v_mov_b32 v38, v63
    v_fma_f32 v37, -v17, v63, v37
    v_fma_f32 v39, v17, v62, v39
    v_pk_mul_f32 v[26:27], v[24:25], v[96:97] op_sel_hi:[0,1] neg_lo:[1,0] neg_hi:[1,0]
    v_pk_mul_f32 v[96:97], v[22:23], v[96:97] op_sel_hi:[0,1]
    v_pk_fma_f32 v[96:97], v[24:25], v[112:113], v[96:97] op_sel_hi:[0,1,1] neg_lo:[1,0,0] neg_hi:[1,0,0]
    v_pk_fma_f32 v[112:113], v[22:23], v[112:113], v[26:27] op_sel_hi:[0,1,1] neg_lo:[1,0,0] neg_hi:[1,0,0]
    v_pk_mul_f32 v[28:29], v[24:25], v[128:129] op_sel:[1,0] neg_lo:[1,0] neg_hi:[1,0]
    v_pk_mul_f32 v[128:129], v[22:23], v[128:129] op_sel:[1,0]
    v_pk_fma_f32 v[128:129], v[24:25], v[144:145], v[128:129] op_sel:[1,0,0] neg_lo:[1,0,0] neg_hi:[1,0,0]
    v_pk_fma_f32 v[144:145], v[22:23], v[144:145], v[28:29] op_sel:[1,0,0] neg_lo:[1,0,0] neg_hi:[1,0,0]
    v_pk_mul_f32 v[26:27], v[24:25], v[98:99] op_sel_hi:[0,1] neg_lo:[1,0] neg_hi:[1,0]
    v_pk_mul_f32 v[98:99], v[22:23], v[98:99] op_sel_hi:[0,1]
    v_pk_fma_f32 v[98:99], v[24:25], v[114:115], v[98:99] op_sel_hi:[0,1,1] neg_lo:[1,0,0] neg_hi:[1,0,0]
    v_pk_fma_f32 v[114:115], v[22:23], v[114:115], v[26:27] op_sel_hi:[0,1,1] neg_lo:[1,0,0] neg_hi:[1,0,0]
    v_pk_mul_f32 v[28:29], v[24:25], v[130:131] op_sel:[1,0] neg_lo:[1,0] neg_hi:[1,0]
    v_pk_mul_f32 v[130:131], v[22:23], v[130:131] op_sel:[1,0]
    v_pk_fma_f32 v[130:131], v[24:25], v[146:147], v[130:131] op_sel:[1,0,0] neg_lo:[1,0,0] neg_hi:[1,0,0]
    v_pk_fma_f32 v[146:147], v[22:23], v[146:147], v[28:29] op_sel:[1,0,0] neg_lo:[1,0,0] neg_hi:[1,0,0]
    v_pk_mul_f32 v[26:27], v[24:25], v[100:101] op_sel_hi:[0,1] neg_lo:[1,0] neg_hi:[1,0]
    v_pk_mul_f32 v[100:101], v[22:23], v[100:101] op_sel_hi:[0,1]
    v_pk_fma_f32 v[100:101], v[24:25], v[116:117], v[100:101] op_sel_hi:[0,1,1] neg_lo:[1,0,0] neg_hi:[1,0,0]
    v_pk_fma_f32 v[116:117], v[22:23], v[116:117], v[26:27] op_sel_hi:[0,1,1] neg_lo:[1,0,0] neg_hi:[1,0,0]
    v_pk_mul_f32 v[28:29], v[24:25], v[132:133] op_sel:[1,0] neg_lo:[1,0] neg_hi:[1,0]
    v_pk_mul_f32 v[132:133], v[22:23], v[132:133] op_sel:[1,0]
    v_pk_fma_f32 v[132:133], v[24:25], v[148:149], v[132:133] op_sel:[1,0,0] neg_lo:[1,0,0] neg_hi:[1,0,0]
    v_pk_fma_f32 v[148:149], v[22:23], v[148:149], v[28:29] op_sel:[1,0,0] neg_lo:[1,0,0] neg_hi:[1,0,0]
    v_pk_mul_f32 v[26:27], v[24:25], v[102:103] op_sel_hi:[0,1] neg_lo:[1,0] neg_hi:[1,0]
    v_pk_mul_f32 v[102:103], v[22:23], v[102:103] op_sel_hi:[0,1]
    v_pk_fma_f32 v[102:103], v[24:25], v[118:119], v[102:103] op_sel_hi:[0,1,1] neg_lo:[1,0,0] neg_hi:[1,0,0]
    v_pk_fma_f32 v[118:119], v[22:23], v[118:119], v[26:27] op_sel_hi:[0,1,1] neg_lo:[1,0,0] neg_hi:[1,0,0]
    v_pk_mul_f32 v[28:29], v[24:25], v[134:135] op_sel:[1,0] neg_lo:[1,0] neg_hi:[1,0]
    v_pk_mul_f32 v[134:135], v[22:23], v[134:135] op_sel:[1,0]
    v_pk_fma_f32 v[134:135], v[24:25], v[150:151], v[134:135] op_sel:[1,0,0] neg_lo:[1,0,0] neg_hi:[1,0,0]
    v_pk_fma_f32 v[150:151], v[22:23], v[150:151], v[28:29] op_sel:[1,0,0] neg_lo:[1,0,0] neg_hi:[1,0,0]
    v_pk_mul_f32 v[26:27], v[24:25], v[104:105] op_sel_hi:[0,1] neg_lo:[1,0] neg_hi:[1,0]
    v_pk_mul_f32 v[104:105], v[22:23], v[104:105] op_sel_hi:[0,1]
    v_pk_fma_f32 v[104:105], v[24:25], v[120:121], v[104:105] op_sel_hi:[0,1,1] neg_lo:[1,0,0] neg_hi:[1,0,0]
    v_pk_fma_f32 v[120:121], v[22:23], v[120:121], v[26:27] op_sel_hi:[0,1,1] neg_lo:[1,0,0] neg_hi:[1,0,0]
    v_pk_mul_f32 v[28:29], v[24:25], v[136:137] op_sel:[1,0] neg_lo:[1,0] neg_hi:[1,0]
    v_pk_mul_f32 v[136:137], v[22:23], v[136:137] op_sel:[1,0]
    v_pk_fma_f32 v[136:137], v[24:25], v[152:153], v[136:137] op_sel:[1,0,0] neg_lo:[1,0,0] neg_hi:[1,0,0]
    v_pk_fma_f32 v[152:153], v[22:23], v[152:153], v[28:29] op_sel:[1,0,0] neg_lo:[1,0,0] neg_hi:[1,0,0]
    v_pk_mul_f32 v[26:27], v[24:25], v[106:107] op_sel_hi:[0,1] neg_lo:[1,0] neg_hi:[1,0]
    v_pk_mul_f32 v[106:107], v[22:23], v[106:107] op_sel_hi:[0,1]
    v_pk_fma_f32 v[106:107], v[24:25], v[122:123], v[106:107] op_sel_hi:[0,1,1] neg_lo:[1,0,0] neg_hi:[1,0,0]
    v_pk_fma_f32 v[122:123], v[22:23], v[122:123], v[26:27] op_sel_hi:[0,1,1] neg_lo:[1,0,0] neg_hi:[1,0,0]
    v_pk_mul_f32 v[28:29], v[24:25], v[138:139] op_sel:[1,0] neg_lo:[1,0] neg_hi:[1,0]
    v_pk_mul_f32 v[138:139], v[22:23], v[138:139] op_sel:[1,0]
    v_pk_fma_f32 v[138:139], v[24:25], v[154:155], v[138:139] op_sel:[1,0,0] neg_lo:[1,0,0] neg_hi:[1,0,0]
    v_pk_fma_f32 v[154:155], v[22:23], v[154:155], v[28:29] op_sel:[1,0,0] neg_lo:[1,0,0] neg_hi:[1,0,0]
    v_pk_mul_f32 v[26:27], v[24:25], v[108:109] op_sel_hi:[0,1] neg_lo:[1,0] neg_hi:[1,0]
    v_pk_mul_f32 v[108:109], v[22:23], v[108:109] op_sel_hi:[0,1]
    v_pk_fma_f32 v[108:109], v[24:25], v[124:125], v[108:109] op_sel_hi:[0,1,1] neg_lo:[1,0,0] neg_hi:[1,0,0]
    v_pk_fma_f32 v[124:125], v[22:23], v[124:125], v[26:27] op_sel_hi:[0,1,1] neg_lo:[1,0,0] neg_hi:[1,0,0]
    v_pk_mul_f32 v[28:29], v[24:25], v[140:141] op_sel:[1,0] neg_lo:[1,0] neg_hi:[1,0]
    v_pk_mul_f32 v[140:141], v[22:23], v[140:141] op_sel:[1,0]
    v_pk_fma_f32 v[140:141], v[24:25], v[156:157], v[140:141] op_sel:[1,0,0] neg_lo:[1,0,0] neg_hi:[1,0,0]
    v_pk_fma_f32 v[156:157], v[22:23], v[156:157], v[28:29] op_sel:[1,0,0] neg_lo:[1,0,0] neg_hi:[1,0,0]
    v_pk_mul_f32 v[26:27], v[24:25], v[110:111] op_sel_hi:[0,1] neg_lo:[1,0] neg_hi:[1,0]
    v_pk_mul_f32 v[110:111], v[22:23], v[110:111] op_sel_hi:[0,1]
    v_pk_fma_f32 v[110:111], v[24:25], v[126:127], v[110:111] op_sel_hi:[0,1,1] neg_lo:[1,0,0] neg_hi:[1,0,0]
    v_pk_fma_f32 v[126:127], v[22:23], v[126:127], v[26:27] op_sel_hi:[0,1,1] neg_lo:[1,0,0] neg_hi:[1,0,0]
    v_pk_mul_f32 v[28:29], v[24:25], v[142:143] op_sel:[1,0] neg_lo:[1,0] neg_hi:[1,0]
    v_pk_mul_f32 v[142:143], v[22:23], v[142:143] op_sel:[1,0]
    v_pk_fma_f32 v[142:143], v[24:25], v[158:159], v[142:143] op_sel:[1,0,0] neg_lo:[1,0,0] neg_hi:[1,0,0]
    v_pk_fma_f32 v[158:159], v[22:23], v[158:159], v[28:29] op_sel:[1,0,0] neg_lo:[1,0,0] neg_hi:[1,0,0]
    s_lshl_b32 s33, s29, 12
    s_add_u32 s33, s33, 131072
    v_lshrrev_b32 v8, 1, v6
    v_and_b32 v8, 4, v8
    v_and_b32 v9, 7, v6
    v_xor_b32 v8, v8, v9
    v_lshlrev_b32 v9, 1, v7
    v_xor_b32 v8, v8, v9
    v_lshlrev_b32 v8, 4, v8
    v_lshl_add_u32 v8, v6, 7, v8
    v_add_u32 v2, s33, v8
    v_xor_b32 v3, 16, v2
    v_bfe_u32 v8, v1, 2, 2
    v_bfe_u32 v9, v1, 1, 1
    v_xor_b32 v9, v9, v8
    v_and_b32 v4, 1, v7
    v_lshlrev_b32 v4, 2, v4
    v_xor_b32 v9, v9, v4
    v_lshlrev_b32 v9, 4, v9
    v_lshl_add_u32 v8, v7, 3, v8
    v_lshl_add_u32 v9, v8, 7, v9
    v_and_b32 v8, 1, v1
    v_lshl_add_u32 v9, v8, 3, v9
    v_add_u32 v4, s33, v9
    v_xor_b32 v5, 32, v4
    v_xor_b32 v30, 64, v4
    v_xor_b32 v31, 96, v4
    s_mov_b32 s45, 32768
    s_sleep 6
    buffer_load_dwordx4 v[160:163], v192, s[36:39], 0 offen offset:0 sc1
    buffer_load_dwordx4 v[164:167], v192, s[36:39], 0 offen offset:256 sc1
    buffer_load_dwordx4 v[168:171], v193, s[36:39], 0 offen offset:0 sc1
    buffer_load_dwordx4 v[172:175], v193, s[36:39], 0 offen offset:256 sc1
    buffer_load_dwordx4 v[176:179], v194, s[36:39], 0 offen offset:0 sc1
    buffer_load_dwordx4 v[180:183], v194, s[36:39], 0 offen offset:256 sc1
    buffer_load_dwordx4 v[184:187], v195, s[36:39], 0 offen offset:0 sc1
    buffer_load_dwordx4 v[188:191], v195, s[36:39], 0 offen offset:256 sc1
Lc_lbpoll:
    s_waitcnt vmcnt(0)
    v_cmp_ne_u64 s[46:47], v[162:163], v[248:249]
    v_cmp_ne_u64 s[48:49], v[166:167], v[248:249]
    v_cmp_ne_u64 s[50:51], v[170:171], v[250:251]
    v_cmp_ne_u64 s[52:53], v[174:175], v[250:251]
    v_cmp_ne_u64 s[54:55], v[178:179], v[252:253]
    v_cmp_ne_u64 s[56:57], v[182:183], v[252:253]
    v_cmp_ne_u64 s[58:59], v[186:187], v[254:255]
    v_cmp_ne_u64 s[60:61], v[190:191], v[254:255]
    s_or_b64 s[46:47], s[46:47], s[48:49]
    s_or_b64 s[50:51], s[50:51], s[52:53]
    s_or_b64 s[54:55], s[54:55], s[56:57]
    s_or_b64 s[58:59], s[58:59], s[60:61]
    s_or_b64 s[46:47], s[46:47], s[50:51]
    s_or_b64 s[54:55], s[54:55], s[58:59]
    s_or_b64 s[46:47], s[46:47], s[54:55]
    s_cbranch_scc0 Lc_lbok
    s_sub_u32 s45, s45, 1
    s_cbranch_scc1 Lc_lbok
    buffer_load_dwordx4 v[160:163], v192, s[36:39], 0 offen offset:0 sc1
    buffer_load_dwordx4 v[164:167], v192, s[36:39], 0 offen offset:256 sc1
    buffer_load_dwordx4 v[168:171], v193, s[36:39], 0 offen offset:0 sc1
    buffer_load_dwordx4 v[172:175], v193, s[36:39], 0 offen offset:256 sc1
    buffer_load_dwordx4 v[176:179], v194, s[36:39], 0 offen offset:0 sc1
    buffer_load_dwordx4 v[180:183], v194, s[36:39], 0 offen offset:256 sc1
    buffer_load_dwordx4 v[184:187], v195, s[36:39], 0 offen offset:0 sc1
    buffer_load_dwordx4 v[188:191], v195, s[36:39], 0 offen offset:256 sc1
    s_branch Lc_lbpoll
Lc_lbok:
    v_pk_fma_f32 v[176:177], v[244:245], v[184:185], v[176:177] op_sel_hi:[0,1,1]
    v_pk_fma_f32 v[176:177], v[184:185], v[246:247], v[176:177] op_sel:[1,0,0] op_sel_hi:[0,0,1] neg_lo:[1,0,0]
    v_pk_fma_f32 v[180:181], v[244:245], v[188:189], v[180:181] op_sel:[1,0,0]
    v_pk_fma_f32 v[180:181], v[246:247], v[188:189], v[180:181] op_sel:[1,1,0] op_sel_hi:[1,0,1] neg_lo:[0,1,0]
    v_pk_fma_f32 v[168:169], v[244:245], v[176:177], v[168:169] op_sel_hi:[0,1,1]
    v_pk_fma_f32 v[168:169], v[176:177], v[246:247], v[168:169] op_sel:[1,0,0] op_sel_hi:[0,0,1] neg_lo:[1,0,0]
    v_pk_fma_f32 v[172:173], v[244:245], v[180:181], v[172:173] op_sel:[1,0,0]
    v_pk_fma_f32 v[172:173], v[246:247], v[180:181], v[172:173] op_sel:[1,1,0] op_sel_hi:[1,0,1] neg_lo:[0,1,0]
    v_pk_fma_f32 v[160:161], v[244:245], v[168:169], v[160:161] op_sel_hi:[0,1,1]
    v_pk_fma_f32 v[160:161], v[168:169], v[246:247], v[160:161] op_sel:[1,0,0] op_sel_hi:[0,0,1] neg_lo:[1,0,0]
    v_pk_fma_f32 v[164:165], v[244:245], v[172:173], v[164:165] op_sel:[1,0,0]
    v_pk_fma_f32 v[164:165], v[246:247], v[172:173], v[164:165] op_sel:[1,1,0] op_sel_hi:[1,0,1] neg_lo:[0,1,0]
    v_pk_mul_f32 v[168:169], v[240:241], v[160:161] op_sel_hi:[0,1]
    v_pk_mul_f32 v[172:173], v[240:241], v[164:165] op_sel:[1,0]
    v_pk_fma_f32 v[168:169], v[160:161], v[242:243], v[168:169] op_sel:[1,0,0] op_sel_hi:[0,0,1] neg_lo:[1,0,0]
    v_pk_fma_f32 v[172:173], v[242:243], v[164:165], v[172:173] op_sel:[1,1,0] op_sel_hi:[1,0,1] neg_lo:[0,1,0]
    v_mov_b32 v170, v168
    v_mov_b32 v171, v169
    v_mov_b32 v174, v172
    v_mov_b32 v175, v173
    v_permlane16_swap_b32 v168, v170
    v_permlane16_swap_b32 v169, v171
    v_permlane16_swap_b32 v172, v174
    v_permlane16_swap_b32 v173, v175
    v_pk_add_f32 v[168:169], v[168:169], v[170:171]
    v_pk_add_f32 v[172:173], v[172:173], v[174:175]
    v_mov_b32 v170, v168
    v_mov_b32 v171, v169
    v_mov_b32 v174, v172
    v_mov_b32 v175, v173
    v_permlane32_swap_b32 v168, v170
    v_permlane32_swap_b32 v169, v171
    v_permlane32_swap_b32 v172, v174
    v_permlane32_swap_b32 v173, v175
    v_pk_add_f32 v[168:169], v[168:169], v[170:171]
    v_pk_add_f32 v[172:173], v[172:173], v[174:175]
    v_pk_fma_f32 v[32:33], v[232:233], v[168:169], v[32:33] op_sel_hi:[1,0,1]
    v_pk_fma_f32 v[34:35], v[168:169], v[232:233], v[34:35] op_sel:[1,0,0]
    v_pk_fma_f32 v[36:37], v[234:235], v[172:173], v[36:37] op_sel_hi:[1,0,1]
    v_pk_fma_f32 v[38:39], v[172:173], v[234:235], v[38:39] op_sel:[1,0,0]
    v_pk_fma_f32 v[32:33], v[168:169], v[236:237], v[32:33] op_sel:[1,0,0] neg_lo:[1,0,0] neg_hi:[1,0,0]
    v_pk_fma_f32 v[34:35], v[236:237], v[168:169], v[34:35] op_sel_hi:[1,0,1]
    v_pk_fma_f32 v[36:37], v[172:173], v[238:239], v[36:37] op_sel:[1,0,0] neg_lo:[1,0,0] neg_hi:[1,0,0]
    v_pk_fma_f32 v[38:39], v[238:239], v[172:173], v[38:39] op_sel_hi:[1,0,1]
    s_mov_b32 s33, 16384
    v_pk_fma_f32 v[96:97], v[200:201], v[32:33], v[96:97] op_sel_hi:[0,1,1]
    v_pk_fma_f32 v[96:97], v[200:201], v[34:35], v[96:97] op_sel:[1,0,0] neg_lo:[1,0,0] neg_hi:[1,0,0]
    v_pk_fma_f32 v[98:99], v[204:205], v[32:33], v[98:99] op_sel_hi:[0,1,1]
    v_pk_fma_f32 v[98:99], v[204:205], v[34:35], v[98:99] op_sel:[1,0,0] neg_lo:[1,0,0] neg_hi:[1,0,0]
    v_pk_fma_f32 v[100:101], v[208:209], v[32:33], v[100:101] op_sel_hi:[0,1,1]
    v_pk_fma_f32 v[100:101], v[208:209], v[34:35], v[100:101] op_sel:[1,0,0] neg_lo:[1,0,0] neg_hi:[1,0,0]
    v_pk_fma_f32 v[102:103], v[212:213], v[32:33], v[102:103] op_sel_hi:[0,1,1]
    v_pk_fma_f32 v[102:103], v[212:213], v[34:35], v[102:103] op_sel:[1,0,0] neg_lo:[1,0,0] neg_hi:[1,0,0]
    v_pk_fma_f32 v[104:105], v[216:217], v[32:33], v[104:105] op_sel_hi:[0,1,1]
    v_pk_fma_f32 v[104:105], v[216:217], v[34:35], v[104:105] op_sel:[1,0,0] neg_lo:[1,0,0] neg_hi:[1,0,0]
    v_pk_fma_f32 v[106:107], v[220:221], v[32:33], v[106:107] op_sel_hi:[0,1,1]
    v_pk_fma_f32 v[106:107], v[220:221], v[34:35], v[106:107] op_sel:[1,0,0] neg_lo:[1,0,0] neg_hi:[1,0,0]
    v_pk_fma_f32 v[108:109], v[224:225], v[32:33], v[108:109] op_sel_hi:[0,1,1]
    v_pk_fma_f32 v[108:109], v[224:225], v[34:35], v[108:109] op_sel:[1,0,0] neg_lo:[1,0,0] neg_hi:[1,0,0]
    v_pk_fma_f32 v[110:111], v[228:229], v[32:33], v[110:111] op_sel_hi:[0,1,1]
    v_pk_fma_f32 v[110:111], v[228:229], v[34:35], v[110:111] op_sel:[1,0,0] neg_lo:[1,0,0] neg_hi:[1,0,0]
    v_cvt_pk_bf16_f32 v160, v96, v98
    v_cvt_pk_bf16_f32 v161, v100, v102
    v_cvt_pk_bf16_f32 v162, v104, v106
    v_cvt_pk_bf16_f32 v163, v108, v110
    ds_write_b128 v2, v[160:163] offset:0
    v_cvt_pk_bf16_f32 v164, v97, v99
    v_cvt_pk_bf16_f32 v165, v101, v103
    v_cvt_pk_bf16_f32 v166, v105, v107
    v_cvt_pk_bf16_f32 v167, v109, v111
    ds_write_b128 v3, v[164:167] offset:0
    v_pk_fma_f32 v[128:129], v[202:203], v[36:37], v[128:129] op_sel_hi:[0,1,1]
    v_pk_fma_f32 v[128:129], v[202:203], v[38:39], v[128:129] op_sel:[1,0,0] neg_lo:[1,0,0] neg_hi:[1,0,0]
    v_pk_fma_f32 v[130:131], v[206:207], v[36:37], v[130:131] op_sel_hi:[0,1,1]
    v_pk_fma_f32 v[130:131], v[206:207], v[38:39], v[130:131] op_sel:[1,0,0] neg_lo:[1,0,0] neg_hi:[1,0,0]
    v_pk_fma_f32 v[132:133], v[210:211], v[36:37], v[132:133] op_sel_hi:[0,1,1]
    v_pk_fma_f32 v[132:133], v[210:211], v[38:39], v[132:133] op_sel:[1,0,0] neg_lo:[1,0,0] neg_hi:[1,0,0]
    v_pk_fma_f32 v[134:135], v[214:215], v[36:37], v[134:135] op_sel_hi:[0,1,1]
    v_pk_fma_f32 v[134:135], v[214:215], v[38:39], v[134:135] op_sel:[1,0,0] neg_lo:[1,0,0] neg_hi:[1,0,0]
    v_pk_fma_f32 v[136:137], v[218:219], v[36:37], v[136:137] op_sel_hi:[0,1,1]
    v_pk_fma_f32 v[136:137], v[218:219], v[38:39], v[136:137] op_sel:[1,0,0] neg_lo:[1,0,0] neg_hi:[1,0,0]
    v_pk_fma_f32 v[138:139], v[222:223], v[36:37], v[138:139] op_sel_hi:[0,1,1]
    v_pk_fma_f32 v[138:139], v[222:223], v[38:39], v[138:139] op_sel:[1,0,0] neg_lo:[1,0,0] neg_hi:[1,0,0]
    v_pk_fma_f32 v[140:141], v[226:227], v[36:37], v[140:141] op_sel_hi:[0,1,1]
    v_pk_fma_f32 v[140:141], v[226:227], v[38:39], v[140:141] op_sel:[1,0,0] neg_lo:[1,0,0] neg_hi:[1,0,0]
    v_pk_fma_f32 v[142:143], v[230:231], v[36:37], v[142:143] op_sel_hi:[0,1,1]
    v_pk_fma_f32 v[142:143], v[230:231], v[38:39], v[142:143] op_sel:[1,0,0] neg_lo:[1,0,0] neg_hi:[1,0,0]
    v_cvt_pk_bf16_f32 v168, v128, v130
    v_cvt_pk_bf16_f32 v169, v132, v134
    v_cvt_pk_bf16_f32 v170, v136, v138
    v_cvt_pk_bf16_f32 v171, v140, v142
    ds_write_b128 v2, v[168:171] offset:2048
    v_cvt_pk_bf16_f32 v172, v129, v131
    v_cvt_pk_bf16_f32 v173, v133, v135
    v_cvt_pk_bf16_f32 v174, v137, v139
    v_cvt_pk_bf16_f32 v175, v141, v143
    ds_write_b128 v3, v[172:175] offset:2048
    ds_read_b64_tr_b16 v[96:97], v4 offset:0
    ds_read_b64_tr_b16 v[98:99], v30 offset:512
    ds_read_b64_tr_b16 v[100:101], v5 offset:0
    ds_read_b64_tr_b16 v[102:103], v31 offset:512
    ds_read_b64_tr_b16 v[104:105], v30 offset:0
    ds_read_b64_tr_b16 v[106:107], v4 offset:512
    ds_read_b64_tr_b16 v[108:109], v31 offset:0
    ds_read_b64_tr_b16 v[110:111], v5 offset:512
    v_pk_fma_f32 v[112:113], v[200:201], v[34:35], v[112:113] op_sel_hi:[0,1,1] neg_lo:[1,0,0] neg_hi:[1,0,0]
    v_pk_fma_f32 v[112:113], v[200:201], v[32:33], v[112:113] op_sel:[1,0,0] neg_lo:[1,0,0] neg_hi:[1,0,0]
    v_pk_fma_f32 v[114:115], v[204:205], v[34:35], v[114:115] op_sel_hi:[0,1,1] neg_lo:[1,0,0] neg_hi:[1,0,0]
    v_pk_fma_f32 v[114:115], v[204:205], v[32:33], v[114:115] op_sel:[1,0,0] neg_lo:[1,0,0] neg_hi:[1,0,0]
    v_pk_fma_f32 v[116:117], v[208:209], v[34:35], v[116:117] op_sel_hi:[0,1,1] neg_lo:[1,0,0] neg_hi:[1,0,0]
    v_pk_fma_f32 v[116:117], v[208:209], v[32:33], v[116:117] op_sel:[1,0,0] neg_lo:[1,0,0] neg_hi:[1,0,0]
    v_pk_fma_f32 v[118:119], v[212:213], v[34:35], v[118:119] op_sel_hi:[0,1,1] neg_lo:[1,0,0] neg_hi:[1,0,0]
    v_pk_fma_f32 v[118:119], v[212:213], v[32:33], v[118:119] op_sel:[1,0,0] neg_lo:[1,0,0] neg_hi:[1,0,0]
    v_pk_fma_f32 v[120:121], v[216:217], v[34:35], v[120:121] op_sel_hi:[0,1,1] neg_lo:[1,0,0] neg_hi:[1,0,0]
    v_pk_fma_f32 v[120:121], v[216:217], v[32:33], v[120:121] op_sel:[1,0,0] neg_lo:[1,0,0] neg_hi:[1,0,0]
    v_pk_fma_f32 v[122:123], v[220:221], v[34:35], v[122:123] op_sel_hi:[0,1,1] neg_lo:[1,0,0] neg_hi:[1,0,0]
    v_pk_fma_f32 v[122:123], v[220:221], v[32:33], v[122:123] op_sel:[1,0,0] neg_lo:[1,0,0] neg_hi:[1,0,0]
    v_pk_fma_f32 v[124:125], v[224:225], v[34:35], v[124:125] op_sel_hi:[0,1,1] neg_lo:[1,0,0] neg_hi:[1,0,0]
    v_pk_fma_f32 v[124:125], v[224:225], v[32:33], v[124:125] op_sel:[1,0,0] neg_lo:[1,0,0] neg_hi:[1,0,0]
    v_pk_fma_f32 v[126:127], v[228:229], v[34:35], v[126:127] op_sel_hi:[0,1,1] neg_lo:[1,0,0] neg_hi:[1,0,0]
    v_pk_fma_f32 v[126:127], v[228:229], v[32:33], v[126:127] op_sel:[1,0,0] neg_lo:[1,0,0] neg_hi:[1,0,0]
    v_cvt_pk_bf16_f32 v176, v112, v114
    v_cvt_pk_bf16_f32 v177, v116, v118
    v_cvt_pk_bf16_f32 v178, v120, v122
    v_cvt_pk_bf16_f32 v179, v124, v126
    ds_write_b128 v2, v[176:179] offset:0
    v_cvt_pk_bf16_f32 v180, v113, v115
    v_cvt_pk_bf16_f32 v181, v117, v119
    v_cvt_pk_bf16_f32 v182, v121, v123
    v_cvt_pk_bf16_f32 v183, v125, v127
    ds_write_b128 v3, v[180:183] offset:0
    s_waitcnt lgkmcnt(8)
    buffer_store_dwordx4 v[96:99], v196, s[40:43], 0 offen offset:0 sc1
    s_waitcnt lgkmcnt(6)
    buffer_store_dwordx4 v[100:103], v196, s[40:43], 0 offen offset:1024 sc1
    s_waitcnt lgkmcnt(4)
    buffer_store_dwordx4 v[104:107], v196, s[40:43], 0 offen offset:2048 sc1
    s_waitcnt lgkmcnt(2)
    buffer_store_dwordx4 v[108:111], v196, s[40:43], 0 offen offset:3072 sc1
    v_pk_fma_f32 v[144:145], v[202:203], v[38:39], v[144:145] op_sel_hi:[0,1,1] neg_lo:[1,0,0] neg_hi:[1,0,0]
    v_pk_fma_f32 v[144:145], v[202:203], v[36:37], v[144:145] op_sel:[1,0,0] neg_lo:[1,0,0] neg_hi:[1,0,0]
    v_pk_fma_f32 v[146:147], v[206:207], v[38:39], v[146:147] op_sel_hi:[0,1,1] neg_lo:[1,0,0] neg_hi:[1,0,0]
    v_pk_fma_f32 v[146:147], v[206:207], v[36:37], v[146:147] op_sel:[1,0,0] neg_lo:[1,0,0] neg_hi:[1,0,0]
    v_pk_fma_f32 v[148:149], v[210:211], v[38:39], v[148:149] op_sel_hi:[0,1,1] neg_lo:[1,0,0] neg_hi:[1,0,0]
    v_pk_fma_f32 v[148:149], v[210:211], v[36:37], v[148:149] op_sel:[1,0,0] neg_lo:[1,0,0] neg_hi:[1,0,0]
    v_pk_fma_f32 v[150:151], v[214:215], v[38:39], v[150:151] op_sel_hi:[0,1,1] neg_lo:[1,0,0] neg_hi:[1,0,0]
    v_pk_fma_f32 v[150:151], v[214:215], v[36:37], v[150:151] op_sel:[1,0,0] neg_lo:[1,0,0] neg_hi:[1,0,0]
    v_pk_fma_f32 v[152:153], v[218:219], v[38:39], v[152:153] op_sel_hi:[0,1,1] neg_lo:[1,0,0] neg_hi:[1,0,0]
    v_pk_fma_f32 v[152:153], v[218:219], v[36:37], v[152:153] op_sel:[1,0,0] neg_lo:[1,0,0] neg_hi:[1,0,0]
    v_pk_fma_f32 v[154:155], v[222:223], v[38:39], v[154:155] op_sel_hi:[0,1,1] neg_lo:[1,0,0] neg_hi:[1,0,0]
    v_pk_fma_f32 v[154:155], v[222:223], v[36:37], v[154:155] op_sel:[1,0,0] neg_lo:[1,0,0] neg_hi:[1,0,0]
    v_pk_fma_f32 v[156:157], v[226:227], v[38:39], v[156:157] op_sel_hi:[0,1,1] neg_lo:[1,0,0] neg_hi:[1,0,0]
    v_pk_fma_f32 v[156:157], v[226:227], v[36:37], v[156:157] op_sel:[1,0,0] neg_lo:[1,0,0] neg_hi:[1,0,0]
    v_pk_fma_f32 v[158:159], v[230:231], v[38:39], v[158:159] op_sel_hi:[0,1,1] neg_lo:[1,0,0] neg_hi:[1,0,0]
    v_pk_fma_f32 v[158:159], v[230:231], v[36:37], v[158:159] op_sel:[1,0,0] neg_lo:[1,0,0] neg_hi:[1,0,0]
    v_cvt_pk_bf16_f32 v184, v144, v146
    v_cvt_pk_bf16_f32 v185, v148, v150
    v_cvt_pk_bf16_f32 v186, v152, v154
    v_cvt_pk_bf16_f32 v187, v156, v158
    ds_write_b128 v2, v[184:187] offset:2048
    v_cvt_pk_bf16_f32 v188, v145, v147
    v_cvt_pk_bf16_f32 v189, v149, v151
    v_cvt_pk_bf16_f32 v190, v153, v155
    v_cvt_pk_bf16_f32 v191, v157, v159
    ds_write_b128 v3, v[188:191] offset:2048
    ds_read_b64_tr_b16 v[128:129], v4 offset:0
    ds_read_b64_tr_b16 v[130:131], v30 offset:512
    ds_read_b64_tr_b16 v[132:133], v5 offset:0
    ds_read_b64_tr_b16 v[134:135], v31 offset:512
    ds_read_b64_tr_b16 v[136:137], v30 offset:0
    ds_read_b64_tr_b16 v[138:139], v4 offset:512
    ds_read_b64_tr_b16 v[140:141], v31 offset:0
    ds_read_b64_tr_b16 v[142:143], v5 offset:512
    s_waitcnt lgkmcnt(6)
    buffer_store_dwordx4 v[128:131], v196, s[40:43], s33 offen offset:0 sc1
    s_waitcnt lgkmcnt(4)
    buffer_store_dwordx4 v[132:135], v196, s[40:43], s33 offen offset:1024 sc1
    s_waitcnt lgkmcnt(2)
    buffer_store_dwordx4 v[136:139], v196, s[40:43], s33 offen offset:2048 sc1
    s_waitcnt lgkmcnt(0)
    buffer_store_dwordx4 v[140:143], v196, s[40:43], s33 offen offset:3072 sc1
    s_lshl_b32 s33, s26, 11
    s_add_u32 s33, s33, 3932160
    s_add_u32 s36, s16, s33
    s_addc_u32 s37, s17, 0
    s_mov_b32 s38, 2048
    s_lshl_b32 s47, s27, 7
    v_mov_b32 v190, s44
    v_lshlrev_b32 v191, 2, v1
    v_lshlrev_b32 v192, 7, v6
    v_mov_b32 v193, 1
    v_mov_b32 v194, 147456
    v_lshrrev_b32 v2, 1, v6
    v_xor_b32 v2, v2, v7
    v_lshlrev_b32 v2, 4, v2
    v_lshl_add_u32 v2, v6, 7, v2
    v_add_u32 v2, 65536, v2
    v_xor_b32 v3, 64, v2
    v_and_b32 v5, 7, v6
    v_xor_b32 v5, v5, v7
    v_lshlrev_b32 v5, 4, v5
    v_lshl_add_u32 v5, v6, 8, v5
    s_lshl_b32 s33, s29, 13
    s_add_u32 s33, s33, 0
    v_add_u32 v186, s33, v5
    v_xor_b32 v187, 64, v186
    v_xor_b32 v188, 128, v186
    v_xor_b32 v189, 192, v186
    v_mov_b32 v200, 0
    v_mov_b32 v201, 0
    v_mov_b32 v202, 0
    v_mov_b32 v203, 0
    v_mov_b32 v204, 0
    v_mov_b32 v205, 0
    v_mov_b32 v206, 0
    v_mov_b32 v207, 0
    v_mov_b32 v208, 0
    v_mov_b32 v209, 0
    v_mov_b32 v210, 0
    v_mov_b32 v211, 0
    v_mov_b32 v212, 0
    v_mov_b32 v213, 0
    v_mov_b32 v214, 0
    v_mov_b32 v215, 0
    v_mov_b32 v216, 0
    v_mov_b32 v217, 0
    v_mov_b32 v218, 0
    v_mov_b32 v219, 0
    v_mov_b32 v220, 0
    v_mov_b32 v221, 0
    v_mov_b32 v222, 0
    v_mov_b32 v223, 0
    v_mov_b32 v224, 0
    v_mov_b32 v225, 0
    v_mov_b32 v226, 0
    v_mov_b32 v227, 0
    v_mov_b32 v228, 0
    v_mov_b32 v229, 0
    v_mov_b32 v230, 0
    v_mov_b32 v231, 0
    s_lshr_b32 s61, s25, 3
    s_lshl_b32 s62, s24, 1
    s_add_u32 s61, s61, s62
    s_and_b32 s61, s61, 15
    s_add_u32 s62, s61, s26
    s_and_b32 s62, s62, 15
    s_lshl_b32 s62, s62, 15
    s_lshl_b32 s32, s29, 11
    s_lshl_b32 s33, s26, 19
    s_add_u32 s33, s33, s32
    s_add_u32 s33, s33, 4194304
    s_waitcnt vmcnt(0)
    s_mov_b64 exec, 1
    ds_add_rtn_u32 v193, v194, v193 offset:24
    s_mov_b64 exec, -1
    s_add_u32 s40, s16, s33
    s_addc_u32 s41, s17, 0
    s_sub_u32 s42, 524288, s32
    s_waitcnt lgkmcnt(0)
    v_readfirstlane_b32 s46, v193
    s_cmp_lg_u32 s46, 3
    s_cbranch_scc1 Lc_hok
    s_mov_b64 exec, 0xffffffff
    buffer_store_dword v190, v191, s[36:39], s47 offen sc1
    s_mov_b64 exec, 0xffff
    s_lshl_b32 s46, 1, s27
    s_andn2_b32 exec_lo, exec_lo, s46
    s_mov_b32 s45, 32768
Lc_hpoll:
    v_mov_b32 v193, 0
    buffer_atomic_or v193, v192, s[36:39], 0 offen sc0 sc1
    s_waitcnt vmcnt(0)
    v_cmp_ne_u32 vcc, s44, v193
    s_cbranch_vccz Lc_hdone
    s_sub_u32 s45, s45, 1
    s_cbranch_scc1 Lc_hdone
    s_sleep 4
    s_branch Lc_hpoll
Lc_hdone:
    s_mov_b64 exec, -1
Lc_hok:
    s_barrier
    buffer_load_dwordx4 v[40:43], v196, s[40:43], s62 offen offset:0 sc1
    buffer_load_dwordx4 v[44:47], v196, s[40:43], s62 offen offset:1024 sc1
    s_add_u32 s62, s62, 8192
    s_and_b32 s62, s62, 524287
    buffer_load_dwordx4 v[48:51], v196, s[40:43], s62 offen offset:0 sc1
    buffer_load_dwordx4 v[52:55], v196, s[40:43], s62 offen offset:1024 sc1
    s_add_u32 s62, s62, 8192
    s_and_b32 s62, s62, 524287
    buffer_load_dwordx4 v[56:59], v196, s[40:43], s62 offen offset:0 sc1
    buffer_load_dwordx4 v[60:63], v196, s[40:43], s62 offen offset:1024 sc1
    s_add_u32 s62, s62, 8192
    s_and_b32 s62, s62, 524287
    buffer_load_dwordx4 v[64:67], v196, s[40:43], s62 offen offset:0 sc1
    buffer_load_dwordx4 v[68:71], v196, s[40:43], s62 offen offset:1024 sc1
    s_add_u32 s62, s62, 8192
    s_and_b32 s62, s62, 524287
    buffer_load_dwordx4 v[72:75], v196, s[40:43], s62 offen offset:0 sc1
    buffer_load_dwordx4 v[76:79], v196, s[40:43], s62 offen offset:1024 sc1
    s_add_u32 s62, s62, 8192
    s_and_b32 s62, s62, 524287
    buffer_load_dwordx4 v[80:83], v196, s[40:43], s62 offen offset:0 sc1
    buffer_load_dwordx4 v[84:87], v196, s[40:43], s62 offen offset:1024 sc1
    s_add_u32 s62, s62, 8192
    s_and_b32 s62, s62, 524287
    ds_read_b128 v[8:11], v2 offset:0
    ds_read_b128 v[12:15], v2 offset:2048
    ds_read_b128 v[16:19], v2 offset:4096
    ds_read_b128 v[20:23], v2 offset:6144
    s_mov_b32 s35, 0
Lc2_loop:
    s_waitcnt vmcnt(11) lgkmcnt(0)
    v_mfma_f32_16x16x32_bf16 v[200:203], v[8:11], v[40:43], v[200:203]
    ds_read_b128 v[24:27], v3 offset:0
    v_mfma_f32_16x16x32_bf16 v[204:207], v[12:15], v[40:43], v[204:207]
    ds_read_b128 v[28:31], v3 offset:2048
    v_mfma_f32_16x16x32_bf16 v[208:211], v[16:19], v[40:43], v[208:211]
    ds_read_b128 v[32:35], v3 offset:4096
    v_mfma_f32_16x16x32_bf16 v[212:215], v[20:23], v[40:43], v[212:215]
    ds_read_b128 v[36:39], v3 offset:6144
    buffer_load_dwordx4 v[88:91], v196, s[40:43], s62 offen offset:0 sc1
    s_waitcnt vmcnt(11)
    v_mfma_f32_16x16x32_bf16 v[228:231], v[20:23], v[44:47], v[228:231]
    v_mfma_f32_16x16x32_bf16 v[224:227], v[16:19], v[44:47], v[224:227]
    v_mfma_f32_16x16x32_bf16 v[220:223], v[12:15], v[44:47], v[220:223]
    v_mfma_f32_16x16x32_bf16 v[216:219], v[8:11], v[44:47], v[216:219]
    buffer_load_dwordx4 v[92:95], v196, s[40:43], s62 offen offset:1024 sc1
    s_add_u32 s62, s62, 8192
    s_and_b32 s62, s62, 524287
    s_waitcnt vmcnt(11) lgkmcnt(0)
    v_mfma_f32_16x16x32_bf16 v[200:203], v[24:27], v[48:51], v[200:203]
    ds_read_b128 v[8:11], v2 offset:8192
    v_mfma_f32_16x16x32_bf16 v[204:207], v[28:31], v[48:51], v[204:207]
    ds_read_b128 v[12:15], v2 offset:10240
    v_mfma_f32_16x16x32_bf16 v[208:211], v[32:35], v[48:51], v[208:211]
    ds_read_b128 v[16:19], v2 offset:12288
    v_mfma_f32_16x16x32_bf16 v[212:215], v[36:39], v[48:51], v[212:215]
    ds_read_b128 v[20:23], v2 offset:14336
    buffer_load_dwordx4 v[96:99], v196, s[40:43], s62 offen offset:0 sc1
    s_waitcnt vmcnt(11)
    v_mfma_f32_16x16x32_bf16 v[228:231], v[36:39], v[52:55], v[228:231]
    v_mfma_f32_16x16x32_bf16 v[224:227], v[32:35], v[52:55], v[224:227]
    v_mfma_f32_16x16x32_bf16 v[220:223], v[28:31], v[52:55], v[220:223]
    v_mfma_f32_16x16x32_bf16 v[216:219], v[24:27], v[52:55], v[216:219]
    buffer_load_dwordx4 v[100:103], v196, s[40:43], s62 offen offset:1024 sc1
    s_add_u32 s62, s62, 8192
    s_and_b32 s62, s62, 524287
    s_cmp_eq_u32 s35, 7
    s_cselect_b32 s42, 0, s42
    s_waitcnt vmcnt(11) lgkmcnt(0)
    v_mfma_f32_16x16x32_bf16 v[200:203], v[8:11], v[56:59], v[200:203]
    ds_read_b128 v[24:27], v3 offset:8192
    v_mfma_f32_16x16x32_bf16 v[204:207], v[12:15], v[56:59], v[204:207]
    ds_read_b128 v[28:31], v3 offset:10240
    v_mfma_f32_16x16x32_bf16 v[208:211], v[16:19], v[56:59], v[208:211]
    ds_read_b128 v[32:35], v3 offset:12288
    v_mfma_f32_16x16x32_bf16 v[212:215], v[20:23], v[56:59], v[212:215]
    ds_read_b128 v[36:39], v3 offset:14336
    buffer_load_dwordx4 v[40:43], v196, s[40:43], s62 offen offset:0 sc1
    s_waitcnt vmcnt(11)
    v_mfma_f32_16x16x32_bf16 v[228:231], v[20:23], v[60:63], v[228:231]
    v_mfma_f32_16x16x32_bf16 v[224:227], v[16:19], v[60:63], v[224:227]
    v_mfma_f32_16x16x32_bf16 v[220:223], v[12:15], v[60:63], v[220:223]
    v_mfma_f32_16x16x32_bf16 v[216:219], v[8:11], v[60:63], v[216:219]
    buffer_load_dwordx4 v[44:47], v196, s[40:43], s62 offen offset:1024 sc1
    s_add_u32 s62, s62, 8192
    s_and_b32 s62, s62, 524287
    s_waitcnt vmcnt(11) lgkmcnt(0)
    v_mfma_f32_16x16x32_bf16 v[200:203], v[24:27], v[64:67], v[200:203]
    s_barrier
    v_mfma_f32_16x16x32_bf16 v[204:207], v[28:31], v[64:67], v[204:207]
    ds_read_b128 v[8:11], v2 offset:16384
    v_mfma_f32_16x16x32_bf16 v[208:211], v[32:35], v[64:67], v[208:211]
    ds_read_b128 v[12:15], v2 offset:18432
    v_mfma_f32_16x16x32_bf16 v[212:215], v[36:39], v[64:67], v[212:215]
    ds_read_b128 v[16:19], v2 offset:20480
    buffer_load_dwordx4 v[48:51], v196, s[40:43], s62 offen offset:0 sc1
    s_waitcnt vmcnt(11)
    v_mfma_f32_16x16x32_bf16 v[228:231], v[36:39], v[68:71], v[228:231]
    ds_read_b128 v[20:23], v2 offset:22528
    v_mfma_f32_16x16x32_bf16 v[224:227], v[32:35], v[68:71], v[224:227]
    v_mfma_f32_16x16x32_bf16 v[220:223], v[28:31], v[68:71], v[220:223]
    v_mfma_f32_16x16x32_bf16 v[216:219], v[24:27], v[68:71], v[216:219]
    buffer_load_dwordx4 v[52:55], v196, s[40:43], s62 offen offset:1024 sc1
    s_add_u32 s62, s62, 8192
    s_and_b32 s62, s62, 524287
    s_waitcnt vmcnt(11) lgkmcnt(0)
    v_mfma_f32_16x16x32_bf16 v[200:203], v[8:11], v[72:75], v[200:203]
    ds_read_b128 v[24:27], v3 offset:16384
    v_mfma_f32_16x16x32_bf16 v[204:207], v[12:15], v[72:75], v[204:207]
    ds_read_b128 v[28:31], v3 offset:18432
    v_mfma_f32_16x16x32_bf16 v[208:211], v[16:19], v[72:75], v[208:211]
    ds_read_b128 v[32:35], v3 offset:20480
    v_mfma_f32_16x16x32_bf16 v[212:215], v[20:23], v[72:75], v[212:215]
    ds_read_b128 v[36:39], v3 offset:22528
    buffer_load_dwordx4 v[56:59], v196, s[40:43], s62 offen offset:0 sc1
    s_waitcnt vmcnt(11)
    v_mfma_f32_16x16x32_bf16 v[228:231], v[20:23], v[76:79], v[228:231]
    v_mfma_f32_16x16x32_bf16 v[224:227], v[16:19], v[76:79], v[224:227]
    v_mfma_f32_16x16x32_bf16 v[220:223], v[12:15], v[76:79], v[220:223]
    v_mfma_f32_16x16x32_bf16 v[216:219], v[8:11], v[76:79], v[216:219]
    buffer_load_dwordx4 v[60:63], v196, s[40:43], s62 offen offset:1024 sc1
    s_add_u32 s62, s62, 8192
    s_and_b32 s62, s62, 524287
    s_waitcnt vmcnt(11) lgkmcnt(0)
    v_mfma_f32_16x16x32_bf16 v[200:203], v[24:27], v[80:83], v[200:203]
    ds_read_b128 v[8:11], v2 offset:24576
    v_mfma_f32_16x16x32_bf16 v[204:207], v[28:31], v[80:83], v[204:207]
    ds_read_b128 v[12:15], v2 offset:26624
    v_mfma_f32_16x16x32_bf16 v[208:211], v[32:35], v[80:83], v[208:211]
    ds_read_b128 v[16:19], v2 offset:28672
    v_mfma_f32_16x16x32_bf16 v[212:215], v[36:39], v[80:83], v[212:215]
    ds_read_b128 v[20:23], v2 offset:30720
    buffer_load_dwordx4 v[64:67], v196, s[40:43], s62 offen offset:0 sc1
    s_waitcnt vmcnt(11)
    v_mfma_f32_16x16x32_bf16 v[228:231], v[36:39], v[84:87], v[228:231]
    v_mfma_f32_16x16x32_bf16 v[224:227], v[32:35], v[84:87], v[224:227]
    v_mfma_f32_16x16x32_bf16 v[220:223], v[28:31], v[84:87], v[220:223]
    v_mfma_f32_16x16x32_bf16 v[216:219], v[24:27], v[84:87], v[216:219]
    buffer_load_dwordx4 v[68:71], v196, s[40:43], s62 offen offset:1024 sc1
    s_add_u32 s62, s62, 8192
    s_and_b32 s62, s62, 524287
    s_waitcnt vmcnt(11) lgkmcnt(0)
    v_mfma_f32_16x16x32_bf16 v[200:203], v[8:11], v[88:91], v[200:203]
    ds_read_b128 v[24:27], v3 offset:24576
    v_mfma_f32_16x16x32_bf16 v[204:207], v[12:15], v[88:91], v[204:207]
    ds_read_b128 v[28:31], v3 offset:26624
    v_mfma_f32_16x16x32_bf16 v[208:211], v[16:19], v[88:91], v[208:211]
    ds_read_b128 v[32:35], v3 offset:28672
    v_mfma_f32_16x16x32_bf16 v[212:215], v[20:23], v[88:91], v[212:215]
    ds_read_b128 v[36:39], v3 offset:30720
    buffer_load_dwordx4 v[72:75], v196, s[40:43], s62 offen offset:0 sc1
    s_waitcnt vmcnt(11)
    v_mfma_f32_16x16x32_bf16 v[228:231], v[20:23], v[92:95], v[228:231]
    v_mfma_f32_16x16x32_bf16 v[224:227], v[16:19], v[92:95], v[224:227]
    v_mfma_f32_16x16x32_bf16 v[220:223], v[12:15], v[92:95], v[220:223]
    v_mfma_f32_16x16x32_bf16 v[216:219], v[8:11], v[92:95], v[216:219]
    buffer_load_dwordx4 v[76:79], v196, s[40:43], s62 offen offset:1024 sc1
    s_add_u32 s62, s62, 8192
    s_and_b32 s62, s62, 524287
    s_cmp_eq_u32 s35, 7
    s_waitcnt vmcnt(11) lgkmcnt(0)
    v_mfma_f32_16x16x32_bf16 v[200:203], v[24:27], v[96:99], v[200:203]
    v_xor_b32 v2, 0x8000, v2
    v_xor_b32 v3, 0x8000, v3
    s_cbranch_scc1 Lc2_nobar
    s_barrier
Lc2_nobar:
    v_mfma_f32_16x16x32_bf16 v[204:207], v[28:31], v[96:99], v[204:207]
    ds_read_b128 v[8:11], v2 offset:0
    v_mfma_f32_16x16x32_bf16 v[208:211], v[32:35], v[96:99], v[208:211]
    ds_read_b128 v[12:15], v2 offset:2048
    v_mfma_f32_16x16x32_bf16 v[212:215], v[36:39], v[96:99], v[212:215]
    ds_read_b128 v[16:19], v2 offset:4096
    buffer_load_dwordx4 v[80:83], v196, s[40:43], s62 offen offset:0 sc1
    s_waitcnt vmcnt(11)
    v_mfma_f32_16x16x32_bf16 v[228:231], v[36:39], v[100:103], v[228:231]
    ds_read_b128 v[20:23], v2 offset:6144
    v_mfma_f32_16x16x32_bf16 v[224:227], v[32:35], v[100:103], v[224:227]
    v_mfma_f32_16x16x32_bf16 v[220:223], v[28:31], v[100:103], v[220:223]
    v_mfma_f32_16x16x32_bf16 v[216:219], v[24:27], v[100:103], v[216:219]
    buffer_load_dwordx4 v[84:87], v196, s[40:43], s62 offen offset:1024 sc1
    s_add_u32 s62, s62, 8192
    s_and_b32 s62, s62, 524287
    s_add_u32 s35, s35, 1
    s_cmp_lt_u32 s35, 8
    s_cbranch_scc1 Lc2_loop
    ds_write_b128 v186, v[200:203] offset:0
    ds_write_b128 v187, v[204:207] offset:0
    ds_write_b128 v188, v[208:211] offset:0
    ds_write_b128 v189, v[212:215] offset:0
    ds_write_b128 v186, v[216:219] offset:4096
    ds_write_b128 v187, v[220:223] offset:4096
    ds_write_b128 v188, v[224:227] offset:4096
    ds_write_b128 v189, v[228:231] offset:4096
    s_waitcnt lgkmcnt(0)
    s_barrier
L_end:
    s_endpgm
.section .rodata,"a"
.p2align 6
.amdhsa_kernel gated_mix__ssm_conv_s5__moe_arch_mod__prompt_kernel
  .amdhsa_next_free_vgpr 256
  .amdhsa_next_free_sgpr 102
  .amdhsa_accum_offset 256
  .amdhsa_group_segment_fixed_size 0
  .amdhsa_kernarg_size 144
  .amdhsa_user_sgpr_count 2
  .amdhsa_user_sgpr_kernarg_segment_ptr 1
  .amdhsa_system_sgpr_workgroup_id_x 1
  .amdhsa_float_denorm_mode_32 3
.end_amdhsa_kernel
```
